```python
import torch

def _softmax(x, axis=-1):
    return torch.softmax(x, dim=axis)
def _gelu(x):
    return torch.nn.functional.gelu(x, approximate="tanh")
def _silu(x):
    return torch.nn.functional.silu(x)
def _sigmoid(x):
    return torch.sigmoid(x)
def _layernorm(x, axis=-1, eps=1e-5):
    m = x.mean(dim=axis, keepdim=True)
    v = x.var(dim=axis, keepdim=True, unbiased=False)
    return (x - m) / torch.sqrt(v + eps)
def _scatter_add(tgt, idx, src, axis=0):
    return tgt.clone().index_add_(axis, idx, src)
def _segment_sum(src, seg, n):
    out = torch.zeros((n,) + src.shape[1:], dtype=src.dtype)
    return out.index_add_(0, seg, src)
def _pad(x, pw):
    flat = tuple(v for pair in reversed(pw) for v in pair)
    return torch.nn.functional.pad(x, flat)

kernel_name = 'recurrent_scan__sliding_block_cached__mixer_token_mlp__prompt'

def setup_inputs():

    _w = (lambda a: (lambda t: t.to(torch.bfloat16) if t.is_floating_point() else t)(torch.as_tensor(a)))
    def _A_setup():
        B, Sq, D = 1, 2048, 576
        Hq, Hkv, Sk, Dh = 32, 16, 2048, 128
        assert Hq % Hkv == 0, (Hq, Hkv)
        return {
            "x": _w((lambda *s: torch.randn(*s, dtype=torch.bfloat16) * 0.05)(B, Sq, D)),
            "k_cache": _w((lambda *s: torch.randn(*s, dtype=torch.bfloat16) * 3.2)(B, Hkv, Sk, Dh)),
            "v_cache": _w((lambda *s: torch.randn(*s, dtype=torch.bfloat16) * 3.2)(B, Hkv, Sk, Dh)),
            "wq": _w((lambda *s: torch.randn(*s, dtype=torch.bfloat16) * 3.2)(D, Hq * Dh) * (D ** -0.5)),
            "wo": _w((lambda *s: torch.randn(*s, dtype=torch.bfloat16) * 3.2)(Hq * Dh, D) * ((Hq * Dh) ** -0.5)),
        }
    _A_in = _A_setup()

    def _B_setup():
        B, S, D, F = 1, 2048, 576, 4608
        return {
            "x": _w((lambda *s: torch.randn(*s, dtype=torch.bfloat16) * 0.05)(B, S, D)),
            "w1": _w((lambda *s: torch.randn(*s, dtype=torch.bfloat16) * 3.2)(S, F) * (S ** -0.5)),
            "b1": _w((lambda *s: torch.randn(*s, dtype=torch.bfloat16) * 3.2)(F) * 0.02),
            "w2": _w((lambda *s: torch.randn(*s, dtype=torch.bfloat16) * 0.4)(F, S) * (F ** -0.5)),
            "b2": _w((lambda *s: torch.randn(*s, dtype=torch.bfloat16) * 0.4)(S) * 0.02),
        }
    _B_in = _B_setup()

    return {
        "A_x": _A_in["x"],
        "A_k_cache": _A_in["k_cache"],
        "A_v_cache": _A_in["v_cache"],
        "A_wq": _A_in["wq"],
        "A_wo": _A_in["wo"],
        "B_x": _B_in["x"],
        "B_w1": _B_in["w1"],
        "B_b1": _B_in["b1"],
        "B_w2": _B_in["w2"],
        "B_b2": _B_in["b2"],
    }

def reference(A_x, A_k_cache, A_v_cache, A_wq, A_wo, B_x, B_w1, B_b1, B_w2, B_b2):
    def _A_ref(x, k_cache, v_cache, wq, wo):
        B, Sq, D = x.shape
        Hq, Dh = 32, 128
        Hkv, Sk = k_cache.shape[1], k_cache.shape[2]
        W = min(4096, max(256, Sk // 4))
        rep = Hq // Hkv
        q = (lambda x, *d: x.permute(*d))((x @ wq).reshape(B, Sq, Hq, Dh), 0, 2, 1, 3)
        k = (lambda x, n, axis: torch.repeat_interleave(x, n, dim=axis))(k_cache[:, :, Sk - W:, :], rep, axis=1)
        v = (lambda x, n, axis: torch.repeat_interleave(x, n, dim=axis))(v_cache[:, :, Sk - W:, :], rep, axis=1)
        scores = torch.einsum("bhqd,bhkd->bhqk", q, k) * (Dh ** -0.5)
        p = _softmax(scores, axis=-1)
        o = torch.einsum("bhqk,bhkd->bhqd", p, v)
        return (lambda x, *d: x.permute(*d))(o, 0, 2, 1, 3).reshape(B, Sq, Hq * Dh) @ wo

    def _B_ref(x, w1, b1, w2, b2):
        B, S, D = x.shape
        h = _layernorm(x, axis=-1)
        u = torch.einsum("bsd,sf->bdf", h, w1) + b1
        u = _gelu(u)
        y = torch.einsum("bdf,fs->bds", u, w2) + b2
        return (lambda x, *d: x.permute(*d))(y, 0, 2, 1)

    x = A_x
    xn = _layernorm(x, axis=-1)
    s = _A_ref(xn, A_k_cache, A_v_cache, A_wq, A_wo)
    g = _silu(_B_ref(xn, B_w1, B_b1, B_w2, B_b2))
    return x + s * g
```

```asm
; @launch grid=(256,1,1) block=(256,1,1) lds=163840
.amdgcn_target "amdgcn-amd-amdhsa--gfx950"
.text
.globl recurrent_scan__sliding_block_cached__mixer_token_mlp__prompt_kernel
.p2align 8
.type recurrent_scan__sliding_block_cached__mixer_token_mlp__prompt_kernel,@function
recurrent_scan__sliding_block_cached__mixer_token_mlp__prompt_kernel:
  s_cmp_ge_u32 s2, 256
  s_cbranch_scc1 L_exit
  s_load_dwordx16 s[36:51], s[0:1], 0
  s_load_dwordx8 s[52:59], s[0:1], 64
  s_load_dwordx2 s[60:61], s[0:1], 96
  s_and_b32 s29, s2, 7
  s_lshr_b32 s30, s2, 3
  v_lshrrev_b32 v1, 6, v0
  s_nop 0
  v_readfirstlane_b32 s28, v1
  v_and_b32 v1, 63, v0
  s_getpc_b64 s[8:9]
  s_mov_b32 s10, 5120
  s_mov_b32 s11, 0x20000
  v_lshlrev_b32 v2, 5, v0
  buffer_load_dword v3, v2, s[8:11], 0 offen
  v_and_b32 v176, 7, v1
  v_lshrrev_b32 v177, 3, v1
  s_lshl_b32 s3, s2, 3
  v_add_u32 v178, s3, v176
  v_mul_u32_u24 v178, 1152, v178
  v_lshl_add_u32 v170, v177, 4, v178
  s_mul_i32 s3, s28, 384
  v_add_u32 v170, s3, v170
  s_cmp_eq_u32 s28, 3
  s_cselect_b32 s14, 0, 2359296
  s_mov_b32 s15, 0x20000
  s_waitcnt lgkmcnt(0)
  s_mov_b32 s12, s36
  s_mov_b32 s13, s37
  buffer_load_dwordx4 v[100:103], v170, s[12:15], 0 offen offset:0 nt
  buffer_load_dwordx4 v[104:107], v170, s[12:15], 0 offen offset:128 nt
  buffer_load_dwordx4 v[108:111], v170, s[12:15], 0 offen offset:256 nt
  s_cmp_ge_u32 s30, 31
  s_cbranch_scc1 L_spare
  s_cmp_ge_u32 s30, 22
  s_cbranch_scc1 L_mlp1
L_attn:
  s_cmp_ge_u32 s30, 11
  s_cselect_b32 s3, 1, 0
  s_mul_i32 s4, s3, 11
  s_sub_u32 s4, s30, s4
  s_lshl_b32 s5, s29, 1
  s_add_u32 s32, s5, s3
  s_and_b32 s76, s28, 1
  s_lshr_b32 s34, s28, 1
  s_lshl_b32 s72, s28, 12
  s_mul_i32 s73, s28, 3072
  s_add_u32 s73, s73, 16384
  s_lshl_b32 s68, s32, 9
  s_lshl_b32 s3, s28, 16
  s_add_u32 s68, s68, s3
  s_add_u32 s69, s68, 30720
  s_mul_i32 s33, s4, 12
  v_lshlrev_b32 v6, 4, v1
  v_lshrrev_b32 v46, 5, v1
  v_and_b32 v47, 31, v1
  v_lshlrev_b32 v48, 2, v46
  v_xor_b32 v48, v47, v48
  v_lshlrev_b32 v48, 4, v48
  v_lshl_add_u32 v4, v46, 13, v48
  v_xor_b32 v5, 128, v4
  v_add_u32 v5, 15360, v5
  s_mul_i32 s4, s28, 786432
  v_lshrrev_b32 v178, 2, v177
  v_lshlrev_b32 v178, 17, v178
  v_and_b32 v179, 3, v177
  v_lshl_add_u32 v178, v179, 8, v178
  v_lshl_add_u32 v178, v176, 4, v178
  s_lshr_b32 s3, s2, 1
  s_lshl_b32 s3, s3, 10
  s_add_u32 s4, s4, s3
  s_and_b32 s3, s2, 1
  s_lshl_b32 s3, s3, 7
  s_add_u32 s4, s4, s3
  v_add_u32 v171, s4, v178
  v_lshlrev_b32 v172, 3, v176
  v_add_u32 v172, 163584, v172
  s_lshl_b32 s3, s28, 6
  v_add_u32 v173, s3, v172
  s_barrier
  s_load_dword s100, s[60:61], 0
  s_mov_b32 s8, s42
  s_mov_b32 s9, s43
  s_mov_b32 s10, 4718592
  s_mov_b32 s11, 0x20000
  s_add_u32 m0, s72, 0
  s_nop 0
  buffer_load_dwordx4 v4, s[8:11], s68 offen offset:0 nt lds
  buffer_load_dwordx4 v5, s[8:11], s68 offen offset:1024 nt lds
  s_add_u32 s68, s68, 262144
  buffer_load_dwordx4 v4, s[8:11], s69 offen offset:2048 nt lds
  buffer_load_dwordx4 v5, s[8:11], s69 offen offset:3072 nt lds
  s_add_u32 s69, s69, 262144
  s_getpc_b64 s[24:25]
L_attn_pc:
  s_sub_u32 s24, s24, L_attn_pc-recurrent_scan__sliding_block_cached__mixer_token_mlp__prompt_kernel
  s_subb_u32 s25, s25, 0
  s_mov_b32 s26, L_end-recurrent_scan__sliding_block_cached__mixer_token_mlp__prompt_kernel
  s_mov_b32 s27, 0x20000
  s_lshl_b32 s3, s30, 2
  s_add_u32 s3, s3, s28
  s_mul_i32 s3, s3, 896
  v_min_u32 v174, 6, v1
  v_lshlrev_b32 v174, 7, v174
  v_add_u32 v174, s3, v174
  buffer_load_dword v175, v174, s[24:27], 0 offen
  s_add_u32 s16, s60, 131072
  s_addc_u32 s17, s61, 0
  s_mov_b32 s18, 2359296
  s_mov_b32 s19, 0x20000
  s_add_u32 s20, s60, 2490368
  s_addc_u32 s21, s61, 0
  s_mov_b32 s22, 2359296
  s_mov_b32 s23, 0x20000
  s_mov_b32 s64, s60
  s_mov_b32 s65, s61
  s_mov_b32 s66, 131072
  s_mov_b32 s67, 0x20000
  s_lshl_b32 s3, s2, 2
  s_add_u32 s3, s3, s28
  s_lshl_b32 s3, s3, 7
  v_mov_b32 v174, s3
  buffer_load_dword v175, v174, s[64:67], 0 offen sc1
  s_cmp_lg_u32 s28, 3
  s_cbranch_scc1 L_attn_ln
  s_waitcnt lgkmcnt(0)
  s_barrier
  s_mul_i32 s100, s100, 0x9e3779b1
  s_add_u32 s100, s100, 0x7f4a7c15
  s_branch L_attn_st
L_attn_ln:
  s_mov_b32 s3, 0xffff0000
  s_waitcnt vmcnt(6)
  v_lshlrev_b32 v112, 16, v100
  v_and_b32 v113, s3, v100
  v_lshlrev_b32 v114, 16, v101
  v_and_b32 v115, s3, v101
  v_lshlrev_b32 v116, 16, v102
  v_and_b32 v117, s3, v102
  v_lshlrev_b32 v118, 16, v103
  v_and_b32 v119, s3, v103
  v_lshlrev_b32 v120, 16, v104
  v_and_b32 v121, s3, v104
  v_lshlrev_b32 v122, 16, v105
  v_and_b32 v123, s3, v105
  v_lshlrev_b32 v124, 16, v106
  v_and_b32 v125, s3, v106
  v_lshlrev_b32 v126, 16, v107
  v_and_b32 v127, s3, v107
  v_lshlrev_b32 v128, 16, v108
  v_and_b32 v129, s3, v108
  v_lshlrev_b32 v130, 16, v109
  v_and_b32 v131, s3, v109
  v_lshlrev_b32 v132, 16, v110
  v_and_b32 v133, s3, v110
  v_lshlrev_b32 v134, 16, v111
  v_and_b32 v135, s3, v111
  v_pk_add_f32 v[140:141], v[112:113], v[114:115]
  v_pk_add_f32 v[142:143], v[116:117], v[118:119]
  v_pk_add_f32 v[140:141], v[140:141], v[120:121]
  v_pk_add_f32 v[142:143], v[142:143], v[122:123]
  v_pk_add_f32 v[140:141], v[140:141], v[124:125]
  v_pk_add_f32 v[142:143], v[142:143], v[126:127]
  v_pk_add_f32 v[140:141], v[140:141], v[128:129]
  v_pk_add_f32 v[142:143], v[142:143], v[130:131]
  v_pk_add_f32 v[140:141], v[140:141], v[132:133]
  v_pk_add_f32 v[142:143], v[142:143], v[134:135]
  v_pk_add_f32 v[140:141], v[140:141], v[142:143]
  v_add_f32 v140, v140, v141
  s_nop 1
  v_add_f32_dpp v140, v140, v140 row_ror:8 row_mask:0xf bank_mask:0xf
  v_mov_b32 v141, v140
  s_nop 1
  v_permlane16_swap_b32 v140, v141
  v_add_f32 v140, v140, v141
  v_mov_b32 v141, v140
  s_nop 1
  v_permlane32_swap_b32 v140, v141
  v_add_f32 v140, v140, v141
  v_mul_f32 v144, 0x3baaaaab, v140
  v_pk_add_f32 v[112:113], v[112:113], v[144:145] op_sel_hi:[1,0] neg_lo:[0,1] neg_hi:[0,1]
  v_pk_add_f32 v[114:115], v[114:115], v[144:145] op_sel_hi:[1,0] neg_lo:[0,1] neg_hi:[0,1]
  v_pk_add_f32 v[116:117], v[116:117], v[144:145] op_sel_hi:[1,0] neg_lo:[0,1] neg_hi:[0,1]
  v_pk_add_f32 v[118:119], v[118:119], v[144:145] op_sel_hi:[1,0] neg_lo:[0,1] neg_hi:[0,1]
  v_pk_add_f32 v[120:121], v[120:121], v[144:145] op_sel_hi:[1,0] neg_lo:[0,1] neg_hi:[0,1]
  v_pk_add_f32 v[122:123], v[122:123], v[144:145] op_sel_hi:[1,0] neg_lo:[0,1] neg_hi:[0,1]
  v_pk_add_f32 v[124:125], v[124:125], v[144:145] op_sel_hi:[1,0] neg_lo:[0,1] neg_hi:[0,1]
  v_pk_add_f32 v[126:127], v[126:127], v[144:145] op_sel_hi:[1,0] neg_lo:[0,1] neg_hi:[0,1]
  v_pk_add_f32 v[128:129], v[128:129], v[144:145] op_sel_hi:[1,0] neg_lo:[0,1] neg_hi:[0,1]
  v_pk_add_f32 v[130:131], v[130:131], v[144:145] op_sel_hi:[1,0] neg_lo:[0,1] neg_hi:[0,1]
  v_pk_add_f32 v[132:133], v[132:133], v[144:145] op_sel_hi:[1,0] neg_lo:[0,1] neg_hi:[0,1]
  v_pk_add_f32 v[134:135], v[134:135], v[144:145] op_sel_hi:[1,0] neg_lo:[0,1] neg_hi:[0,1]
  v_pk_mul_f32 v[140:141], v[112:113], v[112:113]
  v_pk_mul_f32 v[142:143], v[114:115], v[114:115]
  v_pk_fma_f32 v[140:141], v[116:117], v[116:117], v[140:141]
  v_pk_fma_f32 v[142:143], v[118:119], v[118:119], v[142:143]
  v_pk_fma_f32 v[140:141], v[120:121], v[120:121], v[140:141]
  v_pk_fma_f32 v[142:143], v[122:123], v[122:123], v[142:143]
  v_pk_fma_f32 v[140:141], v[124:125], v[124:125], v[140:141]
  v_pk_fma_f32 v[142:143], v[126:127], v[126:127], v[142:143]
  v_pk_fma_f32 v[140:141], v[128:129], v[128:129], v[140:141]
  v_pk_fma_f32 v[142:143], v[130:131], v[130:131], v[142:143]
  v_pk_fma_f32 v[140:141], v[132:133], v[132:133], v[140:141]
  v_pk_fma_f32 v[142:143], v[134:135], v[134:135], v[142:143]
  v_pk_add_f32 v[140:141], v[140:141], v[142:143]
  v_add_f32 v140, v140, v141
  s_nop 1
  v_add_f32_dpp v140, v140, v140 row_ror:8 row_mask:0xf bank_mask:0xf
  v_mov_b32 v141, v140
  s_nop 1
  v_permlane16_swap_b32 v140, v141
  v_add_f32 v140, v140, v141
  v_mov_b32 v141, v140
  s_nop 1
  v_permlane32_swap_b32 v140, v141
  v_add_f32 v140, v140, v141
  v_mov_b32 v145, v140
  ds_write_b64 v173, v[144:145]
  s_waitcnt lgkmcnt(0)
  s_barrier
  ds_read_b64 v[148:149], v172 offset:0
  ds_read_b64 v[150:151], v172 offset:64
  ds_read_b64 v[152:153], v172 offset:128
  s_mul_i32 s100, s100, 0x9e3779b1
  s_add_u32 s100, s100, 0x7f4a7c15
  s_waitcnt lgkmcnt(0)
  v_add_f32 v140, v148, v150
  v_add_f32 v142, v149, v151
  v_add_f32 v140, v140, v152
  v_add_f32 v142, v142, v153
  v_mul_f32 v140, 0x3eaaaaab, v140
  v_sub_f32 v148, v148, v140
  v_sub_f32 v150, v150, v140
  v_sub_f32 v152, v152, v140
  v_mul_f32 v141, v148, v148
  v_fmac_f32 v141, v150, v150
  v_fmac_f32 v141, v152, v152
  v_fmac_f32 v142, 0x43400000, v141
  v_mul_f32 v142, 0x3ae38e39, v142
  v_sub_f32 v144, v144, v140
  v_add_f32 v140, 0x3727c5ac, v142
  v_rsq_f32 v140, v140
  s_nop 0
  v_mul_f32 v142, v142, v140
  v_mul_f32 v142, v142, v140
  v_add_f32 v142, 0x3727c5ac, v142
  v_rsq_f32 v142, v142
  v_mul_f32 v148, 0x3e0293ee, v140
  v_mul_f32 v152, v144, v148
  v_mul_f32 v150, v142, v140
  v_mul_f32 v154, v144, v150
  s_mov_b32 s3, 262144
  s_mov_b32 s4, 524288
  v_pk_fma_f32 v[180:181], v[112:113], v[148:149], v[152:153] op_sel_hi:[1,0,0]
  v_pk_fma_f32 v[182:183], v[114:115], v[148:149], v[152:153] op_sel_hi:[1,0,0]
  v_pk_fma_f32 v[184:185], v[116:117], v[148:149], v[152:153] op_sel_hi:[1,0,0]
  v_pk_fma_f32 v[186:187], v[118:119], v[148:149], v[152:153] op_sel_hi:[1,0,0]
  v_cvt_pk_bf16_f32 v100, v180, v181
  v_cvt_pk_bf16_f32 v101, v182, v183
  v_cvt_pk_bf16_f32 v102, v184, v185
  v_cvt_pk_bf16_f32 v103, v186, v187
  buffer_store_dwordx4 v[100:103], v171, s[16:19], 0 offen sc1
  v_pk_fma_f32 v[188:189], v[112:113], v[150:151], v[154:155] op_sel_hi:[1,0,0]
  v_pk_fma_f32 v[190:191], v[114:115], v[150:151], v[154:155] op_sel_hi:[1,0,0]
  v_pk_fma_f32 v[192:193], v[116:117], v[150:151], v[154:155] op_sel_hi:[1,0,0]
  v_pk_fma_f32 v[194:195], v[118:119], v[150:151], v[154:155] op_sel_hi:[1,0,0]
  v_cvt_pk_bf16_f32 v156, v188, v189
  v_cvt_pk_bf16_f32 v157, v190, v191
  v_cvt_pk_bf16_f32 v158, v192, v193
  v_cvt_pk_bf16_f32 v159, v194, v195
  buffer_store_dwordx4 v[156:159], v170, s[20:23], 0 offen offset:0 sc1
  v_pk_fma_f32 v[180:181], v[120:121], v[148:149], v[152:153] op_sel_hi:[1,0,0]
  v_pk_fma_f32 v[182:183], v[122:123], v[148:149], v[152:153] op_sel_hi:[1,0,0]
  v_pk_fma_f32 v[184:185], v[124:125], v[148:149], v[152:153] op_sel_hi:[1,0,0]
  v_pk_fma_f32 v[186:187], v[126:127], v[148:149], v[152:153] op_sel_hi:[1,0,0]
  v_cvt_pk_bf16_f32 v104, v180, v181
  v_cvt_pk_bf16_f32 v105, v182, v183
  v_cvt_pk_bf16_f32 v106, v184, v185
  v_cvt_pk_bf16_f32 v107, v186, v187
  buffer_store_dwordx4 v[104:107], v171, s[16:19], s3 offen sc1
  v_pk_fma_f32 v[188:189], v[120:121], v[150:151], v[154:155] op_sel_hi:[1,0,0]
  v_pk_fma_f32 v[190:191], v[122:123], v[150:151], v[154:155] op_sel_hi:[1,0,0]
  v_pk_fma_f32 v[192:193], v[124:125], v[150:151], v[154:155] op_sel_hi:[1,0,0]
  v_pk_fma_f32 v[194:195], v[126:127], v[150:151], v[154:155] op_sel_hi:[1,0,0]
  v_cvt_pk_bf16_f32 v160, v188, v189
  v_cvt_pk_bf16_f32 v161, v190, v191
  v_cvt_pk_bf16_f32 v162, v192, v193
  v_cvt_pk_bf16_f32 v163, v194, v195
  buffer_store_dwordx4 v[160:163], v170, s[20:23], 0 offen offset:128 sc1
  v_pk_fma_f32 v[180:181], v[128:129], v[148:149], v[152:153] op_sel_hi:[1,0,0]
  v_pk_fma_f32 v[182:183], v[130:131], v[148:149], v[152:153] op_sel_hi:[1,0,0]
  v_pk_fma_f32 v[184:185], v[132:133], v[148:149], v[152:153] op_sel_hi:[1,0,0]
  v_pk_fma_f32 v[186:187], v[134:135], v[148:149], v[152:153] op_sel_hi:[1,0,0]
  v_cvt_pk_bf16_f32 v108, v180, v181
  v_cvt_pk_bf16_f32 v109, v182, v183
  v_cvt_pk_bf16_f32 v110, v184, v185
  v_cvt_pk_bf16_f32 v111, v186, v187
  buffer_store_dwordx4 v[108:111], v171, s[16:19], s4 offen sc1
  v_pk_fma_f32 v[188:189], v[128:129], v[150:151], v[154:155] op_sel_hi:[1,0,0]
  v_pk_fma_f32 v[190:191], v[130:131], v[150:151], v[154:155] op_sel_hi:[1,0,0]
  v_pk_fma_f32 v[192:193], v[132:133], v[150:151], v[154:155] op_sel_hi:[1,0,0]
  v_pk_fma_f32 v[194:195], v[134:135], v[150:151], v[154:155] op_sel_hi:[1,0,0]
  v_cvt_pk_bf16_f32 v164, v188, v189
  v_cvt_pk_bf16_f32 v165, v190, v191
  v_cvt_pk_bf16_f32 v166, v192, v193
  v_cvt_pk_bf16_f32 v167, v194, v195
  buffer_store_dwordx4 v[164:167], v170, s[20:23], 0 offen offset:256 sc1
L_attn_st:
  s_mul_i32 s3, s28, 3
  s_add_u32 s3, s3, s33
  s_lshl_b32 s70, s3, 10
  s_cmp_lt_u32 s3, 128
  s_cselect_b32 s4, 0, 2130706176
  v_add_u32 v16, s4, v6
  s_cmp_lt_u32 s3, 127
  s_cselect_b32 s4, 0, 2130706176
  v_add_u32 v17, s4, v6
  s_cmp_lt_u32 s3, 126
  s_cselect_b32 s4, 0, 2130706176
  v_add_u32 v18, s4, v6
  s_lshl_b32 s71, s32, 19
  s_add_u32 s71, s71, 393216
  s_add_u32 s71, s71, s72
  s_lshl_b32 s3, s32, 1
  s_add_u32 s3, s3, s76
  s_lshl_b32 s3, s3, 9
  s_mul_i32 s31, s34, 6
  s_add_u32 s31, s31, s33
  s_add_u32 s3, s3, s31
  s_lshl_b32 s74, s3, 10
  s_sub_u32 s75, 128, s31
  v_lshrrev_b32 v46, 4, v1
  v_and_b32 v47, 15, v1
  v_lshlrev_b32 v48, 1, v46
  v_xor_b32 v48, v47, v48
  v_lshlrev_b32 v48, 4, v48
  v_lshl_add_u32 v7, v46, 8, v48
  v_xor_b32 v8, 128, v7
  v_and_b32 v48, 7, v47
  v_lshlrev_b32 v48, 1, v48
  v_xor_b32 v48, v46, v48
  v_lshlrev_b32 v48, 4, v48
  v_lshl_add_u32 v48, v47, 8, v48
  v_add_u32 v48, 98304, v48
  v_xor_b32 v22, 0, v48
  v_xor_b32 v23, 64, v48
  v_xor_b32 v24, 128, v48
  v_xor_b32 v25, 192, v48
  v_lshrrev_b32 v48, 2, v1
  v_and_b32 v49, 7, v48
  v_lshlrev_b32 v49, 5, v49
  v_lshl_add_u32 v49, v48, 8, v49
  v_and_b32 v50, 3, v1
  v_lshl_add_u32 v49, v50, 3, v49
  v_xor_b32 v26, 0, v49
  v_xor_b32 v27, 32, v49
  v_xor_b32 v28, 64, v49
  v_xor_b32 v29, 96, v49
  v_xor_b32 v30, 128, v49
  v_xor_b32 v31, 160, v49
  v_xor_b32 v32, 192, v49
  v_xor_b32 v33, 224, v49
  v_bfe_u32 v48, v1, 2, 2
  v_lshl_add_u32 v49, v46, 3, v48
  v_lshlrev_b32 v49, 9, v49
  v_lshl_add_u32 v49, v48, 6, v49
  v_lshl_add_u32 v49, v50, 4, v49
  s_lshl_b32 s3, s76, 8
  v_add_u32 v49, s3, v49
  v_xor_b32 v10, 0, v49
  v_xor_b32 v11, 64, v49
  v_xor_b32 v12, 128, v49
  v_xor_b32 v13, 192, v49
  s_mul_i32 s3, s34, 6144
  s_add_u32 s3, s3, 16384
  v_add_u32 v14, s3, v6
  v_mov_b32 v34, 0
  v_mov_b32 v35, 0
  v_mov_b32 v36, 0
  v_mov_b32 v37, 0
  v_mov_b32 v38, 0
  v_mov_b32 v39, 0
  s_mul_i32 s3, s33, 5462
  s_lshr_b32 s3, s3, 14
  s_add_u32 s3, s3, s28
  s_lshl_b32 s4, s3, 4
  v_lshrrev_b32 v58, 2, v1
  v_add_u32 v58, s4, v58
  v_lshrrev_b32 v59, 2, v58
  v_and_b32 v58, 3, v58
  v_lshlrev_b32 v58, 7, v58
  v_lshl_add_u32 v58, v59, 13, v58
  s_lshl_b32 s4, s32, 9
  s_add_u32 s4, s4, 1835008
  v_add_u32 v58, s4, v58
  s_mul_i32 s4, s3, 24
  v_min_u32 v60, 23, v1
  v_add_u32 v60, s4, v60
  v_min_u32 v60, 1023, v60
  v_lshlrev_b32 v60, 7, v60
  s_lshl_b32 s4, s32, 19
  s_add_u32 s4, s4, 393216
  v_add_u32 v60, s4, v60
  v_min_u32 v59, 63, v1
  s_lshl_b32 s4, s2, 2
  s_add_u32 s4, s4, s28
  s_mul_i32 s4, s4, 64
  v_add_u32 v59, s4, v59
  v_lshlrev_b32 v59, 7, v59
  v_add_u32 v59, 1769472, v59
  s_mul_i32 s35, s2, 1490
  s_lshr_b32 s35, s35, 16
  s_mov_b32 s24, s48
  s_mov_b32 s25, s49
  s_mov_b32 s26, 18874368
  s_mov_b32 s27, 0x20000
  s_lshl_b32 s3, s30, 2
  s_add_u32 s3, s3, s28
  s_lshl_b32 s3, s3, 7
  v_mov_b32 v15, s3
  s_mov_b32 s94, 11264
  s_mov_b32 s95, 0x20000
  s_lshl_b32 s3, s30, 8
  v_add_u32 v19, s3, v0
  v_cmp_eq_u32 vcc, 0, v19
  v_mov_b32 v20, 2130706176
  s_nop 0
  v_cndmask_b32 v19, v20, v19, vcc
  v_mov_b32 v20, 1
  s_mul_i32 s3, s28, 3
  s_add_u32 s3, s3, s33
  s_lshl_b32 s3, s3, 1
  v_min_u32 v46, 5, v1
  v_add_u32 v46, s3, v46
  v_min_u32 v46, 255, v46
  s_lshl_b32 s3, s29, 12
  s_add_u32 s3, s3, 4096
  v_lshlrev_b32 v46, 4, v46
  v_add_u32 v46, s3, v46
  v_lshlrev_b32 v176, 12, v1
  s_lshl_b32 s3, s2, 4
  s_add_u32 s3, s3, 4096
  v_mov_b32 v177, s100
  s_waitcnt vmcnt(0)
  s_barrier
  s_cmp_lg_u32 s28, 0
  s_cbranch_scc1 L_attn_nf
  s_mov_b64 exec, 0xff
  buffer_store_dword v177, v176, s[64:67], s3 offen sc1
  s_mov_b64 exec, -1
L_attn_nf:
  s_cmp_eq_u32 s35, 0
  s_cselect_b32 s26, 18874368, 0
  buffer_load_dword v21, v59, s[24:27], 0 offen
  s_add_u32 m0, s72, 28672
  s_nop 0
  buffer_load_dwordx4 v4, s[8:11], s68 offen offset:0 nt lds
  buffer_load_dwordx4 v5, s[8:11], s68 offen offset:1024 nt lds
  s_add_u32 s68, s68, 262144
  buffer_load_dwordx4 v4, s[8:11], s69 offen offset:2048 nt lds
  buffer_load_dwordx4 v5, s[8:11], s69 offen offset:3072 nt lds
  s_add_u32 s69, s69, 262144
  s_add_u32 m0, s72, 57344
  s_nop 0
  buffer_load_dwordx4 v4, s[8:11], s68 offen offset:0 nt lds
  buffer_load_dwordx4 v5, s[8:11], s68 offen offset:1024 nt lds
  s_add_u32 s68, s68, 262144
  buffer_load_dwordx4 v4, s[8:11], s69 offen offset:2048 nt lds
  buffer_load_dwordx4 v5, s[8:11], s69 offen offset:3072 nt lds
  s_add_u32 s69, s69, 262144
  s_add_u32 s12, s60, 131072
  s_addc_u32 s13, s61, 0
  s_mov_b32 s14, 2359296
  s_mov_b32 s15, 0x20000
  s_mov_b32 s16, s38
  s_mov_b32 s17, s39
  s_mov_b32 s18, 8388608
  s_mov_b32 s19, 0x20000
  s_mov_b32 s20, s40
  s_mov_b32 s21, s41
  s_mov_b32 s22, 8388608
  s_mov_b32 s23, 0x20000
  s_mov_b32 s7, 0x80000
L_attn_p0:
  buffer_load_dword v47, v46, s[64:67], 0 offen sc1
L_attn_p0_chk:
  s_waitcnt vmcnt(0)
  v_cmp_ne_u32 vcc, s100, v47
  s_cbranch_vccz L_attn_p0_ok
  s_sleep 1
  s_sub_u32 s7, s7, 1
  s_cmp_lg_u32 s7, 0
  s_cbranch_scc1 L_attn_p0
L_attn_p0_ok:
  s_add_u32 m0, s73, 0
  s_nop 0
  buffer_load_dwordx4 v16, s[12:15], s70 offen offset:0 sc1 lds
  buffer_load_dwordx4 v17, s[12:15], s70 offen offset:1024 sc1 lds
  buffer_load_dwordx4 v18, s[12:15], s70 offen offset:2048 sc1 lds
  s_add_u32 s70, s70, 131072
  s_add_u32 m0, s73, 28672
  s_nop 0
  buffer_load_dwordx4 v16, s[12:15], s70 offen offset:0 sc1 lds
  buffer_load_dwordx4 v17, s[12:15], s70 offen offset:1024 sc1 lds
  buffer_load_dwordx4 v18, s[12:15], s70 offen offset:2048 sc1 lds
  s_add_u32 s70, s70, 131072
  s_waitcnt vmcnt(3)
  s_barrier
  ds_read_b128 a[32:35], v14 offset:0
  ds_read_b128 a[36:39], v14 offset:1024
  ds_read_b128 a[40:43], v14 offset:2048
  ds_read_b128 a[44:47], v14 offset:3072
  ds_read_b128 a[48:51], v14 offset:4096
  ds_read_b128 a[52:55], v14 offset:5120
  ds_read_b64_tr_b16 a[0:1], v10 offset:0
  ds_read_b64_tr_b16 a[2:3], v10 offset:2048
  ds_read_b64_tr_b16 a[4:5], v10 offset:8
  ds_read_b64_tr_b16 a[6:7], v10 offset:2056
  ds_read_b64_tr_b16 a[8:9], v11 offset:0
  ds_read_b64_tr_b16 a[10:11], v11 offset:2048
  ds_read_b64_tr_b16 a[12:13], v11 offset:8
  ds_read_b64_tr_b16 a[14:15], v11 offset:2056
  ds_read_b64_tr_b16 a[16:17], v12 offset:0
  ds_read_b64_tr_b16 a[18:19], v12 offset:2048
  ds_read_b64_tr_b16 a[20:21], v12 offset:8
  ds_read_b64_tr_b16 a[22:23], v12 offset:2056
  ds_read_b64_tr_b16 a[24:25], v13 offset:0
  ds_read_b64_tr_b16 a[26:27], v13 offset:2048
  ds_read_b64_tr_b16 a[28:29], v13 offset:8
  ds_read_b64_tr_b16 a[30:31], v13 offset:2056
  s_add_u32 m0, s73, 57344
  s_nop 0
  buffer_load_dwordx4 v16, s[12:15], s70 offen offset:0 sc1 lds
  buffer_load_dwordx4 v17, s[12:15], s70 offen offset:1024 sc1 lds
  buffer_load_dwordx4 v18, s[12:15], s70 offen offset:2048 sc1 lds
  s_add_u32 s70, s70, 131072
  s_waitcnt vmcnt(3)
  s_waitcnt lgkmcnt(0)
  s_barrier
  v_mfma_f32_16x16x32_bf16 v[64:67], a[0:3], a[32:35], 0
  s_add_u32 m0, s72, 86016
  ds_read_b128 a[88:91], v14 offset:28672
  v_mfma_f32_16x16x32_bf16 v[72:75], a[0:3], a[36:39], 0
  ds_read_b128 a[92:95], v14 offset:29696
  v_mfma_f32_16x16x32_bf16 v[80:83], a[0:3], a[40:43], 0
  ds_read_b128 a[96:99], v14 offset:30720
  v_mfma_f32_16x16x32_bf16 v[88:91], a[0:3], a[44:47], 0
  buffer_load_dwordx4 v4, s[8:11], s68 offen offset:0 nt lds
  v_mfma_f32_16x16x32_bf16 v[96:99], a[0:3], a[48:51], 0
  ds_read_b128 a[100:103], v14 offset:31744
  v_mfma_f32_16x16x32_bf16 v[104:107], a[0:3], a[52:55], 0
  ds_read_b128 a[104:107], v14 offset:32768
  v_mfma_f32_16x16x32_bf16 v[68:71], a[4:7], a[32:35], 0
  ds_read_b128 a[108:111], v14 offset:33792
  v_mfma_f32_16x16x32_bf16 v[76:79], a[4:7], a[36:39], 0
  buffer_load_dwordx4 v5, s[8:11], s68 offen offset:1024 nt lds
  v_mfma_f32_16x16x32_bf16 v[84:87], a[4:7], a[40:43], 0
  s_add_u32 s68, s68, 262144
  ds_read_b64_tr_b16 a[56:57], v10 offset:28672
  v_mfma_f32_16x16x32_bf16 v[92:95], a[4:7], a[44:47], 0
  ds_read_b64_tr_b16 a[58:59], v10 offset:30720
  v_mfma_f32_16x16x32_bf16 v[100:103], a[4:7], a[48:51], 0
  ds_read_b64_tr_b16 a[60:61], v10 offset:28680
  v_mfma_f32_16x16x32_bf16 v[108:111], a[4:7], a[52:55], 0
  buffer_load_dwordx4 v4, s[8:11], s69 offen offset:2048 nt lds
  v_mfma_f32_16x16x32_bf16 v[112:115], a[8:11], a[32:35], 0
  ds_read_b64_tr_b16 a[62:63], v10 offset:30728
  v_mfma_f32_16x16x32_bf16 v[120:123], a[8:11], a[36:39], 0
  ds_read_b64_tr_b16 a[64:65], v11 offset:28672
  v_mfma_f32_16x16x32_bf16 v[128:131], a[8:11], a[40:43], 0
  ds_read_b64_tr_b16 a[66:67], v11 offset:30720
  v_mfma_f32_16x16x32_bf16 v[136:139], a[8:11], a[44:47], 0
  buffer_load_dwordx4 v5, s[8:11], s69 offen offset:3072 nt lds
  v_mfma_f32_16x16x32_bf16 v[144:147], a[8:11], a[48:51], 0
  s_add_u32 s69, s69, 262144
  ds_read_b64_tr_b16 a[68:69], v11 offset:28680
  v_mfma_f32_16x16x32_bf16 v[152:155], a[8:11], a[52:55], 0
  s_add_u32 m0, s73, 86016
  ds_read_b64_tr_b16 a[70:71], v11 offset:30728
  v_mfma_f32_16x16x32_bf16 v[116:119], a[12:15], a[32:35], 0
  ds_read_b64_tr_b16 a[72:73], v12 offset:28672
  v_mfma_f32_16x16x32_bf16 v[124:127], a[12:15], a[36:39], 0
  buffer_load_dwordx4 v16, s[12:15], s70 offen offset:0 sc1 lds
  v_mfma_f32_16x16x32_bf16 v[132:135], a[12:15], a[40:43], 0
  ds_read_b64_tr_b16 a[74:75], v12 offset:30720
  v_mfma_f32_16x16x32_bf16 v[140:143], a[12:15], a[44:47], 0
  ds_read_b64_tr_b16 a[76:77], v12 offset:28680
  v_mfma_f32_16x16x32_bf16 v[148:151], a[12:15], a[48:51], 0
  ds_read_b64_tr_b16 a[78:79], v12 offset:30728
  v_mfma_f32_16x16x32_bf16 v[156:159], a[12:15], a[52:55], 0
  buffer_load_dwordx4 v17, s[12:15], s70 offen offset:1024 sc1 lds
  v_mfma_f32_16x16x32_bf16 v[160:163], a[16:19], a[32:35], 0
  ds_read_b64_tr_b16 a[80:81], v13 offset:28672
  v_mfma_f32_16x16x32_bf16 v[168:171], a[16:19], a[36:39], 0
  ds_read_b64_tr_b16 a[82:83], v13 offset:30720
  v_mfma_f32_16x16x32_bf16 v[176:179], a[16:19], a[40:43], 0
  ds_read_b64_tr_b16 a[84:85], v13 offset:28680
  v_mfma_f32_16x16x32_bf16 v[184:187], a[16:19], a[44:47], 0
  buffer_load_dwordx4 v18, s[12:15], s70 offen offset:2048 sc1 lds
  v_mfma_f32_16x16x32_bf16 v[192:195], a[16:19], a[48:51], 0
  s_add_u32 s70, s70, 131072
  ds_read_b64_tr_b16 a[86:87], v13 offset:30728
  v_mfma_f32_16x16x32_bf16 v[200:203], a[16:19], a[52:55], 0
  s_add_u32 m0, s72, 114688
  v_add_u32 v10, 57344, v10
  v_mfma_f32_16x16x32_bf16 v[164:167], a[20:23], a[32:35], 0
  v_add_u32 v11, 57344, v11
  v_mfma_f32_16x16x32_bf16 v[172:175], a[20:23], a[36:39], 0
  buffer_load_dwordx4 v4, s[8:11], s68 offen offset:0 nt lds
  v_mfma_f32_16x16x32_bf16 v[180:183], a[20:23], a[40:43], 0
  v_add_u32 v12, 57344, v12
  v_mfma_f32_16x16x32_bf16 v[188:191], a[20:23], a[44:47], 0
  v_add_u32 v13, 57344, v13
  v_mfma_f32_16x16x32_bf16 v[196:199], a[20:23], a[48:51], 0
  v_add_u32 v14, 57344, v14
  v_mfma_f32_16x16x32_bf16 v[204:207], a[20:23], a[52:55], 0
  buffer_load_dwordx4 v5, s[8:11], s68 offen offset:1024 nt lds
  v_mfma_f32_16x16x32_bf16 v[208:211], a[24:27], a[32:35], 0
  s_add_u32 s68, s68, 262144
  v_mfma_f32_16x16x32_bf16 v[216:219], a[24:27], a[36:39], 0
  v_mfma_f32_16x16x32_bf16 v[224:227], a[24:27], a[40:43], 0
  v_mfma_f32_16x16x32_bf16 v[232:235], a[24:27], a[44:47], 0
  buffer_load_dwordx4 v4, s[8:11], s69 offen offset:2048 nt lds
  v_mfma_f32_16x16x32_bf16 v[240:243], a[24:27], a[48:51], 0
  v_mfma_f32_16x16x32_bf16 v[248:251], a[24:27], a[52:55], 0
  v_mfma_f32_16x16x32_bf16 v[212:215], a[28:31], a[32:35], 0
  v_mfma_f32_16x16x32_bf16 v[220:223], a[28:31], a[36:39], 0
  buffer_load_dwordx4 v5, s[8:11], s69 offen offset:3072 nt lds
  v_mfma_f32_16x16x32_bf16 v[228:231], a[28:31], a[40:43], 0
  s_add_u32 s69, s69, 262144
  v_mfma_f32_16x16x32_bf16 v[236:239], a[28:31], a[44:47], 0
  v_mfma_f32_16x16x32_bf16 v[244:247], a[28:31], a[48:51], 0
  s_waitcnt vmcnt(11)
  s_waitcnt lgkmcnt(0)
  v_mfma_f32_16x16x32_bf16 v[252:255], a[28:31], a[52:55], 0
  s_barrier
  v_mfma_f32_16x16x32_bf16 v[64:67], a[56:59], a[88:91], v[64:67]
  s_add_u32 m0, s73, 114688
  ds_read_b128 a[32:35], v14 offset:0
  v_mfma_f32_16x16x32_bf16 v[72:75], a[56:59], a[92:95], v[72:75]
  ds_read_b128 a[36:39], v14 offset:1024
  v_mfma_f32_16x16x32_bf16 v[80:83], a[56:59], a[96:99], v[80:83]
  ds_read_b128 a[40:43], v14 offset:2048
  v_mfma_f32_16x16x32_bf16 v[88:91], a[56:59], a[100:103], v[88:91]
  buffer_load_dwordx4 v16, s[12:15], s70 offen offset:0 sc1 lds
  v_mfma_f32_16x16x32_bf16 v[96:99], a[56:59], a[104:107], v[96:99]
  ds_read_b128 a[44:47], v14 offset:3072
  v_mfma_f32_16x16x32_bf16 v[104:107], a[56:59], a[108:111], v[104:107]
  ds_read_b128 a[48:51], v14 offset:4096
  v_mfma_f32_16x16x32_bf16 v[68:71], a[60:63], a[88:91], v[68:71]
  ds_read_b128 a[52:55], v14 offset:5120
  v_mfma_f32_16x16x32_bf16 v[76:79], a[60:63], a[92:95], v[76:79]
  buffer_load_dwordx4 v17, s[12:15], s70 offen offset:1024 sc1 lds
  v_mfma_f32_16x16x32_bf16 v[84:87], a[60:63], a[96:99], v[84:87]
  ds_read_b64_tr_b16 a[0:1], v10 offset:0
  v_mfma_f32_16x16x32_bf16 v[92:95], a[60:63], a[100:103], v[92:95]
  ds_read_b64_tr_b16 a[2:3], v10 offset:2048
  v_mfma_f32_16x16x32_bf16 v[100:103], a[60:63], a[104:107], v[100:103]
  ds_read_b64_tr_b16 a[4:5], v10 offset:8
  v_mfma_f32_16x16x32_bf16 v[108:111], a[60:63], a[108:111], v[108:111]
  buffer_load_dwordx4 v18, s[12:15], s70 offen offset:2048 sc1 lds
  v_mfma_f32_16x16x32_bf16 v[112:115], a[64:67], a[88:91], v[112:115]
  s_add_u32 s70, s70, 131072
  ds_read_b64_tr_b16 a[6:7], v10 offset:2056
  v_mfma_f32_16x16x32_bf16 v[120:123], a[64:67], a[92:95], v[120:123]
  s_add_u32 m0, s72, 0
  ds_read_b64_tr_b16 a[8:9], v11 offset:0
  v_mfma_f32_16x16x32_bf16 v[128:131], a[64:67], a[96:99], v[128:131]
  ds_read_b64_tr_b16 a[10:11], v11 offset:2048
  v_mfma_f32_16x16x32_bf16 v[136:139], a[64:67], a[100:103], v[136:139]
  buffer_load_dwordx4 v4, s[8:11], s68 offen offset:0 nt lds
  v_mfma_f32_16x16x32_bf16 v[144:147], a[64:67], a[104:107], v[144:147]
  ds_read_b64_tr_b16 a[12:13], v11 offset:8
  v_mfma_f32_16x16x32_bf16 v[152:155], a[64:67], a[108:111], v[152:155]
  ds_read_b64_tr_b16 a[14:15], v11 offset:2056
  v_mfma_f32_16x16x32_bf16 v[116:119], a[68:71], a[88:91], v[116:119]
  ds_read_b64_tr_b16 a[16:17], v12 offset:0
  v_mfma_f32_16x16x32_bf16 v[124:127], a[68:71], a[92:95], v[124:127]
  buffer_load_dwordx4 v5, s[8:11], s68 offen offset:1024 nt lds
  v_mfma_f32_16x16x32_bf16 v[132:135], a[68:71], a[96:99], v[132:135]
  s_add_u32 s68, s68, 262144
  ds_read_b64_tr_b16 a[18:19], v12 offset:2048
  v_mfma_f32_16x16x32_bf16 v[140:143], a[68:71], a[100:103], v[140:143]
  ds_read_b64_tr_b16 a[20:21], v12 offset:8
  v_mfma_f32_16x16x32_bf16 v[148:151], a[68:71], a[104:107], v[148:151]
  ds_read_b64_tr_b16 a[22:23], v12 offset:2056
  v_mfma_f32_16x16x32_bf16 v[156:159], a[68:71], a[108:111], v[156:159]
  buffer_load_dwordx4 v4, s[8:11], s69 offen offset:2048 nt lds
  v_mfma_f32_16x16x32_bf16 v[160:163], a[72:75], a[88:91], v[160:163]
  ds_read_b64_tr_b16 a[24:25], v13 offset:0
  v_mfma_f32_16x16x32_bf16 v[168:171], a[72:75], a[92:95], v[168:171]
  ds_read_b64_tr_b16 a[26:27], v13 offset:2048
  v_mfma_f32_16x16x32_bf16 v[176:179], a[72:75], a[96:99], v[176:179]
  ds_read_b64_tr_b16 a[28:29], v13 offset:8
  v_mfma_f32_16x16x32_bf16 v[184:187], a[72:75], a[100:103], v[184:187]
  buffer_load_dwordx4 v5, s[8:11], s69 offen offset:3072 nt lds
  v_mfma_f32_16x16x32_bf16 v[192:195], a[72:75], a[104:107], v[192:195]
  s_add_u32 s69, s69, 262144
  ds_read_b64_tr_b16 a[30:31], v13 offset:2056
  v_mfma_f32_16x16x32_bf16 v[200:203], a[72:75], a[108:111], v[200:203]
  s_add_u32 m0, s73, 0
  v_mfma_f32_16x16x32_bf16 v[164:167], a[76:79], a[88:91], v[164:167]
  v_mfma_f32_16x16x32_bf16 v[172:175], a[76:79], a[92:95], v[172:175]
  buffer_load_dwordx4 v16, s[12:15], s70 offen offset:0 sc1 lds
  v_mfma_f32_16x16x32_bf16 v[180:183], a[76:79], a[96:99], v[180:183]
  v_mfma_f32_16x16x32_bf16 v[188:191], a[76:79], a[100:103], v[188:191]
  v_mfma_f32_16x16x32_bf16 v[196:199], a[76:79], a[104:107], v[196:199]
  v_mfma_f32_16x16x32_bf16 v[204:207], a[76:79], a[108:111], v[204:207]
  buffer_load_dwordx4 v17, s[12:15], s70 offen offset:1024 sc1 lds
  v_mfma_f32_16x16x32_bf16 v[208:211], a[80:83], a[88:91], v[208:211]
  v_mfma_f32_16x16x32_bf16 v[216:219], a[80:83], a[92:95], v[216:219]
  v_mfma_f32_16x16x32_bf16 v[224:227], a[80:83], a[96:99], v[224:227]
  v_mfma_f32_16x16x32_bf16 v[232:235], a[80:83], a[100:103], v[232:235]
  buffer_load_dwordx4 v18, s[12:15], s70 offen offset:2048 sc1 lds
  v_mfma_f32_16x16x32_bf16 v[240:243], a[80:83], a[104:107], v[240:243]
  s_add_u32 s70, s70, 131072
  v_mfma_f32_16x16x32_bf16 v[248:251], a[80:83], a[108:111], v[248:251]
  s_cmp_eq_u32 s35, 1
  v_mfma_f32_16x16x32_bf16 v[212:215], a[84:87], a[88:91], v[212:215]
  s_cselect_b32 s26, 18874368, 0
  v_mfma_f32_16x16x32_bf16 v[220:223], a[84:87], a[92:95], v[220:223]
  buffer_load_dword v21, v59, s[24:27], 0 offen
  v_mfma_f32_16x16x32_bf16 v[228:231], a[84:87], a[96:99], v[228:231]
  v_mfma_f32_16x16x32_bf16 v[236:239], a[84:87], a[100:103], v[236:239]
  v_mfma_f32_16x16x32_bf16 v[244:247], a[84:87], a[104:107], v[244:247]
  s_waitcnt vmcnt(15)
  s_waitcnt lgkmcnt(0)
  v_mfma_f32_16x16x32_bf16 v[252:255], a[84:87], a[108:111], v[252:255]
  s_barrier
  v_mfma_f32_16x16x32_bf16 v[64:67], a[0:3], a[32:35], v[64:67]
  s_add_u32 m0, s72, 28672
  ds_read_b128 a[88:91], v14 offset:28672
  v_mfma_f32_16x16x32_bf16 v[72:75], a[0:3], a[36:39], v[72:75]
  ds_read_b128 a[92:95], v14 offset:29696
  v_mfma_f32_16x16x32_bf16 v[80:83], a[0:3], a[40:43], v[80:83]
  ds_read_b128 a[96:99], v14 offset:30720
  v_mfma_f32_16x16x32_bf16 v[88:91], a[0:3], a[44:47], v[88:91]
  buffer_load_dwordx4 v4, s[8:11], s68 offen offset:0 nt lds
  v_mfma_f32_16x16x32_bf16 v[96:99], a[0:3], a[48:51], v[96:99]
  ds_read_b128 a[100:103], v14 offset:31744
  v_mfma_f32_16x16x32_bf16 v[104:107], a[0:3], a[52:55], v[104:107]
  ds_read_b128 a[104:107], v14 offset:32768
  v_mfma_f32_16x16x32_bf16 v[68:71], a[4:7], a[32:35], v[68:71]
  ds_read_b128 a[108:111], v14 offset:33792
  v_mfma_f32_16x16x32_bf16 v[76:79], a[4:7], a[36:39], v[76:79]
  buffer_load_dwordx4 v5, s[8:11], s68 offen offset:1024 nt lds
  v_mfma_f32_16x16x32_bf16 v[84:87], a[4:7], a[40:43], v[84:87]
  s_add_u32 s68, s68, 262144
  ds_read_b64_tr_b16 a[56:57], v10 offset:28672
  v_mfma_f32_16x16x32_bf16 v[92:95], a[4:7], a[44:47], v[92:95]
  ds_read_b64_tr_b16 a[58:59], v10 offset:30720
  v_mfma_f32_16x16x32_bf16 v[100:103], a[4:7], a[48:51], v[100:103]
  ds_read_b64_tr_b16 a[60:61], v10 offset:28680
  v_mfma_f32_16x16x32_bf16 v[108:111], a[4:7], a[52:55], v[108:111]
  buffer_load_dwordx4 v4, s[8:11], s69 offen offset:2048 nt lds
  v_mfma_f32_16x16x32_bf16 v[112:115], a[8:11], a[32:35], v[112:115]
  ds_read_b64_tr_b16 a[62:63], v10 offset:30728
  v_mfma_f32_16x16x32_bf16 v[120:123], a[8:11], a[36:39], v[120:123]
  ds_read_b64_tr_b16 a[64:65], v11 offset:28672
  v_mfma_f32_16x16x32_bf16 v[128:131], a[8:11], a[40:43], v[128:131]
  ds_read_b64_tr_b16 a[66:67], v11 offset:30720
  v_mfma_f32_16x16x32_bf16 v[136:139], a[8:11], a[44:47], v[136:139]
  buffer_load_dwordx4 v5, s[8:11], s69 offen offset:3072 nt lds
  v_mfma_f32_16x16x32_bf16 v[144:147], a[8:11], a[48:51], v[144:147]
  s_add_u32 s69, s69, 262144
  ds_read_b64_tr_b16 a[68:69], v11 offset:28680
  v_mfma_f32_16x16x32_bf16 v[152:155], a[8:11], a[52:55], v[152:155]
  s_add_u32 m0, s73, 28672
  ds_read_b64_tr_b16 a[70:71], v11 offset:30728
  v_mfma_f32_16x16x32_bf16 v[116:119], a[12:15], a[32:35], v[116:119]
  ds_read_b64_tr_b16 a[72:73], v12 offset:28672
  v_mfma_f32_16x16x32_bf16 v[124:127], a[12:15], a[36:39], v[124:127]
  buffer_load_dwordx4 v16, s[12:15], s70 offen offset:0 sc1 lds
  v_mfma_f32_16x16x32_bf16 v[132:135], a[12:15], a[40:43], v[132:135]
  ds_read_b64_tr_b16 a[74:75], v12 offset:30720
  v_mfma_f32_16x16x32_bf16 v[140:143], a[12:15], a[44:47], v[140:143]
  ds_read_b64_tr_b16 a[76:77], v12 offset:28680
  v_mfma_f32_16x16x32_bf16 v[148:151], a[12:15], a[48:51], v[148:151]
  ds_read_b64_tr_b16 a[78:79], v12 offset:30728
  v_mfma_f32_16x16x32_bf16 v[156:159], a[12:15], a[52:55], v[156:159]
  buffer_load_dwordx4 v17, s[12:15], s70 offen offset:1024 sc1 lds
  v_mfma_f32_16x16x32_bf16 v[160:163], a[16:19], a[32:35], v[160:163]
  ds_read_b64_tr_b16 a[80:81], v13 offset:28672
  v_mfma_f32_16x16x32_bf16 v[168:171], a[16:19], a[36:39], v[168:171]
  ds_read_b64_tr_b16 a[82:83], v13 offset:30720
  v_mfma_f32_16x16x32_bf16 v[176:179], a[16:19], a[40:43], v[176:179]
  ds_read_b64_tr_b16 a[84:85], v13 offset:28680
  v_mfma_f32_16x16x32_bf16 v[184:187], a[16:19], a[44:47], v[184:187]
  buffer_load_dwordx4 v18, s[12:15], s70 offen offset:2048 sc1 lds
  v_mfma_f32_16x16x32_bf16 v[192:195], a[16:19], a[48:51], v[192:195]
  s_add_u32 s70, s70, 131072
  ds_read_b64_tr_b16 a[86:87], v13 offset:30728
  v_mfma_f32_16x16x32_bf16 v[200:203], a[16:19], a[52:55], v[200:203]
  s_add_u32 m0, s72, 57344
  v_add_u32 v10, 57344, v10
  v_mfma_f32_16x16x32_bf16 v[164:167], a[20:23], a[32:35], v[164:167]
  v_add_u32 v11, 57344, v11
  v_mfma_f32_16x16x32_bf16 v[172:175], a[20:23], a[36:39], v[172:175]
  buffer_load_dwordx4 v4, s[8:11], s68 offen offset:0 nt lds
  v_mfma_f32_16x16x32_bf16 v[180:183], a[20:23], a[40:43], v[180:183]
  v_add_u32 v12, 57344, v12
  v_mfma_f32_16x16x32_bf16 v[188:191], a[20:23], a[44:47], v[188:191]
  v_add_u32 v13, 57344, v13
  v_mfma_f32_16x16x32_bf16 v[196:199], a[20:23], a[48:51], v[196:199]
  v_add_u32 v14, 57344, v14
  v_mfma_f32_16x16x32_bf16 v[204:207], a[20:23], a[52:55], v[204:207]
  buffer_load_dwordx4 v5, s[8:11], s68 offen offset:1024 nt lds
  v_mfma_f32_16x16x32_bf16 v[208:211], a[24:27], a[32:35], v[208:211]
  s_add_u32 s68, s68, 262144
  v_mfma_f32_16x16x32_bf16 v[216:219], a[24:27], a[36:39], v[216:219]
  v_mfma_f32_16x16x32_bf16 v[224:227], a[24:27], a[40:43], v[224:227]
  v_mfma_f32_16x16x32_bf16 v[232:235], a[24:27], a[44:47], v[232:235]
  buffer_load_dwordx4 v4, s[8:11], s69 offen offset:2048 nt lds
  v_mfma_f32_16x16x32_bf16 v[240:243], a[24:27], a[48:51], v[240:243]
  v_mfma_f32_16x16x32_bf16 v[248:251], a[24:27], a[52:55], v[248:251]
  v_mfma_f32_16x16x32_bf16 v[212:215], a[28:31], a[32:35], v[212:215]
  v_mfma_f32_16x16x32_bf16 v[220:223], a[28:31], a[36:39], v[220:223]
  buffer_load_dwordx4 v5, s[8:11], s69 offen offset:3072 nt lds
  v_mfma_f32_16x16x32_bf16 v[228:231], a[28:31], a[40:43], v[228:231]
  s_add_u32 s69, s69, 262144
  v_mfma_f32_16x16x32_bf16 v[236:239], a[28:31], a[44:47], v[236:239]
  v_mfma_f32_16x16x32_bf16 v[244:247], a[28:31], a[48:51], v[244:247]
  s_waitcnt vmcnt(19)
  s_waitcnt lgkmcnt(0)
  v_mfma_f32_16x16x32_bf16 v[252:255], a[28:31], a[52:55], v[252:255]
  s_barrier
  v_mfma_f32_16x16x32_bf16 v[64:67], a[56:59], a[88:91], v[64:67]
  s_add_u32 m0, s73, 57344
  ds_read_b128 a[32:35], v14 offset:0
  v_mfma_f32_16x16x32_bf16 v[72:75], a[56:59], a[92:95], v[72:75]
  ds_read_b128 a[36:39], v14 offset:1024
  v_mfma_f32_16x16x32_bf16 v[80:83], a[56:59], a[96:99], v[80:83]
  ds_read_b128 a[40:43], v14 offset:2048
  v_mfma_f32_16x16x32_bf16 v[88:91], a[56:59], a[100:103], v[88:91]
  buffer_load_dwordx4 v16, s[12:15], s70 offen offset:0 sc1 lds
  v_mfma_f32_16x16x32_bf16 v[96:99], a[56:59], a[104:107], v[96:99]
  ds_read_b128 a[44:47], v14 offset:3072
  v_mfma_f32_16x16x32_bf16 v[104:107], a[56:59], a[108:111], v[104:107]
  ds_read_b128 a[48:51], v14 offset:4096
  v_mfma_f32_16x16x32_bf16 v[68:71], a[60:63], a[88:91], v[68:71]
  ds_read_b128 a[52:55], v14 offset:5120
  v_mfma_f32_16x16x32_bf16 v[76:79], a[60:63], a[92:95], v[76:79]
  ds_read_b64_tr_b16 a[0:1], v10 offset:0
  v_mfma_f32_16x16x32_bf16 v[84:87], a[60:63], a[96:99], v[84:87]
  buffer_load_dwordx4 v17, s[12:15], s70 offen offset:1024 sc1 lds
  v_mfma_f32_16x16x32_bf16 v[92:95], a[60:63], a[100:103], v[92:95]
  ds_read_b64_tr_b16 a[2:3], v10 offset:2048
  v_mfma_f32_16x16x32_bf16 v[100:103], a[60:63], a[104:107], v[100:103]
  ds_read_b64_tr_b16 a[4:5], v10 offset:8
  v_mfma_f32_16x16x32_bf16 v[108:111], a[60:63], a[108:111], v[108:111]
  ds_read_b64_tr_b16 a[6:7], v10 offset:2056
  v_mfma_f32_16x16x32_bf16 v[112:115], a[64:67], a[88:91], v[112:115]
  ds_read_b64_tr_b16 a[8:9], v11 offset:0
  v_mfma_f32_16x16x32_bf16 v[120:123], a[64:67], a[92:95], v[120:123]
  buffer_load_dwordx4 v18, s[12:15], s70 offen offset:2048 sc1 lds
  v_mfma_f32_16x16x32_bf16 v[128:131], a[64:67], a[96:99], v[128:131]
  s_add_u32 s70, s70, 131072
  ds_read_b64_tr_b16 a[10:11], v11 offset:2048
  v_mfma_f32_16x16x32_bf16 v[136:139], a[64:67], a[100:103], v[136:139]
  s_add_u32 m0, s72, 86016
  ds_read_b64_tr_b16 a[12:13], v11 offset:8
  v_mfma_f32_16x16x32_bf16 v[144:147], a[64:67], a[104:107], v[144:147]
  ds_read_b64_tr_b16 a[14:15], v11 offset:2056
  v_mfma_f32_16x16x32_bf16 v[152:155], a[64:67], a[108:111], v[152:155]
  ds_read_b64_tr_b16 a[16:17], v12 offset:0
  v_mfma_f32_16x16x32_bf16 v[116:119], a[68:71], a[88:91], v[116:119]
  buffer_load_dwordx4 v4, s[8:11], s68 offen offset:0 nt lds
  v_mfma_f32_16x16x32_bf16 v[124:127], a[68:71], a[92:95], v[124:127]
  ds_read_b64_tr_b16 a[18:19], v12 offset:2048
  v_mfma_f32_16x16x32_bf16 v[132:135], a[68:71], a[96:99], v[132:135]
  ds_read_b64_tr_b16 a[20:21], v12 offset:8
  v_mfma_f32_16x16x32_bf16 v[140:143], a[68:71], a[100:103], v[140:143]
  ds_read_b64_tr_b16 a[22:23], v12 offset:2056
  v_mfma_f32_16x16x32_bf16 v[148:151], a[68:71], a[104:107], v[148:151]
  ds_read_b64_tr_b16 a[24:25], v13 offset:0
  v_mfma_f32_16x16x32_bf16 v[156:159], a[68:71], a[108:111], v[156:159]
  buffer_load_dwordx4 v5, s[8:11], s68 offen offset:1024 nt lds
  v_mfma_f32_16x16x32_bf16 v[160:163], a[72:75], a[88:91], v[160:163]
  s_add_u32 s68, s68, 262144
  ds_read_b64_tr_b16 a[26:27], v13 offset:2048
  v_mfma_f32_16x16x32_bf16 v[168:171], a[72:75], a[92:95], v[168:171]
  ds_read_b64_tr_b16 a[28:29], v13 offset:8
  v_mfma_f32_16x16x32_bf16 v[176:179], a[72:75], a[96:99], v[176:179]
  ds_read_b64_tr_b16 a[30:31], v13 offset:2056
  v_mfma_f32_16x16x32_bf16 v[184:187], a[72:75], a[100:103], v[184:187]
  v_add_u32 v10, 4294852608, v10
  v_mfma_f32_16x16x32_bf16 v[192:195], a[72:75], a[104:107], v[192:195]
  buffer_load_dwordx4 v4, s[8:11], s69 offen offset:2048 nt lds
  v_mfma_f32_16x16x32_bf16 v[200:203], a[72:75], a[108:111], v[200:203]
  v_add_u32 v11, 4294852608, v11
  v_mfma_f32_16x16x32_bf16 v[164:167], a[76:79], a[88:91], v[164:167]
  v_add_u32 v12, 4294852608, v12
  v_mfma_f32_16x16x32_bf16 v[172:175], a[76:79], a[92:95], v[172:175]
  v_add_u32 v13, 4294852608, v13
  v_mfma_f32_16x16x32_bf16 v[180:183], a[76:79], a[96:99], v[180:183]
  v_add_u32 v14, 4294852608, v14
  v_mfma_f32_16x16x32_bf16 v[188:191], a[76:79], a[100:103], v[188:191]
  buffer_load_dwordx4 v5, s[8:11], s69 offen offset:3072 nt lds
  v_mfma_f32_16x16x32_bf16 v[196:199], a[76:79], a[104:107], v[196:199]
  s_add_u32 s69, s69, 262144
  v_mfma_f32_16x16x32_bf16 v[204:207], a[76:79], a[108:111], v[204:207]
  s_cmp_eq_u32 s35, 2
  v_mfma_f32_16x16x32_bf16 v[208:211], a[80:83], a[88:91], v[208:211]
  s_cselect_b32 s26, 18874368, 0
  v_mfma_f32_16x16x32_bf16 v[216:219], a[80:83], a[92:95], v[216:219]
  v_mfma_f32_16x16x32_bf16 v[224:227], a[80:83], a[96:99], v[224:227]
  buffer_load_dword v21, v59, s[24:27], 0 offen
  v_mfma_f32_16x16x32_bf16 v[232:235], a[80:83], a[100:103], v[232:235]
  v_mfma_f32_16x16x32_bf16 v[240:243], a[80:83], a[104:107], v[240:243]
  v_mfma_f32_16x16x32_bf16 v[248:251], a[80:83], a[108:111], v[248:251]
  v_mfma_f32_16x16x32_bf16 v[212:215], a[84:87], a[88:91], v[212:215]
  v_mfma_f32_16x16x32_bf16 v[220:223], a[84:87], a[92:95], v[220:223]
  v_mfma_f32_16x16x32_bf16 v[228:231], a[84:87], a[96:99], v[228:231]
  v_mfma_f32_16x16x32_bf16 v[236:239], a[84:87], a[100:103], v[236:239]
  v_mfma_f32_16x16x32_bf16 v[244:247], a[84:87], a[104:107], v[244:247]
  s_waitcnt vmcnt(20)
  s_waitcnt lgkmcnt(0)
  v_mfma_f32_16x16x32_bf16 v[252:255], a[84:87], a[108:111], v[252:255]
  s_barrier
  v_mfma_f32_16x16x32_bf16 v[64:67], a[0:3], a[32:35], v[64:67]
  s_add_u32 m0, s73, 86016
  ds_read_b128 a[88:91], v14 offset:0
  v_mfma_f32_16x16x32_bf16 v[72:75], a[0:3], a[36:39], v[72:75]
  ds_read_b128 a[92:95], v14 offset:1024
  v_mfma_f32_16x16x32_bf16 v[80:83], a[0:3], a[40:43], v[80:83]
  ds_read_b128 a[96:99], v14 offset:2048
  v_mfma_f32_16x16x32_bf16 v[88:91], a[0:3], a[44:47], v[88:91]
  buffer_load_dwordx4 v16, s[12:15], s70 offen offset:0 sc1 lds
  v_mfma_f32_16x16x32_bf16 v[96:99], a[0:3], a[48:51], v[96:99]
  ds_read_b128 a[100:103], v14 offset:3072
  v_mfma_f32_16x16x32_bf16 v[104:107], a[0:3], a[52:55], v[104:107]
  ds_read_b128 a[104:107], v14 offset:4096
  v_mfma_f32_16x16x32_bf16 v[68:71], a[4:7], a[32:35], v[68:71]
  ds_read_b128 a[108:111], v14 offset:5120
  v_mfma_f32_16x16x32_bf16 v[76:79], a[4:7], a[36:39], v[76:79]
  ds_read_b64_tr_b16 a[56:57], v10 offset:0
  v_mfma_f32_16x16x32_bf16 v[84:87], a[4:7], a[40:43], v[84:87]
  ds_read_b64_tr_b16 a[58:59], v10 offset:2048
  v_mfma_f32_16x16x32_bf16 v[92:95], a[4:7], a[44:47], v[92:95]
  buffer_load_dwordx4 v17, s[12:15], s70 offen offset:1024 sc1 lds
  v_mfma_f32_16x16x32_bf16 v[100:103], a[4:7], a[48:51], v[100:103]
  ds_read_b64_tr_b16 a[60:61], v10 offset:8
  v_mfma_f32_16x16x32_bf16 v[108:111], a[4:7], a[52:55], v[108:111]
  ds_read_b64_tr_b16 a[62:63], v10 offset:2056
  v_mfma_f32_16x16x32_bf16 v[112:115], a[8:11], a[32:35], v[112:115]
  ds_read_b64_tr_b16 a[64:65], v11 offset:0
  v_mfma_f32_16x16x32_bf16 v[120:123], a[8:11], a[36:39], v[120:123]
  ds_read_b64_tr_b16 a[66:67], v11 offset:2048
  v_mfma_f32_16x16x32_bf16 v[128:131], a[8:11], a[40:43], v[128:131]
  ds_read_b64_tr_b16 a[68:69], v11 offset:8
  v_mfma_f32_16x16x32_bf16 v[136:139], a[8:11], a[44:47], v[136:139]
  buffer_load_dwordx4 v18, s[12:15], s70 offen offset:2048 sc1 lds
  v_mfma_f32_16x16x32_bf16 v[144:147], a[8:11], a[48:51], v[144:147]
  s_add_u32 s70, s70, 131072
  ds_read_b64_tr_b16 a[70:71], v11 offset:2056
  v_mfma_f32_16x16x32_bf16 v[152:155], a[8:11], a[52:55], v[152:155]
  s_add_u32 m0, s72, 114688
  ds_read_b64_tr_b16 a[72:73], v12 offset:0
  v_mfma_f32_16x16x32_bf16 v[116:119], a[12:15], a[32:35], v[116:119]
  ds_read_b64_tr_b16 a[74:75], v12 offset:2048
  v_mfma_f32_16x16x32_bf16 v[124:127], a[12:15], a[36:39], v[124:127]
  ds_read_b64_tr_b16 a[76:77], v12 offset:8
  v_mfma_f32_16x16x32_bf16 v[132:135], a[12:15], a[40:43], v[132:135]
  ds_read_b64_tr_b16 a[78:79], v12 offset:2056
  v_mfma_f32_16x16x32_bf16 v[140:143], a[12:15], a[44:47], v[140:143]
  buffer_load_dwordx4 v4, s[8:11], s68 offen offset:0 nt lds
  v_mfma_f32_16x16x32_bf16 v[148:151], a[12:15], a[48:51], v[148:151]
  ds_read_b64_tr_b16 a[80:81], v13 offset:0
  v_mfma_f32_16x16x32_bf16 v[156:159], a[12:15], a[52:55], v[156:159]
  ds_read_b64_tr_b16 a[82:83], v13 offset:2048
  v_mfma_f32_16x16x32_bf16 v[160:163], a[16:19], a[32:35], v[160:163]
  ds_read_b64_tr_b16 a[84:85], v13 offset:8
  v_mfma_f32_16x16x32_bf16 v[168:171], a[16:19], a[36:39], v[168:171]
  ds_read_b64_tr_b16 a[86:87], v13 offset:2056
  v_mfma_f32_16x16x32_bf16 v[176:179], a[16:19], a[40:43], v[176:179]
  v_mfma_f32_16x16x32_bf16 v[184:187], a[16:19], a[44:47], v[184:187]
  buffer_load_dwordx4 v5, s[8:11], s68 offen offset:1024 nt lds
  v_mfma_f32_16x16x32_bf16 v[192:195], a[16:19], a[48:51], v[192:195]
  s_add_u32 s68, s68, 262144
  v_mfma_f32_16x16x32_bf16 v[200:203], a[16:19], a[52:55], v[200:203]
  v_mfma_f32_16x16x32_bf16 v[164:167], a[20:23], a[32:35], v[164:167]
  v_mfma_f32_16x16x32_bf16 v[172:175], a[20:23], a[36:39], v[172:175]
  v_mfma_f32_16x16x32_bf16 v[180:183], a[20:23], a[40:43], v[180:183]
  v_mfma_f32_16x16x32_bf16 v[188:191], a[20:23], a[44:47], v[188:191]
  buffer_load_dwordx4 v4, s[8:11], s69 offen offset:2048 nt lds
  v_mfma_f32_16x16x32_bf16 v[196:199], a[20:23], a[48:51], v[196:199]
  v_mfma_f32_16x16x32_bf16 v[204:207], a[20:23], a[52:55], v[204:207]
  v_mfma_f32_16x16x32_bf16 v[208:211], a[24:27], a[32:35], v[208:211]
  s_getpc_b64 s[92:93]
L_jq4:
  v_mfma_f32_16x16x32_bf16 v[216:219], a[24:27], a[36:39], v[216:219]
  v_mfma_f32_16x16x32_bf16 v[224:227], a[24:27], a[40:43], v[224:227]
  s_add_u32 s92, s92, 2048
  s_addc_u32 s93, s93, 0
  v_mfma_f32_16x16x32_bf16 v[232:235], a[24:27], a[44:47], v[232:235]
  buffer_load_dwordx4 v5, s[8:11], s69 offen offset:3072 nt lds
  v_mfma_f32_16x16x32_bf16 v[240:243], a[24:27], a[48:51], v[240:243]
  s_add_u32 s69, s69, 262144
  v_mfma_f32_16x16x32_bf16 v[248:251], a[24:27], a[52:55], v[248:251]
  v_mfma_f32_16x16x32_bf16 v[212:215], a[28:31], a[32:35], v[212:215]
  buffer_load_dword v21, v15, s[92:95], 0 offen
  v_mfma_f32_16x16x32_bf16 v[220:223], a[28:31], a[36:39], v[220:223]
  v_mfma_f32_16x16x32_bf16 v[228:231], a[28:31], a[40:43], v[228:231]
  v_mfma_f32_16x16x32_bf16 v[236:239], a[28:31], a[44:47], v[236:239]
  v_mfma_f32_16x16x32_bf16 v[244:247], a[28:31], a[48:51], v[244:247]
  s_waitcnt vmcnt(20)
  s_waitcnt lgkmcnt(0)
  v_mfma_f32_16x16x32_bf16 v[252:255], a[28:31], a[52:55], v[252:255]
  s_barrier
  v_mfma_f32_16x16x32_bf16 v[64:67], a[56:59], a[88:91], v[64:67]
  s_add_u32 m0, s73, 114688
  ds_read_b128 a[32:35], v14 offset:28672
  v_mfma_f32_16x16x32_bf16 v[72:75], a[56:59], a[92:95], v[72:75]
  ds_read_b128 a[36:39], v14 offset:29696
  v_mfma_f32_16x16x32_bf16 v[80:83], a[56:59], a[96:99], v[80:83]
  ds_read_b128 a[40:43], v14 offset:30720
  v_mfma_f32_16x16x32_bf16 v[88:91], a[56:59], a[100:103], v[88:91]
  buffer_load_dwordx4 v16, s[12:15], s70 offen offset:0 sc1 lds
  v_mfma_f32_16x16x32_bf16 v[96:99], a[56:59], a[104:107], v[96:99]
  ds_read_b128 a[44:47], v14 offset:31744
  v_mfma_f32_16x16x32_bf16 v[104:107], a[56:59], a[108:111], v[104:107]
  ds_read_b128 a[48:51], v14 offset:32768
  v_mfma_f32_16x16x32_bf16 v[68:71], a[60:63], a[88:91], v[68:71]
  ds_read_b128 a[52:55], v14 offset:33792
  v_mfma_f32_16x16x32_bf16 v[76:79], a[60:63], a[92:95], v[76:79]
  ds_read_b64_tr_b16 a[0:1], v10 offset:28672
  v_mfma_f32_16x16x32_bf16 v[84:87], a[60:63], a[96:99], v[84:87]
  buffer_load_dwordx4 v17, s[12:15], s70 offen offset:1024 sc1 lds
  v_mfma_f32_16x16x32_bf16 v[92:95], a[60:63], a[100:103], v[92:95]
  ds_read_b64_tr_b16 a[2:3], v10 offset:30720
  v_mfma_f32_16x16x32_bf16 v[100:103], a[60:63], a[104:107], v[100:103]
  ds_read_b64_tr_b16 a[4:5], v10 offset:28680
  v_mfma_f32_16x16x32_bf16 v[108:111], a[60:63], a[108:111], v[108:111]
  ds_read_b64_tr_b16 a[6:7], v10 offset:30728
  v_mfma_f32_16x16x32_bf16 v[112:115], a[64:67], a[88:91], v[112:115]
  ds_read_b64_tr_b16 a[8:9], v11 offset:28672
  v_mfma_f32_16x16x32_bf16 v[120:123], a[64:67], a[92:95], v[120:123]
  buffer_load_dwordx4 v18, s[12:15], s70 offen offset:2048 sc1 lds
  v_mfma_f32_16x16x32_bf16 v[128:131], a[64:67], a[96:99], v[128:131]
  s_add_u32 s70, s70, 131072
  ds_read_b64_tr_b16 a[10:11], v11 offset:30720
  v_mfma_f32_16x16x32_bf16 v[136:139], a[64:67], a[100:103], v[136:139]
  s_add_u32 m0, s72, 0
  ds_read_b64_tr_b16 a[12:13], v11 offset:28680
  v_mfma_f32_16x16x32_bf16 v[144:147], a[64:67], a[104:107], v[144:147]
  ds_read_b64_tr_b16 a[14:15], v11 offset:30728
  v_mfma_f32_16x16x32_bf16 v[152:155], a[64:67], a[108:111], v[152:155]
  ds_read_b64_tr_b16 a[16:17], v12 offset:28672
  v_mfma_f32_16x16x32_bf16 v[116:119], a[68:71], a[88:91], v[116:119]
  buffer_load_dwordx4 v4, s[8:11], s68 offen offset:0 nt lds
  v_mfma_f32_16x16x32_bf16 v[124:127], a[68:71], a[92:95], v[124:127]
  ds_read_b64_tr_b16 a[18:19], v12 offset:30720
  v_mfma_f32_16x16x32_bf16 v[132:135], a[68:71], a[96:99], v[132:135]
  ds_read_b64_tr_b16 a[20:21], v12 offset:28680
  v_mfma_f32_16x16x32_bf16 v[140:143], a[68:71], a[100:103], v[140:143]
  ds_read_b64_tr_b16 a[22:23], v12 offset:30728
  v_mfma_f32_16x16x32_bf16 v[148:151], a[68:71], a[104:107], v[148:151]
  ds_read_b64_tr_b16 a[24:25], v13 offset:28672
  v_mfma_f32_16x16x32_bf16 v[156:159], a[68:71], a[108:111], v[156:159]
  buffer_load_dwordx4 v5, s[8:11], s68 offen offset:1024 nt lds
  v_mfma_f32_16x16x32_bf16 v[160:163], a[72:75], a[88:91], v[160:163]
  s_add_u32 s68, s68, 262144
  ds_read_b64_tr_b16 a[26:27], v13 offset:30720
  v_mfma_f32_16x16x32_bf16 v[168:171], a[72:75], a[92:95], v[168:171]
  ds_read_b64_tr_b16 a[28:29], v13 offset:28680
  v_mfma_f32_16x16x32_bf16 v[176:179], a[72:75], a[96:99], v[176:179]
  ds_read_b64_tr_b16 a[30:31], v13 offset:30728
  v_mfma_f32_16x16x32_bf16 v[184:187], a[72:75], a[100:103], v[184:187]
  v_add_u32 v10, 57344, v10
  v_mfma_f32_16x16x32_bf16 v[192:195], a[72:75], a[104:107], v[192:195]
  buffer_load_dwordx4 v4, s[8:11], s69 offen offset:2048 nt lds
  v_mfma_f32_16x16x32_bf16 v[200:203], a[72:75], a[108:111], v[200:203]
  v_add_u32 v11, 57344, v11
  v_mfma_f32_16x16x32_bf16 v[164:167], a[76:79], a[88:91], v[164:167]
  v_add_u32 v12, 57344, v12
  v_mfma_f32_16x16x32_bf16 v[172:175], a[76:79], a[92:95], v[172:175]
  v_add_u32 v13, 57344, v13
  v_mfma_f32_16x16x32_bf16 v[180:183], a[76:79], a[96:99], v[180:183]
  v_add_u32 v14, 57344, v14
  v_mfma_f32_16x16x32_bf16 v[188:191], a[76:79], a[100:103], v[188:191]
  buffer_load_dwordx4 v5, s[8:11], s69 offen offset:3072 nt lds
  v_mfma_f32_16x16x32_bf16 v[196:199], a[76:79], a[104:107], v[196:199]
  s_add_u32 s69, s69, 262144
  v_mfma_f32_16x16x32_bf16 v[204:207], a[76:79], a[108:111], v[204:207]
  s_cmp_eq_u32 s35, 3
  v_mfma_f32_16x16x32_bf16 v[208:211], a[80:83], a[88:91], v[208:211]
  s_cselect_b32 s26, 18874368, 0
  v_mfma_f32_16x16x32_bf16 v[216:219], a[80:83], a[92:95], v[216:219]
  v_mfma_f32_16x16x32_bf16 v[224:227], a[80:83], a[96:99], v[224:227]
  buffer_load_dword v21, v59, s[24:27], 0 offen
  v_mfma_f32_16x16x32_bf16 v[232:235], a[80:83], a[100:103], v[232:235]
  v_mfma_f32_16x16x32_bf16 v[240:243], a[80:83], a[104:107], v[240:243]
  v_mfma_f32_16x16x32_bf16 v[248:251], a[80:83], a[108:111], v[248:251]
  v_mfma_f32_16x16x32_bf16 v[212:215], a[84:87], a[88:91], v[212:215]
  v_mfma_f32_16x16x32_bf16 v[220:223], a[84:87], a[92:95], v[220:223]
  v_mfma_f32_16x16x32_bf16 v[228:231], a[84:87], a[96:99], v[228:231]
  v_mfma_f32_16x16x32_bf16 v[236:239], a[84:87], a[100:103], v[236:239]
  v_mfma_f32_16x16x32_bf16 v[244:247], a[84:87], a[104:107], v[244:247]
  s_waitcnt vmcnt(21)
  s_waitcnt lgkmcnt(0)
  v_mfma_f32_16x16x32_bf16 v[252:255], a[84:87], a[108:111], v[252:255]
  s_barrier
  v_mfma_f32_16x16x32_bf16 v[64:67], a[0:3], a[32:35], v[64:67]
  s_add_u32 m0, s73, 0
  ds_read_b128 a[88:91], v14 offset:0
  v_mfma_f32_16x16x32_bf16 v[72:75], a[0:3], a[36:39], v[72:75]
  ds_read_b128 a[92:95], v14 offset:1024
  v_mfma_f32_16x16x32_bf16 v[80:83], a[0:3], a[40:43], v[80:83]
  ds_read_b128 a[96:99], v14 offset:2048
  v_mfma_f32_16x16x32_bf16 v[88:91], a[0:3], a[44:47], v[88:91]
  buffer_load_dwordx4 v16, s[12:15], s70 offen offset:0 sc1 lds
  v_mfma_f32_16x16x32_bf16 v[96:99], a[0:3], a[48:51], v[96:99]
  ds_read_b128 a[100:103], v14 offset:3072
  v_mfma_f32_16x16x32_bf16 v[104:107], a[0:3], a[52:55], v[104:107]
  ds_read_b128 a[104:107], v14 offset:4096
  v_mfma_f32_16x16x32_bf16 v[68:71], a[4:7], a[32:35], v[68:71]
  ds_read_b128 a[108:111], v14 offset:5120
  v_mfma_f32_16x16x32_bf16 v[76:79], a[4:7], a[36:39], v[76:79]
  ds_read_b64_tr_b16 a[56:57], v10 offset:0
  v_mfma_f32_16x16x32_bf16 v[84:87], a[4:7], a[40:43], v[84:87]
  ds_read_b64_tr_b16 a[58:59], v10 offset:2048
  v_mfma_f32_16x16x32_bf16 v[92:95], a[4:7], a[44:47], v[92:95]
  buffer_load_dwordx4 v17, s[12:15], s70 offen offset:1024 sc1 lds
  v_mfma_f32_16x16x32_bf16 v[100:103], a[4:7], a[48:51], v[100:103]
  ds_read_b64_tr_b16 a[60:61], v10 offset:8
  v_mfma_f32_16x16x32_bf16 v[108:111], a[4:7], a[52:55], v[108:111]
  ds_read_b64_tr_b16 a[62:63], v10 offset:2056
  v_mfma_f32_16x16x32_bf16 v[112:115], a[8:11], a[32:35], v[112:115]
  ds_read_b64_tr_b16 a[64:65], v11 offset:0
  v_mfma_f32_16x16x32_bf16 v[120:123], a[8:11], a[36:39], v[120:123]
  ds_read_b64_tr_b16 a[66:67], v11 offset:2048
  v_mfma_f32_16x16x32_bf16 v[128:131], a[8:11], a[40:43], v[128:131]
  ds_read_b64_tr_b16 a[68:69], v11 offset:8
  v_mfma_f32_16x16x32_bf16 v[136:139], a[8:11], a[44:47], v[136:139]
  buffer_load_dwordx4 v18, s[12:15], s70 offen offset:2048 sc1 lds
  v_mfma_f32_16x16x32_bf16 v[144:147], a[8:11], a[48:51], v[144:147]
  s_add_u32 s70, s70, 131072
  ds_read_b64_tr_b16 a[70:71], v11 offset:2056
  v_mfma_f32_16x16x32_bf16 v[152:155], a[8:11], a[52:55], v[152:155]
  s_add_u32 m0, s72, 28672
  ds_read_b64_tr_b16 a[72:73], v12 offset:0
  v_mfma_f32_16x16x32_bf16 v[116:119], a[12:15], a[32:35], v[116:119]
  ds_read_b64_tr_b16 a[74:75], v12 offset:2048
  v_mfma_f32_16x16x32_bf16 v[124:127], a[12:15], a[36:39], v[124:127]
  ds_read_b64_tr_b16 a[76:77], v12 offset:8
  v_mfma_f32_16x16x32_bf16 v[132:135], a[12:15], a[40:43], v[132:135]
  ds_read_b64_tr_b16 a[78:79], v12 offset:2056
  v_mfma_f32_16x16x32_bf16 v[140:143], a[12:15], a[44:47], v[140:143]
  buffer_load_dwordx4 v4, s[8:11], s68 offen offset:0 nt lds
  v_mfma_f32_16x16x32_bf16 v[148:151], a[12:15], a[48:51], v[148:151]
  ds_read_b64_tr_b16 a[80:81], v13 offset:0
  v_mfma_f32_16x16x32_bf16 v[156:159], a[12:15], a[52:55], v[156:159]
  ds_read_b64_tr_b16 a[82:83], v13 offset:2048
  v_mfma_f32_16x16x32_bf16 v[160:163], a[16:19], a[32:35], v[160:163]
  ds_read_b64_tr_b16 a[84:85], v13 offset:8
  v_mfma_f32_16x16x32_bf16 v[168:171], a[16:19], a[36:39], v[168:171]
  ds_read_b64_tr_b16 a[86:87], v13 offset:2056
  v_mfma_f32_16x16x32_bf16 v[176:179], a[16:19], a[40:43], v[176:179]
  v_mfma_f32_16x16x32_bf16 v[184:187], a[16:19], a[44:47], v[184:187]
  buffer_load_dwordx4 v5, s[8:11], s68 offen offset:1024 nt lds
  v_mfma_f32_16x16x32_bf16 v[192:195], a[16:19], a[48:51], v[192:195]
  s_add_u32 s68, s68, 262144
  v_mfma_f32_16x16x32_bf16 v[200:203], a[16:19], a[52:55], v[200:203]
  v_mfma_f32_16x16x32_bf16 v[164:167], a[20:23], a[32:35], v[164:167]
  v_mfma_f32_16x16x32_bf16 v[172:175], a[20:23], a[36:39], v[172:175]
  v_mfma_f32_16x16x32_bf16 v[180:183], a[20:23], a[40:43], v[180:183]
  v_mfma_f32_16x16x32_bf16 v[188:191], a[20:23], a[44:47], v[188:191]
  buffer_load_dwordx4 v4, s[8:11], s69 offen offset:2048 nt lds
  v_mfma_f32_16x16x32_bf16 v[196:199], a[20:23], a[48:51], v[196:199]
  v_mfma_f32_16x16x32_bf16 v[204:207], a[20:23], a[52:55], v[204:207]
  v_mfma_f32_16x16x32_bf16 v[208:211], a[24:27], a[32:35], v[208:211]
  v_mfma_f32_16x16x32_bf16 v[216:219], a[24:27], a[36:39], v[216:219]
  v_mfma_f32_16x16x32_bf16 v[224:227], a[24:27], a[40:43], v[224:227]
  v_mfma_f32_16x16x32_bf16 v[232:235], a[24:27], a[44:47], v[232:235]
  buffer_load_dwordx4 v5, s[8:11], s69 offen offset:3072 nt lds
  v_mfma_f32_16x16x32_bf16 v[240:243], a[24:27], a[48:51], v[240:243]
  s_add_u32 s69, s69, 262144
  v_mfma_f32_16x16x32_bf16 v[248:251], a[24:27], a[52:55], v[248:251]
  v_mfma_f32_16x16x32_bf16 v[212:215], a[28:31], a[32:35], v[212:215]
  v_mfma_f32_16x16x32_bf16 v[220:223], a[28:31], a[36:39], v[220:223]
  v_mfma_f32_16x16x32_bf16 v[228:231], a[28:31], a[40:43], v[228:231]
  v_mfma_f32_16x16x32_bf16 v[236:239], a[28:31], a[44:47], v[236:239]
  v_mfma_f32_16x16x32_bf16 v[244:247], a[28:31], a[48:51], v[244:247]
  s_waitcnt vmcnt(20)
  s_waitcnt lgkmcnt(0)
  v_mfma_f32_16x16x32_bf16 v[252:255], a[28:31], a[52:55], v[252:255]
  s_barrier
  v_mfma_f32_16x16x32_bf16 v[64:67], a[56:59], a[88:91], v[64:67]
  s_add_u32 m0, s73, 28672
  ds_read_b128 a[32:35], v14 offset:28672
  v_mfma_f32_16x16x32_bf16 v[72:75], a[56:59], a[92:95], v[72:75]
  ds_read_b128 a[36:39], v14 offset:29696
  v_mfma_f32_16x16x32_bf16 v[80:83], a[56:59], a[96:99], v[80:83]
  ds_read_b128 a[40:43], v14 offset:30720
  v_mfma_f32_16x16x32_bf16 v[88:91], a[56:59], a[100:103], v[88:91]
  buffer_load_dwordx4 v16, s[12:15], s70 offen offset:0 sc1 lds
  v_mfma_f32_16x16x32_bf16 v[96:99], a[56:59], a[104:107], v[96:99]
  ds_read_b128 a[44:47], v14 offset:31744
  v_mfma_f32_16x16x32_bf16 v[104:107], a[56:59], a[108:111], v[104:107]
  ds_read_b128 a[48:51], v14 offset:32768
  v_mfma_f32_16x16x32_bf16 v[68:71], a[60:63], a[88:91], v[68:71]
  ds_read_b128 a[52:55], v14 offset:33792
  v_mfma_f32_16x16x32_bf16 v[76:79], a[60:63], a[92:95], v[76:79]
  ds_read_b64_tr_b16 a[0:1], v10 offset:28672
  v_mfma_f32_16x16x32_bf16 v[84:87], a[60:63], a[96:99], v[84:87]
  ds_read_b64_tr_b16 a[2:3], v10 offset:30720
  v_mfma_f32_16x16x32_bf16 v[92:95], a[60:63], a[100:103], v[92:95]
  buffer_load_dwordx4 v17, s[12:15], s70 offen offset:1024 sc1 lds
  v_mfma_f32_16x16x32_bf16 v[100:103], a[60:63], a[104:107], v[100:103]
  ds_read_b64_tr_b16 a[4:5], v10 offset:28680
  v_mfma_f32_16x16x32_bf16 v[108:111], a[60:63], a[108:111], v[108:111]
  ds_read_b64_tr_b16 a[6:7], v10 offset:30728
  v_mfma_f32_16x16x32_bf16 v[112:115], a[64:67], a[88:91], v[112:115]
  ds_read_b64_tr_b16 a[8:9], v11 offset:28672
  v_mfma_f32_16x16x32_bf16 v[120:123], a[64:67], a[92:95], v[120:123]
  ds_read_b64_tr_b16 a[10:11], v11 offset:30720
  v_mfma_f32_16x16x32_bf16 v[128:131], a[64:67], a[96:99], v[128:131]
  ds_read_b64_tr_b16 a[12:13], v11 offset:28680
  v_mfma_f32_16x16x32_bf16 v[136:139], a[64:67], a[100:103], v[136:139]
  buffer_load_dwordx4 v18, s[12:15], s70 offen offset:2048 sc1 lds
  v_mfma_f32_16x16x32_bf16 v[144:147], a[64:67], a[104:107], v[144:147]
  s_add_u32 s70, s70, 131072
  ds_read_b64_tr_b16 a[14:15], v11 offset:30728
  v_mfma_f32_16x16x32_bf16 v[152:155], a[64:67], a[108:111], v[152:155]
  s_add_u32 m0, s72, 57344
  ds_read_b64_tr_b16 a[16:17], v12 offset:28672
  v_mfma_f32_16x16x32_bf16 v[116:119], a[68:71], a[88:91], v[116:119]
  ds_read_b64_tr_b16 a[18:19], v12 offset:30720
  v_mfma_f32_16x16x32_bf16 v[124:127], a[68:71], a[92:95], v[124:127]
  ds_read_b64_tr_b16 a[20:21], v12 offset:28680
  v_mfma_f32_16x16x32_bf16 v[132:135], a[68:71], a[96:99], v[132:135]
  ds_read_b64_tr_b16 a[22:23], v12 offset:30728
  v_mfma_f32_16x16x32_bf16 v[140:143], a[68:71], a[100:103], v[140:143]
  buffer_load_dwordx4 v4, s[8:11], s68 offen offset:0 nt lds
  v_mfma_f32_16x16x32_bf16 v[148:151], a[68:71], a[104:107], v[148:151]
  ds_read_b64_tr_b16 a[24:25], v13 offset:28672
  v_mfma_f32_16x16x32_bf16 v[156:159], a[68:71], a[108:111], v[156:159]
  ds_read_b64_tr_b16 a[26:27], v13 offset:30720
  v_mfma_f32_16x16x32_bf16 v[160:163], a[72:75], a[88:91], v[160:163]
  ds_read_b64_tr_b16 a[28:29], v13 offset:28680
  v_mfma_f32_16x16x32_bf16 v[168:171], a[72:75], a[92:95], v[168:171]
  ds_read_b64_tr_b16 a[30:31], v13 offset:30728
  v_mfma_f32_16x16x32_bf16 v[176:179], a[72:75], a[96:99], v[176:179]
  v_add_u32 v10, 57344, v10
  v_mfma_f32_16x16x32_bf16 v[184:187], a[72:75], a[100:103], v[184:187]
  buffer_load_dwordx4 v5, s[8:11], s68 offen offset:1024 nt lds
  v_mfma_f32_16x16x32_bf16 v[192:195], a[72:75], a[104:107], v[192:195]
  s_add_u32 s68, s68, 262144
  v_add_u32 v11, 57344, v11
  v_mfma_f32_16x16x32_bf16 v[200:203], a[72:75], a[108:111], v[200:203]
  v_add_u32 v12, 57344, v12
  v_mfma_f32_16x16x32_bf16 v[164:167], a[76:79], a[88:91], v[164:167]
  v_add_u32 v13, 57344, v13
  v_mfma_f32_16x16x32_bf16 v[172:175], a[76:79], a[92:95], v[172:175]
  v_add_u32 v14, 57344, v14
  v_mfma_f32_16x16x32_bf16 v[180:183], a[76:79], a[96:99], v[180:183]
  v_mfma_f32_16x16x32_bf16 v[188:191], a[76:79], a[100:103], v[188:191]
  buffer_load_dwordx4 v4, s[8:11], s69 offen offset:2048 nt lds
  v_mfma_f32_16x16x32_bf16 v[196:199], a[76:79], a[104:107], v[196:199]
  v_mfma_f32_16x16x32_bf16 v[204:207], a[76:79], a[108:111], v[204:207]
  v_mfma_f32_16x16x32_bf16 v[208:211], a[80:83], a[88:91], v[208:211]
  v_mfma_f32_16x16x32_bf16 v[216:219], a[80:83], a[92:95], v[216:219]
  v_mfma_f32_16x16x32_bf16 v[224:227], a[80:83], a[96:99], v[224:227]
  v_mfma_f32_16x16x32_bf16 v[232:235], a[80:83], a[100:103], v[232:235]
  buffer_load_dwordx4 v5, s[8:11], s69 offen offset:3072 nt lds
  v_mfma_f32_16x16x32_bf16 v[240:243], a[80:83], a[104:107], v[240:243]
  s_add_u32 s69, s69, 262144
  v_mfma_f32_16x16x32_bf16 v[248:251], a[80:83], a[108:111], v[248:251]
  v_mfma_f32_16x16x32_bf16 v[212:215], a[84:87], a[88:91], v[212:215]
  v_mfma_f32_16x16x32_bf16 v[220:223], a[84:87], a[92:95], v[220:223]
  v_mfma_f32_16x16x32_bf16 v[228:231], a[84:87], a[96:99], v[228:231]
  v_mfma_f32_16x16x32_bf16 v[236:239], a[84:87], a[100:103], v[236:239]
  v_mfma_f32_16x16x32_bf16 v[244:247], a[84:87], a[104:107], v[244:247]
  s_waitcnt vmcnt(19)
  s_waitcnt lgkmcnt(0)
  v_mfma_f32_16x16x32_bf16 v[252:255], a[84:87], a[108:111], v[252:255]
  s_barrier
  v_mfma_f32_16x16x32_bf16 v[64:67], a[0:3], a[32:35], v[64:67]
  s_add_u32 m0, s73, 57344
  ds_read_b128 a[88:91], v14 offset:0
  v_mfma_f32_16x16x32_bf16 v[72:75], a[0:3], a[36:39], v[72:75]
  ds_read_b128 a[92:95], v14 offset:1024
  v_mfma_f32_16x16x32_bf16 v[80:83], a[0:3], a[40:43], v[80:83]
  ds_read_b128 a[96:99], v14 offset:2048
  v_mfma_f32_16x16x32_bf16 v[88:91], a[0:3], a[44:47], v[88:91]
  buffer_load_dwordx4 v16, s[12:15], s70 offen offset:0 sc1 lds
  v_mfma_f32_16x16x32_bf16 v[96:99], a[0:3], a[48:51], v[96:99]
  ds_read_b128 a[100:103], v14 offset:3072
  v_mfma_f32_16x16x32_bf16 v[104:107], a[0:3], a[52:55], v[104:107]
  ds_read_b128 a[104:107], v14 offset:4096
  v_mfma_f32_16x16x32_bf16 v[68:71], a[4:7], a[32:35], v[68:71]
  ds_read_b128 a[108:111], v14 offset:5120
  v_mfma_f32_16x16x32_bf16 v[76:79], a[4:7], a[36:39], v[76:79]
  ds_read_b64_tr_b16 a[56:57], v10 offset:0
  v_mfma_f32_16x16x32_bf16 v[84:87], a[4:7], a[40:43], v[84:87]
  ds_read_b64_tr_b16 a[58:59], v10 offset:2048
  v_mfma_f32_16x16x32_bf16 v[92:95], a[4:7], a[44:47], v[92:95]
  buffer_load_dwordx4 v17, s[12:15], s70 offen offset:1024 sc1 lds
  v_mfma_f32_16x16x32_bf16 v[100:103], a[4:7], a[48:51], v[100:103]
  ds_read_b64_tr_b16 a[60:61], v10 offset:8
  v_mfma_f32_16x16x32_bf16 v[108:111], a[4:7], a[52:55], v[108:111]
  ds_read_b64_tr_b16 a[62:63], v10 offset:2056
  v_mfma_f32_16x16x32_bf16 v[112:115], a[8:11], a[32:35], v[112:115]
  ds_read_b64_tr_b16 a[64:65], v11 offset:0
  v_mfma_f32_16x16x32_bf16 v[120:123], a[8:11], a[36:39], v[120:123]
  ds_read_b64_tr_b16 a[66:67], v11 offset:2048
  v_mfma_f32_16x16x32_bf16 v[128:131], a[8:11], a[40:43], v[128:131]
  ds_read_b64_tr_b16 a[68:69], v11 offset:8
  v_mfma_f32_16x16x32_bf16 v[136:139], a[8:11], a[44:47], v[136:139]
  buffer_load_dwordx4 v18, s[12:15], s70 offen offset:2048 sc1 lds
  v_mfma_f32_16x16x32_bf16 v[144:147], a[8:11], a[48:51], v[144:147]
  s_add_u32 s70, s70, 131072
  ds_read_b64_tr_b16 a[70:71], v11 offset:2056
  v_mfma_f32_16x16x32_bf16 v[152:155], a[8:11], a[52:55], v[152:155]
  s_add_u32 m0, s72, 86016
  ds_read_b64_tr_b16 a[72:73], v12 offset:0
  v_mfma_f32_16x16x32_bf16 v[116:119], a[12:15], a[32:35], v[116:119]
  ds_read_b64_tr_b16 a[74:75], v12 offset:2048
  v_mfma_f32_16x16x32_bf16 v[124:127], a[12:15], a[36:39], v[124:127]
  ds_read_b64_tr_b16 a[76:77], v12 offset:8
  v_mfma_f32_16x16x32_bf16 v[132:135], a[12:15], a[40:43], v[132:135]
  ds_read_b64_tr_b16 a[78:79], v12 offset:2056
  v_mfma_f32_16x16x32_bf16 v[140:143], a[12:15], a[44:47], v[140:143]
  buffer_load_dwordx4 v4, s[8:11], s68 offen offset:0 nt lds
  v_mfma_f32_16x16x32_bf16 v[148:151], a[12:15], a[48:51], v[148:151]
  ds_read_b64_tr_b16 a[80:81], v13 offset:0
  v_mfma_f32_16x16x32_bf16 v[156:159], a[12:15], a[52:55], v[156:159]
  ds_read_b64_tr_b16 a[82:83], v13 offset:2048
  v_mfma_f32_16x16x32_bf16 v[160:163], a[16:19], a[32:35], v[160:163]
  ds_read_b64_tr_b16 a[84:85], v13 offset:8
  v_mfma_f32_16x16x32_bf16 v[168:171], a[16:19], a[36:39], v[168:171]
  ds_read_b64_tr_b16 a[86:87], v13 offset:2056
  v_mfma_f32_16x16x32_bf16 v[176:179], a[16:19], a[40:43], v[176:179]
  v_add_u32 v10, 4294852608, v10
  v_mfma_f32_16x16x32_bf16 v[184:187], a[16:19], a[44:47], v[184:187]
  buffer_load_dwordx4 v5, s[8:11], s68 offen offset:1024 nt lds
  v_mfma_f32_16x16x32_bf16 v[192:195], a[16:19], a[48:51], v[192:195]
  s_add_u32 s68, s68, 262144
  v_add_u32 v11, 4294852608, v11
  v_mfma_f32_16x16x32_bf16 v[200:203], a[16:19], a[52:55], v[200:203]
  v_add_u32 v12, 4294852608, v12
  v_mfma_f32_16x16x32_bf16 v[164:167], a[20:23], a[32:35], v[164:167]
  v_add_u32 v13, 4294852608, v13
  v_mfma_f32_16x16x32_bf16 v[172:175], a[20:23], a[36:39], v[172:175]
  v_add_u32 v14, 4294852608, v14
  v_mfma_f32_16x16x32_bf16 v[180:183], a[20:23], a[40:43], v[180:183]
  v_mfma_f32_16x16x32_bf16 v[188:191], a[20:23], a[44:47], v[188:191]
  buffer_load_dwordx4 v4, s[8:11], s69 offen offset:2048 nt lds
  v_mfma_f32_16x16x32_bf16 v[196:199], a[20:23], a[48:51], v[196:199]
  v_mfma_f32_16x16x32_bf16 v[204:207], a[20:23], a[52:55], v[204:207]
  v_mfma_f32_16x16x32_bf16 v[208:211], a[24:27], a[32:35], v[208:211]
  v_mfma_f32_16x16x32_bf16 v[216:219], a[24:27], a[36:39], v[216:219]
  v_mfma_f32_16x16x32_bf16 v[224:227], a[24:27], a[40:43], v[224:227]
  v_mfma_f32_16x16x32_bf16 v[232:235], a[24:27], a[44:47], v[232:235]
  buffer_load_dwordx4 v5, s[8:11], s69 offen offset:3072 nt lds
  v_mfma_f32_16x16x32_bf16 v[240:243], a[24:27], a[48:51], v[240:243]
  s_add_u32 s69, s69, 262144
  v_mfma_f32_16x16x32_bf16 v[248:251], a[24:27], a[52:55], v[248:251]
  v_mfma_f32_16x16x32_bf16 v[212:215], a[28:31], a[32:35], v[212:215]
  v_mfma_f32_16x16x32_bf16 v[220:223], a[28:31], a[36:39], v[220:223]
  v_mfma_f32_16x16x32_bf16 v[228:231], a[28:31], a[40:43], v[228:231]
  v_mfma_f32_16x16x32_bf16 v[236:239], a[28:31], a[44:47], v[236:239]
  v_mfma_f32_16x16x32_bf16 v[244:247], a[28:31], a[48:51], v[244:247]
  s_waitcnt vmcnt(18)
  s_waitcnt lgkmcnt(0)
  v_mfma_f32_16x16x32_bf16 v[252:255], a[28:31], a[52:55], v[252:255]
  s_barrier
  v_mfma_f32_16x16x32_bf16 v[64:67], a[56:59], a[88:91], v[64:67]
  s_add_u32 m0, s73, 86016
  ds_read_b128 a[32:35], v14 offset:0
  v_mfma_f32_16x16x32_bf16 v[72:75], a[56:59], a[92:95], v[72:75]
  ds_read_b128 a[36:39], v14 offset:1024
  v_mfma_f32_16x16x32_bf16 v[80:83], a[56:59], a[96:99], v[80:83]
  ds_read_b128 a[40:43], v14 offset:2048
  v_mfma_f32_16x16x32_bf16 v[88:91], a[56:59], a[100:103], v[88:91]
  buffer_load_dwordx4 v16, s[12:15], s70 offen offset:0 sc1 lds
  v_mfma_f32_16x16x32_bf16 v[96:99], a[56:59], a[104:107], v[96:99]
  ds_read_b128 a[44:47], v14 offset:3072
  v_mfma_f32_16x16x32_bf16 v[104:107], a[56:59], a[108:111], v[104:107]
  ds_read_b128 a[48:51], v14 offset:4096
  v_mfma_f32_16x16x32_bf16 v[68:71], a[60:63], a[88:91], v[68:71]
  ds_read_b128 a[52:55], v14 offset:5120
  v_mfma_f32_16x16x32_bf16 v[76:79], a[60:63], a[92:95], v[76:79]
  ds_read_b64_tr_b16 a[0:1], v10 offset:0
  v_mfma_f32_16x16x32_bf16 v[84:87], a[60:63], a[96:99], v[84:87]
  ds_read_b64_tr_b16 a[2:3], v10 offset:2048
  v_mfma_f32_16x16x32_bf16 v[92:95], a[60:63], a[100:103], v[92:95]
  buffer_load_dwordx4 v17, s[12:15], s70 offen offset:1024 sc1 lds
  v_mfma_f32_16x16x32_bf16 v[100:103], a[60:63], a[104:107], v[100:103]
  ds_read_b64_tr_b16 a[4:5], v10 offset:8
  v_mfma_f32_16x16x32_bf16 v[108:111], a[60:63], a[108:111], v[108:111]
  ds_read_b64_tr_b16 a[6:7], v10 offset:2056
  v_mfma_f32_16x16x32_bf16 v[112:115], a[64:67], a[88:91], v[112:115]
  ds_read_b64_tr_b16 a[8:9], v11 offset:0
  v_mfma_f32_16x16x32_bf16 v[120:123], a[64:67], a[92:95], v[120:123]
  ds_read_b64_tr_b16 a[10:11], v11 offset:2048
  v_mfma_f32_16x16x32_bf16 v[128:131], a[64:67], a[96:99], v[128:131]
  ds_read_b64_tr_b16 a[12:13], v11 offset:8
  v_mfma_f32_16x16x32_bf16 v[136:139], a[64:67], a[100:103], v[136:139]
  buffer_load_dwordx4 v18, s[12:15], s70 offen offset:2048 sc1 lds
  v_mfma_f32_16x16x32_bf16 v[144:147], a[64:67], a[104:107], v[144:147]
  s_add_u32 s70, s70, 131072
  ds_read_b64_tr_b16 a[14:15], v11 offset:2056
  v_mfma_f32_16x16x32_bf16 v[152:155], a[64:67], a[108:111], v[152:155]
  s_add_u32 m0, s72, 114688
  ds_read_b64_tr_b16 a[16:17], v12 offset:0
  v_mfma_f32_16x16x32_bf16 v[116:119], a[68:71], a[88:91], v[116:119]
  ds_read_b64_tr_b16 a[18:19], v12 offset:2048
  v_mfma_f32_16x16x32_bf16 v[124:127], a[68:71], a[92:95], v[124:127]
  ds_read_b64_tr_b16 a[20:21], v12 offset:8
  v_mfma_f32_16x16x32_bf16 v[132:135], a[68:71], a[96:99], v[132:135]
  ds_read_b64_tr_b16 a[22:23], v12 offset:2056
  v_mfma_f32_16x16x32_bf16 v[140:143], a[68:71], a[100:103], v[140:143]
  buffer_load_dwordx4 v4, s[8:11], s68 offen offset:0 nt lds
  v_mfma_f32_16x16x32_bf16 v[148:151], a[68:71], a[104:107], v[148:151]
  ds_read_b64_tr_b16 a[24:25], v13 offset:0
  v_mfma_f32_16x16x32_bf16 v[156:159], a[68:71], a[108:111], v[156:159]
  ds_read_b64_tr_b16 a[26:27], v13 offset:2048
  v_mfma_f32_16x16x32_bf16 v[160:163], a[72:75], a[88:91], v[160:163]
  ds_read_b64_tr_b16 a[28:29], v13 offset:8
  v_mfma_f32_16x16x32_bf16 v[168:171], a[72:75], a[92:95], v[168:171]
  ds_read_b64_tr_b16 a[30:31], v13 offset:2056
  v_mfma_f32_16x16x32_bf16 v[176:179], a[72:75], a[96:99], v[176:179]
  v_mfma_f32_16x16x32_bf16 v[184:187], a[72:75], a[100:103], v[184:187]
  buffer_load_dwordx4 v5, s[8:11], s68 offen offset:1024 nt lds
  v_mfma_f32_16x16x32_bf16 v[192:195], a[72:75], a[104:107], v[192:195]
  s_add_u32 s68, s68, 262144
  v_mfma_f32_16x16x32_bf16 v[200:203], a[72:75], a[108:111], v[200:203]
  v_mfma_f32_16x16x32_bf16 v[164:167], a[76:79], a[88:91], v[164:167]
  v_mfma_f32_16x16x32_bf16 v[172:175], a[76:79], a[92:95], v[172:175]
  v_mfma_f32_16x16x32_bf16 v[180:183], a[76:79], a[96:99], v[180:183]
  v_mfma_f32_16x16x32_bf16 v[188:191], a[76:79], a[100:103], v[188:191]
  buffer_load_dwordx4 v4, s[8:11], s69 offen offset:2048 nt lds
  v_mfma_f32_16x16x32_bf16 v[196:199], a[76:79], a[104:107], v[196:199]
  v_mfma_f32_16x16x32_bf16 v[204:207], a[76:79], a[108:111], v[204:207]
  v_mfma_f32_16x16x32_bf16 v[208:211], a[80:83], a[88:91], v[208:211]
  v_mfma_f32_16x16x32_bf16 v[216:219], a[80:83], a[92:95], v[216:219]
  v_mfma_f32_16x16x32_bf16 v[224:227], a[80:83], a[96:99], v[224:227]
  v_mfma_f32_16x16x32_bf16 v[232:235], a[80:83], a[100:103], v[232:235]
  buffer_load_dwordx4 v5, s[8:11], s69 offen offset:3072 nt lds
  v_mfma_f32_16x16x32_bf16 v[240:243], a[80:83], a[104:107], v[240:243]
  s_add_u32 s69, s69, 262144
  v_mfma_f32_16x16x32_bf16 v[248:251], a[80:83], a[108:111], v[248:251]
  v_mfma_f32_16x16x32_bf16 v[212:215], a[84:87], a[88:91], v[212:215]
  v_mfma_f32_16x16x32_bf16 v[220:223], a[84:87], a[92:95], v[220:223]
  v_mfma_f32_16x16x32_bf16 v[228:231], a[84:87], a[96:99], v[228:231]
  v_mfma_f32_16x16x32_bf16 v[236:239], a[84:87], a[100:103], v[236:239]
  v_mfma_f32_16x16x32_bf16 v[244:247], a[84:87], a[104:107], v[244:247]
  s_waitcnt vmcnt(18)
  s_waitcnt lgkmcnt(0)
  v_mfma_f32_16x16x32_bf16 v[252:255], a[84:87], a[108:111], v[252:255]
  s_barrier
  v_mfma_f32_16x16x32_bf16 v[64:67], a[0:3], a[32:35], v[64:67]
  s_add_u32 m0, s73, 114688
  ds_read_b128 a[88:91], v14 offset:28672
  v_mfma_f32_16x16x32_bf16 v[72:75], a[0:3], a[36:39], v[72:75]
  ds_read_b128 a[92:95], v14 offset:29696
  v_mfma_f32_16x16x32_bf16 v[80:83], a[0:3], a[40:43], v[80:83]
  ds_read_b128 a[96:99], v14 offset:30720
  v_mfma_f32_16x16x32_bf16 v[88:91], a[0:3], a[44:47], v[88:91]
  buffer_load_dwordx4 v16, s[12:15], s70 offen offset:0 sc1 lds
  v_mfma_f32_16x16x32_bf16 v[96:99], a[0:3], a[48:51], v[96:99]
  ds_read_b128 a[100:103], v14 offset:31744
  v_mfma_f32_16x16x32_bf16 v[104:107], a[0:3], a[52:55], v[104:107]
  ds_read_b128 a[104:107], v14 offset:32768
  v_mfma_f32_16x16x32_bf16 v[68:71], a[4:7], a[32:35], v[68:71]
  ds_read_b128 a[108:111], v14 offset:33792
  v_mfma_f32_16x16x32_bf16 v[76:79], a[4:7], a[36:39], v[76:79]
  ds_read_b64_tr_b16 a[56:57], v10 offset:28672
  v_mfma_f32_16x16x32_bf16 v[84:87], a[4:7], a[40:43], v[84:87]
  ds_read_b64_tr_b16 a[58:59], v10 offset:30720
  v_mfma_f32_16x16x32_bf16 v[92:95], a[4:7], a[44:47], v[92:95]
  buffer_load_dwordx4 v17, s[12:15], s70 offen offset:1024 sc1 lds
  v_mfma_f32_16x16x32_bf16 v[100:103], a[4:7], a[48:51], v[100:103]
  ds_read_b64_tr_b16 a[60:61], v10 offset:28680
  v_mfma_f32_16x16x32_bf16 v[108:111], a[4:7], a[52:55], v[108:111]
  ds_read_b64_tr_b16 a[62:63], v10 offset:30728
  v_mfma_f32_16x16x32_bf16 v[112:115], a[8:11], a[32:35], v[112:115]
  ds_read_b64_tr_b16 a[64:65], v11 offset:28672
  v_mfma_f32_16x16x32_bf16 v[120:123], a[8:11], a[36:39], v[120:123]
  ds_read_b64_tr_b16 a[66:67], v11 offset:30720
  v_mfma_f32_16x16x32_bf16 v[128:131], a[8:11], a[40:43], v[128:131]
  ds_read_b64_tr_b16 a[68:69], v11 offset:28680
  v_mfma_f32_16x16x32_bf16 v[136:139], a[8:11], a[44:47], v[136:139]
  buffer_load_dwordx4 v18, s[12:15], s70 offen offset:2048 sc1 lds
  v_mfma_f32_16x16x32_bf16 v[144:147], a[8:11], a[48:51], v[144:147]
  s_add_u32 s70, s70, 131072
  ds_read_b64_tr_b16 a[70:71], v11 offset:30728
  v_mfma_f32_16x16x32_bf16 v[152:155], a[8:11], a[52:55], v[152:155]
  s_add_u32 m0, s72, 0
  ds_read_b64_tr_b16 a[72:73], v12 offset:28672
  v_mfma_f32_16x16x32_bf16 v[116:119], a[12:15], a[32:35], v[116:119]
  ds_read_b64_tr_b16 a[74:75], v12 offset:30720
  v_mfma_f32_16x16x32_bf16 v[124:127], a[12:15], a[36:39], v[124:127]
  ds_read_b64_tr_b16 a[76:77], v12 offset:28680
  v_mfma_f32_16x16x32_bf16 v[132:135], a[12:15], a[40:43], v[132:135]
  ds_read_b64_tr_b16 a[78:79], v12 offset:30728
  v_mfma_f32_16x16x32_bf16 v[140:143], a[12:15], a[44:47], v[140:143]
  buffer_load_dwordx4 v4, s[8:11], s68 offen offset:0 nt lds
  v_mfma_f32_16x16x32_bf16 v[148:151], a[12:15], a[48:51], v[148:151]
  ds_read_b64_tr_b16 a[80:81], v13 offset:28672
  v_mfma_f32_16x16x32_bf16 v[156:159], a[12:15], a[52:55], v[156:159]
  ds_read_b64_tr_b16 a[82:83], v13 offset:30720
  v_mfma_f32_16x16x32_bf16 v[160:163], a[16:19], a[32:35], v[160:163]
  ds_read_b64_tr_b16 a[84:85], v13 offset:28680
  v_mfma_f32_16x16x32_bf16 v[168:171], a[16:19], a[36:39], v[168:171]
  ds_read_b64_tr_b16 a[86:87], v13 offset:30728
  v_mfma_f32_16x16x32_bf16 v[176:179], a[16:19], a[40:43], v[176:179]
  v_add_u32 v10, 57344, v10
  v_mfma_f32_16x16x32_bf16 v[184:187], a[16:19], a[44:47], v[184:187]
  buffer_load_dwordx4 v5, s[8:11], s68 offen offset:1024 nt lds
  v_mfma_f32_16x16x32_bf16 v[192:195], a[16:19], a[48:51], v[192:195]
  s_add_u32 s68, s68, 262144
  v_add_u32 v11, 57344, v11
  v_mfma_f32_16x16x32_bf16 v[200:203], a[16:19], a[52:55], v[200:203]
  v_add_u32 v12, 57344, v12
  v_mfma_f32_16x16x32_bf16 v[164:167], a[20:23], a[32:35], v[164:167]
  v_add_u32 v13, 57344, v13
  v_mfma_f32_16x16x32_bf16 v[172:175], a[20:23], a[36:39], v[172:175]
  v_add_u32 v14, 57344, v14
  v_mfma_f32_16x16x32_bf16 v[180:183], a[20:23], a[40:43], v[180:183]
  v_mfma_f32_16x16x32_bf16 v[188:191], a[20:23], a[44:47], v[188:191]
  buffer_load_dwordx4 v4, s[8:11], s69 offen offset:2048 nt lds
  v_mfma_f32_16x16x32_bf16 v[196:199], a[20:23], a[48:51], v[196:199]
  v_mfma_f32_16x16x32_bf16 v[204:207], a[20:23], a[52:55], v[204:207]
  v_mfma_f32_16x16x32_bf16 v[208:211], a[24:27], a[32:35], v[208:211]
  v_mfma_f32_16x16x32_bf16 v[216:219], a[24:27], a[36:39], v[216:219]
  v_mfma_f32_16x16x32_bf16 v[224:227], a[24:27], a[40:43], v[224:227]
  v_mfma_f32_16x16x32_bf16 v[232:235], a[24:27], a[44:47], v[232:235]
  buffer_load_dwordx4 v5, s[8:11], s69 offen offset:3072 nt lds
  v_mfma_f32_16x16x32_bf16 v[240:243], a[24:27], a[48:51], v[240:243]
  s_add_u32 s69, s69, 262144
  v_mfma_f32_16x16x32_bf16 v[248:251], a[24:27], a[52:55], v[248:251]
  v_mfma_f32_16x16x32_bf16 v[212:215], a[28:31], a[32:35], v[212:215]
  v_mfma_f32_16x16x32_bf16 v[220:223], a[28:31], a[36:39], v[220:223]
  v_mfma_f32_16x16x32_bf16 v[228:231], a[28:31], a[40:43], v[228:231]
  v_mfma_f32_16x16x32_bf16 v[236:239], a[28:31], a[44:47], v[236:239]
  v_mfma_f32_16x16x32_bf16 v[244:247], a[28:31], a[48:51], v[244:247]
  s_waitcnt vmcnt(18)
  s_waitcnt lgkmcnt(0)
  v_mfma_f32_16x16x32_bf16 v[252:255], a[28:31], a[52:55], v[252:255]
  s_barrier
  v_mfma_f32_16x16x32_bf16 v[64:67], a[56:59], a[88:91], v[64:67]
  s_add_u32 m0, s73, 0
  ds_read_b128 a[32:35], v14 offset:0
  v_mfma_f32_16x16x32_bf16 v[72:75], a[56:59], a[92:95], v[72:75]
  ds_read_b128 a[36:39], v14 offset:1024
  v_mfma_f32_16x16x32_bf16 v[80:83], a[56:59], a[96:99], v[80:83]
  ds_read_b128 a[40:43], v14 offset:2048
  v_mfma_f32_16x16x32_bf16 v[88:91], a[56:59], a[100:103], v[88:91]
  buffer_load_dwordx4 v16, s[12:15], s70 offen offset:0 sc1 lds
  v_mfma_f32_16x16x32_bf16 v[96:99], a[56:59], a[104:107], v[96:99]
  ds_read_b128 a[44:47], v14 offset:3072
  v_mfma_f32_16x16x32_bf16 v[104:107], a[56:59], a[108:111], v[104:107]
  ds_read_b128 a[48:51], v14 offset:4096
  v_mfma_f32_16x16x32_bf16 v[68:71], a[60:63], a[88:91], v[68:71]
  ds_read_b128 a[52:55], v14 offset:5120
  v_mfma_f32_16x16x32_bf16 v[76:79], a[60:63], a[92:95], v[76:79]
  ds_read_b64_tr_b16 a[0:1], v10 offset:0
  v_mfma_f32_16x16x32_bf16 v[84:87], a[60:63], a[96:99], v[84:87]
  ds_read_b64_tr_b16 a[2:3], v10 offset:2048
  v_mfma_f32_16x16x32_bf16 v[92:95], a[60:63], a[100:103], v[92:95]
  buffer_load_dwordx4 v17, s[12:15], s70 offen offset:1024 sc1 lds
  v_mfma_f32_16x16x32_bf16 v[100:103], a[60:63], a[104:107], v[100:103]
  ds_read_b64_tr_b16 a[4:5], v10 offset:8
  v_mfma_f32_16x16x32_bf16 v[108:111], a[60:63], a[108:111], v[108:111]
  ds_read_b64_tr_b16 a[6:7], v10 offset:2056
  v_mfma_f32_16x16x32_bf16 v[112:115], a[64:67], a[88:91], v[112:115]
  ds_read_b64_tr_b16 a[8:9], v11 offset:0
  v_mfma_f32_16x16x32_bf16 v[120:123], a[64:67], a[92:95], v[120:123]
  ds_read_b64_tr_b16 a[10:11], v11 offset:2048
  v_mfma_f32_16x16x32_bf16 v[128:131], a[64:67], a[96:99], v[128:131]
  ds_read_b64_tr_b16 a[12:13], v11 offset:8
  v_mfma_f32_16x16x32_bf16 v[136:139], a[64:67], a[100:103], v[136:139]
  buffer_load_dwordx4 v18, s[12:15], s70 offen offset:2048 sc1 lds
  v_mfma_f32_16x16x32_bf16 v[144:147], a[64:67], a[104:107], v[144:147]
  s_add_u32 s70, s70, 131072
  ds_read_b64_tr_b16 a[14:15], v11 offset:2056
  v_mfma_f32_16x16x32_bf16 v[152:155], a[64:67], a[108:111], v[152:155]
  s_add_u32 m0, s72, 28672
  ds_read_b64_tr_b16 a[16:17], v12 offset:0
  v_mfma_f32_16x16x32_bf16 v[116:119], a[68:71], a[88:91], v[116:119]
  ds_read_b64_tr_b16 a[18:19], v12 offset:2048
  v_mfma_f32_16x16x32_bf16 v[124:127], a[68:71], a[92:95], v[124:127]
  ds_read_b64_tr_b16 a[20:21], v12 offset:8
  v_mfma_f32_16x16x32_bf16 v[132:135], a[68:71], a[96:99], v[132:135]
  ds_read_b64_tr_b16 a[22:23], v12 offset:2056
  v_mfma_f32_16x16x32_bf16 v[140:143], a[68:71], a[100:103], v[140:143]
  buffer_load_dwordx4 v4, s[8:11], s68 offen offset:0 nt lds
  v_mfma_f32_16x16x32_bf16 v[148:151], a[68:71], a[104:107], v[148:151]
  ds_read_b64_tr_b16 a[24:25], v13 offset:0
  v_mfma_f32_16x16x32_bf16 v[156:159], a[68:71], a[108:111], v[156:159]
  ds_read_b64_tr_b16 a[26:27], v13 offset:2048
  v_mfma_f32_16x16x32_bf16 v[160:163], a[72:75], a[88:91], v[160:163]
  ds_read_b64_tr_b16 a[28:29], v13 offset:8
  v_mfma_f32_16x16x32_bf16 v[168:171], a[72:75], a[92:95], v[168:171]
  ds_read_b64_tr_b16 a[30:31], v13 offset:2056
  v_mfma_f32_16x16x32_bf16 v[176:179], a[72:75], a[96:99], v[176:179]
  v_mfma_f32_16x16x32_bf16 v[184:187], a[72:75], a[100:103], v[184:187]
  buffer_load_dwordx4 v5, s[8:11], s68 offen offset:1024 nt lds
  v_mfma_f32_16x16x32_bf16 v[192:195], a[72:75], a[104:107], v[192:195]
  s_add_u32 s68, s68, 262144
  v_mfma_f32_16x16x32_bf16 v[200:203], a[72:75], a[108:111], v[200:203]
  v_mfma_f32_16x16x32_bf16 v[164:167], a[76:79], a[88:91], v[164:167]
  v_mfma_f32_16x16x32_bf16 v[172:175], a[76:79], a[92:95], v[172:175]
  v_mfma_f32_16x16x32_bf16 v[180:183], a[76:79], a[96:99], v[180:183]
  v_mfma_f32_16x16x32_bf16 v[188:191], a[76:79], a[100:103], v[188:191]
  buffer_load_dwordx4 v4, s[8:11], s69 offen offset:2048 nt lds
  v_mfma_f32_16x16x32_bf16 v[196:199], a[76:79], a[104:107], v[196:199]
  v_mfma_f32_16x16x32_bf16 v[204:207], a[76:79], a[108:111], v[204:207]
  v_mfma_f32_16x16x32_bf16 v[208:211], a[80:83], a[88:91], v[208:211]
  v_mfma_f32_16x16x32_bf16 v[216:219], a[80:83], a[92:95], v[216:219]
  v_mfma_f32_16x16x32_bf16 v[224:227], a[80:83], a[96:99], v[224:227]
  v_mfma_f32_16x16x32_bf16 v[232:235], a[80:83], a[100:103], v[232:235]
  buffer_load_dwordx4 v5, s[8:11], s69 offen offset:3072 nt lds
  v_mfma_f32_16x16x32_bf16 v[240:243], a[80:83], a[104:107], v[240:243]
  s_add_u32 s69, s69, 262144
  v_mfma_f32_16x16x32_bf16 v[248:251], a[80:83], a[108:111], v[248:251]
  v_mfma_f32_16x16x32_bf16 v[212:215], a[84:87], a[88:91], v[212:215]
  v_mfma_f32_16x16x32_bf16 v[220:223], a[84:87], a[92:95], v[220:223]
  v_mfma_f32_16x16x32_bf16 v[228:231], a[84:87], a[96:99], v[228:231]
  v_mfma_f32_16x16x32_bf16 v[236:239], a[84:87], a[100:103], v[236:239]
  v_mfma_f32_16x16x32_bf16 v[244:247], a[84:87], a[104:107], v[244:247]
  s_waitcnt vmcnt(18)
  s_waitcnt lgkmcnt(0)
  v_mfma_f32_16x16x32_bf16 v[252:255], a[84:87], a[108:111], v[252:255]
  s_barrier
  v_mfma_f32_16x16x32_bf16 v[64:67], a[0:3], a[32:35], v[64:67]
  s_add_u32 m0, s73, 28672
  ds_read_b128 a[88:91], v14 offset:28672
  v_mfma_f32_16x16x32_bf16 v[72:75], a[0:3], a[36:39], v[72:75]
  ds_read_b128 a[92:95], v14 offset:29696
  v_mfma_f32_16x16x32_bf16 v[80:83], a[0:3], a[40:43], v[80:83]
  ds_read_b128 a[96:99], v14 offset:30720
  v_mfma_f32_16x16x32_bf16 v[88:91], a[0:3], a[44:47], v[88:91]
  buffer_load_dwordx4 v16, s[12:15], s70 offen offset:0 sc1 lds
  v_mfma_f32_16x16x32_bf16 v[96:99], a[0:3], a[48:51], v[96:99]
  ds_read_b128 a[100:103], v14 offset:31744
  v_mfma_f32_16x16x32_bf16 v[104:107], a[0:3], a[52:55], v[104:107]
  ds_read_b128 a[104:107], v14 offset:32768
  v_mfma_f32_16x16x32_bf16 v[68:71], a[4:7], a[32:35], v[68:71]
  ds_read_b128 a[108:111], v14 offset:33792
  v_mfma_f32_16x16x32_bf16 v[76:79], a[4:7], a[36:39], v[76:79]
  ds_read_b64_tr_b16 a[56:57], v10 offset:28672
  v_mfma_f32_16x16x32_bf16 v[84:87], a[4:7], a[40:43], v[84:87]
  ds_read_b64_tr_b16 a[58:59], v10 offset:30720
  v_mfma_f32_16x16x32_bf16 v[92:95], a[4:7], a[44:47], v[92:95]
  buffer_load_dwordx4 v17, s[12:15], s70 offen offset:1024 sc1 lds
  v_mfma_f32_16x16x32_bf16 v[100:103], a[4:7], a[48:51], v[100:103]
  ds_read_b64_tr_b16 a[60:61], v10 offset:28680
  v_mfma_f32_16x16x32_bf16 v[108:111], a[4:7], a[52:55], v[108:111]
  ds_read_b64_tr_b16 a[62:63], v10 offset:30728
  v_mfma_f32_16x16x32_bf16 v[112:115], a[8:11], a[32:35], v[112:115]
  ds_read_b64_tr_b16 a[64:65], v11 offset:28672
  v_mfma_f32_16x16x32_bf16 v[120:123], a[8:11], a[36:39], v[120:123]
  ds_read_b64_tr_b16 a[66:67], v11 offset:30720
  v_mfma_f32_16x16x32_bf16 v[128:131], a[8:11], a[40:43], v[128:131]
  ds_read_b64_tr_b16 a[68:69], v11 offset:28680
  v_mfma_f32_16x16x32_bf16 v[136:139], a[8:11], a[44:47], v[136:139]
  buffer_load_dwordx4 v18, s[12:15], s70 offen offset:2048 sc1 lds
  v_mfma_f32_16x16x32_bf16 v[144:147], a[8:11], a[48:51], v[144:147]
  s_add_u32 s70, s70, 131072
  ds_read_b64_tr_b16 a[70:71], v11 offset:30728
  v_mfma_f32_16x16x32_bf16 v[152:155], a[8:11], a[52:55], v[152:155]
  s_add_u32 m0, s72, 57344
  ds_read_b64_tr_b16 a[72:73], v12 offset:28672
  v_mfma_f32_16x16x32_bf16 v[116:119], a[12:15], a[32:35], v[116:119]
  ds_read_b64_tr_b16 a[74:75], v12 offset:30720
  v_mfma_f32_16x16x32_bf16 v[124:127], a[12:15], a[36:39], v[124:127]
  ds_read_b64_tr_b16 a[76:77], v12 offset:28680
  v_mfma_f32_16x16x32_bf16 v[132:135], a[12:15], a[40:43], v[132:135]
  ds_read_b64_tr_b16 a[78:79], v12 offset:30728
  v_mfma_f32_16x16x32_bf16 v[140:143], a[12:15], a[44:47], v[140:143]
  buffer_load_dwordx4 v4, s[8:11], s68 offen offset:0 nt lds
  v_mfma_f32_16x16x32_bf16 v[148:151], a[12:15], a[48:51], v[148:151]
  ds_read_b64_tr_b16 a[80:81], v13 offset:28672
  v_mfma_f32_16x16x32_bf16 v[156:159], a[12:15], a[52:55], v[156:159]
  ds_read_b64_tr_b16 a[82:83], v13 offset:30720
  v_mfma_f32_16x16x32_bf16 v[160:163], a[16:19], a[32:35], v[160:163]
  ds_read_b64_tr_b16 a[84:85], v13 offset:28680
  v_mfma_f32_16x16x32_bf16 v[168:171], a[16:19], a[36:39], v[168:171]
  ds_read_b64_tr_b16 a[86:87], v13 offset:30728
  v_mfma_f32_16x16x32_bf16 v[176:179], a[16:19], a[40:43], v[176:179]
  v_add_u32 v10, 57344, v10
  v_mfma_f32_16x16x32_bf16 v[184:187], a[16:19], a[44:47], v[184:187]
  buffer_load_dwordx4 v5, s[8:11], s68 offen offset:1024 nt lds
  v_mfma_f32_16x16x32_bf16 v[192:195], a[16:19], a[48:51], v[192:195]
  s_add_u32 s68, s68, 262144
  v_add_u32 v11, 57344, v11
  v_mfma_f32_16x16x32_bf16 v[200:203], a[16:19], a[52:55], v[200:203]
  v_add_u32 v12, 57344, v12
  v_mfma_f32_16x16x32_bf16 v[164:167], a[20:23], a[32:35], v[164:167]
  v_add_u32 v13, 57344, v13
  v_mfma_f32_16x16x32_bf16 v[172:175], a[20:23], a[36:39], v[172:175]
  v_add_u32 v14, 57344, v14
  v_mfma_f32_16x16x32_bf16 v[180:183], a[20:23], a[40:43], v[180:183]
  v_mfma_f32_16x16x32_bf16 v[188:191], a[20:23], a[44:47], v[188:191]
  buffer_load_dwordx4 v4, s[8:11], s69 offen offset:2048 nt lds
  v_mfma_f32_16x16x32_bf16 v[196:199], a[20:23], a[48:51], v[196:199]
  v_mfma_f32_16x16x32_bf16 v[204:207], a[20:23], a[52:55], v[204:207]
  v_mfma_f32_16x16x32_bf16 v[208:211], a[24:27], a[32:35], v[208:211]
  s_getpc_b64 s[92:93]
L_jq12:
  v_mfma_f32_16x16x32_bf16 v[216:219], a[24:27], a[36:39], v[216:219]
  v_mfma_f32_16x16x32_bf16 v[224:227], a[24:27], a[40:43], v[224:227]
  s_add_u32 s92, s92, 2048
  s_addc_u32 s93, s93, 0
  v_mfma_f32_16x16x32_bf16 v[232:235], a[24:27], a[44:47], v[232:235]
  buffer_load_dwordx4 v5, s[8:11], s69 offen offset:3072 nt lds
  v_mfma_f32_16x16x32_bf16 v[240:243], a[24:27], a[48:51], v[240:243]
  s_add_u32 s69, s69, 262144
  v_mfma_f32_16x16x32_bf16 v[248:251], a[24:27], a[52:55], v[248:251]
  v_mfma_f32_16x16x32_bf16 v[212:215], a[28:31], a[32:35], v[212:215]
  buffer_load_dword v21, v15, s[92:95], 0 offen
  v_mfma_f32_16x16x32_bf16 v[220:223], a[28:31], a[36:39], v[220:223]
  v_mfma_f32_16x16x32_bf16 v[228:231], a[28:31], a[40:43], v[228:231]
  v_mfma_f32_16x16x32_bf16 v[236:239], a[28:31], a[44:47], v[236:239]
  v_mfma_f32_16x16x32_bf16 v[244:247], a[28:31], a[48:51], v[244:247]
  s_waitcnt vmcnt(19)
  s_waitcnt lgkmcnt(0)
  v_mfma_f32_16x16x32_bf16 v[252:255], a[28:31], a[52:55], v[252:255]
  s_barrier
  v_mfma_f32_16x16x32_bf16 v[64:67], a[56:59], a[88:91], v[64:67]
  s_add_u32 m0, s73, 57344
  ds_read_b128 a[32:35], v14 offset:0
  v_mfma_f32_16x16x32_bf16 v[72:75], a[56:59], a[92:95], v[72:75]
  ds_read_b128 a[36:39], v14 offset:1024
  v_mfma_f32_16x16x32_bf16 v[80:83], a[56:59], a[96:99], v[80:83]
  ds_read_b128 a[40:43], v14 offset:2048
  v_mfma_f32_16x16x32_bf16 v[88:91], a[56:59], a[100:103], v[88:91]
  buffer_load_dwordx4 v16, s[12:15], s70 offen offset:0 sc1 lds
  v_mfma_f32_16x16x32_bf16 v[96:99], a[56:59], a[104:107], v[96:99]
  ds_read_b128 a[44:47], v14 offset:3072
  v_mfma_f32_16x16x32_bf16 v[104:107], a[56:59], a[108:111], v[104:107]
  ds_read_b128 a[48:51], v14 offset:4096
  v_mfma_f32_16x16x32_bf16 v[68:71], a[60:63], a[88:91], v[68:71]
  ds_read_b128 a[52:55], v14 offset:5120
  v_mfma_f32_16x16x32_bf16 v[76:79], a[60:63], a[92:95], v[76:79]
  ds_read_b64_tr_b16 a[0:1], v10 offset:0
  v_mfma_f32_16x16x32_bf16 v[84:87], a[60:63], a[96:99], v[84:87]
  ds_read_b64_tr_b16 a[2:3], v10 offset:2048
  v_mfma_f32_16x16x32_bf16 v[92:95], a[60:63], a[100:103], v[92:95]
  buffer_load_dwordx4 v17, s[12:15], s70 offen offset:1024 sc1 lds
  v_mfma_f32_16x16x32_bf16 v[100:103], a[60:63], a[104:107], v[100:103]
  ds_read_b64_tr_b16 a[4:5], v10 offset:8
  v_mfma_f32_16x16x32_bf16 v[108:111], a[60:63], a[108:111], v[108:111]
  ds_read_b64_tr_b16 a[6:7], v10 offset:2056
  v_mfma_f32_16x16x32_bf16 v[112:115], a[64:67], a[88:91], v[112:115]
  ds_read_b64_tr_b16 a[8:9], v11 offset:0
  v_mfma_f32_16x16x32_bf16 v[120:123], a[64:67], a[92:95], v[120:123]
  ds_read_b64_tr_b16 a[10:11], v11 offset:2048
  v_mfma_f32_16x16x32_bf16 v[128:131], a[64:67], a[96:99], v[128:131]
  ds_read_b64_tr_b16 a[12:13], v11 offset:8
  v_mfma_f32_16x16x32_bf16 v[136:139], a[64:67], a[100:103], v[136:139]
  buffer_load_dwordx4 v18, s[12:15], s70 offen offset:2048 sc1 lds
  v_mfma_f32_16x16x32_bf16 v[144:147], a[64:67], a[104:107], v[144:147]
  s_add_u32 s70, s70, 131072
  ds_read_b64_tr_b16 a[14:15], v11 offset:2056
  v_mfma_f32_16x16x32_bf16 v[152:155], a[64:67], a[108:111], v[152:155]
  s_add_u32 m0, s72, 147456
  ds_read_b64_tr_b16 a[16:17], v12 offset:0
  v_mfma_f32_16x16x32_bf16 v[116:119], a[68:71], a[88:91], v[116:119]
  s_add_u32 s3, s71, 0
  ds_read_b64_tr_b16 a[18:19], v12 offset:2048
  v_mfma_f32_16x16x32_bf16 v[124:127], a[68:71], a[92:95], v[124:127]
  ds_read_b64_tr_b16 a[20:21], v12 offset:8
  v_mfma_f32_16x16x32_bf16 v[132:135], a[68:71], a[96:99], v[132:135]
  ds_read_b64_tr_b16 a[22:23], v12 offset:2056
  v_mfma_f32_16x16x32_bf16 v[140:143], a[68:71], a[100:103], v[140:143]
  buffer_load_dwordx4 v7, s[16:19], s3 offen offset:0 nt lds
  v_mfma_f32_16x16x32_bf16 v[148:151], a[68:71], a[104:107], v[148:151]
  ds_read_b64_tr_b16 a[24:25], v13 offset:0
  v_mfma_f32_16x16x32_bf16 v[156:159], a[68:71], a[108:111], v[156:159]
  ds_read_b64_tr_b16 a[26:27], v13 offset:2048
  v_mfma_f32_16x16x32_bf16 v[160:163], a[72:75], a[88:91], v[160:163]
  ds_read_b64_tr_b16 a[28:29], v13 offset:8
  v_mfma_f32_16x16x32_bf16 v[168:171], a[72:75], a[92:95], v[168:171]
  ds_read_b64_tr_b16 a[30:31], v13 offset:2056
  v_mfma_f32_16x16x32_bf16 v[176:179], a[72:75], a[96:99], v[176:179]
  v_add_u32 v10, 4294852608, v10
  v_mfma_f32_16x16x32_bf16 v[184:187], a[72:75], a[100:103], v[184:187]
  buffer_load_dwordx4 v8, s[16:19], s3 offen offset:1024 nt lds
  v_mfma_f32_16x16x32_bf16 v[192:195], a[72:75], a[104:107], v[192:195]
  v_add_u32 v11, 4294852608, v11
  v_mfma_f32_16x16x32_bf16 v[200:203], a[72:75], a[108:111], v[200:203]
  v_add_u32 v12, 4294852608, v12
  v_mfma_f32_16x16x32_bf16 v[164:167], a[76:79], a[88:91], v[164:167]
  v_add_u32 v13, 4294852608, v13
  v_mfma_f32_16x16x32_bf16 v[172:175], a[76:79], a[92:95], v[172:175]
  v_add_u32 v14, 4294852608, v14
  v_mfma_f32_16x16x32_bf16 v[180:183], a[76:79], a[96:99], v[180:183]
  v_mfma_f32_16x16x32_bf16 v[188:191], a[76:79], a[100:103], v[188:191]
  buffer_load_dwordx4 v7, s[16:19], s3 offen offset:2048 nt lds
  v_mfma_f32_16x16x32_bf16 v[196:199], a[76:79], a[104:107], v[196:199]
  v_mfma_f32_16x16x32_bf16 v[204:207], a[76:79], a[108:111], v[204:207]
  v_mfma_f32_16x16x32_bf16 v[208:211], a[80:83], a[88:91], v[208:211]
  v_mfma_f32_16x16x32_bf16 v[216:219], a[80:83], a[92:95], v[216:219]
  v_mfma_f32_16x16x32_bf16 v[224:227], a[80:83], a[96:99], v[224:227]
  v_mfma_f32_16x16x32_bf16 v[232:235], a[80:83], a[100:103], v[232:235]
  buffer_load_dwordx4 v8, s[16:19], s3 offen offset:3072 nt lds
  v_mfma_f32_16x16x32_bf16 v[240:243], a[80:83], a[104:107], v[240:243]
  v_mfma_f32_16x16x32_bf16 v[248:251], a[80:83], a[108:111], v[248:251]
  v_mfma_f32_16x16x32_bf16 v[212:215], a[84:87], a[88:91], v[212:215]
  v_mfma_f32_16x16x32_bf16 v[220:223], a[84:87], a[92:95], v[220:223]
  v_mfma_f32_16x16x32_bf16 v[228:231], a[84:87], a[96:99], v[228:231]
  v_mfma_f32_16x16x32_bf16 v[236:239], a[84:87], a[100:103], v[236:239]
  v_mfma_f32_16x16x32_bf16 v[244:247], a[84:87], a[104:107], v[244:247]
  s_waitcnt vmcnt(19)
  s_waitcnt lgkmcnt(0)
  v_mfma_f32_16x16x32_bf16 v[252:255], a[84:87], a[108:111], v[252:255]
  s_barrier
  v_mfma_f32_16x16x32_bf16 v[64:67], a[0:3], a[32:35], v[64:67]
  s_add_u32 m0, s72, 98304
  ds_read_b128 a[88:91], v14 offset:0
  v_mfma_f32_16x16x32_bf16 v[72:75], a[0:3], a[36:39], v[72:75]
  s_add_u32 s3, s71, 16384
  ds_read_b128 a[92:95], v14 offset:1024
  v_mfma_f32_16x16x32_bf16 v[80:83], a[0:3], a[40:43], v[80:83]
  ds_read_b128 a[96:99], v14 offset:2048
  v_mfma_f32_16x16x32_bf16 v[88:91], a[0:3], a[44:47], v[88:91]
  buffer_load_dwordx4 v7, s[16:19], s3 offen offset:0 nt lds
  v_mfma_f32_16x16x32_bf16 v[96:99], a[0:3], a[48:51], v[96:99]
  ds_read_b128 a[100:103], v14 offset:3072
  v_mfma_f32_16x16x32_bf16 v[104:107], a[0:3], a[52:55], v[104:107]
  ds_read_b128 a[104:107], v14 offset:4096
  v_mfma_f32_16x16x32_bf16 v[68:71], a[4:7], a[32:35], v[68:71]
  ds_read_b128 a[108:111], v14 offset:5120
  v_mfma_f32_16x16x32_bf16 v[76:79], a[4:7], a[36:39], v[76:79]
  ds_read_b64_tr_b16 a[56:57], v10 offset:0
  v_mfma_f32_16x16x32_bf16 v[84:87], a[4:7], a[40:43], v[84:87]
  buffer_load_dwordx4 v8, s[16:19], s3 offen offset:1024 nt lds
  v_mfma_f32_16x16x32_bf16 v[92:95], a[4:7], a[44:47], v[92:95]
  ds_read_b64_tr_b16 a[58:59], v10 offset:2048
  v_mfma_f32_16x16x32_bf16 v[100:103], a[4:7], a[48:51], v[100:103]
  ds_read_b64_tr_b16 a[60:61], v10 offset:8
  v_mfma_f32_16x16x32_bf16 v[108:111], a[4:7], a[52:55], v[108:111]
  ds_read_b64_tr_b16 a[62:63], v10 offset:2056
  v_mfma_f32_16x16x32_bf16 v[112:115], a[8:11], a[32:35], v[112:115]
  ds_read_b64_tr_b16 a[64:65], v11 offset:0
  v_mfma_f32_16x16x32_bf16 v[120:123], a[8:11], a[36:39], v[120:123]
  buffer_load_dwordx4 v7, s[16:19], s3 offen offset:2048 nt lds
  v_mfma_f32_16x16x32_bf16 v[128:131], a[8:11], a[40:43], v[128:131]
  ds_read_b64_tr_b16 a[66:67], v11 offset:2048
  v_mfma_f32_16x16x32_bf16 v[136:139], a[8:11], a[44:47], v[136:139]
  ds_read_b64_tr_b16 a[68:69], v11 offset:8
  v_mfma_f32_16x16x32_bf16 v[144:147], a[8:11], a[48:51], v[144:147]
  ds_read_b64_tr_b16 a[70:71], v11 offset:2056
  v_mfma_f32_16x16x32_bf16 v[152:155], a[8:11], a[52:55], v[152:155]
  ds_read_b64_tr_b16 a[72:73], v12 offset:0
  v_mfma_f32_16x16x32_bf16 v[116:119], a[12:15], a[32:35], v[116:119]
  buffer_load_dwordx4 v8, s[16:19], s3 offen offset:3072 nt lds
  v_mfma_f32_16x16x32_bf16 v[124:127], a[12:15], a[36:39], v[124:127]
  s_add_u32 m0, s72, 114688
  ds_read_b64_tr_b16 a[74:75], v12 offset:2048
  v_mfma_f32_16x16x32_bf16 v[132:135], a[12:15], a[40:43], v[132:135]
  s_add_u32 s3, s71, 32768
  ds_read_b64_tr_b16 a[76:77], v12 offset:8
  v_mfma_f32_16x16x32_bf16 v[140:143], a[12:15], a[44:47], v[140:143]
  ds_read_b64_tr_b16 a[78:79], v12 offset:2056
  v_mfma_f32_16x16x32_bf16 v[148:151], a[12:15], a[48:51], v[148:151]
  ds_read_b64_tr_b16 a[80:81], v13 offset:0
  v_mfma_f32_16x16x32_bf16 v[156:159], a[12:15], a[52:55], v[156:159]
  buffer_load_dwordx4 v7, s[16:19], s3 offen offset:0 nt lds
  v_mfma_f32_16x16x32_bf16 v[160:163], a[16:19], a[32:35], v[160:163]
  ds_read_b64_tr_b16 a[82:83], v13 offset:2048
  v_mfma_f32_16x16x32_bf16 v[168:171], a[16:19], a[36:39], v[168:171]
  ds_read_b64_tr_b16 a[84:85], v13 offset:8
  v_mfma_f32_16x16x32_bf16 v[176:179], a[16:19], a[40:43], v[176:179]
  ds_read_b64_tr_b16 a[86:87], v13 offset:2056
  v_mfma_f32_16x16x32_bf16 v[184:187], a[16:19], a[44:47], v[184:187]
  v_mfma_f32_16x16x32_bf16 v[192:195], a[16:19], a[48:51], v[192:195]
  buffer_load_dwordx4 v8, s[16:19], s3 offen offset:1024 nt lds
  v_mfma_f32_16x16x32_bf16 v[200:203], a[16:19], a[52:55], v[200:203]
  v_mfma_f32_16x16x32_bf16 v[164:167], a[20:23], a[32:35], v[164:167]
  v_mfma_f32_16x16x32_bf16 v[172:175], a[20:23], a[36:39], v[172:175]
  v_mfma_f32_16x16x32_bf16 v[180:183], a[20:23], a[40:43], v[180:183]
  v_mfma_f32_16x16x32_bf16 v[188:191], a[20:23], a[44:47], v[188:191]
  buffer_load_dwordx4 v7, s[16:19], s3 offen offset:2048 nt lds
  v_mfma_f32_16x16x32_bf16 v[196:199], a[20:23], a[48:51], v[196:199]
  v_mfma_f32_16x16x32_bf16 v[204:207], a[20:23], a[52:55], v[204:207]
  v_mfma_f32_16x16x32_bf16 v[208:211], a[24:27], a[32:35], v[208:211]
  v_mfma_f32_16x16x32_bf16 v[216:219], a[24:27], a[36:39], v[216:219]
  v_mfma_f32_16x16x32_bf16 v[224:227], a[24:27], a[40:43], v[224:227]
  buffer_load_dwordx4 v8, s[16:19], s3 offen offset:3072 nt lds
  v_mfma_f32_16x16x32_bf16 v[232:235], a[24:27], a[44:47], v[232:235]
  v_mfma_f32_16x16x32_bf16 v[240:243], a[24:27], a[48:51], v[240:243]
  v_mfma_f32_16x16x32_bf16 v[248:251], a[24:27], a[52:55], v[248:251]
  v_mfma_f32_16x16x32_bf16 v[212:215], a[28:31], a[32:35], v[212:215]
  v_mfma_f32_16x16x32_bf16 v[220:223], a[28:31], a[36:39], v[220:223]
  v_mfma_f32_16x16x32_bf16 v[228:231], a[28:31], a[40:43], v[228:231]
  v_mfma_f32_16x16x32_bf16 v[236:239], a[28:31], a[44:47], v[236:239]
  v_mfma_f32_16x16x32_bf16 v[244:247], a[28:31], a[48:51], v[244:247]
  s_waitcnt vmcnt(20)
  s_waitcnt lgkmcnt(0)
  v_mfma_f32_16x16x32_bf16 v[252:255], a[28:31], a[52:55], v[252:255]
  s_barrier
  v_mfma_f32_16x16x32_bf16 v[64:67], a[56:59], a[88:91], v[64:67]
  s_add_u32 m0, s72, 0
  ds_read_b128 a[32:35], v14 offset:28672
  v_mfma_f32_16x16x32_bf16 v[72:75], a[56:59], a[92:95], v[72:75]
  s_add_u32 s3, s71, 0
  ds_read_b128 a[36:39], v14 offset:29696
  v_mfma_f32_16x16x32_bf16 v[80:83], a[56:59], a[96:99], v[80:83]
  ds_read_b128 a[40:43], v14 offset:30720
  v_mfma_f32_16x16x32_bf16 v[88:91], a[56:59], a[100:103], v[88:91]
  buffer_load_dwordx4 v7, s[20:23], s3 offen offset:0 nt lds
  v_mfma_f32_16x16x32_bf16 v[96:99], a[56:59], a[104:107], v[96:99]
  ds_read_b128 a[44:47], v14 offset:31744
  v_mfma_f32_16x16x32_bf16 v[104:107], a[56:59], a[108:111], v[104:107]
  ds_read_b128 a[48:51], v14 offset:32768
  v_mfma_f32_16x16x32_bf16 v[68:71], a[60:63], a[88:91], v[68:71]
  ds_read_b128 a[52:55], v14 offset:33792
  v_mfma_f32_16x16x32_bf16 v[76:79], a[60:63], a[92:95], v[76:79]
  ds_read_b64_tr_b16 a[0:1], v10 offset:28672
  v_mfma_f32_16x16x32_bf16 v[84:87], a[60:63], a[96:99], v[84:87]
  buffer_load_dwordx4 v8, s[20:23], s3 offen offset:1024 nt lds
  v_mfma_f32_16x16x32_bf16 v[92:95], a[60:63], a[100:103], v[92:95]
  ds_read_b64_tr_b16 a[2:3], v10 offset:30720
  v_mfma_f32_16x16x32_bf16 v[100:103], a[60:63], a[104:107], v[100:103]
  ds_read_b64_tr_b16 a[4:5], v10 offset:28680
  v_mfma_f32_16x16x32_bf16 v[108:111], a[60:63], a[108:111], v[108:111]
  ds_read_b64_tr_b16 a[6:7], v10 offset:30728
  v_mfma_f32_16x16x32_bf16 v[112:115], a[64:67], a[88:91], v[112:115]
  ds_read_b64_tr_b16 a[8:9], v11 offset:28672
  v_mfma_f32_16x16x32_bf16 v[120:123], a[64:67], a[92:95], v[120:123]
  buffer_load_dwordx4 v7, s[20:23], s3 offen offset:2048 nt lds
  v_mfma_f32_16x16x32_bf16 v[128:131], a[64:67], a[96:99], v[128:131]
  ds_read_b64_tr_b16 a[10:11], v11 offset:30720
  v_mfma_f32_16x16x32_bf16 v[136:139], a[64:67], a[100:103], v[136:139]
  ds_read_b64_tr_b16 a[12:13], v11 offset:28680
  v_mfma_f32_16x16x32_bf16 v[144:147], a[64:67], a[104:107], v[144:147]
  ds_read_b64_tr_b16 a[14:15], v11 offset:30728
  v_mfma_f32_16x16x32_bf16 v[152:155], a[64:67], a[108:111], v[152:155]
  ds_read_b64_tr_b16 a[16:17], v12 offset:28672
  v_mfma_f32_16x16x32_bf16 v[116:119], a[68:71], a[88:91], v[116:119]
  buffer_load_dwordx4 v8, s[20:23], s3 offen offset:3072 nt lds
  v_mfma_f32_16x16x32_bf16 v[124:127], a[68:71], a[92:95], v[124:127]
  s_add_u32 m0, s72, 131072
  ds_read_b64_tr_b16 a[18:19], v12 offset:30720
  v_mfma_f32_16x16x32_bf16 v[132:135], a[68:71], a[96:99], v[132:135]
  s_add_u32 s3, s71, 49152
  ds_read_b64_tr_b16 a[20:21], v12 offset:28680
  v_mfma_f32_16x16x32_bf16 v[140:143], a[68:71], a[100:103], v[140:143]
  ds_read_b64_tr_b16 a[22:23], v12 offset:30728
  v_mfma_f32_16x16x32_bf16 v[148:151], a[68:71], a[104:107], v[148:151]
  ds_read_b64_tr_b16 a[24:25], v13 offset:28672
  v_mfma_f32_16x16x32_bf16 v[156:159], a[68:71], a[108:111], v[156:159]
  buffer_load_dwordx4 v7, s[16:19], s3 offen offset:0 nt lds
  v_mfma_f32_16x16x32_bf16 v[160:163], a[72:75], a[88:91], v[160:163]
  ds_read_b64_tr_b16 a[26:27], v13 offset:30720
  v_mfma_f32_16x16x32_bf16 v[168:171], a[72:75], a[92:95], v[168:171]
  ds_read_b64_tr_b16 a[28:29], v13 offset:28680
  v_mfma_f32_16x16x32_bf16 v[176:179], a[72:75], a[96:99], v[176:179]
  ds_read_b64_tr_b16 a[30:31], v13 offset:30728
  v_mfma_f32_16x16x32_bf16 v[184:187], a[72:75], a[100:103], v[184:187]
  v_add_u32 v10, 57344, v10
  v_mfma_f32_16x16x32_bf16 v[192:195], a[72:75], a[104:107], v[192:195]
  buffer_load_dwordx4 v8, s[16:19], s3 offen offset:1024 nt lds
  v_mfma_f32_16x16x32_bf16 v[200:203], a[72:75], a[108:111], v[200:203]
  v_add_u32 v11, 57344, v11
  v_mfma_f32_16x16x32_bf16 v[164:167], a[76:79], a[88:91], v[164:167]
  v_add_u32 v12, 57344, v12
  v_mfma_f32_16x16x32_bf16 v[172:175], a[76:79], a[92:95], v[172:175]
  v_add_u32 v13, 57344, v13
  v_mfma_f32_16x16x32_bf16 v[180:183], a[76:79], a[96:99], v[180:183]
  v_add_u32 v14, 57344, v14
  v_mfma_f32_16x16x32_bf16 v[188:191], a[76:79], a[100:103], v[188:191]
  buffer_load_dwordx4 v7, s[16:19], s3 offen offset:2048 nt lds
  v_mfma_f32_16x16x32_bf16 v[196:199], a[76:79], a[104:107], v[196:199]
  v_mfma_f32_16x16x32_bf16 v[204:207], a[76:79], a[108:111], v[204:207]
  v_mfma_f32_16x16x32_bf16 v[208:211], a[80:83], a[88:91], v[208:211]
  v_mfma_f32_16x16x32_bf16 v[216:219], a[80:83], a[92:95], v[216:219]
  v_mfma_f32_16x16x32_bf16 v[224:227], a[80:83], a[96:99], v[224:227]
  buffer_load_dwordx4 v8, s[16:19], s3 offen offset:3072 nt lds
  v_mfma_f32_16x16x32_bf16 v[232:235], a[80:83], a[100:103], v[232:235]
  v_mfma_f32_16x16x32_bf16 v[240:243], a[80:83], a[104:107], v[240:243]
  v_mfma_f32_16x16x32_bf16 v[248:251], a[80:83], a[108:111], v[248:251]
  v_mfma_f32_16x16x32_bf16 v[212:215], a[84:87], a[88:91], v[212:215]
  v_mfma_f32_16x16x32_bf16 v[220:223], a[84:87], a[92:95], v[220:223]
  v_mfma_f32_16x16x32_bf16 v[228:231], a[84:87], a[96:99], v[228:231]
  v_mfma_f32_16x16x32_bf16 v[236:239], a[84:87], a[100:103], v[236:239]
  v_mfma_f32_16x16x32_bf16 v[244:247], a[84:87], a[104:107], v[244:247]
  s_waitcnt vmcnt(20)
  s_waitcnt lgkmcnt(0)
  v_mfma_f32_16x16x32_bf16 v[252:255], a[84:87], a[108:111], v[252:255]
  s_barrier
  v_mfma_f32_16x16x32_bf16 v[64:67], a[0:3], a[32:35], v[64:67]
  s_add_u32 m0, s72, 16384
  ds_read_b128 a[88:91], v14 offset:0
  v_mfma_f32_16x16x32_bf16 v[72:75], a[0:3], a[36:39], v[72:75]
  s_add_u32 s3, s71, 16384
  ds_read_b128 a[92:95], v14 offset:1024
  v_mfma_f32_16x16x32_bf16 v[80:83], a[0:3], a[40:43], v[80:83]
  ds_read_b128 a[96:99], v14 offset:2048
  v_mfma_f32_16x16x32_bf16 v[88:91], a[0:3], a[44:47], v[88:91]
  buffer_load_dwordx4 v7, s[20:23], s3 offen offset:0 nt lds
  v_mfma_f32_16x16x32_bf16 v[96:99], a[0:3], a[48:51], v[96:99]
  ds_read_b128 a[100:103], v14 offset:3072
  v_mfma_f32_16x16x32_bf16 v[104:107], a[0:3], a[52:55], v[104:107]
  ds_read_b128 a[104:107], v14 offset:4096
  v_mfma_f32_16x16x32_bf16 v[68:71], a[4:7], a[32:35], v[68:71]
  ds_read_b128 a[108:111], v14 offset:5120
  v_mfma_f32_16x16x32_bf16 v[76:79], a[4:7], a[36:39], v[76:79]
  ds_read_b64_tr_b16 a[56:57], v10 offset:0
  v_mfma_f32_16x16x32_bf16 v[84:87], a[4:7], a[40:43], v[84:87]
  buffer_load_dwordx4 v8, s[20:23], s3 offen offset:1024 nt lds
  v_mfma_f32_16x16x32_bf16 v[92:95], a[4:7], a[44:47], v[92:95]
  ds_read_b64_tr_b16 a[58:59], v10 offset:2048
  v_mfma_f32_16x16x32_bf16 v[100:103], a[4:7], a[48:51], v[100:103]
  ds_read_b64_tr_b16 a[60:61], v10 offset:8
  v_mfma_f32_16x16x32_bf16 v[108:111], a[4:7], a[52:55], v[108:111]
  ds_read_b64_tr_b16 a[62:63], v10 offset:2056
  v_mfma_f32_16x16x32_bf16 v[112:115], a[8:11], a[32:35], v[112:115]
  ds_read_b64_tr_b16 a[64:65], v11 offset:0
  v_mfma_f32_16x16x32_bf16 v[120:123], a[8:11], a[36:39], v[120:123]
  buffer_load_dwordx4 v7, s[20:23], s3 offen offset:2048 nt lds
  v_mfma_f32_16x16x32_bf16 v[128:131], a[8:11], a[40:43], v[128:131]
  ds_read_b64_tr_b16 a[66:67], v11 offset:2048
  v_mfma_f32_16x16x32_bf16 v[136:139], a[8:11], a[44:47], v[136:139]
  ds_read_b64_tr_b16 a[68:69], v11 offset:8
  v_mfma_f32_16x16x32_bf16 v[144:147], a[8:11], a[48:51], v[144:147]
  ds_read_b64_tr_b16 a[70:71], v11 offset:2056
  v_mfma_f32_16x16x32_bf16 v[152:155], a[8:11], a[52:55], v[152:155]
  ds_read_b64_tr_b16 a[72:73], v12 offset:0
  v_mfma_f32_16x16x32_bf16 v[116:119], a[12:15], a[32:35], v[116:119]
  buffer_load_dwordx4 v8, s[20:23], s3 offen offset:3072 nt lds
  v_mfma_f32_16x16x32_bf16 v[124:127], a[12:15], a[36:39], v[124:127]
  s_add_u32 m0, s72, 32768
  ds_read_b64_tr_b16 a[74:75], v12 offset:2048
  v_mfma_f32_16x16x32_bf16 v[132:135], a[12:15], a[40:43], v[132:135]
  s_add_u32 s3, s71, 32768
  ds_read_b64_tr_b16 a[76:77], v12 offset:8
  v_mfma_f32_16x16x32_bf16 v[140:143], a[12:15], a[44:47], v[140:143]
  ds_read_b64_tr_b16 a[78:79], v12 offset:2056
  v_mfma_f32_16x16x32_bf16 v[148:151], a[12:15], a[48:51], v[148:151]
  ds_read_b64_tr_b16 a[80:81], v13 offset:0
  v_mfma_f32_16x16x32_bf16 v[156:159], a[12:15], a[52:55], v[156:159]
  buffer_load_dwordx4 v7, s[20:23], s3 offen offset:0 nt lds
  v_mfma_f32_16x16x32_bf16 v[160:163], a[16:19], a[32:35], v[160:163]
  ds_read_b64_tr_b16 a[82:83], v13 offset:2048
  v_mfma_f32_16x16x32_bf16 v[168:171], a[16:19], a[36:39], v[168:171]
  ds_read_b64_tr_b16 a[84:85], v13 offset:8
  v_mfma_f32_16x16x32_bf16 v[176:179], a[16:19], a[40:43], v[176:179]
  ds_read_b64_tr_b16 a[86:87], v13 offset:2056
  v_mfma_f32_16x16x32_bf16 v[184:187], a[16:19], a[44:47], v[184:187]
  v_mfma_f32_16x16x32_bf16 v[192:195], a[16:19], a[48:51], v[192:195]
  buffer_load_dwordx4 v8, s[20:23], s3 offen offset:1024 nt lds
  v_mfma_f32_16x16x32_bf16 v[200:203], a[16:19], a[52:55], v[200:203]
  v_mfma_f32_16x16x32_bf16 v[164:167], a[20:23], a[32:35], v[164:167]
  v_mfma_f32_16x16x32_bf16 v[172:175], a[20:23], a[36:39], v[172:175]
  v_mfma_f32_16x16x32_bf16 v[180:183], a[20:23], a[40:43], v[180:183]
  v_mfma_f32_16x16x32_bf16 v[188:191], a[20:23], a[44:47], v[188:191]
  buffer_load_dwordx4 v7, s[20:23], s3 offen offset:2048 nt lds
  v_mfma_f32_16x16x32_bf16 v[196:199], a[20:23], a[48:51], v[196:199]
  v_mfma_f32_16x16x32_bf16 v[204:207], a[20:23], a[52:55], v[204:207]
  v_mfma_f32_16x16x32_bf16 v[208:211], a[24:27], a[32:35], v[208:211]
  v_mfma_f32_16x16x32_bf16 v[216:219], a[24:27], a[36:39], v[216:219]
  v_mfma_f32_16x16x32_bf16 v[224:227], a[24:27], a[40:43], v[224:227]
  buffer_load_dwordx4 v8, s[20:23], s3 offen offset:3072 nt lds
  v_mfma_f32_16x16x32_bf16 v[232:235], a[24:27], a[44:47], v[232:235]
  v_mfma_f32_16x16x32_bf16 v[240:243], a[24:27], a[48:51], v[240:243]
  v_mfma_f32_16x16x32_bf16 v[248:251], a[24:27], a[52:55], v[248:251]
  v_mfma_f32_16x16x32_bf16 v[212:215], a[28:31], a[32:35], v[212:215]
  v_mfma_f32_16x16x32_bf16 v[220:223], a[28:31], a[36:39], v[220:223]
  v_mfma_f32_16x16x32_bf16 v[228:231], a[28:31], a[40:43], v[228:231]
  v_mfma_f32_16x16x32_bf16 v[236:239], a[28:31], a[44:47], v[236:239]
  v_mfma_f32_16x16x32_bf16 v[244:247], a[28:31], a[48:51], v[244:247]
  s_waitcnt vmcnt(24)
  s_waitcnt lgkmcnt(0)
  v_mfma_f32_16x16x32_bf16 v[252:255], a[28:31], a[52:55], v[252:255]
  s_barrier
  v_mfma_f32_16x16x32_bf16 v[64:67], a[56:59], a[88:91], v[64:67]
  s_mov_b32 s8, s52
  ds_read_b128 a[192:195], v22 offset:49152
  v_mfma_f32_16x16x32_bf16 v[72:75], a[56:59], a[92:95], v[72:75]
  s_mov_b32 s9, s53
  v_mfma_f32_16x16x32_bf16 v[80:83], a[56:59], a[96:99], v[80:83]
  s_mov_b32 s10, 18874368
  ds_read_b128 a[196:199], v23 offset:49152
  v_mfma_f32_16x16x32_bf16 v[88:91], a[56:59], a[100:103], v[88:91]
  s_add_u32 s12, s48, 11501568
  v_mfma_f32_16x16x32_bf16 v[96:99], a[56:59], a[104:107], v[96:99]
  s_addc_u32 s13, s49, 0
  ds_read_b128 a[200:203], v24 offset:49152
  v_mfma_f32_16x16x32_bf16 v[104:107], a[56:59], a[108:111], v[104:107]
  s_mov_b32 s14, 7372800
  v_mfma_f32_16x16x32_bf16 v[68:71], a[60:63], a[88:91], v[68:71]
  s_mul_i32 s4, s2, 8192
  ds_read_b128 a[204:207], v25 offset:49152
  v_mfma_f32_16x16x32_bf16 v[76:79], a[60:63], a[92:95], v[76:79]
  s_add_u32 s24, s60, 4849664
  v_lshrrev_b32 v9, 2, v0
  v_mfma_f32_16x16x32_bf16 v[84:87], a[60:63], a[96:99], v[84:87]
  s_addc_u32 s25, s61, 0
  v_lshlrev_b32 v9, 7, v9
  v_mfma_f32_16x16x32_bf16 v[92:95], a[60:63], a[100:103], v[92:95]
  s_mov_b32 s26, 16777216
  v_add_u32 v9, s4, v9
  v_mfma_f32_16x16x32_bf16 v[100:103], a[60:63], a[104:107], v[100:103]
  v_cvt_pk_bf16_f32 v64, v64, v65
  v_cvt_pk_bf16_f32 v65, v66, v67
  v_mfma_f32_16x16x32_bf16 v[108:111], a[60:63], a[108:111], v[108:111]
  v_cvt_pk_bf16_f32 v66, v68, v69
  v_cvt_pk_bf16_f32 v67, v70, v71
  v_mfma_f32_16x16x32_bf16 v[112:115], a[64:67], a[88:91], v[112:115]
  v_cvt_pk_bf16_f32 v68, v72, v73
  v_cvt_pk_bf16_f32 v69, v74, v75
  v_mfma_f32_16x16x32_bf16 v[120:123], a[64:67], a[92:95], v[120:123]
  v_cvt_pk_bf16_f32 v70, v76, v77
  v_cvt_pk_bf16_f32 v71, v78, v79
  v_mfma_f32_16x16x32_bf16 v[128:131], a[64:67], a[96:99], v[128:131]
  v_cvt_pk_bf16_f32 v72, v80, v81
  v_cvt_pk_bf16_f32 v73, v82, v83
  v_mfma_f32_16x16x32_bf16 v[136:139], a[64:67], a[100:103], v[136:139]
  v_cvt_pk_bf16_f32 v74, v84, v85
  v_cvt_pk_bf16_f32 v75, v86, v87
  v_mfma_f32_16x16x32_bf16 v[144:147], a[64:67], a[104:107], v[144:147]
  v_cvt_pk_bf16_f32 v76, v88, v89
  v_cvt_pk_bf16_f32 v77, v90, v91
  v_mfma_f32_16x16x32_bf16 v[152:155], a[64:67], a[108:111], v[152:155]
  v_cvt_pk_bf16_f32 v78, v92, v93
  v_cvt_pk_bf16_f32 v79, v94, v95
  v_mfma_f32_16x16x32_bf16 v[116:119], a[68:71], a[88:91], v[116:119]
  v_cvt_pk_bf16_f32 v80, v96, v97
  v_cvt_pk_bf16_f32 v81, v98, v99
  v_mfma_f32_16x16x32_bf16 v[124:127], a[68:71], a[92:95], v[124:127]
  v_cvt_pk_bf16_f32 v82, v100, v101
  v_cvt_pk_bf16_f32 v83, v102, v103
  v_mfma_f32_16x16x32_bf16 v[132:135], a[68:71], a[96:99], v[132:135]
  v_cvt_pk_bf16_f32 v84, v104, v105
  v_cvt_pk_bf16_f32 v85, v106, v107
  v_mfma_f32_16x16x32_bf16 v[140:143], a[68:71], a[100:103], v[140:143]
  v_cvt_pk_bf16_f32 v86, v108, v109
  v_cvt_pk_bf16_f32 v87, v110, v111
  v_mfma_f32_16x16x32_bf16 v[148:151], a[68:71], a[104:107], v[148:151]
  v_cvt_pk_bf16_f32 v88, v112, v113
  v_cvt_pk_bf16_f32 v89, v114, v115
  v_mfma_f32_16x16x32_bf16 v[156:159], a[68:71], a[108:111], v[156:159]
  v_cvt_pk_bf16_f32 v90, v116, v117
  v_cvt_pk_bf16_f32 v91, v118, v119
  v_mfma_f32_16x16x32_bf16 v[160:163], a[72:75], a[88:91], v[160:163]
  v_cvt_pk_bf16_f32 v92, v120, v121
  v_cvt_pk_bf16_f32 v93, v122, v123
  v_mfma_f32_16x16x32_bf16 v[168:171], a[72:75], a[92:95], v[168:171]
  v_cvt_pk_bf16_f32 v94, v124, v125
  v_cvt_pk_bf16_f32 v95, v126, v127
  v_mfma_f32_16x16x32_bf16 v[176:179], a[72:75], a[96:99], v[176:179]
  v_cvt_pk_bf16_f32 v96, v128, v129
  v_cvt_pk_bf16_f32 v97, v130, v131
  v_mfma_f32_16x16x32_bf16 v[184:187], a[72:75], a[100:103], v[184:187]
  v_cvt_pk_bf16_f32 v98, v132, v133
  v_cvt_pk_bf16_f32 v99, v134, v135
  v_mfma_f32_16x16x32_bf16 v[192:195], a[72:75], a[104:107], v[192:195]
  v_cvt_pk_bf16_f32 v100, v136, v137
  v_cvt_pk_bf16_f32 v101, v138, v139
  v_mfma_f32_16x16x32_bf16 v[200:203], a[72:75], a[108:111], v[200:203]
  v_cvt_pk_bf16_f32 v102, v140, v141
  v_cvt_pk_bf16_f32 v103, v142, v143
  v_mfma_f32_16x16x32_bf16 v[164:167], a[76:79], a[88:91], v[164:167]
  v_cvt_pk_bf16_f32 v104, v144, v145
  v_cvt_pk_bf16_f32 v105, v146, v147
  v_mfma_f32_16x16x32_bf16 v[172:175], a[76:79], a[92:95], v[172:175]
  v_cvt_pk_bf16_f32 v106, v148, v149
  v_cvt_pk_bf16_f32 v107, v150, v151
  v_mfma_f32_16x16x32_bf16 v[180:183], a[76:79], a[96:99], v[180:183]
  v_cvt_pk_bf16_f32 v108, v152, v153
  v_cvt_pk_bf16_f32 v109, v154, v155
  v_mfma_f32_16x16x32_bf16 v[188:191], a[76:79], a[100:103], v[188:191]
  v_cvt_pk_bf16_f32 v110, v156, v157
  v_cvt_pk_bf16_f32 v111, v158, v159
  v_mfma_f32_16x16x32_bf16 v[196:199], a[76:79], a[104:107], v[196:199]
  v_cvt_pk_bf16_f32 v112, v160, v161
  v_cvt_pk_bf16_f32 v113, v162, v163
  v_mfma_f32_16x16x32_bf16 v[204:207], a[76:79], a[108:111], v[204:207]
  v_cvt_pk_bf16_f32 v114, v164, v165
  v_cvt_pk_bf16_f32 v115, v166, v167
  v_mfma_f32_16x16x32_bf16 v[208:211], a[80:83], a[88:91], v[208:211]
  v_cvt_pk_bf16_f32 v116, v168, v169
  v_cvt_pk_bf16_f32 v117, v170, v171
  v_mfma_f32_16x16x32_bf16 v[216:219], a[80:83], a[92:95], v[216:219]
  v_cvt_pk_bf16_f32 v118, v172, v173
  v_cvt_pk_bf16_f32 v119, v174, v175
  v_mfma_f32_16x16x32_bf16 v[224:227], a[80:83], a[96:99], v[224:227]
  v_cvt_pk_bf16_f32 v120, v176, v177
  v_cvt_pk_bf16_f32 v121, v178, v179
  v_mfma_f32_16x16x32_bf16 v[232:235], a[80:83], a[100:103], v[232:235]
  v_cvt_pk_bf16_f32 v122, v180, v181
  v_cvt_pk_bf16_f32 v123, v182, v183
  v_mfma_f32_16x16x32_bf16 v[240:243], a[80:83], a[104:107], v[240:243]
  v_cvt_pk_bf16_f32 v124, v184, v185
  v_cvt_pk_bf16_f32 v125, v186, v187
  v_mfma_f32_16x16x32_bf16 v[248:251], a[80:83], a[108:111], v[248:251]
  v_cvt_pk_bf16_f32 v126, v188, v189
  v_cvt_pk_bf16_f32 v127, v190, v191
  v_mfma_f32_16x16x32_bf16 v[212:215], a[84:87], a[88:91], v[212:215]
  v_cvt_pk_bf16_f32 v128, v192, v193
  v_cvt_pk_bf16_f32 v129, v194, v195
  v_mfma_f32_16x16x32_bf16 v[220:223], a[84:87], a[92:95], v[220:223]
  v_cvt_pk_bf16_f32 v130, v196, v197
  v_cvt_pk_bf16_f32 v131, v198, v199
  v_mfma_f32_16x16x32_bf16 v[228:231], a[84:87], a[96:99], v[228:231]
  v_cvt_pk_bf16_f32 v132, v200, v201
  v_cvt_pk_bf16_f32 v133, v202, v203
  v_mfma_f32_16x16x32_bf16 v[236:239], a[84:87], a[100:103], v[236:239]
  v_cvt_pk_bf16_f32 v134, v204, v205
  v_cvt_pk_bf16_f32 v135, v206, v207
  v_mfma_f32_16x16x32_bf16 v[244:247], a[84:87], a[104:107], v[244:247]
  v_cvt_pk_bf16_f32 v136, v208, v209
  v_cvt_pk_bf16_f32 v137, v210, v211
  v_mfma_f32_16x16x32_bf16 v[252:255], a[84:87], a[108:111], v[252:255]
  s_waitcnt lgkmcnt(3)
  v_cvt_pk_bf16_f32 v138, v212, v213
  v_cvt_pk_bf16_f32 v139, v214, v215
  v_mfma_f32_16x16x32_bf16 v[160:163], a[192:195], v[64:67], 0
  s_add_u32 m0, s72, 49152
  v_cvt_pk_bf16_f32 v140, v216, v217
  v_cvt_pk_bf16_f32 v141, v218, v219
  v_mfma_f32_16x16x32_bf16 v[168:171], a[192:195], v[68:71], 0
  s_add_u32 s3, s71, 49152
  v_cvt_pk_bf16_f32 v142, v220, v221
  v_cvt_pk_bf16_f32 v143, v222, v223
  v_mfma_f32_16x16x32_bf16 v[176:179], a[192:195], v[72:75], 0
  v_cvt_pk_bf16_f32 v144, v224, v225
  v_cvt_pk_bf16_f32 v145, v226, v227
  v_mfma_f32_16x16x32_bf16 v[184:187], a[192:195], v[76:79], 0
  v_cvt_pk_bf16_f32 v146, v228, v229
  v_cvt_pk_bf16_f32 v147, v230, v231
  v_mfma_f32_16x16x32_bf16 v[192:195], a[192:195], v[80:83], 0
  v_cvt_pk_bf16_f32 v148, v232, v233
  v_cvt_pk_bf16_f32 v149, v234, v235
  v_mfma_f32_16x16x32_bf16 v[200:203], a[192:195], v[84:87], 0
  s_waitcnt lgkmcnt(2)
  v_cvt_pk_bf16_f32 v150, v236, v237
  v_cvt_pk_bf16_f32 v151, v238, v239
  v_mfma_f32_16x16x32_bf16 v[160:163], a[196:199], v[88:91], v[160:163]
  v_cvt_pk_bf16_f32 v152, v240, v241
  v_cvt_pk_bf16_f32 v153, v242, v243
  v_mfma_f32_16x16x32_bf16 v[168:171], a[196:199], v[92:95], v[168:171]
  v_cvt_pk_bf16_f32 v154, v244, v245
  v_cvt_pk_bf16_f32 v155, v246, v247
  v_mfma_f32_16x16x32_bf16 v[176:179], a[196:199], v[96:99], v[176:179]
  v_cvt_pk_bf16_f32 v156, v248, v249
  v_cvt_pk_bf16_f32 v157, v250, v251
  v_mfma_f32_16x16x32_bf16 v[184:187], a[196:199], v[100:103], v[184:187]
  v_cvt_pk_bf16_f32 v158, v252, v253
  v_cvt_pk_bf16_f32 v159, v254, v255
  v_mfma_f32_16x16x32_bf16 v[192:195], a[196:199], v[104:107], v[192:195]
  ds_read_b128 a[208:211], v22 offset:53248
  v_mfma_f32_16x16x32_bf16 v[200:203], a[196:199], v[108:111], v[200:203]
  s_waitcnt lgkmcnt(2)
  buffer_load_dwordx4 v7, s[20:23], s3 offen offset:0 nt lds
  v_mfma_f32_16x16x32_bf16 v[160:163], a[200:203], v[112:115], v[160:163]
  ds_read_b128 a[212:215], v23 offset:53248
  v_mfma_f32_16x16x32_bf16 v[168:171], a[200:203], v[116:119], v[168:171]
  v_mfma_f32_16x16x32_bf16 v[176:179], a[200:203], v[120:123], v[176:179]
  ds_read_b128 a[216:219], v24 offset:53248
  v_mfma_f32_16x16x32_bf16 v[184:187], a[200:203], v[124:127], v[184:187]
  buffer_load_dwordx4 v8, s[20:23], s3 offen offset:1024 nt lds
  v_mfma_f32_16x16x32_bf16 v[192:195], a[200:203], v[128:131], v[192:195]
  ds_read_b128 a[220:223], v25 offset:53248
  v_mfma_f32_16x16x32_bf16 v[200:203], a[200:203], v[132:135], v[200:203]
  s_waitcnt lgkmcnt(4)
  v_mfma_f32_16x16x32_bf16 v[160:163], a[204:207], v[136:139], v[160:163]
  v_mfma_f32_16x16x32_bf16 v[168:171], a[204:207], v[140:143], v[168:171]
  buffer_load_dwordx4 v7, s[20:23], s3 offen offset:2048 nt lds
  v_mfma_f32_16x16x32_bf16 v[176:179], a[204:207], v[144:147], v[176:179]
  v_mfma_f32_16x16x32_bf16 v[184:187], a[204:207], v[148:151], v[184:187]
  buffer_load_dwordx4 v8, s[20:23], s3 offen offset:3072 nt lds
  v_mfma_f32_16x16x32_bf16 v[192:195], a[204:207], v[152:155], v[192:195]
  v_mfma_f32_16x16x32_bf16 v[200:203], a[204:207], v[156:159], v[200:203]
  s_waitcnt lgkmcnt(3)
  v_mfma_f32_16x16x32_bf16 v[164:167], a[208:211], v[64:67], 0
  v_mfma_f32_16x16x32_bf16 v[172:175], a[208:211], v[68:71], 0
  v_max3_f32 v40, v160, v161, v162
  v_max3_f32 v44, v168, v169, v170
  v_mfma_f32_16x16x32_bf16 v[180:183], a[208:211], v[72:75], 0
  v_max3_f32 v48, v176, v177, v178
  v_max3_f32 v52, v184, v185, v186
  v_mfma_f32_16x16x32_bf16 v[188:191], a[208:211], v[76:79], 0
  v_max3_f32 v56, v192, v193, v194
  v_max3_f32 v60, v200, v201, v202
  v_mfma_f32_16x16x32_bf16 v[196:199], a[208:211], v[80:83], 0
  v_max_f32 v40, v40, v163
  v_max_f32 v44, v44, v171
  v_mfma_f32_16x16x32_bf16 v[204:207], a[208:211], v[84:87], 0
  s_waitcnt lgkmcnt(2)
  v_max_f32 v48, v48, v179
  v_max_f32 v52, v52, v187
  v_mfma_f32_16x16x32_bf16 v[164:167], a[212:215], v[88:91], v[164:167]
  v_max_f32 v56, v56, v195
  v_max_f32 v60, v60, v203
  v_mfma_f32_16x16x32_bf16 v[172:175], a[212:215], v[92:95], v[172:175]
  v_mov_b32 v41, v40
  v_mov_b32 v45, v44
  v_mfma_f32_16x16x32_bf16 v[180:183], a[212:215], v[96:99], v[180:183]
  v_mov_b32 v49, v48
  v_mov_b32 v53, v52
  v_mfma_f32_16x16x32_bf16 v[188:191], a[212:215], v[100:103], v[188:191]
  v_mov_b32 v57, v56
  v_mov_b32 v61, v60
  v_mfma_f32_16x16x32_bf16 v[196:199], a[212:215], v[104:107], v[196:199]
  v_permlane32_swap_b32 v40, v41
  v_permlane32_swap_b32 v44, v45
  v_mfma_f32_16x16x32_bf16 v[204:207], a[212:215], v[108:111], v[204:207]
  s_waitcnt lgkmcnt(1)
  v_permlane32_swap_b32 v48, v49
  v_permlane32_swap_b32 v52, v53
  v_mfma_f32_16x16x32_bf16 v[164:167], a[216:219], v[112:115], v[164:167]
  v_permlane32_swap_b32 v56, v57
  v_permlane32_swap_b32 v60, v61
  v_mfma_f32_16x16x32_bf16 v[172:175], a[216:219], v[116:119], v[172:175]
  v_max_f32 v40, v40, v41
  v_max_f32 v44, v44, v45
  v_mfma_f32_16x16x32_bf16 v[180:183], a[216:219], v[120:123], v[180:183]
  v_max_f32 v48, v48, v49
  v_max_f32 v52, v52, v53
  v_mfma_f32_16x16x32_bf16 v[188:191], a[216:219], v[124:127], v[188:191]
  v_max_f32 v56, v56, v57
  v_max_f32 v60, v60, v61
  v_mfma_f32_16x16x32_bf16 v[196:199], a[216:219], v[128:131], v[196:199]
  v_mov_b32 v41, v40
  v_mov_b32 v45, v44
  v_mfma_f32_16x16x32_bf16 v[204:207], a[216:219], v[132:135], v[204:207]
  s_waitcnt lgkmcnt(0)
  v_mov_b32 v49, v48
  v_mov_b32 v53, v52
  v_mfma_f32_16x16x32_bf16 v[164:167], a[220:223], v[136:139], v[164:167]
  v_mov_b32 v57, v56
  v_mov_b32 v61, v60
  v_mfma_f32_16x16x32_bf16 v[172:175], a[220:223], v[140:143], v[172:175]
  v_permlane16_swap_b32 v40, v41
  v_permlane16_swap_b32 v44, v45
  v_mfma_f32_16x16x32_bf16 v[180:183], a[220:223], v[144:147], v[180:183]
  s_waitcnt vmcnt(16)
  s_barrier
  v_permlane16_swap_b32 v48, v49
  v_permlane16_swap_b32 v52, v53
  v_mfma_f32_16x16x32_bf16 v[188:191], a[220:223], v[148:151], v[188:191]
  v_permlane16_swap_b32 v56, v57
  v_permlane16_swap_b32 v60, v61
  v_mfma_f32_16x16x32_bf16 v[196:199], a[220:223], v[152:155], v[196:199]
  v_max_f32 v40, v40, v41
  v_max_f32 v44, v44, v45
  v_mfma_f32_16x16x32_bf16 v[204:207], a[220:223], v[156:159], v[204:207]
  v_max_f32 v48, v48, v49
  v_max_f32 v52, v52, v53
  v_max_f32 v56, v56, v57
  v_max_f32 v60, v60, v61
  v_mul_f32 v41, -1.0, v40
  v_mul_f32 v42, -1.0, v40
  v_mul_f32 v43, -1.0, v40
  v_mul_f32 v40, -1.0, v40
  v_mul_f32 v45, -1.0, v44
  v_mul_f32 v46, -1.0, v44
  v_mul_f32 v47, -1.0, v44
  v_mul_f32 v44, -1.0, v44
  v_mul_f32 v49, -1.0, v48
  v_mul_f32 v50, -1.0, v48
  v_mul_f32 v51, -1.0, v48
  v_mul_f32 v48, -1.0, v48
  v_mul_f32 v53, -1.0, v52
  v_mul_f32 v54, -1.0, v52
  v_mul_f32 v55, -1.0, v52
  v_mul_f32 v52, -1.0, v52
  v_mul_f32 v57, -1.0, v56
  v_mul_f32 v58, -1.0, v56
  v_mul_f32 v59, -1.0, v56
  v_mul_f32 v56, -1.0, v56
  v_mul_f32 v61, -1.0, v60
  v_mul_f32 v62, -1.0, v60
  v_mul_f32 v63, -1.0, v60
  v_mul_f32 v60, -1.0, v60
  v_pk_add_f32 v[160:161], v[160:161], v[40:41]
  v_pk_add_f32 v[162:163], v[162:163], v[40:41]
  v_pk_add_f32 v[164:165], v[164:165], v[40:41]
  v_pk_add_f32 v[166:167], v[166:167], v[40:41]
  v_pk_add_f32 v[168:169], v[168:169], v[44:45]
  v_pk_add_f32 v[170:171], v[170:171], v[44:45]
  v_pk_add_f32 v[172:173], v[172:173], v[44:45]
  v_pk_add_f32 v[174:175], v[174:175], v[44:45]
  v_pk_add_f32 v[176:177], v[176:177], v[48:49]
  v_pk_add_f32 v[178:179], v[178:179], v[48:49]
  v_pk_add_f32 v[180:181], v[180:181], v[48:49]
  v_pk_add_f32 v[182:183], v[182:183], v[48:49]
  v_pk_add_f32 v[184:185], v[184:185], v[52:53]
  v_pk_add_f32 v[186:187], v[186:187], v[52:53]
  v_pk_add_f32 v[188:189], v[188:189], v[52:53]
  v_pk_add_f32 v[190:191], v[190:191], v[52:53]
  v_pk_add_f32 v[192:193], v[192:193], v[56:57]
  v_pk_add_f32 v[194:195], v[194:195], v[56:57]
  v_pk_add_f32 v[196:197], v[196:197], v[56:57]
  v_pk_add_f32 v[198:199], v[198:199], v[56:57]
  v_pk_add_f32 v[200:201], v[200:201], v[60:61]
  v_pk_add_f32 v[202:203], v[202:203], v[60:61]
  v_pk_add_f32 v[204:205], v[204:205], v[60:61]
  v_pk_add_f32 v[206:207], v[206:207], v[60:61]
  v_exp_f32 v160, v160
  v_exp_f32 v161, v161
  v_add_f32 v34, v34, v160
  v_exp_f32 v162, v162
  v_add_f32 v34, v34, v161
  v_exp_f32 v163, v163
  v_add_f32 v34, v34, v162
  v_cvt_pk_bf16_f32 v160, v160, v161
  v_exp_f32 v164, v164
  v_add_f32 v34, v34, v163
  v_exp_f32 v165, v165
  v_add_f32 v34, v34, v164
  v_cvt_pk_bf16_f32 v161, v162, v163
  v_exp_f32 v166, v166
  v_add_f32 v34, v34, v165
  v_exp_f32 v167, v167
  v_add_f32 v34, v34, v166
  v_cvt_pk_bf16_f32 v162, v164, v165
  v_exp_f32 v168, v168
  v_add_f32 v34, v34, v167
  buffer_load_dword v21, v9, s[12:15], 0 offen
  v_exp_f32 v169, v169
  v_add_f32 v35, v35, v168
  v_cvt_pk_bf16_f32 v163, v166, v167
  v_exp_f32 v170, v170
  v_add_f32 v35, v35, v169
  v_exp_f32 v171, v171
  v_add_f32 v35, v35, v170
  v_cvt_pk_bf16_f32 v168, v168, v169
  v_exp_f32 v172, v172
  v_add_f32 v35, v35, v171
  v_exp_f32 v173, v173
  v_add_f32 v35, v35, v172
  v_cvt_pk_bf16_f32 v169, v170, v171
  v_exp_f32 v174, v174
  v_add_f32 v35, v35, v173
  v_exp_f32 v175, v175
  v_add_f32 v35, v35, v174
  v_cvt_pk_bf16_f32 v170, v172, v173
  v_exp_f32 v176, v176
  v_add_f32 v35, v35, v175
  v_exp_f32 v177, v177
  v_add_f32 v36, v36, v176
  v_cvt_pk_bf16_f32 v171, v174, v175
  v_exp_f32 v178, v178
  v_add_f32 v36, v36, v177
  v_exp_f32 v179, v179
  v_add_f32 v36, v36, v178
  v_cvt_pk_bf16_f32 v176, v176, v177
  v_exp_f32 v180, v180
  ds_read_b128 a[192:195], v22 offset:57344
  v_add_f32 v36, v36, v179
  v_exp_f32 v181, v181
  v_add_f32 v36, v36, v180
  v_cvt_pk_bf16_f32 v177, v178, v179
  v_exp_f32 v182, v182
  ds_read_b128 a[196:199], v23 offset:57344
  v_add_f32 v36, v36, v181
  v_exp_f32 v183, v183
  v_add_f32 v36, v36, v182
  v_cvt_pk_bf16_f32 v178, v180, v181
  v_exp_f32 v184, v184
  ds_read_b128 a[200:203], v24 offset:57344
  v_add_f32 v36, v36, v183
  v_exp_f32 v185, v185
  v_add_f32 v37, v37, v184
  v_cvt_pk_bf16_f32 v179, v182, v183
  s_waitcnt lgkmcnt(2)
  ds_read_b128 a[204:207], v25 offset:57344
  v_add_f32 v37, v37, v185
  v_mfma_f32_16x16x32_bf16 v[208:211], a[192:195], v[64:67], v[40:43]
  v_exp_f32 v186, v186
  v_mfma_f32_16x16x32_bf16 v[216:219], a[192:195], v[68:71], v[44:47]
  v_add_f32 v37, v37, v186
  v_cvt_pk_bf16_f32 v184, v184, v185
  v_mfma_f32_16x16x32_bf16 v[224:227], a[192:195], v[72:75], v[48:51]
  v_exp_f32 v187, v187
  v_mfma_f32_16x16x32_bf16 v[232:235], a[192:195], v[76:79], v[52:55]
  ds_read_b128 a[208:211], v22 offset:61440
  v_add_f32 v37, v37, v187
  v_mfma_f32_16x16x32_bf16 v[240:243], a[192:195], v[80:83], v[56:59]
  v_exp_f32 v188, v188
  v_mfma_f32_16x16x32_bf16 v[248:251], a[192:195], v[84:87], v[60:63]
  s_waitcnt lgkmcnt(3)
  v_add_f32 v37, v37, v188
  v_cvt_pk_bf16_f32 v185, v186, v187
  v_mfma_f32_16x16x32_bf16 v[208:211], a[196:199], v[88:91], v[208:211]
  v_exp_f32 v189, v189
  v_mfma_f32_16x16x32_bf16 v[216:219], a[196:199], v[92:95], v[216:219]
  ds_read_b128 a[212:215], v23 offset:61440
  v_add_f32 v37, v37, v189
  v_mfma_f32_16x16x32_bf16 v[224:227], a[196:199], v[96:99], v[224:227]
  v_exp_f32 v190, v190
  v_add_u32 v9, 1441792, v9
  v_mfma_f32_16x16x32_bf16 v[232:235], a[196:199], v[100:103], v[232:235]
  v_add_f32 v37, v37, v190
  v_cvt_pk_bf16_f32 v186, v188, v189
  v_mfma_f32_16x16x32_bf16 v[240:243], a[196:199], v[104:107], v[240:243]
  v_exp_f32 v191, v191
  v_mfma_f32_16x16x32_bf16 v[248:251], a[196:199], v[108:111], v[248:251]
  s_waitcnt lgkmcnt(3)
  ds_read_b128 a[216:219], v24 offset:61440
  v_add_f32 v37, v37, v191
  v_mfma_f32_16x16x32_bf16 v[208:211], a[200:203], v[112:115], v[208:211]
  v_exp_f32 v192, v192
  v_mfma_f32_16x16x32_bf16 v[216:219], a[200:203], v[116:119], v[216:219]
  v_add_f32 v38, v38, v192
  v_cvt_pk_bf16_f32 v187, v190, v191
  v_mfma_f32_16x16x32_bf16 v[224:227], a[200:203], v[120:123], v[224:227]
  buffer_load_dword v21, v9, s[12:15], 0 offen
  v_exp_f32 v193, v193
  v_mfma_f32_16x16x32_bf16 v[232:235], a[200:203], v[124:127], v[232:235]
  ds_read_b128 a[220:223], v25 offset:61440
  v_add_f32 v38, v38, v193
  v_mfma_f32_16x16x32_bf16 v[240:243], a[200:203], v[128:131], v[240:243]
  s_getpc_b64 s[92:93]
L_j1:
  v_exp_f32 v194, v194
  v_mfma_f32_16x16x32_bf16 v[248:251], a[200:203], v[132:135], v[248:251]
  s_waitcnt lgkmcnt(4)
  v_add_f32 v38, v38, v194
  v_cvt_pk_bf16_f32 v192, v192, v193
  v_mfma_f32_16x16x32_bf16 v[208:211], a[204:207], v[136:139], v[208:211]
  s_add_u32 s92, s92, 3072
  s_addc_u32 s93, s93, 0
  v_exp_f32 v195, v195
  v_mfma_f32_16x16x32_bf16 v[216:219], a[204:207], v[140:143], v[216:219]
  ds_read_b64_tr_b16 a[224:225], v26 offset:0
  v_add_f32 v38, v38, v195
  v_mfma_f32_16x16x32_bf16 v[224:227], a[204:207], v[144:147], v[224:227]
  v_exp_f32 v196, v196
  v_mfma_f32_16x16x32_bf16 v[232:235], a[204:207], v[148:151], v[232:235]
  v_add_f32 v38, v38, v196
  v_cvt_pk_bf16_f32 v193, v194, v195
  v_mfma_f32_16x16x32_bf16 v[240:243], a[204:207], v[152:155], v[240:243]
  buffer_load_dword v21, v15, s[92:95], 0 offen
  v_exp_f32 v197, v197
  v_mfma_f32_16x16x32_bf16 v[248:251], a[204:207], v[156:159], v[248:251]
  s_waitcnt lgkmcnt(4)
  ds_read_b64_tr_b16 a[226:227], v26 offset:4096
  v_add_f32 v38, v38, v197
  v_mfma_f32_16x16x32_bf16 v[212:215], a[208:211], v[64:67], v[40:43]
  v_exp_f32 v198, v198
  v_mfma_f32_16x16x32_bf16 v[220:223], a[208:211], v[68:71], v[44:47]
  v_add_f32 v38, v38, v198
  v_cvt_pk_bf16_f32 v194, v196, v197
  v_mfma_f32_16x16x32_bf16 v[228:231], a[208:211], v[72:75], v[48:51]
  v_exp_f32 v199, v199
  v_mfma_f32_16x16x32_bf16 v[236:239], a[208:211], v[76:79], v[52:55]
  ds_read_b64_tr_b16 a[228:229], v27 offset:0
  v_add_f32 v38, v38, v199
  v_mfma_f32_16x16x32_bf16 v[244:247], a[208:211], v[80:83], v[56:59]
  v_exp_f32 v200, v200
  v_mfma_f32_16x16x32_bf16 v[252:255], a[208:211], v[84:87], v[60:63]
  s_waitcnt lgkmcnt(5)
  v_add_f32 v39, v39, v200
  v_cvt_pk_bf16_f32 v195, v198, v199
  v_mfma_f32_16x16x32_bf16 v[212:215], a[212:215], v[88:91], v[212:215]
  v_exp_f32 v201, v201
  v_mfma_f32_16x16x32_bf16 v[220:223], a[212:215], v[92:95], v[220:223]
  ds_read_b64_tr_b16 a[230:231], v27 offset:4096
  v_add_f32 v39, v39, v201
  v_mfma_f32_16x16x32_bf16 v[228:231], a[212:215], v[96:99], v[228:231]
  v_exp_f32 v202, v202
  v_mfma_f32_16x16x32_bf16 v[236:239], a[212:215], v[100:103], v[236:239]
  v_add_f32 v39, v39, v202
  v_cvt_pk_bf16_f32 v200, v200, v201
  v_mfma_f32_16x16x32_bf16 v[244:247], a[212:215], v[104:107], v[244:247]
  v_exp_f32 v203, v203
  v_mfma_f32_16x16x32_bf16 v[252:255], a[212:215], v[108:111], v[252:255]
  s_waitcnt lgkmcnt(5)
  ds_read_b64_tr_b16 a[232:233], v28 offset:0
  v_add_f32 v39, v39, v203
  v_mfma_f32_16x16x32_bf16 v[212:215], a[216:219], v[112:115], v[212:215]
  v_exp_f32 v204, v204
  v_mfma_f32_16x16x32_bf16 v[220:223], a[216:219], v[116:119], v[220:223]
  v_add_f32 v39, v39, v204
  v_cvt_pk_bf16_f32 v201, v202, v203
  v_mfma_f32_16x16x32_bf16 v[228:231], a[216:219], v[120:123], v[228:231]
  v_exp_f32 v205, v205
  v_mfma_f32_16x16x32_bf16 v[236:239], a[216:219], v[124:127], v[236:239]
  ds_read_b64_tr_b16 a[234:235], v28 offset:4096
  v_add_f32 v39, v39, v205
  v_mfma_f32_16x16x32_bf16 v[244:247], a[216:219], v[128:131], v[244:247]
  v_exp_f32 v206, v206
  v_mfma_f32_16x16x32_bf16 v[252:255], a[216:219], v[132:135], v[252:255]
  s_waitcnt lgkmcnt(6)
  v_add_f32 v39, v39, v206
  v_cvt_pk_bf16_f32 v202, v204, v205
  v_mfma_f32_16x16x32_bf16 v[212:215], a[220:223], v[136:139], v[212:215]
  v_exp_f32 v207, v207
  v_mfma_f32_16x16x32_bf16 v[220:223], a[220:223], v[140:143], v[220:223]
  ds_read_b64_tr_b16 a[236:237], v29 offset:0
  v_add_f32 v39, v39, v207
  v_mfma_f32_16x16x32_bf16 v[228:231], a[220:223], v[144:147], v[228:231]
  v_exp_f32 v208, v208
  v_mfma_f32_16x16x32_bf16 v[236:239], a[220:223], v[148:151], v[236:239]
  v_cvt_pk_bf16_f32 v203, v206, v207
  v_add_f32 v34, v34, v208
  v_mfma_f32_16x16x32_bf16 v[244:247], a[220:223], v[152:155], v[244:247]
  v_exp_f32 v209, v209
  v_mfma_f32_16x16x32_bf16 v[252:255], a[220:223], v[156:159], v[252:255]
  s_waitcnt lgkmcnt(5)
  ds_read_b64_tr_b16 a[238:239], v29 offset:4096
  v_add_f32 v34, v34, v209
  v_mfma_f32_16x16x32_bf16 a[0:3], a[224:227], v[160:163], 0
  v_exp_f32 v210, v210
  v_mfma_f32_16x16x32_bf16 a[32:35], a[224:227], v[168:171], 0
  v_add_f32 v34, v34, v210
  v_cvt_pk_bf16_f32 v208, v208, v209
  v_mfma_f32_16x16x32_bf16 a[64:67], a[224:227], v[176:179], 0
  v_exp_f32 v211, v211
  v_mfma_f32_16x16x32_bf16 a[96:99], a[224:227], v[184:187], 0
  ds_read_b64_tr_b16 a[240:241], v30 offset:0
  v_add_f32 v34, v34, v211
  v_mfma_f32_16x16x32_bf16 a[128:131], a[224:227], v[192:195], 0
  v_exp_f32 v212, v212
  v_mfma_f32_16x16x32_bf16 a[160:163], a[224:227], v[200:203], 0
  s_waitcnt lgkmcnt(5)
  v_add_f32 v34, v34, v212
  v_cvt_pk_bf16_f32 v209, v210, v211
  v_mfma_f32_16x16x32_bf16 a[4:7], a[228:231], v[160:163], 0
  v_exp_f32 v213, v213
  v_mfma_f32_16x16x32_bf16 a[36:39], a[228:231], v[168:171], 0
  ds_read_b64_tr_b16 a[242:243], v30 offset:4096
  v_add_f32 v34, v34, v213
  v_mfma_f32_16x16x32_bf16 a[68:71], a[228:231], v[176:179], 0
  v_exp_f32 v214, v214
  v_mfma_f32_16x16x32_bf16 a[100:103], a[228:231], v[184:187], 0
  v_add_f32 v34, v34, v214
  v_cvt_pk_bf16_f32 v210, v212, v213
  v_mfma_f32_16x16x32_bf16 a[132:135], a[228:231], v[192:195], 0
  v_exp_f32 v215, v215
  v_mfma_f32_16x16x32_bf16 a[164:167], a[228:231], v[200:203], 0
  s_waitcnt lgkmcnt(4)
  ds_read_b64_tr_b16 a[244:245], v31 offset:0
  v_add_f32 v34, v34, v215
  v_mfma_f32_16x16x32_bf16 a[8:11], a[232:235], v[160:163], 0
  v_exp_f32 v216, v216
  v_add_u32 v9, 1441792, v9
  v_mfma_f32_16x16x32_bf16 a[40:43], a[232:235], v[168:171], 0
  v_add_f32 v35, v35, v216
  v_cvt_pk_bf16_f32 v211, v214, v215
  v_mfma_f32_16x16x32_bf16 a[72:75], a[232:235], v[176:179], 0
  v_exp_f32 v217, v217
  v_mfma_f32_16x16x32_bf16 a[104:107], a[232:235], v[184:187], 0
  ds_read_b64_tr_b16 a[246:247], v31 offset:4096
  v_add_f32 v35, v35, v217
  v_mfma_f32_16x16x32_bf16 a[136:139], a[232:235], v[192:195], 0
  v_exp_f32 v218, v218
  v_mfma_f32_16x16x32_bf16 a[168:171], a[232:235], v[200:203], 0
  s_waitcnt lgkmcnt(4)
  v_add_f32 v35, v35, v218
  v_cvt_pk_bf16_f32 v216, v216, v217
  v_mfma_f32_16x16x32_bf16 a[12:15], a[236:239], v[160:163], 0
  buffer_load_dword v21, v9, s[12:15], 0 offen
  v_exp_f32 v219, v219
  v_mfma_f32_16x16x32_bf16 a[44:47], a[236:239], v[168:171], 0
  ds_read_b64_tr_b16 a[248:249], v32 offset:0
  v_add_f32 v35, v35, v219
  v_mfma_f32_16x16x32_bf16 a[76:79], a[236:239], v[176:179], 0
  v_exp_f32 v220, v220
  v_mfma_f32_16x16x32_bf16 a[108:111], a[236:239], v[184:187], 0
  v_add_f32 v35, v35, v220
  v_cvt_pk_bf16_f32 v217, v218, v219
  v_mfma_f32_16x16x32_bf16 a[140:143], a[236:239], v[192:195], 0
  v_exp_f32 v221, v221
  v_mfma_f32_16x16x32_bf16 a[172:175], a[236:239], v[200:203], 0
  s_waitcnt lgkmcnt(3)
  ds_read_b64_tr_b16 a[250:251], v32 offset:4096
  v_add_f32 v35, v35, v221
  v_mfma_f32_16x16x32_bf16 a[16:19], a[240:243], v[160:163], 0
  v_exp_f32 v222, v222
  v_mfma_f32_16x16x32_bf16 a[48:51], a[240:243], v[168:171], 0
  v_add_f32 v35, v35, v222
  v_cvt_pk_bf16_f32 v218, v220, v221
  v_mfma_f32_16x16x32_bf16 a[80:83], a[240:243], v[176:179], 0
  v_exp_f32 v223, v223
  v_mfma_f32_16x16x32_bf16 a[112:115], a[240:243], v[184:187], 0
  ds_read_b64_tr_b16 a[252:253], v33 offset:0
  v_add_f32 v35, v35, v223
  v_mfma_f32_16x16x32_bf16 a[144:147], a[240:243], v[192:195], 0
  v_exp_f32 v224, v224
  v_mfma_f32_16x16x32_bf16 a[176:179], a[240:243], v[200:203], 0
  s_waitcnt lgkmcnt(3)
  v_add_f32 v36, v36, v224
  v_cvt_pk_bf16_f32 v219, v222, v223
  v_mfma_f32_16x16x32_bf16 a[20:23], a[244:247], v[160:163], 0
  v_exp_f32 v225, v225
  v_mfma_f32_16x16x32_bf16 a[52:55], a[244:247], v[168:171], 0
  ds_read_b64_tr_b16 a[254:255], v33 offset:4096
  v_add_f32 v36, v36, v225
  v_mfma_f32_16x16x32_bf16 a[84:87], a[244:247], v[176:179], 0
  v_exp_f32 v226, v226
  v_mfma_f32_16x16x32_bf16 a[116:119], a[244:247], v[184:187], 0
  v_add_f32 v36, v36, v226
  v_cvt_pk_bf16_f32 v224, v224, v225
  v_mfma_f32_16x16x32_bf16 a[148:151], a[244:247], v[192:195], 0
  v_exp_f32 v227, v227
  v_mfma_f32_16x16x32_bf16 a[180:183], a[244:247], v[200:203], 0
  s_waitcnt lgkmcnt(2)
  ds_read_b128 a[192:195], v22 offset:0
  v_add_f32 v36, v36, v227
  v_mfma_f32_16x16x32_bf16 a[24:27], a[248:251], v[160:163], 0
  v_exp_f32 v228, v228
  v_mfma_f32_16x16x32_bf16 a[56:59], a[248:251], v[168:171], 0
  v_add_f32 v36, v36, v228
  v_cvt_pk_bf16_f32 v225, v226, v227
  v_mfma_f32_16x16x32_bf16 a[88:91], a[248:251], v[176:179], 0
  v_exp_f32 v229, v229
  v_mfma_f32_16x16x32_bf16 a[120:123], a[248:251], v[184:187], 0
  ds_read_b128 a[196:199], v23 offset:0
  v_add_f32 v36, v36, v229
  v_mfma_f32_16x16x32_bf16 a[152:155], a[248:251], v[192:195], 0
  v_exp_f32 v230, v230
  v_mfma_f32_16x16x32_bf16 a[184:187], a[248:251], v[200:203], 0
  s_waitcnt lgkmcnt(2)
  v_add_f32 v36, v36, v230
  v_cvt_pk_bf16_f32 v226, v228, v229
  v_mfma_f32_16x16x32_bf16 a[28:31], a[252:255], v[160:163], 0
  v_exp_f32 v231, v231
  v_mfma_f32_16x16x32_bf16 a[60:63], a[252:255], v[168:171], 0
  ds_read_b128 a[200:203], v24 offset:0
  v_add_f32 v36, v36, v231
  v_mfma_f32_16x16x32_bf16 a[92:95], a[252:255], v[176:179], 0
  v_exp_f32 v232, v232
  v_mfma_f32_16x16x32_bf16 a[124:127], a[252:255], v[184:187], 0
  v_add_f32 v37, v37, v232
  v_cvt_pk_bf16_f32 v227, v230, v231
  v_mfma_f32_16x16x32_bf16 a[156:159], a[252:255], v[192:195], 0
  v_exp_f32 v233, v233
  v_mfma_f32_16x16x32_bf16 a[188:191], a[252:255], v[200:203], 0
  s_waitcnt lgkmcnt(2)
  ds_read_b128 a[204:207], v25 offset:0
  v_add_f32 v37, v37, v233
  v_mfma_f32_16x16x32_bf16 v[160:163], a[192:195], v[64:67], v[40:43]
  v_exp_f32 v234, v234
  v_mfma_f32_16x16x32_bf16 v[168:171], a[192:195], v[68:71], v[44:47]
  v_add_f32 v37, v37, v234
  v_cvt_pk_bf16_f32 v232, v232, v233
  v_mfma_f32_16x16x32_bf16 v[176:179], a[192:195], v[72:75], v[48:51]
  v_exp_f32 v235, v235
  v_mfma_f32_16x16x32_bf16 v[184:187], a[192:195], v[76:79], v[52:55]
  ds_read_b128 a[208:211], v22 offset:4096
  v_add_f32 v37, v37, v235
  v_mfma_f32_16x16x32_bf16 v[192:195], a[192:195], v[80:83], v[56:59]
  v_exp_f32 v236, v236
  v_mfma_f32_16x16x32_bf16 v[200:203], a[192:195], v[84:87], v[60:63]
  s_waitcnt lgkmcnt(3)
  v_add_f32 v37, v37, v236
  v_cvt_pk_bf16_f32 v233, v234, v235
  v_mfma_f32_16x16x32_bf16 v[160:163], a[196:199], v[88:91], v[160:163]
  v_exp_f32 v237, v237
  v_mfma_f32_16x16x32_bf16 v[168:171], a[196:199], v[92:95], v[168:171]
  ds_read_b128 a[212:215], v23 offset:4096
  v_add_f32 v37, v37, v237
  v_mfma_f32_16x16x32_bf16 v[176:179], a[196:199], v[96:99], v[176:179]
  v_exp_f32 v238, v238
  v_mfma_f32_16x16x32_bf16 v[184:187], a[196:199], v[100:103], v[184:187]
  v_add_f32 v37, v37, v238
  v_cvt_pk_bf16_f32 v234, v236, v237
  v_mfma_f32_16x16x32_bf16 v[192:195], a[196:199], v[104:107], v[192:195]
  v_exp_f32 v239, v239
  v_mfma_f32_16x16x32_bf16 v[200:203], a[196:199], v[108:111], v[200:203]
  s_waitcnt lgkmcnt(3)
  ds_read_b128 a[216:219], v24 offset:4096
  v_add_f32 v37, v37, v239
  v_mfma_f32_16x16x32_bf16 v[160:163], a[200:203], v[112:115], v[160:163]
  v_exp_f32 v240, v240
  v_mfma_f32_16x16x32_bf16 v[168:171], a[200:203], v[116:119], v[168:171]
  v_add_f32 v38, v38, v240
  v_cvt_pk_bf16_f32 v235, v238, v239
  v_mfma_f32_16x16x32_bf16 v[176:179], a[200:203], v[120:123], v[176:179]
  v_exp_f32 v241, v241
  v_mfma_f32_16x16x32_bf16 v[184:187], a[200:203], v[124:127], v[184:187]
  ds_read_b128 a[220:223], v25 offset:4096
  v_add_f32 v38, v38, v241
  v_mfma_f32_16x16x32_bf16 v[192:195], a[200:203], v[128:131], v[192:195]
  v_exp_f32 v242, v242
  v_add_u32 v9, 1441792, v9
  v_mfma_f32_16x16x32_bf16 v[200:203], a[200:203], v[132:135], v[200:203]
  s_waitcnt lgkmcnt(4)
  v_add_f32 v38, v38, v242
  v_cvt_pk_bf16_f32 v240, v240, v241
  v_mfma_f32_16x16x32_bf16 v[160:163], a[204:207], v[136:139], v[160:163]
  v_exp_f32 v243, v243
  v_mfma_f32_16x16x32_bf16 v[168:171], a[204:207], v[140:143], v[168:171]
  ds_read_b64_tr_b16 a[224:225], v26 offset:8192
  v_add_f32 v38, v38, v243
  v_mfma_f32_16x16x32_bf16 v[176:179], a[204:207], v[144:147], v[176:179]
  v_exp_f32 v244, v244
  v_mfma_f32_16x16x32_bf16 v[184:187], a[204:207], v[148:151], v[184:187]
  v_add_f32 v38, v38, v244
  v_cvt_pk_bf16_f32 v241, v242, v243
  v_mfma_f32_16x16x32_bf16 v[192:195], a[204:207], v[152:155], v[192:195]
  buffer_load_dword v21, v9, s[12:15], 0 offen
  v_exp_f32 v245, v245
  v_mfma_f32_16x16x32_bf16 v[200:203], a[204:207], v[156:159], v[200:203]
  s_waitcnt lgkmcnt(4)
  ds_read_b64_tr_b16 a[226:227], v26 offset:12288
  v_add_f32 v38, v38, v245
  v_mfma_f32_16x16x32_bf16 v[164:167], a[208:211], v[64:67], v[40:43]
  v_exp_f32 v246, v246
  v_mfma_f32_16x16x32_bf16 v[172:175], a[208:211], v[68:71], v[44:47]
  v_add_f32 v38, v38, v246
  v_cvt_pk_bf16_f32 v242, v244, v245
  v_mfma_f32_16x16x32_bf16 v[180:183], a[208:211], v[72:75], v[48:51]
  v_exp_f32 v247, v247
  v_mfma_f32_16x16x32_bf16 v[188:191], a[208:211], v[76:79], v[52:55]
  ds_read_b64_tr_b16 a[228:229], v27 offset:8192
  v_add_f32 v38, v38, v247
  v_mfma_f32_16x16x32_bf16 v[196:199], a[208:211], v[80:83], v[56:59]
  v_exp_f32 v248, v248
  v_mfma_f32_16x16x32_bf16 v[204:207], a[208:211], v[84:87], v[60:63]
  s_waitcnt lgkmcnt(5)
  v_add_f32 v39, v39, v248
  v_cvt_pk_bf16_f32 v243, v246, v247
  v_mfma_f32_16x16x32_bf16 v[164:167], a[212:215], v[88:91], v[164:167]
  v_exp_f32 v249, v249
  v_mfma_f32_16x16x32_bf16 v[172:175], a[212:215], v[92:95], v[172:175]
  ds_read_b64_tr_b16 a[230:231], v27 offset:12288
  v_add_f32 v39, v39, v249
  v_mfma_f32_16x16x32_bf16 v[180:183], a[212:215], v[96:99], v[180:183]
  v_exp_f32 v250, v250
  v_mfma_f32_16x16x32_bf16 v[188:191], a[212:215], v[100:103], v[188:191]
  v_add_f32 v39, v39, v250
  v_cvt_pk_bf16_f32 v248, v248, v249
  v_mfma_f32_16x16x32_bf16 v[196:199], a[212:215], v[104:107], v[196:199]
  v_exp_f32 v251, v251
  v_mfma_f32_16x16x32_bf16 v[204:207], a[212:215], v[108:111], v[204:207]
  s_waitcnt lgkmcnt(5)
  ds_read_b64_tr_b16 a[232:233], v28 offset:8192
  v_add_f32 v39, v39, v251
  v_mfma_f32_16x16x32_bf16 v[164:167], a[216:219], v[112:115], v[164:167]
  v_exp_f32 v252, v252
  v_mfma_f32_16x16x32_bf16 v[172:175], a[216:219], v[116:119], v[172:175]
  v_add_f32 v39, v39, v252
  v_cvt_pk_bf16_f32 v249, v250, v251
  v_mfma_f32_16x16x32_bf16 v[180:183], a[216:219], v[120:123], v[180:183]
  v_exp_f32 v253, v253
  v_mfma_f32_16x16x32_bf16 v[188:191], a[216:219], v[124:127], v[188:191]
  ds_read_b64_tr_b16 a[234:235], v28 offset:12288
  v_add_f32 v39, v39, v253
  v_mfma_f32_16x16x32_bf16 v[196:199], a[216:219], v[128:131], v[196:199]
  v_exp_f32 v254, v254
  v_mfma_f32_16x16x32_bf16 v[204:207], a[216:219], v[132:135], v[204:207]
  s_waitcnt lgkmcnt(6)
  v_add_f32 v39, v39, v254
  v_cvt_pk_bf16_f32 v250, v252, v253
  v_mfma_f32_16x16x32_bf16 v[164:167], a[220:223], v[136:139], v[164:167]
  v_exp_f32 v255, v255
  v_mfma_f32_16x16x32_bf16 v[172:175], a[220:223], v[140:143], v[172:175]
  ds_read_b64_tr_b16 a[236:237], v29 offset:8192
  v_add_f32 v39, v39, v255
  v_mfma_f32_16x16x32_bf16 v[180:183], a[220:223], v[144:147], v[180:183]
  v_exp_f32 v160, v160
  v_mfma_f32_16x16x32_bf16 v[188:191], a[220:223], v[148:151], v[188:191]
  v_cvt_pk_bf16_f32 v251, v254, v255
  v_add_f32 v34, v34, v160
  v_mfma_f32_16x16x32_bf16 v[196:199], a[220:223], v[152:155], v[196:199]
  v_exp_f32 v161, v161
  v_mfma_f32_16x16x32_bf16 v[204:207], a[220:223], v[156:159], v[204:207]
  s_waitcnt lgkmcnt(5)
  ds_read_b64_tr_b16 a[238:239], v29 offset:12288
  v_add_f32 v34, v34, v161
  v_mfma_f32_16x16x32_bf16 a[0:3], a[224:227], v[208:211], a[0:3]
  v_exp_f32 v162, v162
  v_mfma_f32_16x16x32_bf16 a[32:35], a[224:227], v[216:219], a[32:35]
  v_add_f32 v34, v34, v162
  v_cvt_pk_bf16_f32 v160, v160, v161
  v_mfma_f32_16x16x32_bf16 a[64:67], a[224:227], v[224:227], a[64:67]
  v_exp_f32 v163, v163
  v_mfma_f32_16x16x32_bf16 a[96:99], a[224:227], v[232:235], a[96:99]
  ds_read_b64_tr_b16 a[240:241], v30 offset:8192
  v_add_f32 v34, v34, v163
  v_mfma_f32_16x16x32_bf16 a[128:131], a[224:227], v[240:243], a[128:131]
  v_exp_f32 v164, v164
  v_mfma_f32_16x16x32_bf16 a[160:163], a[224:227], v[248:251], a[160:163]
  s_waitcnt lgkmcnt(5)
  v_add_f32 v34, v34, v164
  v_cvt_pk_bf16_f32 v161, v162, v163
  v_mfma_f32_16x16x32_bf16 a[4:7], a[228:231], v[208:211], a[4:7]
  v_exp_f32 v165, v165
  v_mfma_f32_16x16x32_bf16 a[36:39], a[228:231], v[216:219], a[36:39]
  ds_read_b64_tr_b16 a[242:243], v30 offset:12288
  v_add_f32 v34, v34, v165
  v_mfma_f32_16x16x32_bf16 a[68:71], a[228:231], v[224:227], a[68:71]
  v_exp_f32 v166, v166
  v_mfma_f32_16x16x32_bf16 a[100:103], a[228:231], v[232:235], a[100:103]
  v_add_f32 v34, v34, v166
  v_cvt_pk_bf16_f32 v162, v164, v165
  v_mfma_f32_16x16x32_bf16 a[132:135], a[228:231], v[240:243], a[132:135]
  v_exp_f32 v167, v167
  v_mfma_f32_16x16x32_bf16 a[164:167], a[228:231], v[248:251], a[164:167]
  s_waitcnt lgkmcnt(4)
  ds_read_b64_tr_b16 a[244:245], v31 offset:8192
  v_add_f32 v34, v34, v167
  v_mfma_f32_16x16x32_bf16 a[8:11], a[232:235], v[208:211], a[8:11]
  v_exp_f32 v168, v168
  v_mfma_f32_16x16x32_bf16 a[40:43], a[232:235], v[216:219], a[40:43]
  v_add_f32 v35, v35, v168
  v_cvt_pk_bf16_f32 v163, v166, v167
  v_mfma_f32_16x16x32_bf16 a[72:75], a[232:235], v[224:227], a[72:75]
  v_exp_f32 v169, v169
  v_mfma_f32_16x16x32_bf16 a[104:107], a[232:235], v[232:235], a[104:107]
  ds_read_b64_tr_b16 a[246:247], v31 offset:12288
  v_add_f32 v35, v35, v169
  v_mfma_f32_16x16x32_bf16 a[136:139], a[232:235], v[240:243], a[136:139]
  v_exp_f32 v170, v170
  v_mfma_f32_16x16x32_bf16 a[168:171], a[232:235], v[248:251], a[168:171]
  s_waitcnt lgkmcnt(4)
  v_add_f32 v35, v35, v170
  v_cvt_pk_bf16_f32 v168, v168, v169
  v_mfma_f32_16x16x32_bf16 a[12:15], a[236:239], v[208:211], a[12:15]
  v_exp_f32 v171, v171
  v_add_u32 v9, 1441792, v9
  v_mfma_f32_16x16x32_bf16 a[44:47], a[236:239], v[216:219], a[44:47]
  ds_read_b64_tr_b16 a[248:249], v32 offset:8192
  v_add_f32 v35, v35, v171
  v_mfma_f32_16x16x32_bf16 a[76:79], a[236:239], v[224:227], a[76:79]
  v_exp_f32 v172, v172
  v_mfma_f32_16x16x32_bf16 a[108:111], a[236:239], v[232:235], a[108:111]
  v_add_f32 v35, v35, v172
  v_cvt_pk_bf16_f32 v169, v170, v171
  v_mfma_f32_16x16x32_bf16 a[140:143], a[236:239], v[240:243], a[140:143]
  v_exp_f32 v173, v173
  v_mfma_f32_16x16x32_bf16 a[172:175], a[236:239], v[248:251], a[172:175]
  s_waitcnt lgkmcnt(3)
  ds_read_b64_tr_b16 a[250:251], v32 offset:12288
  v_add_f32 v35, v35, v173
  v_mfma_f32_16x16x32_bf16 a[16:19], a[240:243], v[208:211], a[16:19]
  buffer_load_dword v21, v9, s[12:15], 0 offen
  v_exp_f32 v174, v174
  v_mfma_f32_16x16x32_bf16 a[48:51], a[240:243], v[216:219], a[48:51]
  v_add_f32 v35, v35, v174
  v_cvt_pk_bf16_f32 v170, v172, v173
  v_mfma_f32_16x16x32_bf16 a[80:83], a[240:243], v[224:227], a[80:83]
  v_exp_f32 v175, v175
  v_mfma_f32_16x16x32_bf16 a[112:115], a[240:243], v[232:235], a[112:115]
  ds_read_b64_tr_b16 a[252:253], v33 offset:8192
  v_add_f32 v35, v35, v175
  v_mfma_f32_16x16x32_bf16 a[144:147], a[240:243], v[240:243], a[144:147]
  v_exp_f32 v176, v176
  v_mfma_f32_16x16x32_bf16 a[176:179], a[240:243], v[248:251], a[176:179]
  s_waitcnt lgkmcnt(3)
  v_add_f32 v36, v36, v176
  v_cvt_pk_bf16_f32 v171, v174, v175
  v_mfma_f32_16x16x32_bf16 a[20:23], a[244:247], v[208:211], a[20:23]
  v_exp_f32 v177, v177
  v_mfma_f32_16x16x32_bf16 a[52:55], a[244:247], v[216:219], a[52:55]
  ds_read_b64_tr_b16 a[254:255], v33 offset:12288
  v_add_f32 v36, v36, v177
  v_mfma_f32_16x16x32_bf16 a[84:87], a[244:247], v[224:227], a[84:87]
  v_exp_f32 v178, v178
  v_mfma_f32_16x16x32_bf16 a[116:119], a[244:247], v[232:235], a[116:119]
  v_add_f32 v36, v36, v178
  v_cvt_pk_bf16_f32 v176, v176, v177
  v_mfma_f32_16x16x32_bf16 a[148:151], a[244:247], v[240:243], a[148:151]
  v_exp_f32 v179, v179
  v_mfma_f32_16x16x32_bf16 a[180:183], a[244:247], v[248:251], a[180:183]
  s_waitcnt lgkmcnt(2)
  ds_read_b128 a[192:195], v22 offset:8192
  v_add_f32 v36, v36, v179
  v_mfma_f32_16x16x32_bf16 a[24:27], a[248:251], v[208:211], a[24:27]
  v_exp_f32 v180, v180
  v_mfma_f32_16x16x32_bf16 a[56:59], a[248:251], v[216:219], a[56:59]
  v_add_f32 v36, v36, v180
  v_cvt_pk_bf16_f32 v177, v178, v179
  v_mfma_f32_16x16x32_bf16 a[88:91], a[248:251], v[224:227], a[88:91]
  v_exp_f32 v181, v181
  v_mfma_f32_16x16x32_bf16 a[120:123], a[248:251], v[232:235], a[120:123]
  ds_read_b128 a[196:199], v23 offset:8192
  v_add_f32 v36, v36, v181
  v_mfma_f32_16x16x32_bf16 a[152:155], a[248:251], v[240:243], a[152:155]
  v_exp_f32 v182, v182
  v_mfma_f32_16x16x32_bf16 a[184:187], a[248:251], v[248:251], a[184:187]
  s_waitcnt lgkmcnt(2)
  v_add_f32 v36, v36, v182
  v_cvt_pk_bf16_f32 v178, v180, v181
  v_mfma_f32_16x16x32_bf16 a[28:31], a[252:255], v[208:211], a[28:31]
  v_exp_f32 v183, v183
  v_mfma_f32_16x16x32_bf16 a[60:63], a[252:255], v[216:219], a[60:63]
  ds_read_b128 a[200:203], v24 offset:8192
  v_add_f32 v36, v36, v183
  v_mfma_f32_16x16x32_bf16 a[92:95], a[252:255], v[224:227], a[92:95]
  v_exp_f32 v184, v184
  v_mfma_f32_16x16x32_bf16 a[124:127], a[252:255], v[232:235], a[124:127]
  v_add_f32 v37, v37, v184
  v_cvt_pk_bf16_f32 v179, v182, v183
  v_mfma_f32_16x16x32_bf16 a[156:159], a[252:255], v[240:243], a[156:159]
  s_waitcnt vmcnt(14)
  s_barrier
  v_exp_f32 v185, v185
  v_mfma_f32_16x16x32_bf16 a[188:191], a[252:255], v[248:251], a[188:191]
  s_waitcnt lgkmcnt(2)
  ds_read_b128 a[204:207], v25 offset:8192
  v_add_f32 v37, v37, v185
  v_mfma_f32_16x16x32_bf16 v[208:211], a[192:195], v[64:67], v[40:43]
  s_add_u32 m0, s72, 147456
  v_exp_f32 v186, v186
  v_mfma_f32_16x16x32_bf16 v[216:219], a[192:195], v[68:71], v[44:47]
  v_add_f32 v37, v37, v186
  v_cvt_pk_bf16_f32 v184, v184, v185
  v_mfma_f32_16x16x32_bf16 v[224:227], a[192:195], v[72:75], v[48:51]
  v_exp_f32 v187, v187
  v_mfma_f32_16x16x32_bf16 v[232:235], a[192:195], v[76:79], v[52:55]
  ds_read_b128 a[208:211], v22 offset:12288
  v_add_f32 v37, v37, v187
  v_mfma_f32_16x16x32_bf16 v[240:243], a[192:195], v[80:83], v[56:59]
  v_exp_f32 v188, v188
  v_mfma_f32_16x16x32_bf16 v[248:251], a[192:195], v[84:87], v[60:63]
  s_waitcnt lgkmcnt(3)
  v_add_f32 v37, v37, v188
  v_cvt_pk_bf16_f32 v185, v186, v187
  v_mfma_f32_16x16x32_bf16 v[208:211], a[196:199], v[88:91], v[208:211]
  v_exp_f32 v189, v189
  v_mfma_f32_16x16x32_bf16 v[216:219], a[196:199], v[92:95], v[216:219]
  ds_read_b128 a[212:215], v23 offset:12288
  v_add_f32 v37, v37, v189
  v_mfma_f32_16x16x32_bf16 v[224:227], a[196:199], v[96:99], v[224:227]
  s_add_u32 s3, s71, 65536
  v_exp_f32 v190, v190
  v_mfma_f32_16x16x32_bf16 v[232:235], a[196:199], v[100:103], v[232:235]
  v_add_f32 v37, v37, v190
  v_cvt_pk_bf16_f32 v186, v188, v189
  v_mfma_f32_16x16x32_bf16 v[240:243], a[196:199], v[104:107], v[240:243]
  v_exp_f32 v191, v191
  v_mfma_f32_16x16x32_bf16 v[248:251], a[196:199], v[108:111], v[248:251]
  s_waitcnt lgkmcnt(3)
  ds_read_b128 a[216:219], v24 offset:12288
  v_add_f32 v37, v37, v191
  v_mfma_f32_16x16x32_bf16 v[208:211], a[200:203], v[112:115], v[208:211]
  v_exp_f32 v192, v192
  v_mfma_f32_16x16x32_bf16 v[216:219], a[200:203], v[116:119], v[216:219]
  v_add_f32 v38, v38, v192
  v_cvt_pk_bf16_f32 v187, v190, v191
  v_mfma_f32_16x16x32_bf16 v[224:227], a[200:203], v[120:123], v[224:227]
  v_exp_f32 v193, v193
  v_mfma_f32_16x16x32_bf16 v[232:235], a[200:203], v[124:127], v[232:235]
  ds_read_b128 a[220:223], v25 offset:12288
  v_add_f32 v38, v38, v193
  v_mfma_f32_16x16x32_bf16 v[240:243], a[200:203], v[128:131], v[240:243]
  buffer_load_dwordx4 v7, s[16:19], s3 offen offset:0 nt lds
  v_exp_f32 v194, v194
  v_mfma_f32_16x16x32_bf16 v[248:251], a[200:203], v[132:135], v[248:251]
  s_waitcnt lgkmcnt(4)
  v_add_f32 v38, v38, v194
  v_cvt_pk_bf16_f32 v192, v192, v193
  v_mfma_f32_16x16x32_bf16 v[208:211], a[204:207], v[136:139], v[208:211]
  v_exp_f32 v195, v195
  v_mfma_f32_16x16x32_bf16 v[216:219], a[204:207], v[140:143], v[216:219]
  ds_read_b64_tr_b16 a[224:225], v26 offset:16384
  v_add_f32 v38, v38, v195
  v_mfma_f32_16x16x32_bf16 v[224:227], a[204:207], v[144:147], v[224:227]
  v_exp_f32 v196, v196
  v_mfma_f32_16x16x32_bf16 v[232:235], a[204:207], v[148:151], v[232:235]
  v_add_f32 v38, v38, v196
  v_cvt_pk_bf16_f32 v193, v194, v195
  v_mfma_f32_16x16x32_bf16 v[240:243], a[204:207], v[152:155], v[240:243]
  v_exp_f32 v197, v197
  v_add_u32 v9, 1441792, v9
  v_mfma_f32_16x16x32_bf16 v[248:251], a[204:207], v[156:159], v[248:251]
  s_waitcnt lgkmcnt(4)
  ds_read_b64_tr_b16 a[226:227], v26 offset:20480
  v_add_f32 v38, v38, v197
  v_mfma_f32_16x16x32_bf16 v[212:215], a[208:211], v[64:67], v[40:43]
  buffer_load_dwordx4 v8, s[16:19], s3 offen offset:1024 nt lds
  v_exp_f32 v198, v198
  v_mfma_f32_16x16x32_bf16 v[220:223], a[208:211], v[68:71], v[44:47]
  v_add_f32 v38, v38, v198
  v_cvt_pk_bf16_f32 v194, v196, v197
  v_mfma_f32_16x16x32_bf16 v[228:231], a[208:211], v[72:75], v[48:51]
  v_exp_f32 v199, v199
  v_mfma_f32_16x16x32_bf16 v[236:239], a[208:211], v[76:79], v[52:55]
  ds_read_b64_tr_b16 a[228:229], v27 offset:16384
  v_add_f32 v38, v38, v199
  v_mfma_f32_16x16x32_bf16 v[244:247], a[208:211], v[80:83], v[56:59]
  buffer_load_dword v21, v9, s[12:15], 0 offen
  v_exp_f32 v200, v200
  v_mfma_f32_16x16x32_bf16 v[252:255], a[208:211], v[84:87], v[60:63]
  s_waitcnt lgkmcnt(5)
  v_add_f32 v39, v39, v200
  v_cvt_pk_bf16_f32 v195, v198, v199
  v_mfma_f32_16x16x32_bf16 v[212:215], a[212:215], v[88:91], v[212:215]
  v_exp_f32 v201, v201
  v_mfma_f32_16x16x32_bf16 v[220:223], a[212:215], v[92:95], v[220:223]
  ds_read_b64_tr_b16 a[230:231], v27 offset:20480
  v_add_f32 v39, v39, v201
  v_mfma_f32_16x16x32_bf16 v[228:231], a[212:215], v[96:99], v[228:231]
  buffer_load_dwordx4 v7, s[16:19], s3 offen offset:2048 nt lds
  v_exp_f32 v202, v202
  v_mfma_f32_16x16x32_bf16 v[236:239], a[212:215], v[100:103], v[236:239]
  v_add_f32 v39, v39, v202
  v_cvt_pk_bf16_f32 v200, v200, v201
  v_mfma_f32_16x16x32_bf16 v[244:247], a[212:215], v[104:107], v[244:247]
  v_exp_f32 v203, v203
  v_mfma_f32_16x16x32_bf16 v[252:255], a[212:215], v[108:111], v[252:255]
  s_waitcnt lgkmcnt(5)
  ds_read_b64_tr_b16 a[232:233], v28 offset:16384
  v_add_f32 v39, v39, v203
  v_mfma_f32_16x16x32_bf16 v[212:215], a[216:219], v[112:115], v[212:215]
  v_exp_f32 v204, v204
  v_mfma_f32_16x16x32_bf16 v[220:223], a[216:219], v[116:119], v[220:223]
  v_add_f32 v39, v39, v204
  v_cvt_pk_bf16_f32 v201, v202, v203
  v_mfma_f32_16x16x32_bf16 v[228:231], a[216:219], v[120:123], v[228:231]
  v_exp_f32 v205, v205
  v_mfma_f32_16x16x32_bf16 v[236:239], a[216:219], v[124:127], v[236:239]
  ds_read_b64_tr_b16 a[234:235], v28 offset:20480
  v_add_f32 v39, v39, v205
  v_mfma_f32_16x16x32_bf16 v[244:247], a[216:219], v[128:131], v[244:247]
  buffer_load_dwordx4 v8, s[16:19], s3 offen offset:3072 nt lds
  v_exp_f32 v206, v206
  v_mfma_f32_16x16x32_bf16 v[252:255], a[216:219], v[132:135], v[252:255]
  s_waitcnt lgkmcnt(6)
  v_add_f32 v39, v39, v206
  v_cvt_pk_bf16_f32 v202, v204, v205
  v_mfma_f32_16x16x32_bf16 v[212:215], a[220:223], v[136:139], v[212:215]
  v_exp_f32 v207, v207
  v_mfma_f32_16x16x32_bf16 v[220:223], a[220:223], v[140:143], v[220:223]
  ds_read_b64_tr_b16 a[236:237], v29 offset:16384
  v_add_f32 v39, v39, v207
  v_mfma_f32_16x16x32_bf16 v[228:231], a[220:223], v[144:147], v[228:231]
  v_exp_f32 v208, v208
  v_mfma_f32_16x16x32_bf16 v[236:239], a[220:223], v[148:151], v[236:239]
  v_cvt_pk_bf16_f32 v203, v206, v207
  v_add_f32 v34, v34, v208
  v_mfma_f32_16x16x32_bf16 v[244:247], a[220:223], v[152:155], v[244:247]
  v_exp_f32 v209, v209
  v_mfma_f32_16x16x32_bf16 v[252:255], a[220:223], v[156:159], v[252:255]
  s_waitcnt lgkmcnt(5)
  ds_read_b64_tr_b16 a[238:239], v29 offset:20480
  v_add_f32 v34, v34, v209
  v_mfma_f32_16x16x32_bf16 a[0:3], a[224:227], v[160:163], a[0:3]
  s_add_u32 m0, s72, 0
  v_exp_f32 v210, v210
  v_mfma_f32_16x16x32_bf16 a[32:35], a[224:227], v[168:171], a[32:35]
  v_add_f32 v34, v34, v210
  v_cvt_pk_bf16_f32 v208, v208, v209
  v_mfma_f32_16x16x32_bf16 a[64:67], a[224:227], v[176:179], a[64:67]
  v_exp_f32 v211, v211
  v_mfma_f32_16x16x32_bf16 a[96:99], a[224:227], v[184:187], a[96:99]
  ds_read_b64_tr_b16 a[240:241], v30 offset:16384
  v_add_f32 v34, v34, v211
  v_mfma_f32_16x16x32_bf16 a[128:131], a[224:227], v[192:195], a[128:131]
  v_exp_f32 v212, v212
  v_mfma_f32_16x16x32_bf16 a[160:163], a[224:227], v[200:203], a[160:163]
  s_waitcnt lgkmcnt(5)
  v_add_f32 v34, v34, v212
  v_cvt_pk_bf16_f32 v209, v210, v211
  v_mfma_f32_16x16x32_bf16 a[4:7], a[228:231], v[160:163], a[4:7]
  v_exp_f32 v213, v213
  v_mfma_f32_16x16x32_bf16 a[36:39], a[228:231], v[168:171], a[36:39]
  ds_read_b64_tr_b16 a[242:243], v30 offset:20480
  v_add_f32 v34, v34, v213
  v_mfma_f32_16x16x32_bf16 a[68:71], a[228:231], v[176:179], a[68:71]
  s_add_u32 s3, s71, 65536
  v_exp_f32 v214, v214
  v_mfma_f32_16x16x32_bf16 a[100:103], a[228:231], v[184:187], a[100:103]
  v_add_f32 v34, v34, v214
  v_cvt_pk_bf16_f32 v210, v212, v213
  v_mfma_f32_16x16x32_bf16 a[132:135], a[228:231], v[192:195], a[132:135]
  v_exp_f32 v215, v215
  v_mfma_f32_16x16x32_bf16 a[164:167], a[228:231], v[200:203], a[164:167]
  s_waitcnt lgkmcnt(4)
  ds_read_b64_tr_b16 a[244:245], v31 offset:16384
  v_add_f32 v34, v34, v215
  v_mfma_f32_16x16x32_bf16 a[8:11], a[232:235], v[160:163], a[8:11]
  v_exp_f32 v216, v216
  v_mfma_f32_16x16x32_bf16 a[40:43], a[232:235], v[168:171], a[40:43]
  v_add_f32 v35, v35, v216
  v_cvt_pk_bf16_f32 v211, v214, v215
  v_mfma_f32_16x16x32_bf16 a[72:75], a[232:235], v[176:179], a[72:75]
  v_exp_f32 v217, v217
  v_mfma_f32_16x16x32_bf16 a[104:107], a[232:235], v[184:187], a[104:107]
  ds_read_b64_tr_b16 a[246:247], v31 offset:20480
  v_add_f32 v35, v35, v217
  v_mfma_f32_16x16x32_bf16 a[136:139], a[232:235], v[192:195], a[136:139]
  buffer_load_dwordx4 v7, s[20:23], s3 offen offset:0 nt lds
  v_exp_f32 v218, v218
  v_mfma_f32_16x16x32_bf16 a[168:171], a[232:235], v[200:203], a[168:171]
  s_waitcnt lgkmcnt(4)
  v_add_f32 v35, v35, v218
  v_cvt_pk_bf16_f32 v216, v216, v217
  v_mfma_f32_16x16x32_bf16 a[12:15], a[236:239], v[160:163], a[12:15]
  s_mov_b32 s12, s44
  v_exp_f32 v219, v219
  v_mfma_f32_16x16x32_bf16 a[44:47], a[236:239], v[168:171], a[44:47]
  ds_read_b64_tr_b16 a[248:249], v32 offset:16384
  v_add_f32 v35, v35, v219
  v_mfma_f32_16x16x32_bf16 a[76:79], a[236:239], v[176:179], a[76:79]
  s_mov_b32 s13, s45
  v_exp_f32 v220, v220
  v_mfma_f32_16x16x32_bf16 a[108:111], a[236:239], v[184:187], a[108:111]
  v_add_f32 v35, v35, v220
  v_cvt_pk_bf16_f32 v217, v218, v219
  v_mfma_f32_16x16x32_bf16 a[140:143], a[236:239], v[192:195], a[140:143]
  s_mov_b32 s14, 4718592
  v_exp_f32 v221, v221
  v_mfma_f32_16x16x32_bf16 a[172:175], a[236:239], v[200:203], a[172:175]
  s_waitcnt lgkmcnt(3)
  ds_read_b64_tr_b16 a[250:251], v32 offset:20480
  v_add_f32 v35, v35, v221
  v_mfma_f32_16x16x32_bf16 a[16:19], a[240:243], v[160:163], a[16:19]
  buffer_load_dwordx4 v8, s[20:23], s3 offen offset:1024 nt lds
  v_exp_f32 v222, v222
  v_mfma_f32_16x16x32_bf16 a[48:51], a[240:243], v[168:171], a[48:51]
  v_add_f32 v35, v35, v222
  v_cvt_pk_bf16_f32 v218, v220, v221
  v_mfma_f32_16x16x32_bf16 a[80:83], a[240:243], v[176:179], a[80:83]
  v_exp_f32 v223, v223
  v_add_u32 v9, 4287758336, v9
  v_mfma_f32_16x16x32_bf16 a[112:115], a[240:243], v[184:187], a[112:115]
  ds_read_b64_tr_b16 a[252:253], v33 offset:16384
  v_add_f32 v35, v35, v223
  v_mfma_f32_16x16x32_bf16 a[144:147], a[240:243], v[192:195], a[144:147]
  v_exp_f32 v224, v224
  v_mfma_f32_16x16x32_bf16 a[176:179], a[240:243], v[200:203], a[176:179]
  s_waitcnt lgkmcnt(3)
  v_add_f32 v36, v36, v224
  v_cvt_pk_bf16_f32 v219, v222, v223
  v_mfma_f32_16x16x32_bf16 a[20:23], a[244:247], v[160:163], a[20:23]
  v_exp_f32 v225, v225
  v_mfma_f32_16x16x32_bf16 a[52:55], a[244:247], v[168:171], a[52:55]
  ds_read_b64_tr_b16 a[254:255], v33 offset:20480
  v_add_f32 v36, v36, v225
  v_mfma_f32_16x16x32_bf16 a[84:87], a[244:247], v[176:179], a[84:87]
  buffer_load_dword v21, v9, s[12:15], 0 offen
  buffer_load_dwordx4 v7, s[20:23], s3 offen offset:2048 nt lds
  v_exp_f32 v226, v226
  v_mfma_f32_16x16x32_bf16 a[116:119], a[244:247], v[184:187], a[116:119]
  v_add_f32 v36, v36, v226
  v_cvt_pk_bf16_f32 v224, v224, v225
  v_mfma_f32_16x16x32_bf16 a[148:151], a[244:247], v[192:195], a[148:151]
  v_exp_f32 v227, v227
  v_mfma_f32_16x16x32_bf16 a[180:183], a[244:247], v[200:203], a[180:183]
  s_waitcnt lgkmcnt(2)
  ds_read_b128 a[192:195], v22 offset:16384
  v_add_f32 v36, v36, v227
  v_mfma_f32_16x16x32_bf16 a[24:27], a[248:251], v[160:163], a[24:27]
  v_exp_f32 v228, v228
  v_mfma_f32_16x16x32_bf16 a[56:59], a[248:251], v[168:171], a[56:59]
  v_add_f32 v36, v36, v228
  v_cvt_pk_bf16_f32 v225, v226, v227
  v_mfma_f32_16x16x32_bf16 a[88:91], a[248:251], v[176:179], a[88:91]
  v_exp_f32 v229, v229
  v_mfma_f32_16x16x32_bf16 a[120:123], a[248:251], v[184:187], a[120:123]
  ds_read_b128 a[196:199], v23 offset:16384
  v_add_f32 v36, v36, v229
  v_mfma_f32_16x16x32_bf16 a[152:155], a[248:251], v[192:195], a[152:155]
  buffer_load_dwordx4 v8, s[20:23], s3 offen offset:3072 nt lds
  v_exp_f32 v230, v230
  v_mfma_f32_16x16x32_bf16 a[184:187], a[248:251], v[200:203], a[184:187]
  s_waitcnt lgkmcnt(2)
  v_add_f32 v36, v36, v230
  v_cvt_pk_bf16_f32 v226, v228, v229
  v_mfma_f32_16x16x32_bf16 a[28:31], a[252:255], v[160:163], a[28:31]
  v_exp_f32 v231, v231
  v_mfma_f32_16x16x32_bf16 a[60:63], a[252:255], v[168:171], a[60:63]
  ds_read_b128 a[200:203], v24 offset:16384
  v_add_f32 v36, v36, v231
  v_mfma_f32_16x16x32_bf16 a[92:95], a[252:255], v[176:179], a[92:95]
  v_exp_f32 v232, v232
  v_mfma_f32_16x16x32_bf16 a[124:127], a[252:255], v[184:187], a[124:127]
  v_add_f32 v37, v37, v232
  v_cvt_pk_bf16_f32 v227, v230, v231
  v_mfma_f32_16x16x32_bf16 a[156:159], a[252:255], v[192:195], a[156:159]
  v_exp_f32 v233, v233
  v_mfma_f32_16x16x32_bf16 a[188:191], a[252:255], v[200:203], a[188:191]
  s_waitcnt lgkmcnt(2)
  ds_read_b128 a[204:207], v25 offset:16384
  v_add_f32 v37, v37, v233
  v_mfma_f32_16x16x32_bf16 v[160:163], a[192:195], v[64:67], v[40:43]
  v_exp_f32 v234, v234
  v_mfma_f32_16x16x32_bf16 v[168:171], a[192:195], v[68:71], v[44:47]
  v_add_f32 v37, v37, v234
  v_cvt_pk_bf16_f32 v232, v232, v233
  v_mfma_f32_16x16x32_bf16 v[176:179], a[192:195], v[72:75], v[48:51]
  v_exp_f32 v235, v235
  v_mfma_f32_16x16x32_bf16 v[184:187], a[192:195], v[76:79], v[52:55]
  ds_read_b128 a[208:211], v22 offset:20480
  v_add_f32 v37, v37, v235
  v_mfma_f32_16x16x32_bf16 v[192:195], a[192:195], v[80:83], v[56:59]
  v_exp_f32 v236, v236
  v_mfma_f32_16x16x32_bf16 v[200:203], a[192:195], v[84:87], v[60:63]
  s_waitcnt lgkmcnt(3)
  v_add_f32 v37, v37, v236
  v_cvt_pk_bf16_f32 v233, v234, v235
  v_mfma_f32_16x16x32_bf16 v[160:163], a[196:199], v[88:91], v[160:163]
  v_exp_f32 v237, v237
  v_mfma_f32_16x16x32_bf16 v[168:171], a[196:199], v[92:95], v[168:171]
  ds_read_b128 a[212:215], v23 offset:20480
  v_add_f32 v37, v37, v237
  v_mfma_f32_16x16x32_bf16 v[176:179], a[196:199], v[96:99], v[176:179]
  v_exp_f32 v238, v238
  v_mfma_f32_16x16x32_bf16 v[184:187], a[196:199], v[100:103], v[184:187]
  v_add_f32 v37, v37, v238
  v_cvt_pk_bf16_f32 v234, v236, v237
  v_mfma_f32_16x16x32_bf16 v[192:195], a[196:199], v[104:107], v[192:195]
  v_exp_f32 v239, v239
  v_mfma_f32_16x16x32_bf16 v[200:203], a[196:199], v[108:111], v[200:203]
  s_waitcnt lgkmcnt(3)
  ds_read_b128 a[216:219], v24 offset:20480
  v_add_f32 v37, v37, v239
  v_mfma_f32_16x16x32_bf16 v[160:163], a[200:203], v[112:115], v[160:163]
  v_exp_f32 v240, v240
  v_mfma_f32_16x16x32_bf16 v[168:171], a[200:203], v[116:119], v[168:171]
  v_add_f32 v38, v38, v240
  v_cvt_pk_bf16_f32 v235, v238, v239
  v_mfma_f32_16x16x32_bf16 v[176:179], a[200:203], v[120:123], v[176:179]
  v_exp_f32 v241, v241
  v_mfma_f32_16x16x32_bf16 v[184:187], a[200:203], v[124:127], v[184:187]
  ds_read_b128 a[220:223], v25 offset:20480
  v_add_f32 v38, v38, v241
  v_mfma_f32_16x16x32_bf16 v[192:195], a[200:203], v[128:131], v[192:195]
  v_exp_f32 v242, v242
  v_mfma_f32_16x16x32_bf16 v[200:203], a[200:203], v[132:135], v[200:203]
  s_waitcnt lgkmcnt(4)
  v_add_f32 v38, v38, v242
  v_cvt_pk_bf16_f32 v240, v240, v241
  v_mfma_f32_16x16x32_bf16 v[160:163], a[204:207], v[136:139], v[160:163]
  v_exp_f32 v243, v243
  v_mfma_f32_16x16x32_bf16 v[168:171], a[204:207], v[140:143], v[168:171]
  ds_read_b64_tr_b16 a[224:225], v26 offset:24576
  v_add_f32 v38, v38, v243
  v_mfma_f32_16x16x32_bf16 v[176:179], a[204:207], v[144:147], v[176:179]
  v_exp_f32 v244, v244
  v_mfma_f32_16x16x32_bf16 v[184:187], a[204:207], v[148:151], v[184:187]
  v_add_f32 v38, v38, v244
  v_cvt_pk_bf16_f32 v241, v242, v243
  v_mfma_f32_16x16x32_bf16 v[192:195], a[204:207], v[152:155], v[192:195]
  v_exp_f32 v245, v245
  v_mfma_f32_16x16x32_bf16 v[200:203], a[204:207], v[156:159], v[200:203]
  s_waitcnt lgkmcnt(4)
  ds_read_b64_tr_b16 a[226:227], v26 offset:28672
  v_add_f32 v38, v38, v245
  v_mfma_f32_16x16x32_bf16 v[164:167], a[208:211], v[64:67], v[40:43]
  v_exp_f32 v246, v246
  v_mfma_f32_16x16x32_bf16 v[172:175], a[208:211], v[68:71], v[44:47]
  v_add_f32 v38, v38, v246
  v_cvt_pk_bf16_f32 v242, v244, v245
  v_mfma_f32_16x16x32_bf16 v[180:183], a[208:211], v[72:75], v[48:51]
  v_exp_f32 v247, v247
  v_mfma_f32_16x16x32_bf16 v[188:191], a[208:211], v[76:79], v[52:55]
  ds_read_b64_tr_b16 a[228:229], v27 offset:24576
  v_add_f32 v38, v38, v247
  v_mfma_f32_16x16x32_bf16 v[196:199], a[208:211], v[80:83], v[56:59]
  v_exp_f32 v248, v248
  v_add_u32 v9, 1441792, v9
  v_mfma_f32_16x16x32_bf16 v[204:207], a[208:211], v[84:87], v[60:63]
  s_waitcnt lgkmcnt(5)
  v_add_f32 v39, v39, v248
  v_cvt_pk_bf16_f32 v243, v246, v247
  v_mfma_f32_16x16x32_bf16 v[164:167], a[212:215], v[88:91], v[164:167]
  v_exp_f32 v249, v249
  v_mfma_f32_16x16x32_bf16 v[172:175], a[212:215], v[92:95], v[172:175]
  ds_read_b64_tr_b16 a[230:231], v27 offset:28672
  v_add_f32 v39, v39, v249
  v_mfma_f32_16x16x32_bf16 v[180:183], a[212:215], v[96:99], v[180:183]
  v_exp_f32 v250, v250
  v_mfma_f32_16x16x32_bf16 v[188:191], a[212:215], v[100:103], v[188:191]
  v_add_f32 v39, v39, v250
  v_cvt_pk_bf16_f32 v248, v248, v249
  v_mfma_f32_16x16x32_bf16 v[196:199], a[212:215], v[104:107], v[196:199]
  buffer_load_dword v21, v9, s[12:15], 0 offen
  v_exp_f32 v251, v251
  v_mfma_f32_16x16x32_bf16 v[204:207], a[212:215], v[108:111], v[204:207]
  s_waitcnt lgkmcnt(5)
  ds_read_b64_tr_b16 a[232:233], v28 offset:24576
  v_add_f32 v39, v39, v251
  v_mfma_f32_16x16x32_bf16 v[164:167], a[216:219], v[112:115], v[164:167]
  v_exp_f32 v252, v252
  v_mfma_f32_16x16x32_bf16 v[172:175], a[216:219], v[116:119], v[172:175]
  v_add_f32 v39, v39, v252
  v_cvt_pk_bf16_f32 v249, v250, v251
  v_mfma_f32_16x16x32_bf16 v[180:183], a[216:219], v[120:123], v[180:183]
  v_exp_f32 v253, v253
  v_mfma_f32_16x16x32_bf16 v[188:191], a[216:219], v[124:127], v[188:191]
  ds_read_b64_tr_b16 a[234:235], v28 offset:28672
  v_add_f32 v39, v39, v253
  v_mfma_f32_16x16x32_bf16 v[196:199], a[216:219], v[128:131], v[196:199]
  v_exp_f32 v254, v254
  v_mfma_f32_16x16x32_bf16 v[204:207], a[216:219], v[132:135], v[204:207]
  s_waitcnt lgkmcnt(6)
  v_add_f32 v39, v39, v254
  v_cvt_pk_bf16_f32 v250, v252, v253
  v_mfma_f32_16x16x32_bf16 v[164:167], a[220:223], v[136:139], v[164:167]
  v_exp_f32 v255, v255
  v_mfma_f32_16x16x32_bf16 v[172:175], a[220:223], v[140:143], v[172:175]
  ds_read_b64_tr_b16 a[236:237], v29 offset:24576
  v_add_f32 v39, v39, v255
  v_mfma_f32_16x16x32_bf16 v[180:183], a[220:223], v[144:147], v[180:183]
  v_exp_f32 v160, v160
  v_mfma_f32_16x16x32_bf16 v[188:191], a[220:223], v[148:151], v[188:191]
  v_cvt_pk_bf16_f32 v251, v254, v255
  v_add_f32 v34, v34, v160
  v_mfma_f32_16x16x32_bf16 v[196:199], a[220:223], v[152:155], v[196:199]
  v_exp_f32 v161, v161
  v_mfma_f32_16x16x32_bf16 v[204:207], a[220:223], v[156:159], v[204:207]
  s_waitcnt lgkmcnt(5)
  ds_read_b64_tr_b16 a[238:239], v29 offset:28672
  v_add_f32 v34, v34, v161
  v_mfma_f32_16x16x32_bf16 a[0:3], a[224:227], v[208:211], a[0:3]
  v_exp_f32 v162, v162
  v_mfma_f32_16x16x32_bf16 a[32:35], a[224:227], v[216:219], a[32:35]
  v_add_f32 v34, v34, v162
  v_cvt_pk_bf16_f32 v160, v160, v161
  v_mfma_f32_16x16x32_bf16 a[64:67], a[224:227], v[224:227], a[64:67]
  v_exp_f32 v163, v163
  v_mfma_f32_16x16x32_bf16 a[96:99], a[224:227], v[232:235], a[96:99]
  ds_read_b64_tr_b16 a[240:241], v30 offset:24576
  v_add_f32 v34, v34, v163
  v_mfma_f32_16x16x32_bf16 a[128:131], a[224:227], v[240:243], a[128:131]
  v_exp_f32 v164, v164
  v_mfma_f32_16x16x32_bf16 a[160:163], a[224:227], v[248:251], a[160:163]
  s_waitcnt lgkmcnt(5)
  v_add_f32 v34, v34, v164
  v_cvt_pk_bf16_f32 v161, v162, v163
  v_mfma_f32_16x16x32_bf16 a[4:7], a[228:231], v[208:211], a[4:7]
  v_exp_f32 v165, v165
  v_mfma_f32_16x16x32_bf16 a[36:39], a[228:231], v[216:219], a[36:39]
  ds_read_b64_tr_b16 a[242:243], v30 offset:28672
  v_add_f32 v34, v34, v165
  v_mfma_f32_16x16x32_bf16 a[68:71], a[228:231], v[224:227], a[68:71]
  v_exp_f32 v166, v166
  v_mfma_f32_16x16x32_bf16 a[100:103], a[228:231], v[232:235], a[100:103]
  v_add_f32 v34, v34, v166
  v_cvt_pk_bf16_f32 v162, v164, v165
  v_mfma_f32_16x16x32_bf16 a[132:135], a[228:231], v[240:243], a[132:135]
  v_exp_f32 v167, v167
  v_mfma_f32_16x16x32_bf16 a[164:167], a[228:231], v[248:251], a[164:167]
  s_waitcnt lgkmcnt(4)
  ds_read_b64_tr_b16 a[244:245], v31 offset:24576
  v_add_f32 v34, v34, v167
  v_mfma_f32_16x16x32_bf16 a[8:11], a[232:235], v[208:211], a[8:11]
  v_exp_f32 v168, v168
  v_mfma_f32_16x16x32_bf16 a[40:43], a[232:235], v[216:219], a[40:43]
  v_add_f32 v35, v35, v168
  v_cvt_pk_bf16_f32 v163, v166, v167
  v_mfma_f32_16x16x32_bf16 a[72:75], a[232:235], v[224:227], a[72:75]
  v_exp_f32 v169, v169
  v_mfma_f32_16x16x32_bf16 a[104:107], a[232:235], v[232:235], a[104:107]
  ds_read_b64_tr_b16 a[246:247], v31 offset:28672
  v_add_f32 v35, v35, v169
  v_mfma_f32_16x16x32_bf16 a[136:139], a[232:235], v[240:243], a[136:139]
  v_exp_f32 v170, v170
  v_mfma_f32_16x16x32_bf16 a[168:171], a[232:235], v[248:251], a[168:171]
  s_waitcnt lgkmcnt(4)
  v_add_f32 v35, v35, v170
  v_cvt_pk_bf16_f32 v168, v168, v169
  v_mfma_f32_16x16x32_bf16 a[12:15], a[236:239], v[208:211], a[12:15]
  v_exp_f32 v171, v171
  v_mfma_f32_16x16x32_bf16 a[44:47], a[236:239], v[216:219], a[44:47]
  ds_read_b64_tr_b16 a[248:249], v32 offset:24576
  v_add_f32 v35, v35, v171
  v_mfma_f32_16x16x32_bf16 a[76:79], a[236:239], v[224:227], a[76:79]
  v_exp_f32 v172, v172
  v_mfma_f32_16x16x32_bf16 a[108:111], a[236:239], v[232:235], a[108:111]
  v_add_f32 v35, v35, v172
  v_cvt_pk_bf16_f32 v169, v170, v171
  v_mfma_f32_16x16x32_bf16 a[140:143], a[236:239], v[240:243], a[140:143]
  v_exp_f32 v173, v173
  v_mfma_f32_16x16x32_bf16 a[172:175], a[236:239], v[248:251], a[172:175]
  s_waitcnt lgkmcnt(3)
  ds_read_b64_tr_b16 a[250:251], v32 offset:28672
  v_add_f32 v35, v35, v173
  v_mfma_f32_16x16x32_bf16 a[16:19], a[240:243], v[208:211], a[16:19]
  v_exp_f32 v174, v174
  v_mfma_f32_16x16x32_bf16 a[48:51], a[240:243], v[216:219], a[48:51]
  v_add_f32 v35, v35, v174
  v_cvt_pk_bf16_f32 v170, v172, v173
  v_mfma_f32_16x16x32_bf16 a[80:83], a[240:243], v[224:227], a[80:83]
  v_exp_f32 v175, v175
  v_mfma_f32_16x16x32_bf16 a[112:115], a[240:243], v[232:235], a[112:115]
  ds_read_b64_tr_b16 a[252:253], v33 offset:24576
  v_add_f32 v35, v35, v175
  v_mfma_f32_16x16x32_bf16 a[144:147], a[240:243], v[240:243], a[144:147]
  v_exp_f32 v176, v176
  v_mfma_f32_16x16x32_bf16 a[176:179], a[240:243], v[248:251], a[176:179]
  s_waitcnt lgkmcnt(3)
  v_add_f32 v36, v36, v176
  v_cvt_pk_bf16_f32 v171, v174, v175
  v_mfma_f32_16x16x32_bf16 a[20:23], a[244:247], v[208:211], a[20:23]
  v_exp_f32 v177, v177
  v_mfma_f32_16x16x32_bf16 a[52:55], a[244:247], v[216:219], a[52:55]
  ds_read_b64_tr_b16 a[254:255], v33 offset:28672
  v_add_f32 v36, v36, v177
  v_mfma_f32_16x16x32_bf16 a[84:87], a[244:247], v[224:227], a[84:87]
  v_exp_f32 v178, v178
  v_add_u32 v9, 1441792, v9
  v_mfma_f32_16x16x32_bf16 a[116:119], a[244:247], v[232:235], a[116:119]
  v_add_f32 v36, v36, v178
  v_cvt_pk_bf16_f32 v176, v176, v177
  v_mfma_f32_16x16x32_bf16 a[148:151], a[244:247], v[240:243], a[148:151]
  v_exp_f32 v179, v179
  v_mfma_f32_16x16x32_bf16 a[180:183], a[244:247], v[248:251], a[180:183]
  s_waitcnt lgkmcnt(2)
  ds_read_b128 a[192:195], v22 offset:24576
  v_add_f32 v36, v36, v179
  v_mfma_f32_16x16x32_bf16 a[24:27], a[248:251], v[208:211], a[24:27]
  v_exp_f32 v180, v180
  v_mfma_f32_16x16x32_bf16 a[56:59], a[248:251], v[216:219], a[56:59]
  v_add_f32 v36, v36, v180
  v_cvt_pk_bf16_f32 v177, v178, v179
  v_mfma_f32_16x16x32_bf16 a[88:91], a[248:251], v[224:227], a[88:91]
  buffer_load_dword v21, v9, s[12:15], 0 offen
  v_exp_f32 v181, v181
  v_mfma_f32_16x16x32_bf16 a[120:123], a[248:251], v[232:235], a[120:123]
  ds_read_b128 a[196:199], v23 offset:24576
  v_add_f32 v36, v36, v181
  v_mfma_f32_16x16x32_bf16 a[152:155], a[248:251], v[240:243], a[152:155]
  v_exp_f32 v182, v182
  v_mfma_f32_16x16x32_bf16 a[184:187], a[248:251], v[248:251], a[184:187]
  s_waitcnt lgkmcnt(2)
  v_add_f32 v36, v36, v182
  v_cvt_pk_bf16_f32 v178, v180, v181
  v_mfma_f32_16x16x32_bf16 a[28:31], a[252:255], v[208:211], a[28:31]
  v_exp_f32 v183, v183
  v_mfma_f32_16x16x32_bf16 a[60:63], a[252:255], v[216:219], a[60:63]
  ds_read_b128 a[200:203], v24 offset:24576
  v_add_f32 v36, v36, v183
  v_mfma_f32_16x16x32_bf16 a[92:95], a[252:255], v[224:227], a[92:95]
  v_exp_f32 v184, v184
  v_mfma_f32_16x16x32_bf16 a[124:127], a[252:255], v[232:235], a[124:127]
  v_add_f32 v37, v37, v184
  v_cvt_pk_bf16_f32 v179, v182, v183
  v_mfma_f32_16x16x32_bf16 a[156:159], a[252:255], v[240:243], a[156:159]
  s_waitcnt vmcnt(22)
  s_barrier
  v_exp_f32 v185, v185
  v_mfma_f32_16x16x32_bf16 a[188:191], a[252:255], v[248:251], a[188:191]
  s_waitcnt lgkmcnt(2)
  ds_read_b128 a[204:207], v25 offset:24576
  v_add_f32 v37, v37, v185
  v_mfma_f32_16x16x32_bf16 v[208:211], a[192:195], v[64:67], v[40:43]
  s_add_u32 m0, s72, 98304
  v_exp_f32 v186, v186
  v_mfma_f32_16x16x32_bf16 v[216:219], a[192:195], v[68:71], v[44:47]
  v_add_f32 v37, v37, v186
  v_cvt_pk_bf16_f32 v184, v184, v185
  v_mfma_f32_16x16x32_bf16 v[224:227], a[192:195], v[72:75], v[48:51]
  v_exp_f32 v187, v187
  v_mfma_f32_16x16x32_bf16 v[232:235], a[192:195], v[76:79], v[52:55]
  ds_read_b128 a[208:211], v22 offset:28672
  v_add_f32 v37, v37, v187
  v_mfma_f32_16x16x32_bf16 v[240:243], a[192:195], v[80:83], v[56:59]
  v_exp_f32 v188, v188
  v_mfma_f32_16x16x32_bf16 v[248:251], a[192:195], v[84:87], v[60:63]
  s_waitcnt lgkmcnt(3)
  v_add_f32 v37, v37, v188
  v_cvt_pk_bf16_f32 v185, v186, v187
  v_mfma_f32_16x16x32_bf16 v[208:211], a[196:199], v[88:91], v[208:211]
  v_exp_f32 v189, v189
  v_mfma_f32_16x16x32_bf16 v[216:219], a[196:199], v[92:95], v[216:219]
  ds_read_b128 a[212:215], v23 offset:28672
  v_add_f32 v37, v37, v189
  v_mfma_f32_16x16x32_bf16 v[224:227], a[196:199], v[96:99], v[224:227]
  s_add_u32 s3, s71, 81920
  v_exp_f32 v190, v190
  v_mfma_f32_16x16x32_bf16 v[232:235], a[196:199], v[100:103], v[232:235]
  v_add_f32 v37, v37, v190
  v_cvt_pk_bf16_f32 v186, v188, v189
  v_mfma_f32_16x16x32_bf16 v[240:243], a[196:199], v[104:107], v[240:243]
  v_exp_f32 v191, v191
  v_mfma_f32_16x16x32_bf16 v[248:251], a[196:199], v[108:111], v[248:251]
  s_waitcnt lgkmcnt(3)
  ds_read_b128 a[216:219], v24 offset:28672
  v_add_f32 v37, v37, v191
  v_mfma_f32_16x16x32_bf16 v[208:211], a[200:203], v[112:115], v[208:211]
  v_exp_f32 v192, v192
  v_mfma_f32_16x16x32_bf16 v[216:219], a[200:203], v[116:119], v[216:219]
  v_add_f32 v38, v38, v192
  v_cvt_pk_bf16_f32 v187, v190, v191
  v_mfma_f32_16x16x32_bf16 v[224:227], a[200:203], v[120:123], v[224:227]
  v_exp_f32 v193, v193
  v_mfma_f32_16x16x32_bf16 v[232:235], a[200:203], v[124:127], v[232:235]
  ds_read_b128 a[220:223], v25 offset:28672
  v_add_f32 v38, v38, v193
  v_mfma_f32_16x16x32_bf16 v[240:243], a[200:203], v[128:131], v[240:243]
  s_getpc_b64 s[92:93]
L_j5:
  buffer_load_dwordx4 v7, s[16:19], s3 offen offset:0 nt lds
  v_exp_f32 v194, v194
  v_mfma_f32_16x16x32_bf16 v[248:251], a[200:203], v[132:135], v[248:251]
  s_waitcnt lgkmcnt(4)
  v_add_f32 v38, v38, v194
  v_cvt_pk_bf16_f32 v192, v192, v193
  v_mfma_f32_16x16x32_bf16 v[208:211], a[204:207], v[136:139], v[208:211]
  s_add_u32 s92, s92, 3072
  s_addc_u32 s93, s93, 0
  v_exp_f32 v195, v195
  v_mfma_f32_16x16x32_bf16 v[216:219], a[204:207], v[140:143], v[216:219]
  ds_read_b64_tr_b16 a[224:225], v26 offset:32768
  v_add_f32 v38, v38, v195
  v_mfma_f32_16x16x32_bf16 v[224:227], a[204:207], v[144:147], v[224:227]
  v_exp_f32 v196, v196
  v_mfma_f32_16x16x32_bf16 v[232:235], a[204:207], v[148:151], v[232:235]
  v_add_f32 v38, v38, v196
  v_cvt_pk_bf16_f32 v193, v194, v195
  v_mfma_f32_16x16x32_bf16 v[240:243], a[204:207], v[152:155], v[240:243]
  buffer_load_dword v21, v15, s[92:95], 0 offen
  v_exp_f32 v197, v197
  v_mfma_f32_16x16x32_bf16 v[248:251], a[204:207], v[156:159], v[248:251]
  s_waitcnt lgkmcnt(4)
  ds_read_b64_tr_b16 a[226:227], v26 offset:36864
  v_add_f32 v38, v38, v197
  v_mfma_f32_16x16x32_bf16 v[212:215], a[208:211], v[64:67], v[40:43]
  buffer_load_dwordx4 v8, s[16:19], s3 offen offset:1024 nt lds
  v_exp_f32 v198, v198
  v_mfma_f32_16x16x32_bf16 v[220:223], a[208:211], v[68:71], v[44:47]
  v_add_f32 v38, v38, v198
  v_cvt_pk_bf16_f32 v194, v196, v197
  v_mfma_f32_16x16x32_bf16 v[228:231], a[208:211], v[72:75], v[48:51]
  v_exp_f32 v199, v199
  v_mfma_f32_16x16x32_bf16 v[236:239], a[208:211], v[76:79], v[52:55]
  ds_read_b64_tr_b16 a[228:229], v27 offset:32768
  v_add_f32 v38, v38, v199
  v_mfma_f32_16x16x32_bf16 v[244:247], a[208:211], v[80:83], v[56:59]
  v_exp_f32 v200, v200
  v_mfma_f32_16x16x32_bf16 v[252:255], a[208:211], v[84:87], v[60:63]
  s_waitcnt lgkmcnt(5)
  v_add_f32 v39, v39, v200
  v_cvt_pk_bf16_f32 v195, v198, v199
  v_mfma_f32_16x16x32_bf16 v[212:215], a[212:215], v[88:91], v[212:215]
  v_exp_f32 v201, v201
  v_mfma_f32_16x16x32_bf16 v[220:223], a[212:215], v[92:95], v[220:223]
  ds_read_b64_tr_b16 a[230:231], v27 offset:36864
  v_add_f32 v39, v39, v201
  v_mfma_f32_16x16x32_bf16 v[228:231], a[212:215], v[96:99], v[228:231]
  buffer_load_dwordx4 v7, s[16:19], s3 offen offset:2048 nt lds
  v_exp_f32 v202, v202
  v_mfma_f32_16x16x32_bf16 v[236:239], a[212:215], v[100:103], v[236:239]
  v_add_f32 v39, v39, v202
  v_cvt_pk_bf16_f32 v200, v200, v201
  v_mfma_f32_16x16x32_bf16 v[244:247], a[212:215], v[104:107], v[244:247]
  v_exp_f32 v203, v203
  v_mfma_f32_16x16x32_bf16 v[252:255], a[212:215], v[108:111], v[252:255]
  s_waitcnt lgkmcnt(5)
  ds_read_b64_tr_b16 a[232:233], v28 offset:32768
  v_add_f32 v39, v39, v203
  v_mfma_f32_16x16x32_bf16 v[212:215], a[216:219], v[112:115], v[212:215]
  v_exp_f32 v204, v204
  v_add_u32 v9, 1441792, v9
  v_mfma_f32_16x16x32_bf16 v[220:223], a[216:219], v[116:119], v[220:223]
  v_add_f32 v39, v39, v204
  v_cvt_pk_bf16_f32 v201, v202, v203
  v_mfma_f32_16x16x32_bf16 v[228:231], a[216:219], v[120:123], v[228:231]
  v_exp_f32 v205, v205
  v_mfma_f32_16x16x32_bf16 v[236:239], a[216:219], v[124:127], v[236:239]
  ds_read_b64_tr_b16 a[234:235], v28 offset:36864
  v_add_f32 v39, v39, v205
  v_mfma_f32_16x16x32_bf16 v[244:247], a[216:219], v[128:131], v[244:247]
  buffer_load_dwordx4 v8, s[16:19], s3 offen offset:3072 nt lds
  v_exp_f32 v206, v206
  v_mfma_f32_16x16x32_bf16 v[252:255], a[216:219], v[132:135], v[252:255]
  s_waitcnt lgkmcnt(6)
  v_add_f32 v39, v39, v206
  v_cvt_pk_bf16_f32 v202, v204, v205
  v_mfma_f32_16x16x32_bf16 v[212:215], a[220:223], v[136:139], v[212:215]
  buffer_load_dword v21, v9, s[12:15], 0 offen
  v_exp_f32 v207, v207
  v_mfma_f32_16x16x32_bf16 v[220:223], a[220:223], v[140:143], v[220:223]
  ds_read_b64_tr_b16 a[236:237], v29 offset:32768
  v_add_f32 v39, v39, v207
  v_mfma_f32_16x16x32_bf16 v[228:231], a[220:223], v[144:147], v[228:231]
  v_exp_f32 v208, v208
  v_mfma_f32_16x16x32_bf16 v[236:239], a[220:223], v[148:151], v[236:239]
  v_cvt_pk_bf16_f32 v203, v206, v207
  v_add_f32 v34, v34, v208
  v_mfma_f32_16x16x32_bf16 v[244:247], a[220:223], v[152:155], v[244:247]
  v_exp_f32 v209, v209
  v_mfma_f32_16x16x32_bf16 v[252:255], a[220:223], v[156:159], v[252:255]
  s_waitcnt lgkmcnt(5)
  ds_read_b64_tr_b16 a[238:239], v29 offset:36864
  v_add_f32 v34, v34, v209
  v_mfma_f32_16x16x32_bf16 a[0:3], a[224:227], v[160:163], a[0:3]
  s_add_u32 m0, s72, 16384
  v_exp_f32 v210, v210
  v_mfma_f32_16x16x32_bf16 a[32:35], a[224:227], v[168:171], a[32:35]
  v_add_f32 v34, v34, v210
  v_cvt_pk_bf16_f32 v208, v208, v209
  v_mfma_f32_16x16x32_bf16 a[64:67], a[224:227], v[176:179], a[64:67]
  v_exp_f32 v211, v211
  v_mfma_f32_16x16x32_bf16 a[96:99], a[224:227], v[184:187], a[96:99]
  ds_read_b64_tr_b16 a[240:241], v30 offset:32768
  v_add_f32 v34, v34, v211
  v_mfma_f32_16x16x32_bf16 a[128:131], a[224:227], v[192:195], a[128:131]
  v_exp_f32 v212, v212
  v_mfma_f32_16x16x32_bf16 a[160:163], a[224:227], v[200:203], a[160:163]
  s_waitcnt lgkmcnt(5)
  v_add_f32 v34, v34, v212
  v_cvt_pk_bf16_f32 v209, v210, v211
  v_mfma_f32_16x16x32_bf16 a[4:7], a[228:231], v[160:163], a[4:7]
  v_exp_f32 v213, v213
  v_mfma_f32_16x16x32_bf16 a[36:39], a[228:231], v[168:171], a[36:39]
  ds_read_b64_tr_b16 a[242:243], v30 offset:36864
  v_add_f32 v34, v34, v213
  v_mfma_f32_16x16x32_bf16 a[68:71], a[228:231], v[176:179], a[68:71]
  s_add_u32 s3, s71, 81920
  v_exp_f32 v214, v214
  v_mfma_f32_16x16x32_bf16 a[100:103], a[228:231], v[184:187], a[100:103]
  v_add_f32 v34, v34, v214
  v_cvt_pk_bf16_f32 v210, v212, v213
  v_mfma_f32_16x16x32_bf16 a[132:135], a[228:231], v[192:195], a[132:135]
  v_exp_f32 v215, v215
  v_mfma_f32_16x16x32_bf16 a[164:167], a[228:231], v[200:203], a[164:167]
  s_waitcnt lgkmcnt(4)
  ds_read_b64_tr_b16 a[244:245], v31 offset:32768
  v_add_f32 v34, v34, v215
  v_mfma_f32_16x16x32_bf16 a[8:11], a[232:235], v[160:163], a[8:11]
  v_exp_f32 v216, v216
  v_mfma_f32_16x16x32_bf16 a[40:43], a[232:235], v[168:171], a[40:43]
  v_add_f32 v35, v35, v216
  v_cvt_pk_bf16_f32 v211, v214, v215
  v_mfma_f32_16x16x32_bf16 a[72:75], a[232:235], v[176:179], a[72:75]
  v_exp_f32 v217, v217
  v_mfma_f32_16x16x32_bf16 a[104:107], a[232:235], v[184:187], a[104:107]
  ds_read_b64_tr_b16 a[246:247], v31 offset:36864
  v_add_f32 v35, v35, v217
  v_mfma_f32_16x16x32_bf16 a[136:139], a[232:235], v[192:195], a[136:139]
  buffer_load_dwordx4 v7, s[20:23], s3 offen offset:0 nt lds
  v_exp_f32 v218, v218
  v_mfma_f32_16x16x32_bf16 a[168:171], a[232:235], v[200:203], a[168:171]
  s_waitcnt lgkmcnt(4)
  v_add_f32 v35, v35, v218
  v_cvt_pk_bf16_f32 v216, v216, v217
  v_mfma_f32_16x16x32_bf16 a[12:15], a[236:239], v[160:163], a[12:15]
  v_exp_f32 v219, v219
  v_mfma_f32_16x16x32_bf16 a[44:47], a[236:239], v[168:171], a[44:47]
  ds_read_b64_tr_b16 a[248:249], v32 offset:32768
  v_add_f32 v35, v35, v219
  v_mfma_f32_16x16x32_bf16 a[76:79], a[236:239], v[176:179], a[76:79]
  v_exp_f32 v220, v220
  v_mfma_f32_16x16x32_bf16 a[108:111], a[236:239], v[184:187], a[108:111]
  v_add_f32 v35, v35, v220
  v_cvt_pk_bf16_f32 v217, v218, v219
  v_mfma_f32_16x16x32_bf16 a[140:143], a[236:239], v[192:195], a[140:143]
  v_exp_f32 v221, v221
  v_mfma_f32_16x16x32_bf16 a[172:175], a[236:239], v[200:203], a[172:175]
  s_waitcnt lgkmcnt(3)
  ds_read_b64_tr_b16 a[250:251], v32 offset:36864
  v_add_f32 v35, v35, v221
  v_mfma_f32_16x16x32_bf16 a[16:19], a[240:243], v[160:163], a[16:19]
  buffer_load_dwordx4 v8, s[20:23], s3 offen offset:1024 nt lds
  v_exp_f32 v222, v222
  v_mfma_f32_16x16x32_bf16 a[48:51], a[240:243], v[168:171], a[48:51]
  v_add_f32 v35, v35, v222
  v_cvt_pk_bf16_f32 v218, v220, v221
  v_mfma_f32_16x16x32_bf16 a[80:83], a[240:243], v[176:179], a[80:83]
  v_exp_f32 v223, v223
  v_mfma_f32_16x16x32_bf16 a[112:115], a[240:243], v[184:187], a[112:115]
  ds_read_b64_tr_b16 a[252:253], v33 offset:32768
  v_add_f32 v35, v35, v223
  v_mfma_f32_16x16x32_bf16 a[144:147], a[240:243], v[192:195], a[144:147]
  v_exp_f32 v224, v224
  v_mfma_f32_16x16x32_bf16 a[176:179], a[240:243], v[200:203], a[176:179]
  s_waitcnt lgkmcnt(3)
  v_add_f32 v36, v36, v224
  v_cvt_pk_bf16_f32 v219, v222, v223
  v_mfma_f32_16x16x32_bf16 a[20:23], a[244:247], v[160:163], a[20:23]
  s_mov_b32 s12, s36
  v_exp_f32 v225, v225
  v_mfma_f32_16x16x32_bf16 a[52:55], a[244:247], v[168:171], a[52:55]
  ds_read_b64_tr_b16 a[254:255], v33 offset:36864
  v_add_f32 v36, v36, v225
  v_mfma_f32_16x16x32_bf16 a[84:87], a[244:247], v[176:179], a[84:87]
  s_mov_b32 s13, s37
  buffer_load_dwordx4 v7, s[20:23], s3 offen offset:2048 nt lds
  v_exp_f32 v226, v226
  v_mfma_f32_16x16x32_bf16 a[116:119], a[244:247], v[184:187], a[116:119]
  v_add_f32 v36, v36, v226
  v_cvt_pk_bf16_f32 v224, v224, v225
  v_mfma_f32_16x16x32_bf16 a[148:151], a[244:247], v[192:195], a[148:151]
  s_mov_b32 s14, 2359296
  v_exp_f32 v227, v227
  v_mfma_f32_16x16x32_bf16 a[180:183], a[244:247], v[200:203], a[180:183]
  s_waitcnt lgkmcnt(2)
  ds_read_b128 a[192:195], v22 offset:32768
  v_add_f32 v36, v36, v227
  v_mfma_f32_16x16x32_bf16 a[24:27], a[248:251], v[160:163], a[24:27]
  v_exp_f32 v228, v228
  v_mfma_f32_16x16x32_bf16 a[56:59], a[248:251], v[168:171], a[56:59]
  v_add_f32 v36, v36, v228
  v_cvt_pk_bf16_f32 v225, v226, v227
  v_mfma_f32_16x16x32_bf16 a[88:91], a[248:251], v[176:179], a[88:91]
  v_exp_f32 v229, v229
  v_add_u32 v9, 4290641920, v9
  v_mfma_f32_16x16x32_bf16 a[120:123], a[248:251], v[184:187], a[120:123]
  ds_read_b128 a[196:199], v23 offset:32768
  v_add_f32 v36, v36, v229
  v_mfma_f32_16x16x32_bf16 a[152:155], a[248:251], v[192:195], a[152:155]
  buffer_load_dwordx4 v8, s[20:23], s3 offen offset:3072 nt lds
  v_exp_f32 v230, v230
  v_mfma_f32_16x16x32_bf16 a[184:187], a[248:251], v[200:203], a[184:187]
  s_waitcnt lgkmcnt(2)
  v_add_f32 v36, v36, v230
  v_cvt_pk_bf16_f32 v226, v228, v229
  v_mfma_f32_16x16x32_bf16 a[28:31], a[252:255], v[160:163], a[28:31]
  v_exp_f32 v231, v231
  v_mfma_f32_16x16x32_bf16 a[60:63], a[252:255], v[168:171], a[60:63]
  ds_read_b128 a[200:203], v24 offset:32768
  v_add_f32 v36, v36, v231
  v_mfma_f32_16x16x32_bf16 a[92:95], a[252:255], v[176:179], a[92:95]
  buffer_load_dword v21, v9, s[12:15], 0 offen
  v_exp_f32 v232, v232
  v_mfma_f32_16x16x32_bf16 a[124:127], a[252:255], v[184:187], a[124:127]
  v_add_f32 v37, v37, v232
  v_cvt_pk_bf16_f32 v227, v230, v231
  v_mfma_f32_16x16x32_bf16 a[156:159], a[252:255], v[192:195], a[156:159]
  v_exp_f32 v233, v233
  v_mfma_f32_16x16x32_bf16 a[188:191], a[252:255], v[200:203], a[188:191]
  s_waitcnt lgkmcnt(2)
  ds_read_b128 a[204:207], v25 offset:32768
  v_add_f32 v37, v37, v233
  v_mfma_f32_16x16x32_bf16 v[160:163], a[192:195], v[64:67], v[40:43]
  v_exp_f32 v234, v234
  v_mfma_f32_16x16x32_bf16 v[168:171], a[192:195], v[68:71], v[44:47]
  v_add_f32 v37, v37, v234
  v_cvt_pk_bf16_f32 v232, v232, v233
  v_mfma_f32_16x16x32_bf16 v[176:179], a[192:195], v[72:75], v[48:51]
  v_exp_f32 v235, v235
  v_mfma_f32_16x16x32_bf16 v[184:187], a[192:195], v[76:79], v[52:55]
  ds_read_b128 a[208:211], v22 offset:36864
  v_add_f32 v37, v37, v235
  v_mfma_f32_16x16x32_bf16 v[192:195], a[192:195], v[80:83], v[56:59]
  v_exp_f32 v236, v236
  v_mfma_f32_16x16x32_bf16 v[200:203], a[192:195], v[84:87], v[60:63]
  s_waitcnt lgkmcnt(3)
  v_add_f32 v37, v37, v236
  v_cvt_pk_bf16_f32 v233, v234, v235
  v_mfma_f32_16x16x32_bf16 v[160:163], a[196:199], v[88:91], v[160:163]
  v_exp_f32 v237, v237
  v_mfma_f32_16x16x32_bf16 v[168:171], a[196:199], v[92:95], v[168:171]
  ds_read_b128 a[212:215], v23 offset:36864
  v_add_f32 v37, v37, v237
  v_mfma_f32_16x16x32_bf16 v[176:179], a[196:199], v[96:99], v[176:179]
  v_exp_f32 v238, v238
  v_mfma_f32_16x16x32_bf16 v[184:187], a[196:199], v[100:103], v[184:187]
  v_add_f32 v37, v37, v238
  v_cvt_pk_bf16_f32 v234, v236, v237
  v_mfma_f32_16x16x32_bf16 v[192:195], a[196:199], v[104:107], v[192:195]
  v_exp_f32 v239, v239
  v_mfma_f32_16x16x32_bf16 v[200:203], a[196:199], v[108:111], v[200:203]
  s_waitcnt lgkmcnt(3)
  ds_read_b128 a[216:219], v24 offset:36864
  v_add_f32 v37, v37, v239
  v_mfma_f32_16x16x32_bf16 v[160:163], a[200:203], v[112:115], v[160:163]
  v_exp_f32 v240, v240
  v_mfma_f32_16x16x32_bf16 v[168:171], a[200:203], v[116:119], v[168:171]
  v_add_f32 v38, v38, v240
  v_cvt_pk_bf16_f32 v235, v238, v239
  v_mfma_f32_16x16x32_bf16 v[176:179], a[200:203], v[120:123], v[176:179]
  v_exp_f32 v241, v241
  v_mfma_f32_16x16x32_bf16 v[184:187], a[200:203], v[124:127], v[184:187]
  ds_read_b128 a[220:223], v25 offset:36864
  v_add_f32 v38, v38, v241
  v_mfma_f32_16x16x32_bf16 v[192:195], a[200:203], v[128:131], v[192:195]
  v_exp_f32 v242, v242
  v_mfma_f32_16x16x32_bf16 v[200:203], a[200:203], v[132:135], v[200:203]
  s_waitcnt lgkmcnt(4)
  v_add_f32 v38, v38, v242
  v_cvt_pk_bf16_f32 v240, v240, v241
  v_mfma_f32_16x16x32_bf16 v[160:163], a[204:207], v[136:139], v[160:163]
  v_exp_f32 v243, v243
  v_mfma_f32_16x16x32_bf16 v[168:171], a[204:207], v[140:143], v[168:171]
  ds_read_b64_tr_b16 a[224:225], v26 offset:40960
  v_add_f32 v38, v38, v243
  v_mfma_f32_16x16x32_bf16 v[176:179], a[204:207], v[144:147], v[176:179]
  v_exp_f32 v244, v244
  v_mfma_f32_16x16x32_bf16 v[184:187], a[204:207], v[148:151], v[184:187]
  v_add_f32 v38, v38, v244
  v_cvt_pk_bf16_f32 v241, v242, v243
  v_mfma_f32_16x16x32_bf16 v[192:195], a[204:207], v[152:155], v[192:195]
  v_exp_f32 v245, v245
  v_mfma_f32_16x16x32_bf16 v[200:203], a[204:207], v[156:159], v[200:203]
  s_waitcnt lgkmcnt(4)
  ds_read_b64_tr_b16 a[226:227], v26 offset:45056
  v_add_f32 v38, v38, v245
  v_mfma_f32_16x16x32_bf16 v[164:167], a[208:211], v[64:67], v[40:43]
  v_exp_f32 v246, v246
  v_mfma_f32_16x16x32_bf16 v[172:175], a[208:211], v[68:71], v[44:47]
  v_add_f32 v38, v38, v246
  v_cvt_pk_bf16_f32 v242, v244, v245
  v_mfma_f32_16x16x32_bf16 v[180:183], a[208:211], v[72:75], v[48:51]
  v_exp_f32 v247, v247
  v_mfma_f32_16x16x32_bf16 v[188:191], a[208:211], v[76:79], v[52:55]
  ds_read_b64_tr_b16 a[228:229], v27 offset:40960
  v_add_f32 v38, v38, v247
  v_mfma_f32_16x16x32_bf16 v[196:199], a[208:211], v[80:83], v[56:59]
  v_exp_f32 v248, v248
  v_mfma_f32_16x16x32_bf16 v[204:207], a[208:211], v[84:87], v[60:63]
  s_waitcnt lgkmcnt(5)
  v_add_f32 v39, v39, v248
  v_cvt_pk_bf16_f32 v243, v246, v247
  v_mfma_f32_16x16x32_bf16 v[164:167], a[212:215], v[88:91], v[164:167]
  v_exp_f32 v249, v249
  v_mfma_f32_16x16x32_bf16 v[172:175], a[212:215], v[92:95], v[172:175]
  ds_read_b64_tr_b16 a[230:231], v27 offset:45056
  v_add_f32 v39, v39, v249
  v_mfma_f32_16x16x32_bf16 v[180:183], a[212:215], v[96:99], v[180:183]
  v_exp_f32 v250, v250
  v_mfma_f32_16x16x32_bf16 v[188:191], a[212:215], v[100:103], v[188:191]
  v_add_f32 v39, v39, v250
  v_cvt_pk_bf16_f32 v248, v248, v249
  v_mfma_f32_16x16x32_bf16 v[196:199], a[212:215], v[104:107], v[196:199]
  v_exp_f32 v251, v251
  v_mfma_f32_16x16x32_bf16 v[204:207], a[212:215], v[108:111], v[204:207]
  s_waitcnt lgkmcnt(5)
  ds_read_b64_tr_b16 a[232:233], v28 offset:40960
  v_add_f32 v39, v39, v251
  v_mfma_f32_16x16x32_bf16 v[164:167], a[216:219], v[112:115], v[164:167]
  v_exp_f32 v252, v252
  v_mfma_f32_16x16x32_bf16 v[172:175], a[216:219], v[116:119], v[172:175]
  v_add_f32 v39, v39, v252
  v_cvt_pk_bf16_f32 v249, v250, v251
  v_mfma_f32_16x16x32_bf16 v[180:183], a[216:219], v[120:123], v[180:183]
  v_exp_f32 v253, v253
  v_mfma_f32_16x16x32_bf16 v[188:191], a[216:219], v[124:127], v[188:191]
  ds_read_b64_tr_b16 a[234:235], v28 offset:45056
  v_add_f32 v39, v39, v253
  v_mfma_f32_16x16x32_bf16 v[196:199], a[216:219], v[128:131], v[196:199]
  v_exp_f32 v254, v254
  v_mfma_f32_16x16x32_bf16 v[204:207], a[216:219], v[132:135], v[204:207]
  s_waitcnt lgkmcnt(6)
  v_add_f32 v39, v39, v254
  v_cvt_pk_bf16_f32 v250, v252, v253
  v_mfma_f32_16x16x32_bf16 v[164:167], a[220:223], v[136:139], v[164:167]
  v_exp_f32 v255, v255
  v_add_u32 v9, 1441792, v9
  v_mfma_f32_16x16x32_bf16 v[172:175], a[220:223], v[140:143], v[172:175]
  ds_read_b64_tr_b16 a[236:237], v29 offset:40960
  v_add_f32 v39, v39, v255
  v_mfma_f32_16x16x32_bf16 v[180:183], a[220:223], v[144:147], v[180:183]
  v_exp_f32 v160, v160
  v_mfma_f32_16x16x32_bf16 v[188:191], a[220:223], v[148:151], v[188:191]
  v_cvt_pk_bf16_f32 v251, v254, v255
  v_add_f32 v34, v34, v160
  v_mfma_f32_16x16x32_bf16 v[196:199], a[220:223], v[152:155], v[196:199]
  v_exp_f32 v161, v161
  v_mfma_f32_16x16x32_bf16 v[204:207], a[220:223], v[156:159], v[204:207]
  s_waitcnt lgkmcnt(5)
  ds_read_b64_tr_b16 a[238:239], v29 offset:45056
  v_add_f32 v34, v34, v161
  v_mfma_f32_16x16x32_bf16 a[0:3], a[224:227], v[208:211], a[0:3]
  buffer_load_dword v21, v9, s[12:15], 0 offen
  v_exp_f32 v162, v162
  v_mfma_f32_16x16x32_bf16 a[32:35], a[224:227], v[216:219], a[32:35]
  v_add_f32 v34, v34, v162
  v_cvt_pk_bf16_f32 v160, v160, v161
  v_mfma_f32_16x16x32_bf16 a[64:67], a[224:227], v[224:227], a[64:67]
  v_exp_f32 v163, v163
  v_mfma_f32_16x16x32_bf16 a[96:99], a[224:227], v[232:235], a[96:99]
  ds_read_b64_tr_b16 a[240:241], v30 offset:40960
  v_add_f32 v34, v34, v163
  v_mfma_f32_16x16x32_bf16 a[128:131], a[224:227], v[240:243], a[128:131]
  v_exp_f32 v164, v164
  v_mfma_f32_16x16x32_bf16 a[160:163], a[224:227], v[248:251], a[160:163]
  s_waitcnt lgkmcnt(5)
  v_add_f32 v34, v34, v164
  v_cvt_pk_bf16_f32 v161, v162, v163
  v_mfma_f32_16x16x32_bf16 a[4:7], a[228:231], v[208:211], a[4:7]
  v_exp_f32 v165, v165
  v_mfma_f32_16x16x32_bf16 a[36:39], a[228:231], v[216:219], a[36:39]
  ds_read_b64_tr_b16 a[242:243], v30 offset:45056
  v_add_f32 v34, v34, v165
  v_mfma_f32_16x16x32_bf16 a[68:71], a[228:231], v[224:227], a[68:71]
  v_exp_f32 v166, v166
  v_mfma_f32_16x16x32_bf16 a[100:103], a[228:231], v[232:235], a[100:103]
  v_add_f32 v34, v34, v166
  v_cvt_pk_bf16_f32 v162, v164, v165
  v_mfma_f32_16x16x32_bf16 a[132:135], a[228:231], v[240:243], a[132:135]
  v_exp_f32 v167, v167
  v_mfma_f32_16x16x32_bf16 a[164:167], a[228:231], v[248:251], a[164:167]
  s_waitcnt lgkmcnt(4)
  ds_read_b64_tr_b16 a[244:245], v31 offset:40960
  v_add_f32 v34, v34, v167
  v_mfma_f32_16x16x32_bf16 a[8:11], a[232:235], v[208:211], a[8:11]
  v_exp_f32 v168, v168
  v_mfma_f32_16x16x32_bf16 a[40:43], a[232:235], v[216:219], a[40:43]
  v_add_f32 v35, v35, v168
  v_cvt_pk_bf16_f32 v163, v166, v167
  v_mfma_f32_16x16x32_bf16 a[72:75], a[232:235], v[224:227], a[72:75]
  v_exp_f32 v169, v169
  v_mfma_f32_16x16x32_bf16 a[104:107], a[232:235], v[232:235], a[104:107]
  ds_read_b64_tr_b16 a[246:247], v31 offset:45056
  v_add_f32 v35, v35, v169
  v_mfma_f32_16x16x32_bf16 a[136:139], a[232:235], v[240:243], a[136:139]
  v_exp_f32 v170, v170
  v_mfma_f32_16x16x32_bf16 a[168:171], a[232:235], v[248:251], a[168:171]
  s_waitcnt lgkmcnt(4)
  v_add_f32 v35, v35, v170
  v_cvt_pk_bf16_f32 v168, v168, v169
  v_mfma_f32_16x16x32_bf16 a[12:15], a[236:239], v[208:211], a[12:15]
  v_exp_f32 v171, v171
  v_mfma_f32_16x16x32_bf16 a[44:47], a[236:239], v[216:219], a[44:47]
  ds_read_b64_tr_b16 a[248:249], v32 offset:40960
  v_add_f32 v35, v35, v171
  v_mfma_f32_16x16x32_bf16 a[76:79], a[236:239], v[224:227], a[76:79]
  v_exp_f32 v172, v172
  v_mfma_f32_16x16x32_bf16 a[108:111], a[236:239], v[232:235], a[108:111]
  v_add_f32 v35, v35, v172
  v_cvt_pk_bf16_f32 v169, v170, v171
  v_mfma_f32_16x16x32_bf16 a[140:143], a[236:239], v[240:243], a[140:143]
  v_exp_f32 v173, v173
  v_mfma_f32_16x16x32_bf16 a[172:175], a[236:239], v[248:251], a[172:175]
  s_waitcnt lgkmcnt(3)
  ds_read_b64_tr_b16 a[250:251], v32 offset:45056
  v_add_f32 v35, v35, v173
  v_mfma_f32_16x16x32_bf16 a[16:19], a[240:243], v[208:211], a[16:19]
  v_exp_f32 v174, v174
  v_mfma_f32_16x16x32_bf16 a[48:51], a[240:243], v[216:219], a[48:51]
  v_add_f32 v35, v35, v174
  v_cvt_pk_bf16_f32 v170, v172, v173
  v_mfma_f32_16x16x32_bf16 a[80:83], a[240:243], v[224:227], a[80:83]
  v_exp_f32 v175, v175
  v_mfma_f32_16x16x32_bf16 a[112:115], a[240:243], v[232:235], a[112:115]
  ds_read_b64_tr_b16 a[252:253], v33 offset:40960
  v_add_f32 v35, v35, v175
  v_mfma_f32_16x16x32_bf16 a[144:147], a[240:243], v[240:243], a[144:147]
  v_exp_f32 v176, v176
  v_mfma_f32_16x16x32_bf16 a[176:179], a[240:243], v[248:251], a[176:179]
  s_waitcnt lgkmcnt(3)
  v_add_f32 v36, v36, v176
  v_cvt_pk_bf16_f32 v171, v174, v175
  v_mfma_f32_16x16x32_bf16 a[20:23], a[244:247], v[208:211], a[20:23]
  v_exp_f32 v177, v177
  v_mfma_f32_16x16x32_bf16 a[52:55], a[244:247], v[216:219], a[52:55]
  ds_read_b64_tr_b16 a[254:255], v33 offset:45056
  v_add_f32 v36, v36, v177
  v_mfma_f32_16x16x32_bf16 a[84:87], a[244:247], v[224:227], a[84:87]
  v_exp_f32 v178, v178
  v_mfma_f32_16x16x32_bf16 a[116:119], a[244:247], v[232:235], a[116:119]
  v_add_f32 v36, v36, v178
  v_cvt_pk_bf16_f32 v176, v176, v177
  v_mfma_f32_16x16x32_bf16 a[148:151], a[244:247], v[240:243], a[148:151]
  v_exp_f32 v179, v179
  v_mfma_f32_16x16x32_bf16 a[180:183], a[244:247], v[248:251], a[180:183]
  s_waitcnt lgkmcnt(2)
  ds_read_b128 a[192:195], v22 offset:40960
  v_add_f32 v36, v36, v179
  v_mfma_f32_16x16x32_bf16 a[24:27], a[248:251], v[208:211], a[24:27]
  v_exp_f32 v180, v180
  v_mfma_f32_16x16x32_bf16 a[56:59], a[248:251], v[216:219], a[56:59]
  v_add_f32 v36, v36, v180
  v_cvt_pk_bf16_f32 v177, v178, v179
  v_mfma_f32_16x16x32_bf16 a[88:91], a[248:251], v[224:227], a[88:91]
  v_exp_f32 v181, v181
  v_mfma_f32_16x16x32_bf16 a[120:123], a[248:251], v[232:235], a[120:123]
  ds_read_b128 a[196:199], v23 offset:40960
  v_add_f32 v36, v36, v181
  v_mfma_f32_16x16x32_bf16 a[152:155], a[248:251], v[240:243], a[152:155]
  v_exp_f32 v182, v182
  v_mfma_f32_16x16x32_bf16 a[184:187], a[248:251], v[248:251], a[184:187]
  s_waitcnt lgkmcnt(2)
  v_add_f32 v36, v36, v182
  v_cvt_pk_bf16_f32 v178, v180, v181
  v_mfma_f32_16x16x32_bf16 a[28:31], a[252:255], v[208:211], a[28:31]
  v_exp_f32 v183, v183
  v_mfma_f32_16x16x32_bf16 a[60:63], a[252:255], v[216:219], a[60:63]
  ds_read_b128 a[200:203], v24 offset:40960
  v_add_f32 v36, v36, v183
  v_mfma_f32_16x16x32_bf16 a[92:95], a[252:255], v[224:227], a[92:95]
  v_exp_f32 v184, v184
  v_mfma_f32_16x16x32_bf16 a[124:127], a[252:255], v[232:235], a[124:127]
  v_add_f32 v37, v37, v184
  v_cvt_pk_bf16_f32 v179, v182, v183
  v_mfma_f32_16x16x32_bf16 a[156:159], a[252:255], v[240:243], a[156:159]
  s_waitcnt vmcnt(19)
  s_barrier
  v_exp_f32 v185, v185
  v_add_u32 v9, 4293525504, v9
  v_mfma_f32_16x16x32_bf16 a[188:191], a[252:255], v[248:251], a[188:191]
  s_waitcnt lgkmcnt(2)
  ds_read_b128 a[204:207], v25 offset:40960
  v_add_f32 v37, v37, v185
  v_mfma_f32_16x16x32_bf16 v[208:211], a[192:195], v[64:67], v[40:43]
  s_add_u32 m0, s72, 114688
  v_exp_f32 v186, v186
  v_mfma_f32_16x16x32_bf16 v[216:219], a[192:195], v[68:71], v[44:47]
  v_add_f32 v37, v37, v186
  v_cvt_pk_bf16_f32 v184, v184, v185
  v_mfma_f32_16x16x32_bf16 v[224:227], a[192:195], v[72:75], v[48:51]
  v_exp_f32 v187, v187
  v_mfma_f32_16x16x32_bf16 v[232:235], a[192:195], v[76:79], v[52:55]
  ds_read_b128 a[208:211], v22 offset:45056
  v_add_f32 v37, v37, v187
  v_mfma_f32_16x16x32_bf16 v[240:243], a[192:195], v[80:83], v[56:59]
  buffer_load_dword v21, v9, s[8:11], 0 offen
  v_exp_f32 v188, v188
  v_mfma_f32_16x16x32_bf16 v[248:251], a[192:195], v[84:87], v[60:63]
  s_waitcnt lgkmcnt(3)
  v_add_f32 v37, v37, v188
  v_cvt_pk_bf16_f32 v185, v186, v187
  v_mfma_f32_16x16x32_bf16 v[208:211], a[196:199], v[88:91], v[208:211]
  v_exp_f32 v189, v189
  v_mfma_f32_16x16x32_bf16 v[216:219], a[196:199], v[92:95], v[216:219]
  ds_read_b128 a[212:215], v23 offset:45056
  v_add_f32 v37, v37, v189
  v_mfma_f32_16x16x32_bf16 v[224:227], a[196:199], v[96:99], v[224:227]
  s_add_u32 s3, s71, 98304
  v_exp_f32 v190, v190
  v_mfma_f32_16x16x32_bf16 v[232:235], a[196:199], v[100:103], v[232:235]
  v_add_f32 v37, v37, v190
  v_cvt_pk_bf16_f32 v186, v188, v189
  v_mfma_f32_16x16x32_bf16 v[240:243], a[196:199], v[104:107], v[240:243]
  v_exp_f32 v191, v191
  v_mfma_f32_16x16x32_bf16 v[248:251], a[196:199], v[108:111], v[248:251]
  s_waitcnt lgkmcnt(3)
  ds_read_b128 a[216:219], v24 offset:45056
  v_add_f32 v37, v37, v191
  v_mfma_f32_16x16x32_bf16 v[208:211], a[200:203], v[112:115], v[208:211]
  v_exp_f32 v192, v192
  v_mfma_f32_16x16x32_bf16 v[216:219], a[200:203], v[116:119], v[216:219]
  v_add_f32 v38, v38, v192
  v_cvt_pk_bf16_f32 v187, v190, v191
  v_mfma_f32_16x16x32_bf16 v[224:227], a[200:203], v[120:123], v[224:227]
  v_exp_f32 v193, v193
  v_mfma_f32_16x16x32_bf16 v[232:235], a[200:203], v[124:127], v[232:235]
  ds_read_b128 a[220:223], v25 offset:45056
  v_add_f32 v38, v38, v193
  v_mfma_f32_16x16x32_bf16 v[240:243], a[200:203], v[128:131], v[240:243]
  buffer_load_dwordx4 v7, s[16:19], s3 offen offset:0 nt lds
  v_exp_f32 v194, v194
  v_mfma_f32_16x16x32_bf16 v[248:251], a[200:203], v[132:135], v[248:251]
  s_waitcnt lgkmcnt(4)
  v_add_f32 v38, v38, v194
  v_cvt_pk_bf16_f32 v192, v192, v193
  v_mfma_f32_16x16x32_bf16 v[208:211], a[204:207], v[136:139], v[208:211]
  v_exp_f32 v195, v195
  v_mfma_f32_16x16x32_bf16 v[216:219], a[204:207], v[140:143], v[216:219]
  ds_read_b64_tr_b16 a[224:225], v26 offset:49152
  v_add_f32 v38, v38, v195
  v_mfma_f32_16x16x32_bf16 v[224:227], a[204:207], v[144:147], v[224:227]
  v_exp_f32 v196, v196
  v_mfma_f32_16x16x32_bf16 v[232:235], a[204:207], v[148:151], v[232:235]
  v_add_f32 v38, v38, v196
  v_cvt_pk_bf16_f32 v193, v194, v195
  v_mfma_f32_16x16x32_bf16 v[240:243], a[204:207], v[152:155], v[240:243]
  v_exp_f32 v197, v197
  v_mfma_f32_16x16x32_bf16 v[248:251], a[204:207], v[156:159], v[248:251]
  s_waitcnt lgkmcnt(4)
  ds_read_b64_tr_b16 a[226:227], v26 offset:53248
  v_add_f32 v38, v38, v197
  v_mfma_f32_16x16x32_bf16 v[212:215], a[208:211], v[64:67], v[40:43]
  buffer_load_dwordx4 v8, s[16:19], s3 offen offset:1024 nt lds
  v_exp_f32 v198, v198
  v_mfma_f32_16x16x32_bf16 v[220:223], a[208:211], v[68:71], v[44:47]
  v_add_f32 v38, v38, v198
  v_cvt_pk_bf16_f32 v194, v196, v197
  v_mfma_f32_16x16x32_bf16 v[228:231], a[208:211], v[72:75], v[48:51]
  v_exp_f32 v199, v199
  v_mfma_f32_16x16x32_bf16 v[236:239], a[208:211], v[76:79], v[52:55]
  ds_read_b64_tr_b16 a[228:229], v27 offset:49152
  v_add_f32 v38, v38, v199
  v_mfma_f32_16x16x32_bf16 v[244:247], a[208:211], v[80:83], v[56:59]
  v_exp_f32 v200, v200
  v_mfma_f32_16x16x32_bf16 v[252:255], a[208:211], v[84:87], v[60:63]
  s_waitcnt lgkmcnt(5)
  v_add_f32 v39, v39, v200
  v_cvt_pk_bf16_f32 v195, v198, v199
  v_mfma_f32_16x16x32_bf16 v[212:215], a[212:215], v[88:91], v[212:215]
  v_exp_f32 v201, v201
  v_mfma_f32_16x16x32_bf16 v[220:223], a[212:215], v[92:95], v[220:223]
  ds_read_b64_tr_b16 a[230:231], v27 offset:53248
  v_add_f32 v39, v39, v201
  v_mfma_f32_16x16x32_bf16 v[228:231], a[212:215], v[96:99], v[228:231]
  buffer_load_dwordx4 v7, s[16:19], s3 offen offset:2048 nt lds
  v_exp_f32 v202, v202
  v_mfma_f32_16x16x32_bf16 v[236:239], a[212:215], v[100:103], v[236:239]
  v_add_f32 v39, v39, v202
  v_cvt_pk_bf16_f32 v200, v200, v201
  v_mfma_f32_16x16x32_bf16 v[244:247], a[212:215], v[104:107], v[244:247]
  v_exp_f32 v203, v203
  v_mfma_f32_16x16x32_bf16 v[252:255], a[212:215], v[108:111], v[252:255]
  s_waitcnt lgkmcnt(5)
  ds_read_b64_tr_b16 a[232:233], v28 offset:49152
  v_add_f32 v39, v39, v203
  v_mfma_f32_16x16x32_bf16 v[212:215], a[216:219], v[112:115], v[212:215]
  v_exp_f32 v204, v204
  v_mfma_f32_16x16x32_bf16 v[220:223], a[216:219], v[116:119], v[220:223]
  v_add_f32 v39, v39, v204
  v_cvt_pk_bf16_f32 v201, v202, v203
  v_mfma_f32_16x16x32_bf16 v[228:231], a[216:219], v[120:123], v[228:231]
  v_exp_f32 v205, v205
  v_mfma_f32_16x16x32_bf16 v[236:239], a[216:219], v[124:127], v[236:239]
  ds_read_b64_tr_b16 a[234:235], v28 offset:53248
  v_add_f32 v39, v39, v205
  v_mfma_f32_16x16x32_bf16 v[244:247], a[216:219], v[128:131], v[244:247]
  buffer_load_dwordx4 v8, s[16:19], s3 offen offset:3072 nt lds
  v_exp_f32 v206, v206
  v_mfma_f32_16x16x32_bf16 v[252:255], a[216:219], v[132:135], v[252:255]
  s_waitcnt lgkmcnt(6)
  v_add_f32 v39, v39, v206
  v_cvt_pk_bf16_f32 v202, v204, v205
  v_mfma_f32_16x16x32_bf16 v[212:215], a[220:223], v[136:139], v[212:215]
  v_exp_f32 v207, v207
  v_mfma_f32_16x16x32_bf16 v[220:223], a[220:223], v[140:143], v[220:223]
  ds_read_b64_tr_b16 a[236:237], v29 offset:49152
  v_add_f32 v39, v39, v207
  v_mfma_f32_16x16x32_bf16 v[228:231], a[220:223], v[144:147], v[228:231]
  v_exp_f32 v208, v208
  v_mfma_f32_16x16x32_bf16 v[236:239], a[220:223], v[148:151], v[236:239]
  v_cvt_pk_bf16_f32 v203, v206, v207
  v_add_f32 v34, v34, v208
  v_mfma_f32_16x16x32_bf16 v[244:247], a[220:223], v[152:155], v[244:247]
  v_exp_f32 v209, v209
  v_mfma_f32_16x16x32_bf16 v[252:255], a[220:223], v[156:159], v[252:255]
  s_waitcnt lgkmcnt(5)
  ds_read_b64_tr_b16 a[238:239], v29 offset:53248
  v_add_f32 v34, v34, v209
  v_mfma_f32_16x16x32_bf16 a[0:3], a[224:227], v[160:163], a[0:3]
  s_add_u32 m0, s72, 32768
  v_exp_f32 v210, v210
  v_add_u32 v9, 1441792, v9
  v_mfma_f32_16x16x32_bf16 a[32:35], a[224:227], v[168:171], a[32:35]
  v_add_f32 v34, v34, v210
  v_cvt_pk_bf16_f32 v208, v208, v209
  v_mfma_f32_16x16x32_bf16 a[64:67], a[224:227], v[176:179], a[64:67]
  v_exp_f32 v211, v211
  v_mfma_f32_16x16x32_bf16 a[96:99], a[224:227], v[184:187], a[96:99]
  ds_read_b64_tr_b16 a[240:241], v30 offset:49152
  v_add_f32 v34, v34, v211
  v_mfma_f32_16x16x32_bf16 a[128:131], a[224:227], v[192:195], a[128:131]
  v_exp_f32 v212, v212
  v_mfma_f32_16x16x32_bf16 a[160:163], a[224:227], v[200:203], a[160:163]
  s_waitcnt lgkmcnt(5)
  v_add_f32 v34, v34, v212
  v_cvt_pk_bf16_f32 v209, v210, v211
  v_mfma_f32_16x16x32_bf16 a[4:7], a[228:231], v[160:163], a[4:7]
  buffer_load_dword v21, v9, s[8:11], 0 offen
  v_exp_f32 v213, v213
  v_mfma_f32_16x16x32_bf16 a[36:39], a[228:231], v[168:171], a[36:39]
  ds_read_b64_tr_b16 a[242:243], v30 offset:53248
  v_add_f32 v34, v34, v213
  v_mfma_f32_16x16x32_bf16 a[68:71], a[228:231], v[176:179], a[68:71]
  s_add_u32 s3, s71, 98304
  v_exp_f32 v214, v214
  v_mfma_f32_16x16x32_bf16 a[100:103], a[228:231], v[184:187], a[100:103]
  v_add_f32 v34, v34, v214
  v_cvt_pk_bf16_f32 v210, v212, v213
  v_mfma_f32_16x16x32_bf16 a[132:135], a[228:231], v[192:195], a[132:135]
  v_exp_f32 v215, v215
  v_mfma_f32_16x16x32_bf16 a[164:167], a[228:231], v[200:203], a[164:167]
  s_waitcnt lgkmcnt(4)
  ds_read_b64_tr_b16 a[244:245], v31 offset:49152
  v_add_f32 v34, v34, v215
  v_mfma_f32_16x16x32_bf16 a[8:11], a[232:235], v[160:163], a[8:11]
  v_exp_f32 v216, v216
  v_mfma_f32_16x16x32_bf16 a[40:43], a[232:235], v[168:171], a[40:43]
  v_add_f32 v35, v35, v216
  v_cvt_pk_bf16_f32 v211, v214, v215
  v_mfma_f32_16x16x32_bf16 a[72:75], a[232:235], v[176:179], a[72:75]
  v_exp_f32 v217, v217
  v_mfma_f32_16x16x32_bf16 a[104:107], a[232:235], v[184:187], a[104:107]
  ds_read_b64_tr_b16 a[246:247], v31 offset:53248
  v_add_f32 v35, v35, v217
  v_mfma_f32_16x16x32_bf16 a[136:139], a[232:235], v[192:195], a[136:139]
  buffer_load_dwordx4 v7, s[20:23], s3 offen offset:0 nt lds
  v_exp_f32 v218, v218
  v_mfma_f32_16x16x32_bf16 a[168:171], a[232:235], v[200:203], a[168:171]
  s_waitcnt lgkmcnt(4)
  v_add_f32 v35, v35, v218
  v_cvt_pk_bf16_f32 v216, v216, v217
  v_mfma_f32_16x16x32_bf16 a[12:15], a[236:239], v[160:163], a[12:15]
  v_exp_f32 v219, v219
  v_mfma_f32_16x16x32_bf16 a[44:47], a[236:239], v[168:171], a[44:47]
  ds_read_b64_tr_b16 a[248:249], v32 offset:49152
  v_add_f32 v35, v35, v219
  v_mfma_f32_16x16x32_bf16 a[76:79], a[236:239], v[176:179], a[76:79]
  v_exp_f32 v220, v220
  v_mfma_f32_16x16x32_bf16 a[108:111], a[236:239], v[184:187], a[108:111]
  v_add_f32 v35, v35, v220
  v_cvt_pk_bf16_f32 v217, v218, v219
  v_mfma_f32_16x16x32_bf16 a[140:143], a[236:239], v[192:195], a[140:143]
  v_exp_f32 v221, v221
  v_mfma_f32_16x16x32_bf16 a[172:175], a[236:239], v[200:203], a[172:175]
  s_waitcnt lgkmcnt(3)
  ds_read_b64_tr_b16 a[250:251], v32 offset:53248
  v_add_f32 v35, v35, v221
  v_mfma_f32_16x16x32_bf16 a[16:19], a[240:243], v[160:163], a[16:19]
  buffer_load_dwordx4 v8, s[20:23], s3 offen offset:1024 nt lds
  v_exp_f32 v222, v222
  v_mfma_f32_16x16x32_bf16 a[48:51], a[240:243], v[168:171], a[48:51]
  v_add_f32 v35, v35, v222
  v_cvt_pk_bf16_f32 v218, v220, v221
  v_mfma_f32_16x16x32_bf16 a[80:83], a[240:243], v[176:179], a[80:83]
  v_exp_f32 v223, v223
  v_mfma_f32_16x16x32_bf16 a[112:115], a[240:243], v[184:187], a[112:115]
  ds_read_b64_tr_b16 a[252:253], v33 offset:49152
  v_add_f32 v35, v35, v223
  v_mfma_f32_16x16x32_bf16 a[144:147], a[240:243], v[192:195], a[144:147]
  v_exp_f32 v224, v224
  v_mfma_f32_16x16x32_bf16 a[176:179], a[240:243], v[200:203], a[176:179]
  s_waitcnt lgkmcnt(3)
  v_add_f32 v36, v36, v224
  v_cvt_pk_bf16_f32 v219, v222, v223
  v_mfma_f32_16x16x32_bf16 a[20:23], a[244:247], v[160:163], a[20:23]
  v_exp_f32 v225, v225
  v_mfma_f32_16x16x32_bf16 a[52:55], a[244:247], v[168:171], a[52:55]
  ds_read_b64_tr_b16 a[254:255], v33 offset:53248
  v_add_f32 v36, v36, v225
  v_mfma_f32_16x16x32_bf16 a[84:87], a[244:247], v[176:179], a[84:87]
  buffer_load_dwordx4 v7, s[20:23], s3 offen offset:2048 nt lds
  v_exp_f32 v226, v226
  v_mfma_f32_16x16x32_bf16 a[116:119], a[244:247], v[184:187], a[116:119]
  v_add_f32 v36, v36, v226
  v_cvt_pk_bf16_f32 v224, v224, v225
  v_mfma_f32_16x16x32_bf16 a[148:151], a[244:247], v[192:195], a[148:151]
  v_exp_f32 v227, v227
  v_mfma_f32_16x16x32_bf16 a[180:183], a[244:247], v[200:203], a[180:183]
  s_waitcnt lgkmcnt(2)
  ds_read_b128 a[192:195], v22 offset:49152
  v_add_f32 v36, v36, v227
  v_mfma_f32_16x16x32_bf16 a[24:27], a[248:251], v[160:163], a[24:27]
  v_exp_f32 v228, v228
  v_mfma_f32_16x16x32_bf16 a[56:59], a[248:251], v[168:171], a[56:59]
  v_add_f32 v36, v36, v228
  v_cvt_pk_bf16_f32 v225, v226, v227
  v_mfma_f32_16x16x32_bf16 a[88:91], a[248:251], v[176:179], a[88:91]
  v_exp_f32 v229, v229
  v_mfma_f32_16x16x32_bf16 a[120:123], a[248:251], v[184:187], a[120:123]
  ds_read_b128 a[196:199], v23 offset:49152
  v_add_f32 v36, v36, v229
  v_mfma_f32_16x16x32_bf16 a[152:155], a[248:251], v[192:195], a[152:155]
  buffer_load_dwordx4 v8, s[20:23], s3 offen offset:3072 nt lds
  v_exp_f32 v230, v230
  v_mfma_f32_16x16x32_bf16 a[184:187], a[248:251], v[200:203], a[184:187]
  s_waitcnt lgkmcnt(2)
  v_add_f32 v36, v36, v230
  v_cvt_pk_bf16_f32 v226, v228, v229
  v_mfma_f32_16x16x32_bf16 a[28:31], a[252:255], v[160:163], a[28:31]
  v_exp_f32 v231, v231
  v_mfma_f32_16x16x32_bf16 a[60:63], a[252:255], v[168:171], a[60:63]
  ds_read_b128 a[200:203], v24 offset:49152
  v_add_f32 v36, v36, v231
  v_mfma_f32_16x16x32_bf16 a[92:95], a[252:255], v[176:179], a[92:95]
  v_exp_f32 v232, v232
  v_mfma_f32_16x16x32_bf16 a[124:127], a[252:255], v[184:187], a[124:127]
  v_add_f32 v37, v37, v232
  v_cvt_pk_bf16_f32 v227, v230, v231
  v_mfma_f32_16x16x32_bf16 a[156:159], a[252:255], v[192:195], a[156:159]
  v_exp_f32 v233, v233
  v_mfma_f32_16x16x32_bf16 a[188:191], a[252:255], v[200:203], a[188:191]
  s_waitcnt lgkmcnt(2)
  ds_read_b128 a[204:207], v25 offset:49152
  v_add_f32 v37, v37, v233
  v_mfma_f32_16x16x32_bf16 v[160:163], a[192:195], v[64:67], v[40:43]
  v_exp_f32 v234, v234
  v_mfma_f32_16x16x32_bf16 v[168:171], a[192:195], v[68:71], v[44:47]
  v_add_f32 v37, v37, v234
  v_cvt_pk_bf16_f32 v232, v232, v233
  v_mfma_f32_16x16x32_bf16 v[176:179], a[192:195], v[72:75], v[48:51]
  v_exp_f32 v235, v235
  v_mfma_f32_16x16x32_bf16 v[184:187], a[192:195], v[76:79], v[52:55]
  ds_read_b128 a[208:211], v22 offset:53248
  v_add_f32 v37, v37, v235
  v_mfma_f32_16x16x32_bf16 v[192:195], a[192:195], v[80:83], v[56:59]
  v_exp_f32 v236, v236
  v_add_u32 v9, 1441792, v9
  v_mfma_f32_16x16x32_bf16 v[200:203], a[192:195], v[84:87], v[60:63]
  s_waitcnt lgkmcnt(3)
  v_add_f32 v37, v37, v236
  v_cvt_pk_bf16_f32 v233, v234, v235
  v_mfma_f32_16x16x32_bf16 v[160:163], a[196:199], v[88:91], v[160:163]
  v_exp_f32 v237, v237
  v_mfma_f32_16x16x32_bf16 v[168:171], a[196:199], v[92:95], v[168:171]
  ds_read_b128 a[212:215], v23 offset:53248
  v_add_f32 v37, v37, v237
  v_mfma_f32_16x16x32_bf16 v[176:179], a[196:199], v[96:99], v[176:179]
  v_exp_f32 v238, v238
  v_mfma_f32_16x16x32_bf16 v[184:187], a[196:199], v[100:103], v[184:187]
  v_add_f32 v37, v37, v238
  v_cvt_pk_bf16_f32 v234, v236, v237
  v_mfma_f32_16x16x32_bf16 v[192:195], a[196:199], v[104:107], v[192:195]
  buffer_load_dword v21, v9, s[8:11], 0 offen
  v_exp_f32 v239, v239
  v_mfma_f32_16x16x32_bf16 v[200:203], a[196:199], v[108:111], v[200:203]
  s_waitcnt lgkmcnt(3)
  ds_read_b128 a[216:219], v24 offset:53248
  v_add_f32 v37, v37, v239
  v_mfma_f32_16x16x32_bf16 v[160:163], a[200:203], v[112:115], v[160:163]
  v_exp_f32 v240, v240
  v_mfma_f32_16x16x32_bf16 v[168:171], a[200:203], v[116:119], v[168:171]
  v_add_f32 v38, v38, v240
  v_cvt_pk_bf16_f32 v235, v238, v239
  v_mfma_f32_16x16x32_bf16 v[176:179], a[200:203], v[120:123], v[176:179]
  v_exp_f32 v241, v241
  v_mfma_f32_16x16x32_bf16 v[184:187], a[200:203], v[124:127], v[184:187]
  ds_read_b128 a[220:223], v25 offset:53248
  v_add_f32 v38, v38, v241
  v_mfma_f32_16x16x32_bf16 v[192:195], a[200:203], v[128:131], v[192:195]
  v_exp_f32 v242, v242
  v_mfma_f32_16x16x32_bf16 v[200:203], a[200:203], v[132:135], v[200:203]
  s_waitcnt lgkmcnt(4)
  v_add_f32 v38, v38, v242
  v_cvt_pk_bf16_f32 v240, v240, v241
  v_mfma_f32_16x16x32_bf16 v[160:163], a[204:207], v[136:139], v[160:163]
  v_exp_f32 v243, v243
  v_mfma_f32_16x16x32_bf16 v[168:171], a[204:207], v[140:143], v[168:171]
  ds_read_b64_tr_b16 a[224:225], v26 offset:57344
  v_add_f32 v38, v38, v243
  v_mfma_f32_16x16x32_bf16 v[176:179], a[204:207], v[144:147], v[176:179]
  v_exp_f32 v244, v244
  v_mfma_f32_16x16x32_bf16 v[184:187], a[204:207], v[148:151], v[184:187]
  v_add_f32 v38, v38, v244
  v_cvt_pk_bf16_f32 v241, v242, v243
  v_mfma_f32_16x16x32_bf16 v[192:195], a[204:207], v[152:155], v[192:195]
  v_exp_f32 v245, v245
  v_mfma_f32_16x16x32_bf16 v[200:203], a[204:207], v[156:159], v[200:203]
  s_waitcnt lgkmcnt(4)
  ds_read_b64_tr_b16 a[226:227], v26 offset:61440
  v_add_f32 v38, v38, v245
  v_mfma_f32_16x16x32_bf16 v[164:167], a[208:211], v[64:67], v[40:43]
  v_exp_f32 v246, v246
  v_mfma_f32_16x16x32_bf16 v[172:175], a[208:211], v[68:71], v[44:47]
  v_add_f32 v38, v38, v246
  v_cvt_pk_bf16_f32 v242, v244, v245
  v_mfma_f32_16x16x32_bf16 v[180:183], a[208:211], v[72:75], v[48:51]
  v_exp_f32 v247, v247
  v_mfma_f32_16x16x32_bf16 v[188:191], a[208:211], v[76:79], v[52:55]
  ds_read_b64_tr_b16 a[228:229], v27 offset:57344
  v_add_f32 v38, v38, v247
  v_mfma_f32_16x16x32_bf16 v[196:199], a[208:211], v[80:83], v[56:59]
  v_exp_f32 v248, v248
  v_mfma_f32_16x16x32_bf16 v[204:207], a[208:211], v[84:87], v[60:63]
  s_waitcnt lgkmcnt(5)
  v_add_f32 v39, v39, v248
  v_cvt_pk_bf16_f32 v243, v246, v247
  v_mfma_f32_16x16x32_bf16 v[164:167], a[212:215], v[88:91], v[164:167]
  v_exp_f32 v249, v249
  v_mfma_f32_16x16x32_bf16 v[172:175], a[212:215], v[92:95], v[172:175]
  ds_read_b64_tr_b16 a[230:231], v27 offset:61440
  v_add_f32 v39, v39, v249
  v_mfma_f32_16x16x32_bf16 v[180:183], a[212:215], v[96:99], v[180:183]
  v_exp_f32 v250, v250
  v_mfma_f32_16x16x32_bf16 v[188:191], a[212:215], v[100:103], v[188:191]
  v_add_f32 v39, v39, v250
  v_cvt_pk_bf16_f32 v248, v248, v249
  v_mfma_f32_16x16x32_bf16 v[196:199], a[212:215], v[104:107], v[196:199]
  v_exp_f32 v251, v251
  v_mfma_f32_16x16x32_bf16 v[204:207], a[212:215], v[108:111], v[204:207]
  s_waitcnt lgkmcnt(5)
  ds_read_b64_tr_b16 a[232:233], v28 offset:57344
  v_add_f32 v39, v39, v251
  v_mfma_f32_16x16x32_bf16 v[164:167], a[216:219], v[112:115], v[164:167]
  v_exp_f32 v252, v252
  v_mfma_f32_16x16x32_bf16 v[172:175], a[216:219], v[116:119], v[172:175]
  v_add_f32 v39, v39, v252
  v_cvt_pk_bf16_f32 v249, v250, v251
  v_mfma_f32_16x16x32_bf16 v[180:183], a[216:219], v[120:123], v[180:183]
  v_exp_f32 v253, v253
  v_mfma_f32_16x16x32_bf16 v[188:191], a[216:219], v[124:127], v[188:191]
  ds_read_b64_tr_b16 a[234:235], v28 offset:61440
  v_add_f32 v39, v39, v253
  v_mfma_f32_16x16x32_bf16 v[196:199], a[216:219], v[128:131], v[196:199]
  v_exp_f32 v254, v254
  v_mfma_f32_16x16x32_bf16 v[204:207], a[216:219], v[132:135], v[204:207]
  s_waitcnt lgkmcnt(6)
  v_add_f32 v39, v39, v254
  v_cvt_pk_bf16_f32 v250, v252, v253
  v_mfma_f32_16x16x32_bf16 v[164:167], a[220:223], v[136:139], v[164:167]
  v_exp_f32 v255, v255
  v_mfma_f32_16x16x32_bf16 v[172:175], a[220:223], v[140:143], v[172:175]
  ds_read_b64_tr_b16 a[236:237], v29 offset:57344
  v_add_f32 v39, v39, v255
  v_mfma_f32_16x16x32_bf16 v[180:183], a[220:223], v[144:147], v[180:183]
  v_exp_f32 v160, v160
  v_mfma_f32_16x16x32_bf16 v[188:191], a[220:223], v[148:151], v[188:191]
  v_cvt_pk_bf16_f32 v251, v254, v255
  v_add_f32 v34, v34, v160
  v_mfma_f32_16x16x32_bf16 v[196:199], a[220:223], v[152:155], v[196:199]
  v_exp_f32 v161, v161
  v_mfma_f32_16x16x32_bf16 v[204:207], a[220:223], v[156:159], v[204:207]
  s_waitcnt lgkmcnt(5)
  ds_read_b64_tr_b16 a[238:239], v29 offset:61440
  v_add_f32 v34, v34, v161
  v_mfma_f32_16x16x32_bf16 a[0:3], a[224:227], v[208:211], a[0:3]
  v_exp_f32 v162, v162
  v_mfma_f32_16x16x32_bf16 a[32:35], a[224:227], v[216:219], a[32:35]
  v_add_f32 v34, v34, v162
  v_cvt_pk_bf16_f32 v160, v160, v161
  v_mfma_f32_16x16x32_bf16 a[64:67], a[224:227], v[224:227], a[64:67]
  v_exp_f32 v163, v163
  v_mfma_f32_16x16x32_bf16 a[96:99], a[224:227], v[232:235], a[96:99]
  ds_read_b64_tr_b16 a[240:241], v30 offset:57344
  v_add_f32 v34, v34, v163
  v_mfma_f32_16x16x32_bf16 a[128:131], a[224:227], v[240:243], a[128:131]
  v_exp_f32 v164, v164
  v_mfma_f32_16x16x32_bf16 a[160:163], a[224:227], v[248:251], a[160:163]
  s_waitcnt lgkmcnt(5)
  v_add_f32 v34, v34, v164
  v_cvt_pk_bf16_f32 v161, v162, v163
  v_mfma_f32_16x16x32_bf16 a[4:7], a[228:231], v[208:211], a[4:7]
  v_exp_f32 v165, v165
  v_mfma_f32_16x16x32_bf16 a[36:39], a[228:231], v[216:219], a[36:39]
  ds_read_b64_tr_b16 a[242:243], v30 offset:61440
  v_add_f32 v34, v34, v165
  v_mfma_f32_16x16x32_bf16 a[68:71], a[228:231], v[224:227], a[68:71]
  v_exp_f32 v166, v166
  v_add_u32 v9, 1441792, v9
  v_mfma_f32_16x16x32_bf16 a[100:103], a[228:231], v[232:235], a[100:103]
  v_add_f32 v34, v34, v166
  v_cvt_pk_bf16_f32 v162, v164, v165
  v_mfma_f32_16x16x32_bf16 a[132:135], a[228:231], v[240:243], a[132:135]
  v_exp_f32 v167, v167
  v_mfma_f32_16x16x32_bf16 a[164:167], a[228:231], v[248:251], a[164:167]
  s_waitcnt lgkmcnt(4)
  ds_read_b64_tr_b16 a[244:245], v31 offset:57344
  v_add_f32 v34, v34, v167
  v_mfma_f32_16x16x32_bf16 a[8:11], a[232:235], v[208:211], a[8:11]
  v_exp_f32 v168, v168
  v_mfma_f32_16x16x32_bf16 a[40:43], a[232:235], v[216:219], a[40:43]
  v_add_f32 v35, v35, v168
  v_cvt_pk_bf16_f32 v163, v166, v167
  v_mfma_f32_16x16x32_bf16 a[72:75], a[232:235], v[224:227], a[72:75]
  buffer_load_dword v21, v9, s[8:11], 0 offen
  v_exp_f32 v169, v169
  v_mfma_f32_16x16x32_bf16 a[104:107], a[232:235], v[232:235], a[104:107]
  ds_read_b64_tr_b16 a[246:247], v31 offset:61440
  v_add_f32 v35, v35, v169
  v_mfma_f32_16x16x32_bf16 a[136:139], a[232:235], v[240:243], a[136:139]
  v_exp_f32 v170, v170
  v_mfma_f32_16x16x32_bf16 a[168:171], a[232:235], v[248:251], a[168:171]
  s_waitcnt lgkmcnt(4)
  v_add_f32 v35, v35, v170
  v_cvt_pk_bf16_f32 v168, v168, v169
  v_mfma_f32_16x16x32_bf16 a[12:15], a[236:239], v[208:211], a[12:15]
  v_exp_f32 v171, v171
  v_mfma_f32_16x16x32_bf16 a[44:47], a[236:239], v[216:219], a[44:47]
  ds_read_b64_tr_b16 a[248:249], v32 offset:57344
  v_add_f32 v35, v35, v171
  v_mfma_f32_16x16x32_bf16 a[76:79], a[236:239], v[224:227], a[76:79]
  v_exp_f32 v172, v172
  v_mfma_f32_16x16x32_bf16 a[108:111], a[236:239], v[232:235], a[108:111]
  v_add_f32 v35, v35, v172
  v_cvt_pk_bf16_f32 v169, v170, v171
  v_mfma_f32_16x16x32_bf16 a[140:143], a[236:239], v[240:243], a[140:143]
  v_exp_f32 v173, v173
  v_mfma_f32_16x16x32_bf16 a[172:175], a[236:239], v[248:251], a[172:175]
  s_waitcnt lgkmcnt(3)
  ds_read_b64_tr_b16 a[250:251], v32 offset:61440
  v_add_f32 v35, v35, v173
  v_mfma_f32_16x16x32_bf16 a[16:19], a[240:243], v[208:211], a[16:19]
  v_exp_f32 v174, v174
  v_mfma_f32_16x16x32_bf16 a[48:51], a[240:243], v[216:219], a[48:51]
  v_add_f32 v35, v35, v174
  v_cvt_pk_bf16_f32 v170, v172, v173
  v_mfma_f32_16x16x32_bf16 a[80:83], a[240:243], v[224:227], a[80:83]
  v_exp_f32 v175, v175
  v_mfma_f32_16x16x32_bf16 a[112:115], a[240:243], v[232:235], a[112:115]
  ds_read_b64_tr_b16 a[252:253], v33 offset:57344
  v_add_f32 v35, v35, v175
  v_mfma_f32_16x16x32_bf16 a[144:147], a[240:243], v[240:243], a[144:147]
  v_exp_f32 v176, v176
  v_mfma_f32_16x16x32_bf16 a[176:179], a[240:243], v[248:251], a[176:179]
  s_waitcnt lgkmcnt(3)
  v_add_f32 v36, v36, v176
  v_cvt_pk_bf16_f32 v171, v174, v175
  v_mfma_f32_16x16x32_bf16 a[20:23], a[244:247], v[208:211], a[20:23]
  v_exp_f32 v177, v177
  v_mfma_f32_16x16x32_bf16 a[52:55], a[244:247], v[216:219], a[52:55]
  ds_read_b64_tr_b16 a[254:255], v33 offset:61440
  v_add_f32 v36, v36, v177
  v_mfma_f32_16x16x32_bf16 a[84:87], a[244:247], v[224:227], a[84:87]
  v_exp_f32 v178, v178
  v_mfma_f32_16x16x32_bf16 a[116:119], a[244:247], v[232:235], a[116:119]
  v_add_f32 v36, v36, v178
  v_cvt_pk_bf16_f32 v176, v176, v177
  v_mfma_f32_16x16x32_bf16 a[148:151], a[244:247], v[240:243], a[148:151]
  v_exp_f32 v179, v179
  v_mfma_f32_16x16x32_bf16 a[180:183], a[244:247], v[248:251], a[180:183]
  s_waitcnt lgkmcnt(2)
  ds_read_b128 a[192:195], v22 offset:57344
  v_add_f32 v36, v36, v179
  v_mfma_f32_16x16x32_bf16 a[24:27], a[248:251], v[208:211], a[24:27]
  v_exp_f32 v180, v180
  v_mfma_f32_16x16x32_bf16 a[56:59], a[248:251], v[216:219], a[56:59]
  v_add_f32 v36, v36, v180
  v_cvt_pk_bf16_f32 v177, v178, v179
  v_mfma_f32_16x16x32_bf16 a[88:91], a[248:251], v[224:227], a[88:91]
  v_exp_f32 v181, v181
  v_mfma_f32_16x16x32_bf16 a[120:123], a[248:251], v[232:235], a[120:123]
  ds_read_b128 a[196:199], v23 offset:57344
  v_add_f32 v36, v36, v181
  v_mfma_f32_16x16x32_bf16 a[152:155], a[248:251], v[240:243], a[152:155]
  v_exp_f32 v182, v182
  v_mfma_f32_16x16x32_bf16 a[184:187], a[248:251], v[248:251], a[184:187]
  s_waitcnt lgkmcnt(2)
  v_add_f32 v36, v36, v182
  v_cvt_pk_bf16_f32 v178, v180, v181
  v_mfma_f32_16x16x32_bf16 a[28:31], a[252:255], v[208:211], a[28:31]
  v_exp_f32 v183, v183
  v_mfma_f32_16x16x32_bf16 a[60:63], a[252:255], v[216:219], a[60:63]
  ds_read_b128 a[200:203], v24 offset:57344
  v_add_f32 v36, v36, v183
  v_mfma_f32_16x16x32_bf16 a[92:95], a[252:255], v[224:227], a[92:95]
  v_exp_f32 v184, v184
  v_mfma_f32_16x16x32_bf16 a[124:127], a[252:255], v[232:235], a[124:127]
  v_add_f32 v37, v37, v184
  v_cvt_pk_bf16_f32 v179, v182, v183
  v_mfma_f32_16x16x32_bf16 a[156:159], a[252:255], v[240:243], a[156:159]
  s_waitcnt vmcnt(19)
  s_barrier
  v_exp_f32 v185, v185
  v_mfma_f32_16x16x32_bf16 a[188:191], a[252:255], v[248:251], a[188:191]
  s_waitcnt lgkmcnt(2)
  ds_read_b128 a[204:207], v25 offset:57344
  v_add_f32 v37, v37, v185
  v_mfma_f32_16x16x32_bf16 v[208:211], a[192:195], v[64:67], v[40:43]
  s_add_u32 m0, s72, 131072
  v_exp_f32 v186, v186
  v_mfma_f32_16x16x32_bf16 v[216:219], a[192:195], v[68:71], v[44:47]
  v_add_f32 v37, v37, v186
  v_cvt_pk_bf16_f32 v184, v184, v185
  v_mfma_f32_16x16x32_bf16 v[224:227], a[192:195], v[72:75], v[48:51]
  v_exp_f32 v187, v187
  v_mfma_f32_16x16x32_bf16 v[232:235], a[192:195], v[76:79], v[52:55]
  ds_read_b128 a[208:211], v22 offset:61440
  v_add_f32 v37, v37, v187
  v_mfma_f32_16x16x32_bf16 v[240:243], a[192:195], v[80:83], v[56:59]
  v_exp_f32 v188, v188
  v_mfma_f32_16x16x32_bf16 v[248:251], a[192:195], v[84:87], v[60:63]
  s_waitcnt lgkmcnt(3)
  v_add_f32 v37, v37, v188
  v_cvt_pk_bf16_f32 v185, v186, v187
  v_mfma_f32_16x16x32_bf16 v[208:211], a[196:199], v[88:91], v[208:211]
  v_exp_f32 v189, v189
  v_mfma_f32_16x16x32_bf16 v[216:219], a[196:199], v[92:95], v[216:219]
  ds_read_b128 a[212:215], v23 offset:61440
  v_add_f32 v37, v37, v189
  v_mfma_f32_16x16x32_bf16 v[224:227], a[196:199], v[96:99], v[224:227]
  s_add_u32 s3, s71, 114688
  v_exp_f32 v190, v190
  v_mfma_f32_16x16x32_bf16 v[232:235], a[196:199], v[100:103], v[232:235]
  v_add_f32 v37, v37, v190
  v_cvt_pk_bf16_f32 v186, v188, v189
  v_mfma_f32_16x16x32_bf16 v[240:243], a[196:199], v[104:107], v[240:243]
  v_exp_f32 v191, v191
  v_add_u32 v9, 1441792, v9
  v_mfma_f32_16x16x32_bf16 v[248:251], a[196:199], v[108:111], v[248:251]
  s_waitcnt lgkmcnt(3)
  ds_read_b128 a[216:219], v24 offset:61440
  v_add_f32 v37, v37, v191
  v_mfma_f32_16x16x32_bf16 v[208:211], a[200:203], v[112:115], v[208:211]
  v_exp_f32 v192, v192
  v_mfma_f32_16x16x32_bf16 v[216:219], a[200:203], v[116:119], v[216:219]
  v_add_f32 v38, v38, v192
  v_cvt_pk_bf16_f32 v187, v190, v191
  v_mfma_f32_16x16x32_bf16 v[224:227], a[200:203], v[120:123], v[224:227]
  v_exp_f32 v193, v193
  v_mfma_f32_16x16x32_bf16 v[232:235], a[200:203], v[124:127], v[232:235]
  ds_read_b128 a[220:223], v25 offset:61440
  v_add_f32 v38, v38, v193
  v_mfma_f32_16x16x32_bf16 v[240:243], a[200:203], v[128:131], v[240:243]
  s_getpc_b64 s[92:93]
L_j9:
  buffer_load_dword v21, v9, s[8:11], 0 offen
  buffer_load_dwordx4 v7, s[16:19], s3 offen offset:0 nt lds
  v_exp_f32 v194, v194
  v_mfma_f32_16x16x32_bf16 v[248:251], a[200:203], v[132:135], v[248:251]
  s_waitcnt lgkmcnt(4)
  v_add_f32 v38, v38, v194
  v_cvt_pk_bf16_f32 v192, v192, v193
  v_mfma_f32_16x16x32_bf16 v[208:211], a[204:207], v[136:139], v[208:211]
  s_add_u32 s92, s92, 3072
  s_addc_u32 s93, s93, 0
  v_exp_f32 v195, v195
  v_mfma_f32_16x16x32_bf16 v[216:219], a[204:207], v[140:143], v[216:219]
  ds_read_b64_tr_b16 a[224:225], v26 offset:0
  v_add_f32 v38, v38, v195
  v_mfma_f32_16x16x32_bf16 v[224:227], a[204:207], v[144:147], v[224:227]
  v_exp_f32 v196, v196
  v_mfma_f32_16x16x32_bf16 v[232:235], a[204:207], v[148:151], v[232:235]
  v_add_f32 v38, v38, v196
  v_cvt_pk_bf16_f32 v193, v194, v195
  v_mfma_f32_16x16x32_bf16 v[240:243], a[204:207], v[152:155], v[240:243]
  buffer_load_dword v21, v15, s[92:95], 0 offen
  v_exp_f32 v197, v197
  v_mfma_f32_16x16x32_bf16 v[248:251], a[204:207], v[156:159], v[248:251]
  s_waitcnt lgkmcnt(4)
  ds_read_b64_tr_b16 a[226:227], v26 offset:4096
  v_add_f32 v38, v38, v197
  v_mfma_f32_16x16x32_bf16 v[212:215], a[208:211], v[64:67], v[40:43]
  buffer_load_dwordx4 v8, s[16:19], s3 offen offset:1024 nt lds
  v_exp_f32 v198, v198
  v_mfma_f32_16x16x32_bf16 v[220:223], a[208:211], v[68:71], v[44:47]
  v_add_f32 v38, v38, v198
  v_cvt_pk_bf16_f32 v194, v196, v197
  v_mfma_f32_16x16x32_bf16 v[228:231], a[208:211], v[72:75], v[48:51]
  v_exp_f32 v199, v199
  v_mfma_f32_16x16x32_bf16 v[236:239], a[208:211], v[76:79], v[52:55]
  ds_read_b64_tr_b16 a[228:229], v27 offset:0
  v_add_f32 v38, v38, v199
  v_mfma_f32_16x16x32_bf16 v[244:247], a[208:211], v[80:83], v[56:59]
  v_exp_f32 v200, v200
  v_mfma_f32_16x16x32_bf16 v[252:255], a[208:211], v[84:87], v[60:63]
  s_waitcnt lgkmcnt(5)
  v_add_f32 v39, v39, v200
  v_cvt_pk_bf16_f32 v195, v198, v199
  v_mfma_f32_16x16x32_bf16 v[212:215], a[212:215], v[88:91], v[212:215]
  v_exp_f32 v201, v201
  v_mfma_f32_16x16x32_bf16 v[220:223], a[212:215], v[92:95], v[220:223]
  ds_read_b64_tr_b16 a[230:231], v27 offset:4096
  v_add_f32 v39, v39, v201
  v_mfma_f32_16x16x32_bf16 v[228:231], a[212:215], v[96:99], v[228:231]
  buffer_load_dwordx4 v7, s[16:19], s3 offen offset:2048 nt lds
  v_exp_f32 v202, v202
  v_mfma_f32_16x16x32_bf16 v[236:239], a[212:215], v[100:103], v[236:239]
  v_add_f32 v39, v39, v202
  v_cvt_pk_bf16_f32 v200, v200, v201
  v_mfma_f32_16x16x32_bf16 v[244:247], a[212:215], v[104:107], v[244:247]
  v_exp_f32 v203, v203
  v_mfma_f32_16x16x32_bf16 v[252:255], a[212:215], v[108:111], v[252:255]
  s_waitcnt lgkmcnt(5)
  ds_read_b64_tr_b16 a[232:233], v28 offset:0
  v_add_f32 v39, v39, v203
  v_mfma_f32_16x16x32_bf16 v[212:215], a[216:219], v[112:115], v[212:215]
  v_exp_f32 v204, v204
  v_mfma_f32_16x16x32_bf16 v[220:223], a[216:219], v[116:119], v[220:223]
  v_add_f32 v39, v39, v204
  v_cvt_pk_bf16_f32 v201, v202, v203
  v_mfma_f32_16x16x32_bf16 v[228:231], a[216:219], v[120:123], v[228:231]
  v_exp_f32 v205, v205
  v_mfma_f32_16x16x32_bf16 v[236:239], a[216:219], v[124:127], v[236:239]
  ds_read_b64_tr_b16 a[234:235], v28 offset:4096
  v_add_f32 v39, v39, v205
  v_mfma_f32_16x16x32_bf16 v[244:247], a[216:219], v[128:131], v[244:247]
  buffer_load_dwordx4 v8, s[16:19], s3 offen offset:3072 nt lds
  v_exp_f32 v206, v206
  v_mfma_f32_16x16x32_bf16 v[252:255], a[216:219], v[132:135], v[252:255]
  s_waitcnt lgkmcnt(6)
  v_add_f32 v39, v39, v206
  v_cvt_pk_bf16_f32 v202, v204, v205
  v_mfma_f32_16x16x32_bf16 v[212:215], a[220:223], v[136:139], v[212:215]
  v_exp_f32 v207, v207
  v_mfma_f32_16x16x32_bf16 v[220:223], a[220:223], v[140:143], v[220:223]
  ds_read_b64_tr_b16 a[236:237], v29 offset:0
  v_add_f32 v39, v39, v207
  v_mfma_f32_16x16x32_bf16 v[228:231], a[220:223], v[144:147], v[228:231]
  v_exp_f32 v208, v208
  v_mfma_f32_16x16x32_bf16 v[236:239], a[220:223], v[148:151], v[236:239]
  v_cvt_pk_bf16_f32 v203, v206, v207
  v_add_f32 v34, v34, v208
  v_mfma_f32_16x16x32_bf16 v[244:247], a[220:223], v[152:155], v[244:247]
  v_exp_f32 v209, v209
  v_mfma_f32_16x16x32_bf16 v[252:255], a[220:223], v[156:159], v[252:255]
  s_waitcnt lgkmcnt(5)
  ds_read_b64_tr_b16 a[238:239], v29 offset:4096
  v_add_f32 v34, v34, v209
  v_mfma_f32_16x16x32_bf16 a[0:3], a[224:227], v[160:163], a[0:3]
  s_add_u32 m0, s72, 49152
  v_exp_f32 v210, v210
  v_mfma_f32_16x16x32_bf16 a[32:35], a[224:227], v[168:171], a[32:35]
  v_add_f32 v34, v34, v210
  v_cvt_pk_bf16_f32 v208, v208, v209
  v_mfma_f32_16x16x32_bf16 a[64:67], a[224:227], v[176:179], a[64:67]
  s_mov_b32 s12, s58
  v_exp_f32 v211, v211
  v_mfma_f32_16x16x32_bf16 a[96:99], a[224:227], v[184:187], a[96:99]
  ds_read_b64_tr_b16 a[240:241], v30 offset:0
  v_add_f32 v34, v34, v211
  v_mfma_f32_16x16x32_bf16 a[128:131], a[224:227], v[192:195], a[128:131]
  s_mov_b32 s13, s59
  v_exp_f32 v212, v212
  v_mfma_f32_16x16x32_bf16 a[160:163], a[224:227], v[200:203], a[160:163]
  s_waitcnt lgkmcnt(5)
  v_add_f32 v34, v34, v212
  v_cvt_pk_bf16_f32 v209, v210, v211
  v_mfma_f32_16x16x32_bf16 a[4:7], a[228:231], v[160:163], a[4:7]
  s_mov_b32 s14, 256
  v_exp_f32 v213, v213
  v_mfma_f32_16x16x32_bf16 a[36:39], a[228:231], v[168:171], a[36:39]
  ds_read_b64_tr_b16 a[242:243], v30 offset:4096
  v_add_f32 v34, v34, v213
  v_mfma_f32_16x16x32_bf16 a[68:71], a[228:231], v[176:179], a[68:71]
  s_add_u32 s3, s71, 114688
  v_exp_f32 v214, v214
  v_mfma_f32_16x16x32_bf16 a[100:103], a[228:231], v[184:187], a[100:103]
  v_add_f32 v34, v34, v214
  v_cvt_pk_bf16_f32 v210, v212, v213
  v_mfma_f32_16x16x32_bf16 a[132:135], a[228:231], v[192:195], a[132:135]
  v_exp_f32 v215, v215
  v_mfma_f32_16x16x32_bf16 a[164:167], a[228:231], v[200:203], a[164:167]
  s_waitcnt lgkmcnt(4)
  ds_read_b64_tr_b16 a[244:245], v31 offset:0
  v_add_f32 v34, v34, v215
  v_mfma_f32_16x16x32_bf16 a[8:11], a[232:235], v[160:163], a[8:11]
  v_exp_f32 v216, v216
  v_mfma_f32_16x16x32_bf16 a[40:43], a[232:235], v[168:171], a[40:43]
  v_add_f32 v35, v35, v216
  v_cvt_pk_bf16_f32 v211, v214, v215
  v_mfma_f32_16x16x32_bf16 a[72:75], a[232:235], v[176:179], a[72:75]
  v_exp_f32 v217, v217
  v_add_u32 v9, 1441792, v9
  v_mfma_f32_16x16x32_bf16 a[104:107], a[232:235], v[184:187], a[104:107]
  ds_read_b64_tr_b16 a[246:247], v31 offset:4096
  v_add_f32 v35, v35, v217
  v_mfma_f32_16x16x32_bf16 a[136:139], a[232:235], v[192:195], a[136:139]
  buffer_load_dwordx4 v7, s[20:23], s3 offen offset:0 nt lds
  v_exp_f32 v218, v218
  v_mfma_f32_16x16x32_bf16 a[168:171], a[232:235], v[200:203], a[168:171]
  s_waitcnt lgkmcnt(4)
  v_add_f32 v35, v35, v218
  v_cvt_pk_bf16_f32 v216, v216, v217
  v_mfma_f32_16x16x32_bf16 a[12:15], a[236:239], v[160:163], a[12:15]
  v_exp_f32 v219, v219
  v_mfma_f32_16x16x32_bf16 a[44:47], a[236:239], v[168:171], a[44:47]
  ds_read_b64_tr_b16 a[248:249], v32 offset:0
  v_add_f32 v35, v35, v219
  v_mfma_f32_16x16x32_bf16 a[76:79], a[236:239], v[176:179], a[76:79]
  buffer_load_dword v21, v9, s[8:11], 0 offen
  v_exp_f32 v220, v220
  v_mfma_f32_16x16x32_bf16 a[108:111], a[236:239], v[184:187], a[108:111]
  v_add_f32 v35, v35, v220
  v_cvt_pk_bf16_f32 v217, v218, v219
  v_mfma_f32_16x16x32_bf16 a[140:143], a[236:239], v[192:195], a[140:143]
  v_exp_f32 v221, v221
  v_mfma_f32_16x16x32_bf16 a[172:175], a[236:239], v[200:203], a[172:175]
  s_waitcnt lgkmcnt(3)
  ds_read_b64_tr_b16 a[250:251], v32 offset:4096
  v_add_f32 v35, v35, v221
  v_mfma_f32_16x16x32_bf16 a[16:19], a[240:243], v[160:163], a[16:19]
  buffer_load_dwordx4 v8, s[20:23], s3 offen offset:1024 nt lds
  v_exp_f32 v222, v222
  v_mfma_f32_16x16x32_bf16 a[48:51], a[240:243], v[168:171], a[48:51]
  v_add_f32 v35, v35, v222
  v_cvt_pk_bf16_f32 v218, v220, v221
  v_mfma_f32_16x16x32_bf16 a[80:83], a[240:243], v[176:179], a[80:83]
  v_exp_f32 v223, v223
  v_mfma_f32_16x16x32_bf16 a[112:115], a[240:243], v[184:187], a[112:115]
  ds_read_b64_tr_b16 a[252:253], v33 offset:0
  v_add_f32 v35, v35, v223
  v_mfma_f32_16x16x32_bf16 a[144:147], a[240:243], v[192:195], a[144:147]
  v_exp_f32 v224, v224
  v_mfma_f32_16x16x32_bf16 a[176:179], a[240:243], v[200:203], a[176:179]
  s_waitcnt lgkmcnt(3)
  v_add_f32 v36, v36, v224
  v_cvt_pk_bf16_f32 v219, v222, v223
  v_mfma_f32_16x16x32_bf16 a[20:23], a[244:247], v[160:163], a[20:23]
  v_exp_f32 v225, v225
  v_mfma_f32_16x16x32_bf16 a[52:55], a[244:247], v[168:171], a[52:55]
  ds_read_b64_tr_b16 a[254:255], v33 offset:4096
  v_add_f32 v36, v36, v225
  v_mfma_f32_16x16x32_bf16 a[84:87], a[244:247], v[176:179], a[84:87]
  buffer_load_dwordx4 v7, s[20:23], s3 offen offset:2048 nt lds
  v_exp_f32 v226, v226
  v_mfma_f32_16x16x32_bf16 a[116:119], a[244:247], v[184:187], a[116:119]
  v_add_f32 v36, v36, v226
  v_cvt_pk_bf16_f32 v224, v224, v225
  v_mfma_f32_16x16x32_bf16 a[148:151], a[244:247], v[192:195], a[148:151]
  v_exp_f32 v227, v227
  v_mfma_f32_16x16x32_bf16 a[180:183], a[244:247], v[200:203], a[180:183]
  s_waitcnt lgkmcnt(2)
  ds_read_b128 a[192:195], v22 offset:0
  v_add_f32 v36, v36, v227
  v_mfma_f32_16x16x32_bf16 a[24:27], a[248:251], v[160:163], a[24:27]
  v_exp_f32 v228, v228
  v_mfma_f32_16x16x32_bf16 a[56:59], a[248:251], v[168:171], a[56:59]
  v_add_f32 v36, v36, v228
  v_cvt_pk_bf16_f32 v225, v226, v227
  v_mfma_f32_16x16x32_bf16 a[88:91], a[248:251], v[176:179], a[88:91]
  v_exp_f32 v229, v229
  v_mfma_f32_16x16x32_bf16 a[120:123], a[248:251], v[184:187], a[120:123]
  ds_read_b128 a[196:199], v23 offset:0
  v_add_f32 v36, v36, v229
  v_mfma_f32_16x16x32_bf16 a[152:155], a[248:251], v[192:195], a[152:155]
  buffer_load_dwordx4 v8, s[20:23], s3 offen offset:3072 nt lds
  v_exp_f32 v230, v230
  v_mfma_f32_16x16x32_bf16 a[184:187], a[248:251], v[200:203], a[184:187]
  s_waitcnt lgkmcnt(2)
  v_add_f32 v36, v36, v230
  v_cvt_pk_bf16_f32 v226, v228, v229
  v_mfma_f32_16x16x32_bf16 a[28:31], a[252:255], v[160:163], a[28:31]
  v_exp_f32 v231, v231
  v_mfma_f32_16x16x32_bf16 a[60:63], a[252:255], v[168:171], a[60:63]
  ds_read_b128 a[200:203], v24 offset:0
  v_add_f32 v36, v36, v231
  v_mfma_f32_16x16x32_bf16 a[92:95], a[252:255], v[176:179], a[92:95]
  v_exp_f32 v232, v232
  v_mfma_f32_16x16x32_bf16 a[124:127], a[252:255], v[184:187], a[124:127]
  v_add_f32 v37, v37, v232
  v_cvt_pk_bf16_f32 v227, v230, v231
  v_mfma_f32_16x16x32_bf16 a[156:159], a[252:255], v[192:195], a[156:159]
  buffer_atomic_add v20, v19, s[12:15], 0 offen sc0 sc1
  v_exp_f32 v233, v233
  v_mfma_f32_16x16x32_bf16 a[188:191], a[252:255], v[200:203], a[188:191]
  s_waitcnt lgkmcnt(2)
  ds_read_b128 a[204:207], v25 offset:0
  v_add_f32 v37, v37, v233
  v_mfma_f32_16x16x32_bf16 v[160:163], a[192:195], v[64:67], v[40:43]
  v_exp_f32 v234, v234
  v_mfma_f32_16x16x32_bf16 v[168:171], a[192:195], v[68:71], v[44:47]
  v_add_f32 v37, v37, v234
  v_cvt_pk_bf16_f32 v232, v232, v233
  v_mfma_f32_16x16x32_bf16 v[176:179], a[192:195], v[72:75], v[48:51]
  v_exp_f32 v235, v235
  v_mfma_f32_16x16x32_bf16 v[184:187], a[192:195], v[76:79], v[52:55]
  ds_read_b128 a[208:211], v22 offset:4096
  v_add_f32 v37, v37, v235
  v_mfma_f32_16x16x32_bf16 v[192:195], a[192:195], v[80:83], v[56:59]
  v_exp_f32 v236, v236
  v_mfma_f32_16x16x32_bf16 v[200:203], a[192:195], v[84:87], v[60:63]
  s_waitcnt lgkmcnt(3)
  v_add_f32 v37, v37, v236
  v_cvt_pk_bf16_f32 v233, v234, v235
  v_mfma_f32_16x16x32_bf16 v[160:163], a[196:199], v[88:91], v[160:163]
  v_exp_f32 v237, v237
  v_mfma_f32_16x16x32_bf16 v[168:171], a[196:199], v[92:95], v[168:171]
  ds_read_b128 a[212:215], v23 offset:4096
  v_add_f32 v37, v37, v237
  v_mfma_f32_16x16x32_bf16 v[176:179], a[196:199], v[96:99], v[176:179]
  v_exp_f32 v238, v238
  v_mfma_f32_16x16x32_bf16 v[184:187], a[196:199], v[100:103], v[184:187]
  v_add_f32 v37, v37, v238
  v_cvt_pk_bf16_f32 v234, v236, v237
  v_mfma_f32_16x16x32_bf16 v[192:195], a[196:199], v[104:107], v[192:195]
  v_exp_f32 v239, v239
  v_mfma_f32_16x16x32_bf16 v[200:203], a[196:199], v[108:111], v[200:203]
  s_waitcnt lgkmcnt(3)
  ds_read_b128 a[216:219], v24 offset:4096
  v_add_f32 v37, v37, v239
  v_mfma_f32_16x16x32_bf16 v[160:163], a[200:203], v[112:115], v[160:163]
  v_exp_f32 v240, v240
  v_mfma_f32_16x16x32_bf16 v[168:171], a[200:203], v[116:119], v[168:171]
  v_add_f32 v38, v38, v240
  v_cvt_pk_bf16_f32 v235, v238, v239
  v_mfma_f32_16x16x32_bf16 v[176:179], a[200:203], v[120:123], v[176:179]
  v_exp_f32 v241, v241
  v_mfma_f32_16x16x32_bf16 v[184:187], a[200:203], v[124:127], v[184:187]
  ds_read_b128 a[220:223], v25 offset:4096
  v_add_f32 v38, v38, v241
  v_mfma_f32_16x16x32_bf16 v[192:195], a[200:203], v[128:131], v[192:195]
  v_exp_f32 v242, v242
  v_mfma_f32_16x16x32_bf16 v[200:203], a[200:203], v[132:135], v[200:203]
  s_waitcnt lgkmcnt(4)
  v_add_f32 v38, v38, v242
  v_cvt_pk_bf16_f32 v240, v240, v241
  v_mfma_f32_16x16x32_bf16 v[160:163], a[204:207], v[136:139], v[160:163]
  v_exp_f32 v243, v243
  v_add_u32 v9, 1441792, v9
  v_mfma_f32_16x16x32_bf16 v[168:171], a[204:207], v[140:143], v[168:171]
  ds_read_b64_tr_b16 a[224:225], v26 offset:8192
  v_add_f32 v38, v38, v243
  v_mfma_f32_16x16x32_bf16 v[176:179], a[204:207], v[144:147], v[176:179]
  v_exp_f32 v244, v244
  v_mfma_f32_16x16x32_bf16 v[184:187], a[204:207], v[148:151], v[184:187]
  v_add_f32 v38, v38, v244
  v_cvt_pk_bf16_f32 v241, v242, v243
  v_mfma_f32_16x16x32_bf16 v[192:195], a[204:207], v[152:155], v[192:195]
  v_exp_f32 v245, v245
  v_mfma_f32_16x16x32_bf16 v[200:203], a[204:207], v[156:159], v[200:203]
  s_waitcnt lgkmcnt(4)
  ds_read_b64_tr_b16 a[226:227], v26 offset:12288
  v_add_f32 v38, v38, v245
  v_mfma_f32_16x16x32_bf16 v[164:167], a[208:211], v[64:67], v[40:43]
  buffer_load_dword v21, v9, s[8:11], 0 offen
  v_exp_f32 v246, v246
  v_mfma_f32_16x16x32_bf16 v[172:175], a[208:211], v[68:71], v[44:47]
  v_add_f32 v38, v38, v246
  v_cvt_pk_bf16_f32 v242, v244, v245
  v_mfma_f32_16x16x32_bf16 v[180:183], a[208:211], v[72:75], v[48:51]
  v_exp_f32 v247, v247
  v_mfma_f32_16x16x32_bf16 v[188:191], a[208:211], v[76:79], v[52:55]
  ds_read_b64_tr_b16 a[228:229], v27 offset:8192
  v_add_f32 v38, v38, v247
  v_mfma_f32_16x16x32_bf16 v[196:199], a[208:211], v[80:83], v[56:59]
  v_exp_f32 v248, v248
  v_mfma_f32_16x16x32_bf16 v[204:207], a[208:211], v[84:87], v[60:63]
  s_waitcnt lgkmcnt(5)
  v_add_f32 v39, v39, v248
  v_cvt_pk_bf16_f32 v243, v246, v247
  v_mfma_f32_16x16x32_bf16 v[164:167], a[212:215], v[88:91], v[164:167]
  v_exp_f32 v249, v249
  v_mfma_f32_16x16x32_bf16 v[172:175], a[212:215], v[92:95], v[172:175]
  ds_read_b64_tr_b16 a[230:231], v27 offset:12288
  v_add_f32 v39, v39, v249
  v_mfma_f32_16x16x32_bf16 v[180:183], a[212:215], v[96:99], v[180:183]
  v_exp_f32 v250, v250
  v_mfma_f32_16x16x32_bf16 v[188:191], a[212:215], v[100:103], v[188:191]
  v_add_f32 v39, v39, v250
  v_cvt_pk_bf16_f32 v248, v248, v249
  v_mfma_f32_16x16x32_bf16 v[196:199], a[212:215], v[104:107], v[196:199]
  v_exp_f32 v251, v251
  v_mfma_f32_16x16x32_bf16 v[204:207], a[212:215], v[108:111], v[204:207]
  s_waitcnt lgkmcnt(5)
  ds_read_b64_tr_b16 a[232:233], v28 offset:8192
  v_add_f32 v39, v39, v251
  v_mfma_f32_16x16x32_bf16 v[164:167], a[216:219], v[112:115], v[164:167]
  v_exp_f32 v252, v252
  v_mfma_f32_16x16x32_bf16 v[172:175], a[216:219], v[116:119], v[172:175]
  v_add_f32 v39, v39, v252
  v_cvt_pk_bf16_f32 v249, v250, v251
  v_mfma_f32_16x16x32_bf16 v[180:183], a[216:219], v[120:123], v[180:183]
  v_exp_f32 v253, v253
  v_mfma_f32_16x16x32_bf16 v[188:191], a[216:219], v[124:127], v[188:191]
  ds_read_b64_tr_b16 a[234:235], v28 offset:12288
  v_add_f32 v39, v39, v253
  v_mfma_f32_16x16x32_bf16 v[196:199], a[216:219], v[128:131], v[196:199]
  v_exp_f32 v254, v254
  v_mfma_f32_16x16x32_bf16 v[204:207], a[216:219], v[132:135], v[204:207]
  s_waitcnt lgkmcnt(6)
  v_add_f32 v39, v39, v254
  v_cvt_pk_bf16_f32 v250, v252, v253
  v_mfma_f32_16x16x32_bf16 v[164:167], a[220:223], v[136:139], v[164:167]
  v_exp_f32 v255, v255
  v_mfma_f32_16x16x32_bf16 v[172:175], a[220:223], v[140:143], v[172:175]
  ds_read_b64_tr_b16 a[236:237], v29 offset:8192
  v_add_f32 v39, v39, v255
  v_mfma_f32_16x16x32_bf16 v[180:183], a[220:223], v[144:147], v[180:183]
  v_exp_f32 v160, v160
  v_mfma_f32_16x16x32_bf16 v[188:191], a[220:223], v[148:151], v[188:191]
  v_cvt_pk_bf16_f32 v251, v254, v255
  v_add_f32 v34, v34, v160
  v_mfma_f32_16x16x32_bf16 v[196:199], a[220:223], v[152:155], v[196:199]
  v_exp_f32 v161, v161
  v_mfma_f32_16x16x32_bf16 v[204:207], a[220:223], v[156:159], v[204:207]
  s_waitcnt lgkmcnt(5)
  ds_read_b64_tr_b16 a[238:239], v29 offset:12288
  v_add_f32 v34, v34, v161
  v_mfma_f32_16x16x32_bf16 a[0:3], a[224:227], v[208:211], a[0:3]
  v_exp_f32 v162, v162
  v_mfma_f32_16x16x32_bf16 a[32:35], a[224:227], v[216:219], a[32:35]
  v_add_f32 v34, v34, v162
  v_cvt_pk_bf16_f32 v160, v160, v161
  v_mfma_f32_16x16x32_bf16 a[64:67], a[224:227], v[224:227], a[64:67]
  v_exp_f32 v163, v163
  v_mfma_f32_16x16x32_bf16 a[96:99], a[224:227], v[232:235], a[96:99]
  ds_read_b64_tr_b16 a[240:241], v30 offset:8192
  v_add_f32 v34, v34, v163
  v_mfma_f32_16x16x32_bf16 a[128:131], a[224:227], v[240:243], a[128:131]
  v_exp_f32 v164, v164
  v_mfma_f32_16x16x32_bf16 a[160:163], a[224:227], v[248:251], a[160:163]
  s_waitcnt lgkmcnt(5)
  v_add_f32 v34, v34, v164
  v_cvt_pk_bf16_f32 v161, v162, v163
  v_mfma_f32_16x16x32_bf16 a[4:7], a[228:231], v[208:211], a[4:7]
  v_exp_f32 v165, v165
  v_mfma_f32_16x16x32_bf16 a[36:39], a[228:231], v[216:219], a[36:39]
  ds_read_b64_tr_b16 a[242:243], v30 offset:12288
  v_add_f32 v34, v34, v165
  v_mfma_f32_16x16x32_bf16 a[68:71], a[228:231], v[224:227], a[68:71]
  v_exp_f32 v166, v166
  v_mfma_f32_16x16x32_bf16 a[100:103], a[228:231], v[232:235], a[100:103]
  v_add_f32 v34, v34, v166
  v_cvt_pk_bf16_f32 v162, v164, v165
  v_mfma_f32_16x16x32_bf16 a[132:135], a[228:231], v[240:243], a[132:135]
  v_exp_f32 v167, v167
  v_mfma_f32_16x16x32_bf16 a[164:167], a[228:231], v[248:251], a[164:167]
  s_waitcnt lgkmcnt(4)
  ds_read_b64_tr_b16 a[244:245], v31 offset:8192
  v_add_f32 v34, v34, v167
  v_mfma_f32_16x16x32_bf16 a[8:11], a[232:235], v[208:211], a[8:11]
  v_exp_f32 v168, v168
  v_mfma_f32_16x16x32_bf16 a[40:43], a[232:235], v[216:219], a[40:43]
  v_add_f32 v35, v35, v168
  v_cvt_pk_bf16_f32 v163, v166, v167
  v_mfma_f32_16x16x32_bf16 a[72:75], a[232:235], v[224:227], a[72:75]
  v_exp_f32 v169, v169
  v_mfma_f32_16x16x32_bf16 a[104:107], a[232:235], v[232:235], a[104:107]
  ds_read_b64_tr_b16 a[246:247], v31 offset:12288
  v_add_f32 v35, v35, v169
  v_mfma_f32_16x16x32_bf16 a[136:139], a[232:235], v[240:243], a[136:139]
  v_exp_f32 v170, v170
  v_mfma_f32_16x16x32_bf16 a[168:171], a[232:235], v[248:251], a[168:171]
  s_waitcnt lgkmcnt(4)
  v_add_f32 v35, v35, v170
  v_cvt_pk_bf16_f32 v168, v168, v169
  v_mfma_f32_16x16x32_bf16 a[12:15], a[236:239], v[208:211], a[12:15]
  v_exp_f32 v171, v171
  v_mfma_f32_16x16x32_bf16 a[44:47], a[236:239], v[216:219], a[44:47]
  ds_read_b64_tr_b16 a[248:249], v32 offset:8192
  v_add_f32 v35, v35, v171
  v_mfma_f32_16x16x32_bf16 a[76:79], a[236:239], v[224:227], a[76:79]
  v_exp_f32 v172, v172
  v_add_u32 v9, 1441792, v9
  v_mfma_f32_16x16x32_bf16 a[108:111], a[236:239], v[232:235], a[108:111]
  v_add_f32 v35, v35, v172
  v_cvt_pk_bf16_f32 v169, v170, v171
  v_mfma_f32_16x16x32_bf16 a[140:143], a[236:239], v[240:243], a[140:143]
  v_exp_f32 v173, v173
  v_mfma_f32_16x16x32_bf16 a[172:175], a[236:239], v[248:251], a[172:175]
  s_waitcnt lgkmcnt(3)
  ds_read_b64_tr_b16 a[250:251], v32 offset:12288
  v_add_f32 v35, v35, v173
  v_mfma_f32_16x16x32_bf16 a[16:19], a[240:243], v[208:211], a[16:19]
  v_exp_f32 v174, v174
  v_mfma_f32_16x16x32_bf16 a[48:51], a[240:243], v[216:219], a[48:51]
  v_add_f32 v35, v35, v174
  v_cvt_pk_bf16_f32 v170, v172, v173
  v_mfma_f32_16x16x32_bf16 a[80:83], a[240:243], v[224:227], a[80:83]
  buffer_load_dword v21, v9, s[8:11], 0 offen
  v_exp_f32 v175, v175
  v_mfma_f32_16x16x32_bf16 a[112:115], a[240:243], v[232:235], a[112:115]
  ds_read_b64_tr_b16 a[252:253], v33 offset:8192
  v_add_f32 v35, v35, v175
  v_mfma_f32_16x16x32_bf16 a[144:147], a[240:243], v[240:243], a[144:147]
  v_exp_f32 v176, v176
  v_mfma_f32_16x16x32_bf16 a[176:179], a[240:243], v[248:251], a[176:179]
  s_waitcnt lgkmcnt(3)
  v_add_f32 v36, v36, v176
  v_cvt_pk_bf16_f32 v171, v174, v175
  v_mfma_f32_16x16x32_bf16 a[20:23], a[244:247], v[208:211], a[20:23]
  v_exp_f32 v177, v177
  v_mfma_f32_16x16x32_bf16 a[52:55], a[244:247], v[216:219], a[52:55]
  ds_read_b64_tr_b16 a[254:255], v33 offset:12288
  v_add_f32 v36, v36, v177
  v_mfma_f32_16x16x32_bf16 a[84:87], a[244:247], v[224:227], a[84:87]
  v_exp_f32 v178, v178
  v_mfma_f32_16x16x32_bf16 a[116:119], a[244:247], v[232:235], a[116:119]
  v_add_f32 v36, v36, v178
  v_cvt_pk_bf16_f32 v176, v176, v177
  v_mfma_f32_16x16x32_bf16 a[148:151], a[244:247], v[240:243], a[148:151]
  v_exp_f32 v179, v179
  v_mfma_f32_16x16x32_bf16 a[180:183], a[244:247], v[248:251], a[180:183]
  s_waitcnt lgkmcnt(2)
  ds_read_b128 a[192:195], v22 offset:8192
  v_add_f32 v36, v36, v179
  v_mfma_f32_16x16x32_bf16 a[24:27], a[248:251], v[208:211], a[24:27]
  v_exp_f32 v180, v180
  v_mfma_f32_16x16x32_bf16 a[56:59], a[248:251], v[216:219], a[56:59]
  v_add_f32 v36, v36, v180
  v_cvt_pk_bf16_f32 v177, v178, v179
  v_mfma_f32_16x16x32_bf16 a[88:91], a[248:251], v[224:227], a[88:91]
  v_exp_f32 v181, v181
  v_mfma_f32_16x16x32_bf16 a[120:123], a[248:251], v[232:235], a[120:123]
  ds_read_b128 a[196:199], v23 offset:8192
  v_add_f32 v36, v36, v181
  v_mfma_f32_16x16x32_bf16 a[152:155], a[248:251], v[240:243], a[152:155]
  v_exp_f32 v182, v182
  v_mfma_f32_16x16x32_bf16 a[184:187], a[248:251], v[248:251], a[184:187]
  s_waitcnt lgkmcnt(2)
  v_add_f32 v36, v36, v182
  v_cvt_pk_bf16_f32 v178, v180, v181
  v_mfma_f32_16x16x32_bf16 a[28:31], a[252:255], v[208:211], a[28:31]
  v_exp_f32 v183, v183
  v_mfma_f32_16x16x32_bf16 a[60:63], a[252:255], v[216:219], a[60:63]
  ds_read_b128 a[200:203], v24 offset:8192
  v_add_f32 v36, v36, v183
  v_mfma_f32_16x16x32_bf16 a[92:95], a[252:255], v[224:227], a[92:95]
  v_exp_f32 v184, v184
  v_mfma_f32_16x16x32_bf16 a[124:127], a[252:255], v[232:235], a[124:127]
  v_add_f32 v37, v37, v184
  v_cvt_pk_bf16_f32 v179, v182, v183
  v_mfma_f32_16x16x32_bf16 a[156:159], a[252:255], v[240:243], a[156:159]
  s_waitcnt vmcnt(21)
  s_barrier
  v_exp_f32 v185, v185
  v_mfma_f32_16x16x32_bf16 a[188:191], a[252:255], v[248:251], a[188:191]
  s_waitcnt lgkmcnt(2)
  ds_read_b128 a[204:207], v25 offset:8192
  v_add_f32 v37, v37, v185
  v_mfma_f32_16x16x32_bf16 v[208:211], a[192:195], v[64:67], v[40:43]
  v_exp_f32 v186, v186
  v_mfma_f32_16x16x32_bf16 v[216:219], a[192:195], v[68:71], v[44:47]
  v_add_f32 v37, v37, v186
  v_cvt_pk_bf16_f32 v184, v184, v185
  v_mfma_f32_16x16x32_bf16 v[224:227], a[192:195], v[72:75], v[48:51]
  v_exp_f32 v187, v187
  v_mfma_f32_16x16x32_bf16 v[232:235], a[192:195], v[76:79], v[52:55]
  ds_read_b128 a[208:211], v22 offset:12288
  v_add_f32 v37, v37, v187
  v_mfma_f32_16x16x32_bf16 v[240:243], a[192:195], v[80:83], v[56:59]
  v_exp_f32 v188, v188
  v_mfma_f32_16x16x32_bf16 v[248:251], a[192:195], v[84:87], v[60:63]
  s_waitcnt lgkmcnt(3)
  v_add_f32 v37, v37, v188
  v_cvt_pk_bf16_f32 v185, v186, v187
  v_mfma_f32_16x16x32_bf16 v[208:211], a[196:199], v[88:91], v[208:211]
  v_exp_f32 v189, v189
  v_mfma_f32_16x16x32_bf16 v[216:219], a[196:199], v[92:95], v[216:219]
  ds_read_b128 a[212:215], v23 offset:12288
  v_add_f32 v37, v37, v189
  v_mfma_f32_16x16x32_bf16 v[224:227], a[196:199], v[96:99], v[224:227]
  v_exp_f32 v190, v190
  v_mfma_f32_16x16x32_bf16 v[232:235], a[196:199], v[100:103], v[232:235]
  v_add_f32 v37, v37, v190
  v_cvt_pk_bf16_f32 v186, v188, v189
  v_mfma_f32_16x16x32_bf16 v[240:243], a[196:199], v[104:107], v[240:243]
  v_exp_f32 v191, v191
  v_mfma_f32_16x16x32_bf16 v[248:251], a[196:199], v[108:111], v[248:251]
  s_waitcnt lgkmcnt(3)
  ds_read_b128 a[216:219], v24 offset:12288
  v_add_f32 v37, v37, v191
  v_mfma_f32_16x16x32_bf16 v[208:211], a[200:203], v[112:115], v[208:211]
  v_exp_f32 v192, v192
  v_mfma_f32_16x16x32_bf16 v[216:219], a[200:203], v[116:119], v[216:219]
  v_add_f32 v38, v38, v192
  v_cvt_pk_bf16_f32 v187, v190, v191
  v_mfma_f32_16x16x32_bf16 v[224:227], a[200:203], v[120:123], v[224:227]
  v_exp_f32 v193, v193
  v_mfma_f32_16x16x32_bf16 v[232:235], a[200:203], v[124:127], v[232:235]
  ds_read_b128 a[220:223], v25 offset:12288
  v_add_f32 v38, v38, v193
  v_mfma_f32_16x16x32_bf16 v[240:243], a[200:203], v[128:131], v[240:243]
  v_exp_f32 v194, v194
  v_mfma_f32_16x16x32_bf16 v[248:251], a[200:203], v[132:135], v[248:251]
  s_waitcnt lgkmcnt(4)
  v_add_f32 v38, v38, v194
  v_cvt_pk_bf16_f32 v192, v192, v193
  v_mfma_f32_16x16x32_bf16 v[208:211], a[204:207], v[136:139], v[208:211]
  v_exp_f32 v195, v195
  v_mfma_f32_16x16x32_bf16 v[216:219], a[204:207], v[140:143], v[216:219]
  ds_read_b64_tr_b16 a[224:225], v26 offset:16384
  v_add_f32 v38, v38, v195
  v_mfma_f32_16x16x32_bf16 v[224:227], a[204:207], v[144:147], v[224:227]
  v_exp_f32 v196, v196
  v_mfma_f32_16x16x32_bf16 v[232:235], a[204:207], v[148:151], v[232:235]
  v_add_f32 v38, v38, v196
  v_cvt_pk_bf16_f32 v193, v194, v195
  v_mfma_f32_16x16x32_bf16 v[240:243], a[204:207], v[152:155], v[240:243]
  v_exp_f32 v197, v197
  v_mfma_f32_16x16x32_bf16 v[248:251], a[204:207], v[156:159], v[248:251]
  s_waitcnt lgkmcnt(4)
  ds_read_b64_tr_b16 a[226:227], v26 offset:20480
  v_add_f32 v38, v38, v197
  v_mfma_f32_16x16x32_bf16 v[212:215], a[208:211], v[64:67], v[40:43]
  v_exp_f32 v198, v198
  v_add_u32 v9, 1441792, v9
  v_mfma_f32_16x16x32_bf16 v[220:223], a[208:211], v[68:71], v[44:47]
  v_add_f32 v38, v38, v198
  v_cvt_pk_bf16_f32 v194, v196, v197
  v_mfma_f32_16x16x32_bf16 v[228:231], a[208:211], v[72:75], v[48:51]
  v_exp_f32 v199, v199
  v_mfma_f32_16x16x32_bf16 v[236:239], a[208:211], v[76:79], v[52:55]
  ds_read_b64_tr_b16 a[228:229], v27 offset:16384
  v_add_f32 v38, v38, v199
  v_mfma_f32_16x16x32_bf16 v[244:247], a[208:211], v[80:83], v[56:59]
  v_exp_f32 v200, v200
  v_mfma_f32_16x16x32_bf16 v[252:255], a[208:211], v[84:87], v[60:63]
  s_waitcnt lgkmcnt(5)
  v_add_f32 v39, v39, v200
  v_cvt_pk_bf16_f32 v195, v198, v199
  v_mfma_f32_16x16x32_bf16 v[212:215], a[212:215], v[88:91], v[212:215]
  buffer_load_dword v21, v9, s[8:11], 0 offen
  v_exp_f32 v201, v201
  v_mfma_f32_16x16x32_bf16 v[220:223], a[212:215], v[92:95], v[220:223]
  ds_read_b64_tr_b16 a[230:231], v27 offset:20480
  v_add_f32 v39, v39, v201
  v_mfma_f32_16x16x32_bf16 v[228:231], a[212:215], v[96:99], v[228:231]
  v_exp_f32 v202, v202
  v_mfma_f32_16x16x32_bf16 v[236:239], a[212:215], v[100:103], v[236:239]
  v_add_f32 v39, v39, v202
  v_cvt_pk_bf16_f32 v200, v200, v201
  v_mfma_f32_16x16x32_bf16 v[244:247], a[212:215], v[104:107], v[244:247]
  v_exp_f32 v203, v203
  v_mfma_f32_16x16x32_bf16 v[252:255], a[212:215], v[108:111], v[252:255]
  s_waitcnt lgkmcnt(5)
  ds_read_b64_tr_b16 a[232:233], v28 offset:16384
  v_add_f32 v39, v39, v203
  v_mfma_f32_16x16x32_bf16 v[212:215], a[216:219], v[112:115], v[212:215]
  v_exp_f32 v204, v204
  v_mfma_f32_16x16x32_bf16 v[220:223], a[216:219], v[116:119], v[220:223]
  v_add_f32 v39, v39, v204
  v_cvt_pk_bf16_f32 v201, v202, v203
  v_mfma_f32_16x16x32_bf16 v[228:231], a[216:219], v[120:123], v[228:231]
  v_exp_f32 v205, v205
  v_mfma_f32_16x16x32_bf16 v[236:239], a[216:219], v[124:127], v[236:239]
  ds_read_b64_tr_b16 a[234:235], v28 offset:20480
  v_add_f32 v39, v39, v205
  v_mfma_f32_16x16x32_bf16 v[244:247], a[216:219], v[128:131], v[244:247]
  v_exp_f32 v206, v206
  v_mfma_f32_16x16x32_bf16 v[252:255], a[216:219], v[132:135], v[252:255]
  s_waitcnt lgkmcnt(6)
  v_add_f32 v39, v39, v206
  v_cvt_pk_bf16_f32 v202, v204, v205
  v_mfma_f32_16x16x32_bf16 v[212:215], a[220:223], v[136:139], v[212:215]
  v_exp_f32 v207, v207
  v_mfma_f32_16x16x32_bf16 v[220:223], a[220:223], v[140:143], v[220:223]
  ds_read_b64_tr_b16 a[236:237], v29 offset:16384
  v_add_f32 v39, v39, v207
  v_mfma_f32_16x16x32_bf16 v[228:231], a[220:223], v[144:147], v[228:231]
  v_exp_f32 v208, v208
  v_mfma_f32_16x16x32_bf16 v[236:239], a[220:223], v[148:151], v[236:239]
  v_cvt_pk_bf16_f32 v203, v206, v207
  v_add_f32 v34, v34, v208
  v_mfma_f32_16x16x32_bf16 v[244:247], a[220:223], v[152:155], v[244:247]
  v_exp_f32 v209, v209
  v_mfma_f32_16x16x32_bf16 v[252:255], a[220:223], v[156:159], v[252:255]
  s_waitcnt lgkmcnt(5)
  ds_read_b64_tr_b16 a[238:239], v29 offset:20480
  v_add_f32 v34, v34, v209
  v_mfma_f32_16x16x32_bf16 a[0:3], a[224:227], v[160:163], a[0:3]
  v_exp_f32 v210, v210
  v_mfma_f32_16x16x32_bf16 a[32:35], a[224:227], v[168:171], a[32:35]
  v_add_f32 v34, v34, v210
  v_cvt_pk_bf16_f32 v208, v208, v209
  v_mfma_f32_16x16x32_bf16 a[64:67], a[224:227], v[176:179], a[64:67]
  v_exp_f32 v211, v211
  v_mfma_f32_16x16x32_bf16 a[96:99], a[224:227], v[184:187], a[96:99]
  ds_read_b64_tr_b16 a[240:241], v30 offset:16384
  v_add_f32 v34, v34, v211
  v_mfma_f32_16x16x32_bf16 a[128:131], a[224:227], v[192:195], a[128:131]
  v_exp_f32 v212, v212
  v_mfma_f32_16x16x32_bf16 a[160:163], a[224:227], v[200:203], a[160:163]
  s_waitcnt lgkmcnt(5)
  v_add_f32 v34, v34, v212
  v_cvt_pk_bf16_f32 v209, v210, v211
  v_mfma_f32_16x16x32_bf16 a[4:7], a[228:231], v[160:163], a[4:7]
  v_exp_f32 v213, v213
  v_mfma_f32_16x16x32_bf16 a[36:39], a[228:231], v[168:171], a[36:39]
  ds_read_b64_tr_b16 a[242:243], v30 offset:20480
  v_add_f32 v34, v34, v213
  v_mfma_f32_16x16x32_bf16 a[68:71], a[228:231], v[176:179], a[68:71]
  v_exp_f32 v214, v214
  v_mfma_f32_16x16x32_bf16 a[100:103], a[228:231], v[184:187], a[100:103]
  v_add_f32 v34, v34, v214
  v_cvt_pk_bf16_f32 v210, v212, v213
  v_mfma_f32_16x16x32_bf16 a[132:135], a[228:231], v[192:195], a[132:135]
  v_exp_f32 v215, v215
  v_mfma_f32_16x16x32_bf16 a[164:167], a[228:231], v[200:203], a[164:167]
  s_waitcnt lgkmcnt(4)
  ds_read_b64_tr_b16 a[244:245], v31 offset:16384
  v_add_f32 v34, v34, v215
  v_mfma_f32_16x16x32_bf16 a[8:11], a[232:235], v[160:163], a[8:11]
  s_waitcnt vmcnt(3)
  v_exp_f32 v216, v216
  v_and_b32 v20, 7, v20
  v_mfma_f32_16x16x32_bf16 a[40:43], a[232:235], v[168:171], a[40:43]
  v_add_f32 v35, v35, v216
  v_cvt_pk_bf16_f32 v211, v214, v215
  v_mfma_f32_16x16x32_bf16 a[72:75], a[232:235], v[176:179], a[72:75]
  s_lshl_b32 s3, s29, 7
  v_exp_f32 v217, v217
  v_add_u32 v20, s100, v20
  v_mfma_f32_16x16x32_bf16 a[104:107], a[232:235], v[184:187], a[104:107]
  ds_read_b64_tr_b16 a[246:247], v31 offset:20480
  v_add_f32 v35, v35, v217
  v_mfma_f32_16x16x32_bf16 a[136:139], a[232:235], v[192:195], a[136:139]
  v_exp_f32 v218, v218
  v_mfma_f32_16x16x32_bf16 a[168:171], a[232:235], v[200:203], a[168:171]
  s_waitcnt lgkmcnt(4)
  v_add_f32 v35, v35, v218
  v_cvt_pk_bf16_f32 v216, v216, v217
  v_mfma_f32_16x16x32_bf16 a[12:15], a[236:239], v[160:163], a[12:15]
  buffer_store_dword v20, v19, s[64:67], s3 offen offset:1024 sc1
  v_exp_f32 v219, v219
  v_mfma_f32_16x16x32_bf16 a[44:47], a[236:239], v[168:171], a[44:47]
  ds_read_b64_tr_b16 a[248:249], v32 offset:16384
  v_add_f32 v35, v35, v219
  v_mfma_f32_16x16x32_bf16 a[76:79], a[236:239], v[176:179], a[76:79]
  v_exp_f32 v220, v220
  v_mfma_f32_16x16x32_bf16 a[108:111], a[236:239], v[184:187], a[108:111]
  v_add_f32 v35, v35, v220
  v_cvt_pk_bf16_f32 v217, v218, v219
  v_mfma_f32_16x16x32_bf16 a[140:143], a[236:239], v[192:195], a[140:143]
  v_exp_f32 v221, v221
  v_mfma_f32_16x16x32_bf16 a[172:175], a[236:239], v[200:203], a[172:175]
  s_waitcnt lgkmcnt(3)
  ds_read_b64_tr_b16 a[250:251], v32 offset:20480
  v_add_f32 v35, v35, v221
  v_mfma_f32_16x16x32_bf16 a[16:19], a[240:243], v[160:163], a[16:19]
  v_exp_f32 v222, v222
  v_mfma_f32_16x16x32_bf16 a[48:51], a[240:243], v[168:171], a[48:51]
  v_add_f32 v35, v35, v222
  v_cvt_pk_bf16_f32 v218, v220, v221
  v_mfma_f32_16x16x32_bf16 a[80:83], a[240:243], v[176:179], a[80:83]
  v_exp_f32 v223, v223
  v_mfma_f32_16x16x32_bf16 a[112:115], a[240:243], v[184:187], a[112:115]
  ds_read_b64_tr_b16 a[252:253], v33 offset:16384
  v_add_f32 v35, v35, v223
  v_mfma_f32_16x16x32_bf16 a[144:147], a[240:243], v[192:195], a[144:147]
  v_exp_f32 v224, v224
  v_add_u32 v9, 1441792, v9
  v_mfma_f32_16x16x32_bf16 a[176:179], a[240:243], v[200:203], a[176:179]
  s_waitcnt lgkmcnt(3)
  v_add_f32 v36, v36, v224
  v_cvt_pk_bf16_f32 v219, v222, v223
  v_mfma_f32_16x16x32_bf16 a[20:23], a[244:247], v[160:163], a[20:23]
  v_exp_f32 v225, v225
  v_mfma_f32_16x16x32_bf16 a[52:55], a[244:247], v[168:171], a[52:55]
  ds_read_b64_tr_b16 a[254:255], v33 offset:20480
  v_add_f32 v36, v36, v225
  v_mfma_f32_16x16x32_bf16 a[84:87], a[244:247], v[176:179], a[84:87]
  v_exp_f32 v226, v226
  v_mfma_f32_16x16x32_bf16 a[116:119], a[244:247], v[184:187], a[116:119]
  v_add_f32 v36, v36, v226
  v_cvt_pk_bf16_f32 v224, v224, v225
  v_mfma_f32_16x16x32_bf16 a[148:151], a[244:247], v[192:195], a[148:151]
  buffer_load_dword v21, v9, s[8:11], 0 offen
  v_exp_f32 v227, v227
  v_mfma_f32_16x16x32_bf16 a[180:183], a[244:247], v[200:203], a[180:183]
  s_waitcnt lgkmcnt(2)
  ds_read_b128 a[192:195], v22 offset:16384
  v_add_f32 v36, v36, v227
  v_mfma_f32_16x16x32_bf16 a[24:27], a[248:251], v[160:163], a[24:27]
  v_exp_f32 v228, v228
  v_mfma_f32_16x16x32_bf16 a[56:59], a[248:251], v[168:171], a[56:59]
  v_add_f32 v36, v36, v228
  v_cvt_pk_bf16_f32 v225, v226, v227
  v_mfma_f32_16x16x32_bf16 a[88:91], a[248:251], v[176:179], a[88:91]
  v_exp_f32 v229, v229
  v_mfma_f32_16x16x32_bf16 a[120:123], a[248:251], v[184:187], a[120:123]
  ds_read_b128 a[196:199], v23 offset:16384
  v_add_f32 v36, v36, v229
  v_mfma_f32_16x16x32_bf16 a[152:155], a[248:251], v[192:195], a[152:155]
  v_exp_f32 v230, v230
  v_mfma_f32_16x16x32_bf16 a[184:187], a[248:251], v[200:203], a[184:187]
  s_waitcnt lgkmcnt(2)
  v_add_f32 v36, v36, v230
  v_cvt_pk_bf16_f32 v226, v228, v229
  v_mfma_f32_16x16x32_bf16 a[28:31], a[252:255], v[160:163], a[28:31]
  v_exp_f32 v231, v231
  v_mfma_f32_16x16x32_bf16 a[60:63], a[252:255], v[168:171], a[60:63]
  ds_read_b128 a[200:203], v24 offset:16384
  v_add_f32 v36, v36, v231
  v_mfma_f32_16x16x32_bf16 a[92:95], a[252:255], v[176:179], a[92:95]
  v_exp_f32 v232, v232
  v_mfma_f32_16x16x32_bf16 a[124:127], a[252:255], v[184:187], a[124:127]
  v_add_f32 v37, v37, v232
  v_cvt_pk_bf16_f32 v227, v230, v231
  v_mfma_f32_16x16x32_bf16 a[156:159], a[252:255], v[192:195], a[156:159]
  v_exp_f32 v233, v233
  v_mfma_f32_16x16x32_bf16 a[188:191], a[252:255], v[200:203], a[188:191]
  s_waitcnt lgkmcnt(2)
  ds_read_b128 a[204:207], v25 offset:16384
  v_add_f32 v37, v37, v233
  v_mfma_f32_16x16x32_bf16 v[160:163], a[192:195], v[64:67], v[40:43]
  v_exp_f32 v234, v234
  v_mfma_f32_16x16x32_bf16 v[168:171], a[192:195], v[68:71], v[44:47]
  v_add_f32 v37, v37, v234
  v_cvt_pk_bf16_f32 v232, v232, v233
  v_mfma_f32_16x16x32_bf16 v[176:179], a[192:195], v[72:75], v[48:51]
  v_exp_f32 v235, v235
  v_mfma_f32_16x16x32_bf16 v[184:187], a[192:195], v[76:79], v[52:55]
  ds_read_b128 a[208:211], v22 offset:20480
  v_add_f32 v37, v37, v235
  v_mfma_f32_16x16x32_bf16 v[192:195], a[192:195], v[80:83], v[56:59]
  v_exp_f32 v236, v236
  v_mfma_f32_16x16x32_bf16 v[200:203], a[192:195], v[84:87], v[60:63]
  s_waitcnt lgkmcnt(3)
  v_add_f32 v37, v37, v236
  v_cvt_pk_bf16_f32 v233, v234, v235
  v_mfma_f32_16x16x32_bf16 v[160:163], a[196:199], v[88:91], v[160:163]
  v_exp_f32 v237, v237
  v_mfma_f32_16x16x32_bf16 v[168:171], a[196:199], v[92:95], v[168:171]
  ds_read_b128 a[212:215], v23 offset:20480
  v_add_f32 v37, v37, v237
  v_mfma_f32_16x16x32_bf16 v[176:179], a[196:199], v[96:99], v[176:179]
  v_exp_f32 v238, v238
  v_mfma_f32_16x16x32_bf16 v[184:187], a[196:199], v[100:103], v[184:187]
  v_add_f32 v37, v37, v238
  v_cvt_pk_bf16_f32 v234, v236, v237
  v_mfma_f32_16x16x32_bf16 v[192:195], a[196:199], v[104:107], v[192:195]
  v_exp_f32 v239, v239
  v_mfma_f32_16x16x32_bf16 v[200:203], a[196:199], v[108:111], v[200:203]
  s_waitcnt lgkmcnt(3)
  ds_read_b128 a[216:219], v24 offset:20480
  v_add_f32 v37, v37, v239
  v_mfma_f32_16x16x32_bf16 v[160:163], a[200:203], v[112:115], v[160:163]
  v_exp_f32 v240, v240
  v_mfma_f32_16x16x32_bf16 v[168:171], a[200:203], v[116:119], v[168:171]
  v_add_f32 v38, v38, v240
  v_cvt_pk_bf16_f32 v235, v238, v239
  v_mfma_f32_16x16x32_bf16 v[176:179], a[200:203], v[120:123], v[176:179]
  v_exp_f32 v241, v241
  v_mfma_f32_16x16x32_bf16 v[184:187], a[200:203], v[124:127], v[184:187]
  ds_read_b128 a[220:223], v25 offset:20480
  v_add_f32 v38, v38, v241
  v_mfma_f32_16x16x32_bf16 v[192:195], a[200:203], v[128:131], v[192:195]
  v_exp_f32 v242, v242
  v_mfma_f32_16x16x32_bf16 v[200:203], a[200:203], v[132:135], v[200:203]
  s_waitcnt lgkmcnt(4)
  v_add_f32 v38, v38, v242
  v_cvt_pk_bf16_f32 v240, v240, v241
  v_mfma_f32_16x16x32_bf16 v[160:163], a[204:207], v[136:139], v[160:163]
  v_exp_f32 v243, v243
  v_mfma_f32_16x16x32_bf16 v[168:171], a[204:207], v[140:143], v[168:171]
  ds_read_b64_tr_b16 a[224:225], v26 offset:24576
  v_add_f32 v38, v38, v243
  v_mfma_f32_16x16x32_bf16 v[176:179], a[204:207], v[144:147], v[176:179]
  v_exp_f32 v244, v244
  v_mfma_f32_16x16x32_bf16 v[184:187], a[204:207], v[148:151], v[184:187]
  v_add_f32 v38, v38, v244
  v_cvt_pk_bf16_f32 v241, v242, v243
  v_mfma_f32_16x16x32_bf16 v[192:195], a[204:207], v[152:155], v[192:195]
  v_exp_f32 v245, v245
  v_mfma_f32_16x16x32_bf16 v[200:203], a[204:207], v[156:159], v[200:203]
  s_waitcnt lgkmcnt(4)
  ds_read_b64_tr_b16 a[226:227], v26 offset:28672
  v_add_f32 v38, v38, v245
  v_mfma_f32_16x16x32_bf16 v[164:167], a[208:211], v[64:67], v[40:43]
  v_exp_f32 v246, v246
  v_mfma_f32_16x16x32_bf16 v[172:175], a[208:211], v[68:71], v[44:47]
  v_add_f32 v38, v38, v246
  v_cvt_pk_bf16_f32 v242, v244, v245
  v_mfma_f32_16x16x32_bf16 v[180:183], a[208:211], v[72:75], v[48:51]
  v_exp_f32 v247, v247
  v_mfma_f32_16x16x32_bf16 v[188:191], a[208:211], v[76:79], v[52:55]
  ds_read_b64_tr_b16 a[228:229], v27 offset:24576
  v_add_f32 v38, v38, v247
  v_mfma_f32_16x16x32_bf16 v[196:199], a[208:211], v[80:83], v[56:59]
  v_exp_f32 v248, v248
  v_mfma_f32_16x16x32_bf16 v[204:207], a[208:211], v[84:87], v[60:63]
  s_waitcnt lgkmcnt(5)
  v_add_f32 v39, v39, v248
  v_cvt_pk_bf16_f32 v243, v246, v247
  v_mfma_f32_16x16x32_bf16 v[164:167], a[212:215], v[88:91], v[164:167]
  v_exp_f32 v249, v249
  v_add_u32 v9, 1441792, v9
  v_mfma_f32_16x16x32_bf16 v[172:175], a[212:215], v[92:95], v[172:175]
  ds_read_b64_tr_b16 a[230:231], v27 offset:28672
  v_add_f32 v39, v39, v249
  v_mfma_f32_16x16x32_bf16 v[180:183], a[212:215], v[96:99], v[180:183]
  v_exp_f32 v250, v250
  v_mfma_f32_16x16x32_bf16 v[188:191], a[212:215], v[100:103], v[188:191]
  v_add_f32 v39, v39, v250
  v_cvt_pk_bf16_f32 v248, v248, v249
  v_mfma_f32_16x16x32_bf16 v[196:199], a[212:215], v[104:107], v[196:199]
  v_exp_f32 v251, v251
  v_mfma_f32_16x16x32_bf16 v[204:207], a[212:215], v[108:111], v[204:207]
  s_waitcnt lgkmcnt(5)
  ds_read_b64_tr_b16 a[232:233], v28 offset:24576
  v_add_f32 v39, v39, v251
  v_mfma_f32_16x16x32_bf16 v[164:167], a[216:219], v[112:115], v[164:167]
  buffer_load_dword v21, v9, s[8:11], 0 offen
  v_exp_f32 v252, v252
  v_mfma_f32_16x16x32_bf16 v[172:175], a[216:219], v[116:119], v[172:175]
  v_add_f32 v39, v39, v252
  v_cvt_pk_bf16_f32 v249, v250, v251
  v_mfma_f32_16x16x32_bf16 v[180:183], a[216:219], v[120:123], v[180:183]
  v_exp_f32 v253, v253
  v_mfma_f32_16x16x32_bf16 v[188:191], a[216:219], v[124:127], v[188:191]
  ds_read_b64_tr_b16 a[234:235], v28 offset:28672
  v_add_f32 v39, v39, v253
  v_mfma_f32_16x16x32_bf16 v[196:199], a[216:219], v[128:131], v[196:199]
  v_exp_f32 v254, v254
  v_mfma_f32_16x16x32_bf16 v[204:207], a[216:219], v[132:135], v[204:207]
  s_waitcnt lgkmcnt(6)
  v_add_f32 v39, v39, v254
  v_cvt_pk_bf16_f32 v250, v252, v253
  v_mfma_f32_16x16x32_bf16 v[164:167], a[220:223], v[136:139], v[164:167]
  v_exp_f32 v255, v255
  v_mfma_f32_16x16x32_bf16 v[172:175], a[220:223], v[140:143], v[172:175]
  ds_read_b64_tr_b16 a[236:237], v29 offset:24576
  v_add_f32 v39, v39, v255
  v_mfma_f32_16x16x32_bf16 v[180:183], a[220:223], v[144:147], v[180:183]
  v_exp_f32 v160, v160
  v_mfma_f32_16x16x32_bf16 v[188:191], a[220:223], v[148:151], v[188:191]
  v_cvt_pk_bf16_f32 v251, v254, v255
  v_add_f32 v34, v34, v160
  v_mfma_f32_16x16x32_bf16 v[196:199], a[220:223], v[152:155], v[196:199]
  v_exp_f32 v161, v161
  v_mfma_f32_16x16x32_bf16 v[204:207], a[220:223], v[156:159], v[204:207]
  s_waitcnt lgkmcnt(5)
  ds_read_b64_tr_b16 a[238:239], v29 offset:28672
  v_add_f32 v34, v34, v161
  v_mfma_f32_16x16x32_bf16 a[0:3], a[224:227], v[208:211], a[0:3]
  v_exp_f32 v162, v162
  v_mfma_f32_16x16x32_bf16 a[32:35], a[224:227], v[216:219], a[32:35]
  v_add_f32 v34, v34, v162
  v_cvt_pk_bf16_f32 v160, v160, v161
  v_mfma_f32_16x16x32_bf16 a[64:67], a[224:227], v[224:227], a[64:67]
  v_exp_f32 v163, v163
  v_mfma_f32_16x16x32_bf16 a[96:99], a[224:227], v[232:235], a[96:99]
  ds_read_b64_tr_b16 a[240:241], v30 offset:24576
  v_add_f32 v34, v34, v163
  v_mfma_f32_16x16x32_bf16 a[128:131], a[224:227], v[240:243], a[128:131]
  v_exp_f32 v164, v164
  v_mfma_f32_16x16x32_bf16 a[160:163], a[224:227], v[248:251], a[160:163]
  s_waitcnt lgkmcnt(5)
  v_add_f32 v34, v34, v164
  v_cvt_pk_bf16_f32 v161, v162, v163
  v_mfma_f32_16x16x32_bf16 a[4:7], a[228:231], v[208:211], a[4:7]
  v_exp_f32 v165, v165
  v_mfma_f32_16x16x32_bf16 a[36:39], a[228:231], v[216:219], a[36:39]
  ds_read_b64_tr_b16 a[242:243], v30 offset:28672
  v_add_f32 v34, v34, v165
  v_mfma_f32_16x16x32_bf16 a[68:71], a[228:231], v[224:227], a[68:71]
  v_exp_f32 v166, v166
  v_mfma_f32_16x16x32_bf16 a[100:103], a[228:231], v[232:235], a[100:103]
  v_add_f32 v34, v34, v166
  v_cvt_pk_bf16_f32 v162, v164, v165
  v_mfma_f32_16x16x32_bf16 a[132:135], a[228:231], v[240:243], a[132:135]
  v_exp_f32 v167, v167
  v_mfma_f32_16x16x32_bf16 a[164:167], a[228:231], v[248:251], a[164:167]
  s_waitcnt lgkmcnt(4)
  ds_read_b64_tr_b16 a[244:245], v31 offset:24576
  v_add_f32 v34, v34, v167
  v_mfma_f32_16x16x32_bf16 a[8:11], a[232:235], v[208:211], a[8:11]
  v_exp_f32 v168, v168
  v_mfma_f32_16x16x32_bf16 a[40:43], a[232:235], v[216:219], a[40:43]
  v_add_f32 v35, v35, v168
  v_cvt_pk_bf16_f32 v163, v166, v167
  v_mfma_f32_16x16x32_bf16 a[72:75], a[232:235], v[224:227], a[72:75]
  v_exp_f32 v169, v169
  v_mfma_f32_16x16x32_bf16 a[104:107], a[232:235], v[232:235], a[104:107]
  ds_read_b64_tr_b16 a[246:247], v31 offset:28672
  v_add_f32 v35, v35, v169
  v_mfma_f32_16x16x32_bf16 a[136:139], a[232:235], v[240:243], a[136:139]
  v_exp_f32 v170, v170
  v_mfma_f32_16x16x32_bf16 a[168:171], a[232:235], v[248:251], a[168:171]
  s_waitcnt lgkmcnt(4)
  v_add_f32 v35, v35, v170
  v_cvt_pk_bf16_f32 v168, v168, v169
  v_mfma_f32_16x16x32_bf16 a[12:15], a[236:239], v[208:211], a[12:15]
  v_exp_f32 v171, v171
  v_mfma_f32_16x16x32_bf16 a[44:47], a[236:239], v[216:219], a[44:47]
  ds_read_b64_tr_b16 a[248:249], v32 offset:24576
  v_add_f32 v35, v35, v171
  v_mfma_f32_16x16x32_bf16 a[76:79], a[236:239], v[224:227], a[76:79]
  v_exp_f32 v172, v172
  v_mfma_f32_16x16x32_bf16 a[108:111], a[236:239], v[232:235], a[108:111]
  v_add_f32 v35, v35, v172
  v_cvt_pk_bf16_f32 v169, v170, v171
  v_mfma_f32_16x16x32_bf16 a[140:143], a[236:239], v[240:243], a[140:143]
  v_exp_f32 v173, v173
  v_mfma_f32_16x16x32_bf16 a[172:175], a[236:239], v[248:251], a[172:175]
  s_waitcnt lgkmcnt(3)
  ds_read_b64_tr_b16 a[250:251], v32 offset:28672
  v_add_f32 v35, v35, v173
  v_mfma_f32_16x16x32_bf16 a[16:19], a[240:243], v[208:211], a[16:19]
  v_exp_f32 v174, v174
  v_mfma_f32_16x16x32_bf16 a[48:51], a[240:243], v[216:219], a[48:51]
  v_add_f32 v35, v35, v174
  v_cvt_pk_bf16_f32 v170, v172, v173
  v_mfma_f32_16x16x32_bf16 a[80:83], a[240:243], v[224:227], a[80:83]
  v_exp_f32 v175, v175
  v_mfma_f32_16x16x32_bf16 a[112:115], a[240:243], v[232:235], a[112:115]
  ds_read_b64_tr_b16 a[252:253], v33 offset:24576
  v_add_f32 v35, v35, v175
  v_mfma_f32_16x16x32_bf16 a[144:147], a[240:243], v[240:243], a[144:147]
  v_exp_f32 v176, v176
  v_mfma_f32_16x16x32_bf16 a[176:179], a[240:243], v[248:251], a[176:179]
  s_waitcnt lgkmcnt(3)
  v_add_f32 v36, v36, v176
  v_cvt_pk_bf16_f32 v171, v174, v175
  v_mfma_f32_16x16x32_bf16 a[20:23], a[244:247], v[208:211], a[20:23]
  v_exp_f32 v177, v177
  v_mfma_f32_16x16x32_bf16 a[52:55], a[244:247], v[216:219], a[52:55]
  ds_read_b64_tr_b16 a[254:255], v33 offset:28672
  v_add_f32 v36, v36, v177
  v_mfma_f32_16x16x32_bf16 a[84:87], a[244:247], v[224:227], a[84:87]
  v_exp_f32 v178, v178
  v_mfma_f32_16x16x32_bf16 a[116:119], a[244:247], v[232:235], a[116:119]
  v_add_f32 v36, v36, v178
  v_cvt_pk_bf16_f32 v176, v176, v177
  v_mfma_f32_16x16x32_bf16 a[148:151], a[244:247], v[240:243], a[148:151]
  v_exp_f32 v179, v179
  v_add_u32 v9, 1441792, v9
  v_mfma_f32_16x16x32_bf16 a[180:183], a[244:247], v[248:251], a[180:183]
  s_waitcnt lgkmcnt(2)
  ds_read_b128 a[192:195], v22 offset:24576
  v_add_f32 v36, v36, v179
  v_mfma_f32_16x16x32_bf16 a[24:27], a[248:251], v[208:211], a[24:27]
  v_exp_f32 v180, v180
  v_mfma_f32_16x16x32_bf16 a[56:59], a[248:251], v[216:219], a[56:59]
  v_add_f32 v36, v36, v180
  v_cvt_pk_bf16_f32 v177, v178, v179
  v_mfma_f32_16x16x32_bf16 a[88:91], a[248:251], v[224:227], a[88:91]
  v_exp_f32 v181, v181
  v_mfma_f32_16x16x32_bf16 a[120:123], a[248:251], v[232:235], a[120:123]
  ds_read_b128 a[196:199], v23 offset:24576
  v_add_f32 v36, v36, v181
  v_mfma_f32_16x16x32_bf16 a[152:155], a[248:251], v[240:243], a[152:155]
  buffer_load_dword v21, v9, s[8:11], 0 offen
  v_exp_f32 v182, v182
  v_mfma_f32_16x16x32_bf16 a[184:187], a[248:251], v[248:251], a[184:187]
  s_waitcnt lgkmcnt(2)
  v_add_f32 v36, v36, v182
  v_cvt_pk_bf16_f32 v178, v180, v181
  v_mfma_f32_16x16x32_bf16 a[28:31], a[252:255], v[208:211], a[28:31]
  v_exp_f32 v183, v183
  v_mfma_f32_16x16x32_bf16 a[60:63], a[252:255], v[216:219], a[60:63]
  ds_read_b128 a[200:203], v24 offset:24576
  v_add_f32 v36, v36, v183
  v_mfma_f32_16x16x32_bf16 a[92:95], a[252:255], v[224:227], a[92:95]
  v_exp_f32 v184, v184
  v_mfma_f32_16x16x32_bf16 a[124:127], a[252:255], v[232:235], a[124:127]
  v_add_f32 v37, v37, v184
  v_cvt_pk_bf16_f32 v179, v182, v183
  v_mfma_f32_16x16x32_bf16 a[156:159], a[252:255], v[240:243], a[156:159]
  s_barrier
  v_exp_f32 v185, v185
  v_mfma_f32_16x16x32_bf16 a[188:191], a[252:255], v[248:251], a[188:191]
  s_waitcnt lgkmcnt(2)
  ds_read_b128 a[204:207], v25 offset:24576
  v_add_f32 v37, v37, v185
  v_mfma_f32_16x16x32_bf16 v[208:211], a[192:195], v[64:67], v[40:43]
  v_exp_f32 v186, v186
  v_mfma_f32_16x16x32_bf16 v[216:219], a[192:195], v[68:71], v[44:47]
  v_add_f32 v37, v37, v186
  v_cvt_pk_bf16_f32 v184, v184, v185
  v_mfma_f32_16x16x32_bf16 v[224:227], a[192:195], v[72:75], v[48:51]
  v_exp_f32 v187, v187
  v_mfma_f32_16x16x32_bf16 v[232:235], a[192:195], v[76:79], v[52:55]
  ds_read_b128 a[208:211], v22 offset:28672
  v_add_f32 v37, v37, v187
  v_mfma_f32_16x16x32_bf16 v[240:243], a[192:195], v[80:83], v[56:59]
  v_exp_f32 v188, v188
  v_mfma_f32_16x16x32_bf16 v[248:251], a[192:195], v[84:87], v[60:63]
  s_waitcnt lgkmcnt(3)
  v_add_f32 v37, v37, v188
  v_cvt_pk_bf16_f32 v185, v186, v187
  v_mfma_f32_16x16x32_bf16 v[208:211], a[196:199], v[88:91], v[208:211]
  v_exp_f32 v189, v189
  v_mfma_f32_16x16x32_bf16 v[216:219], a[196:199], v[92:95], v[216:219]
  ds_read_b128 a[212:215], v23 offset:28672
  v_add_f32 v37, v37, v189
  v_mfma_f32_16x16x32_bf16 v[224:227], a[196:199], v[96:99], v[224:227]
  v_exp_f32 v190, v190
  v_mfma_f32_16x16x32_bf16 v[232:235], a[196:199], v[100:103], v[232:235]
  v_add_f32 v37, v37, v190
  v_cvt_pk_bf16_f32 v186, v188, v189
  v_mfma_f32_16x16x32_bf16 v[240:243], a[196:199], v[104:107], v[240:243]
  v_exp_f32 v191, v191
  v_mfma_f32_16x16x32_bf16 v[248:251], a[196:199], v[108:111], v[248:251]
  s_waitcnt lgkmcnt(3)
  ds_read_b128 a[216:219], v24 offset:28672
  v_add_f32 v37, v37, v191
  v_mfma_f32_16x16x32_bf16 v[208:211], a[200:203], v[112:115], v[208:211]
  v_exp_f32 v192, v192
  v_mfma_f32_16x16x32_bf16 v[216:219], a[200:203], v[116:119], v[216:219]
  v_add_f32 v38, v38, v192
  v_cvt_pk_bf16_f32 v187, v190, v191
  v_mfma_f32_16x16x32_bf16 v[224:227], a[200:203], v[120:123], v[224:227]
  v_exp_f32 v193, v193
  v_mfma_f32_16x16x32_bf16 v[232:235], a[200:203], v[124:127], v[232:235]
  ds_read_b128 a[220:223], v25 offset:28672
  v_add_f32 v38, v38, v193
  v_mfma_f32_16x16x32_bf16 v[240:243], a[200:203], v[128:131], v[240:243]
  s_getpc_b64 s[92:93]
L_j13:
  v_exp_f32 v194, v194
  v_mfma_f32_16x16x32_bf16 v[248:251], a[200:203], v[132:135], v[248:251]
  s_waitcnt lgkmcnt(4)
  v_add_f32 v38, v38, v194
  v_cvt_pk_bf16_f32 v192, v192, v193
  v_mfma_f32_16x16x32_bf16 v[208:211], a[204:207], v[136:139], v[208:211]
  s_add_u32 s92, s92, 3072
  s_addc_u32 s93, s93, 0
  v_exp_f32 v195, v195
  v_mfma_f32_16x16x32_bf16 v[216:219], a[204:207], v[140:143], v[216:219]
  ds_read_b64_tr_b16 a[224:225], v26 offset:32768
  v_add_f32 v38, v38, v195
  v_mfma_f32_16x16x32_bf16 v[224:227], a[204:207], v[144:147], v[224:227]
  v_exp_f32 v196, v196
  v_mfma_f32_16x16x32_bf16 v[232:235], a[204:207], v[148:151], v[232:235]
  v_add_f32 v38, v38, v196
  v_cvt_pk_bf16_f32 v193, v194, v195
  v_mfma_f32_16x16x32_bf16 v[240:243], a[204:207], v[152:155], v[240:243]
  buffer_load_dword v21, v15, s[92:95], 0 offen
  v_exp_f32 v197, v197
  v_mfma_f32_16x16x32_bf16 v[248:251], a[204:207], v[156:159], v[248:251]
  s_waitcnt lgkmcnt(4)
  ds_read_b64_tr_b16 a[226:227], v26 offset:36864
  v_add_f32 v38, v38, v197
  v_mfma_f32_16x16x32_bf16 v[212:215], a[208:211], v[64:67], v[40:43]
  v_exp_f32 v198, v198
  v_mfma_f32_16x16x32_bf16 v[220:223], a[208:211], v[68:71], v[44:47]
  v_add_f32 v38, v38, v198
  v_cvt_pk_bf16_f32 v194, v196, v197
  v_mfma_f32_16x16x32_bf16 v[228:231], a[208:211], v[72:75], v[48:51]
  v_exp_f32 v199, v199
  v_mfma_f32_16x16x32_bf16 v[236:239], a[208:211], v[76:79], v[52:55]
  ds_read_b64_tr_b16 a[228:229], v27 offset:32768
  v_add_f32 v38, v38, v199
  v_mfma_f32_16x16x32_bf16 v[244:247], a[208:211], v[80:83], v[56:59]
  v_exp_f32 v200, v200
  v_mfma_f32_16x16x32_bf16 v[252:255], a[208:211], v[84:87], v[60:63]
  s_waitcnt lgkmcnt(5)
  v_add_f32 v39, v39, v200
  v_cvt_pk_bf16_f32 v195, v198, v199
  v_mfma_f32_16x16x32_bf16 v[212:215], a[212:215], v[88:91], v[212:215]
  v_exp_f32 v201, v201
  v_mfma_f32_16x16x32_bf16 v[220:223], a[212:215], v[92:95], v[220:223]
  ds_read_b64_tr_b16 a[230:231], v27 offset:36864
  v_add_f32 v39, v39, v201
  v_mfma_f32_16x16x32_bf16 v[228:231], a[212:215], v[96:99], v[228:231]
  v_exp_f32 v202, v202
  v_mfma_f32_16x16x32_bf16 v[236:239], a[212:215], v[100:103], v[236:239]
  v_add_f32 v39, v39, v202
  v_cvt_pk_bf16_f32 v200, v200, v201
  v_mfma_f32_16x16x32_bf16 v[244:247], a[212:215], v[104:107], v[244:247]
  v_exp_f32 v203, v203
  v_mfma_f32_16x16x32_bf16 v[252:255], a[212:215], v[108:111], v[252:255]
  s_waitcnt lgkmcnt(5)
  ds_read_b64_tr_b16 a[232:233], v28 offset:32768
  v_add_f32 v39, v39, v203
  v_mfma_f32_16x16x32_bf16 v[212:215], a[216:219], v[112:115], v[212:215]
  v_exp_f32 v204, v204
  v_mfma_f32_16x16x32_bf16 v[220:223], a[216:219], v[116:119], v[220:223]
  v_add_f32 v39, v39, v204
  v_cvt_pk_bf16_f32 v201, v202, v203
  v_mfma_f32_16x16x32_bf16 v[228:231], a[216:219], v[120:123], v[228:231]
  v_exp_f32 v205, v205
  v_add_u32 v9, 1441792, v9
  v_mfma_f32_16x16x32_bf16 v[236:239], a[216:219], v[124:127], v[236:239]
  ds_read_b64_tr_b16 a[234:235], v28 offset:36864
  v_add_f32 v39, v39, v205
  v_mfma_f32_16x16x32_bf16 v[244:247], a[216:219], v[128:131], v[244:247]
  v_exp_f32 v206, v206
  v_mfma_f32_16x16x32_bf16 v[252:255], a[216:219], v[132:135], v[252:255]
  s_waitcnt lgkmcnt(6)
  v_add_f32 v39, v39, v206
  v_cvt_pk_bf16_f32 v202, v204, v205
  v_mfma_f32_16x16x32_bf16 v[212:215], a[220:223], v[136:139], v[212:215]
  v_exp_f32 v207, v207
  v_mfma_f32_16x16x32_bf16 v[220:223], a[220:223], v[140:143], v[220:223]
  ds_read_b64_tr_b16 a[236:237], v29 offset:32768
  v_add_f32 v39, v39, v207
  v_mfma_f32_16x16x32_bf16 v[228:231], a[220:223], v[144:147], v[228:231]
  buffer_load_dword v21, v9, s[8:11], 0 offen
  v_exp_f32 v208, v208
  v_mfma_f32_16x16x32_bf16 v[236:239], a[220:223], v[148:151], v[236:239]
  v_cvt_pk_bf16_f32 v203, v206, v207
  v_add_f32 v34, v34, v208
  v_mfma_f32_16x16x32_bf16 v[244:247], a[220:223], v[152:155], v[244:247]
  v_exp_f32 v209, v209
  v_mfma_f32_16x16x32_bf16 v[252:255], a[220:223], v[156:159], v[252:255]
  s_waitcnt lgkmcnt(5)
  ds_read_b64_tr_b16 a[238:239], v29 offset:36864
  v_add_f32 v34, v34, v209
  v_mfma_f32_16x16x32_bf16 a[0:3], a[224:227], v[160:163], a[0:3]
  v_exp_f32 v210, v210
  v_mfma_f32_16x16x32_bf16 a[32:35], a[224:227], v[168:171], a[32:35]
  v_add_f32 v34, v34, v210
  v_cvt_pk_bf16_f32 v208, v208, v209
  v_mfma_f32_16x16x32_bf16 a[64:67], a[224:227], v[176:179], a[64:67]
  v_exp_f32 v211, v211
  v_mfma_f32_16x16x32_bf16 a[96:99], a[224:227], v[184:187], a[96:99]
  ds_read_b64_tr_b16 a[240:241], v30 offset:32768
  v_add_f32 v34, v34, v211
  v_mfma_f32_16x16x32_bf16 a[128:131], a[224:227], v[192:195], a[128:131]
  v_exp_f32 v212, v212
  v_mfma_f32_16x16x32_bf16 a[160:163], a[224:227], v[200:203], a[160:163]
  s_waitcnt lgkmcnt(5)
  v_add_f32 v34, v34, v212
  v_cvt_pk_bf16_f32 v209, v210, v211
  v_mfma_f32_16x16x32_bf16 a[4:7], a[228:231], v[160:163], a[4:7]
  v_exp_f32 v213, v213
  v_mfma_f32_16x16x32_bf16 a[36:39], a[228:231], v[168:171], a[36:39]
  ds_read_b64_tr_b16 a[242:243], v30 offset:36864
  v_add_f32 v34, v34, v213
  v_mfma_f32_16x16x32_bf16 a[68:71], a[228:231], v[176:179], a[68:71]
  v_exp_f32 v214, v214
  v_mfma_f32_16x16x32_bf16 a[100:103], a[228:231], v[184:187], a[100:103]
  v_add_f32 v34, v34, v214
  v_cvt_pk_bf16_f32 v210, v212, v213
  v_mfma_f32_16x16x32_bf16 a[132:135], a[228:231], v[192:195], a[132:135]
  v_exp_f32 v215, v215
  v_mfma_f32_16x16x32_bf16 a[164:167], a[228:231], v[200:203], a[164:167]
  s_waitcnt lgkmcnt(4)
  ds_read_b64_tr_b16 a[244:245], v31 offset:32768
  v_add_f32 v34, v34, v215
  v_mfma_f32_16x16x32_bf16 a[8:11], a[232:235], v[160:163], a[8:11]
  v_exp_f32 v216, v216
  v_mfma_f32_16x16x32_bf16 a[40:43], a[232:235], v[168:171], a[40:43]
  v_add_f32 v35, v35, v216
  v_cvt_pk_bf16_f32 v211, v214, v215
  v_mfma_f32_16x16x32_bf16 a[72:75], a[232:235], v[176:179], a[72:75]
  v_exp_f32 v217, v217
  v_mfma_f32_16x16x32_bf16 a[104:107], a[232:235], v[184:187], a[104:107]
  ds_read_b64_tr_b16 a[246:247], v31 offset:36864
  v_add_f32 v35, v35, v217
  v_mfma_f32_16x16x32_bf16 a[136:139], a[232:235], v[192:195], a[136:139]
  v_exp_f32 v218, v218
  v_mfma_f32_16x16x32_bf16 a[168:171], a[232:235], v[200:203], a[168:171]
  s_waitcnt lgkmcnt(4)
  v_add_f32 v35, v35, v218
  v_cvt_pk_bf16_f32 v216, v216, v217
  v_mfma_f32_16x16x32_bf16 a[12:15], a[236:239], v[160:163], a[12:15]
  v_exp_f32 v219, v219
  v_mfma_f32_16x16x32_bf16 a[44:47], a[236:239], v[168:171], a[44:47]
  ds_read_b64_tr_b16 a[248:249], v32 offset:32768
  v_add_f32 v35, v35, v219
  v_mfma_f32_16x16x32_bf16 a[76:79], a[236:239], v[176:179], a[76:79]
  v_exp_f32 v220, v220
  v_mfma_f32_16x16x32_bf16 a[108:111], a[236:239], v[184:187], a[108:111]
  v_add_f32 v35, v35, v220
  v_cvt_pk_bf16_f32 v217, v218, v219
  v_mfma_f32_16x16x32_bf16 a[140:143], a[236:239], v[192:195], a[140:143]
  v_exp_f32 v221, v221
  v_mfma_f32_16x16x32_bf16 a[172:175], a[236:239], v[200:203], a[172:175]
  s_waitcnt lgkmcnt(3)
  ds_read_b64_tr_b16 a[250:251], v32 offset:36864
  v_add_f32 v35, v35, v221
  v_mfma_f32_16x16x32_bf16 a[16:19], a[240:243], v[160:163], a[16:19]
  v_exp_f32 v222, v222
  v_mfma_f32_16x16x32_bf16 a[48:51], a[240:243], v[168:171], a[48:51]
  v_add_f32 v35, v35, v222
  v_cvt_pk_bf16_f32 v218, v220, v221
  v_mfma_f32_16x16x32_bf16 a[80:83], a[240:243], v[176:179], a[80:83]
  v_exp_f32 v223, v223
  v_mfma_f32_16x16x32_bf16 a[112:115], a[240:243], v[184:187], a[112:115]
  ds_read_b64_tr_b16 a[252:253], v33 offset:32768
  v_add_f32 v35, v35, v223
  v_mfma_f32_16x16x32_bf16 a[144:147], a[240:243], v[192:195], a[144:147]
  v_exp_f32 v224, v224
  v_mfma_f32_16x16x32_bf16 a[176:179], a[240:243], v[200:203], a[176:179]
  s_waitcnt lgkmcnt(3)
  v_add_f32 v36, v36, v224
  v_cvt_pk_bf16_f32 v219, v222, v223
  v_mfma_f32_16x16x32_bf16 a[20:23], a[244:247], v[160:163], a[20:23]
  v_exp_f32 v225, v225
  v_mfma_f32_16x16x32_bf16 a[52:55], a[244:247], v[168:171], a[52:55]
  ds_read_b64_tr_b16 a[254:255], v33 offset:36864
  v_add_f32 v36, v36, v225
  v_mfma_f32_16x16x32_bf16 a[84:87], a[244:247], v[176:179], a[84:87]
  v_exp_f32 v226, v226
  v_mfma_f32_16x16x32_bf16 a[116:119], a[244:247], v[184:187], a[116:119]
  v_add_f32 v36, v36, v226
  v_cvt_pk_bf16_f32 v224, v224, v225
  v_mfma_f32_16x16x32_bf16 a[148:151], a[244:247], v[192:195], a[148:151]
  v_exp_f32 v227, v227
  v_mfma_f32_16x16x32_bf16 a[180:183], a[244:247], v[200:203], a[180:183]
  s_waitcnt lgkmcnt(2)
  ds_read_b128 a[192:195], v22 offset:32768
  v_add_f32 v36, v36, v227
  v_mfma_f32_16x16x32_bf16 a[24:27], a[248:251], v[160:163], a[24:27]
  v_exp_f32 v228, v228
  v_mfma_f32_16x16x32_bf16 a[56:59], a[248:251], v[168:171], a[56:59]
  v_add_f32 v36, v36, v228
  v_cvt_pk_bf16_f32 v225, v226, v227
  v_mfma_f32_16x16x32_bf16 a[88:91], a[248:251], v[176:179], a[88:91]
  v_exp_f32 v229, v229
  v_mfma_f32_16x16x32_bf16 a[120:123], a[248:251], v[184:187], a[120:123]
  ds_read_b128 a[196:199], v23 offset:32768
  v_add_f32 v36, v36, v229
  v_mfma_f32_16x16x32_bf16 a[152:155], a[248:251], v[192:195], a[152:155]
  v_exp_f32 v230, v230
  v_mfma_f32_16x16x32_bf16 a[184:187], a[248:251], v[200:203], a[184:187]
  s_waitcnt lgkmcnt(2)
  v_add_f32 v36, v36, v230
  v_cvt_pk_bf16_f32 v226, v228, v229
  v_mfma_f32_16x16x32_bf16 a[28:31], a[252:255], v[160:163], a[28:31]
  v_exp_f32 v231, v231
  v_add_u32 v9, 1441792, v9
  v_mfma_f32_16x16x32_bf16 a[60:63], a[252:255], v[168:171], a[60:63]
  ds_read_b128 a[200:203], v24 offset:32768
  v_add_f32 v36, v36, v231
  v_mfma_f32_16x16x32_bf16 a[92:95], a[252:255], v[176:179], a[92:95]
  v_exp_f32 v232, v232
  v_mfma_f32_16x16x32_bf16 a[124:127], a[252:255], v[184:187], a[124:127]
  v_add_f32 v37, v37, v232
  v_cvt_pk_bf16_f32 v227, v230, v231
  v_mfma_f32_16x16x32_bf16 a[156:159], a[252:255], v[192:195], a[156:159]
  v_exp_f32 v233, v233
  v_mfma_f32_16x16x32_bf16 a[188:191], a[252:255], v[200:203], a[188:191]
  s_waitcnt lgkmcnt(2)
  ds_read_b128 a[204:207], v25 offset:32768
  v_add_f32 v37, v37, v233
  v_mfma_f32_16x16x32_bf16 v[160:163], a[192:195], v[64:67], v[40:43]
  buffer_load_dword v21, v9, s[8:11], 0 offen
  v_exp_f32 v234, v234
  v_mfma_f32_16x16x32_bf16 v[168:171], a[192:195], v[68:71], v[44:47]
  v_add_f32 v37, v37, v234
  v_cvt_pk_bf16_f32 v232, v232, v233
  v_mfma_f32_16x16x32_bf16 v[176:179], a[192:195], v[72:75], v[48:51]
  v_exp_f32 v235, v235
  v_mfma_f32_16x16x32_bf16 v[184:187], a[192:195], v[76:79], v[52:55]
  ds_read_b128 a[208:211], v22 offset:36864
  v_add_f32 v37, v37, v235
  v_mfma_f32_16x16x32_bf16 v[192:195], a[192:195], v[80:83], v[56:59]
  v_exp_f32 v236, v236
  v_mfma_f32_16x16x32_bf16 v[200:203], a[192:195], v[84:87], v[60:63]
  s_waitcnt lgkmcnt(3)
  v_add_f32 v37, v37, v236
  v_cvt_pk_bf16_f32 v233, v234, v235
  v_mfma_f32_16x16x32_bf16 v[160:163], a[196:199], v[88:91], v[160:163]
  v_exp_f32 v237, v237
  v_mfma_f32_16x16x32_bf16 v[168:171], a[196:199], v[92:95], v[168:171]
  ds_read_b128 a[212:215], v23 offset:36864
  v_add_f32 v37, v37, v237
  v_mfma_f32_16x16x32_bf16 v[176:179], a[196:199], v[96:99], v[176:179]
  v_exp_f32 v238, v238
  v_mfma_f32_16x16x32_bf16 v[184:187], a[196:199], v[100:103], v[184:187]
  v_add_f32 v37, v37, v238
  v_cvt_pk_bf16_f32 v234, v236, v237
  v_mfma_f32_16x16x32_bf16 v[192:195], a[196:199], v[104:107], v[192:195]
  v_exp_f32 v239, v239
  v_mfma_f32_16x16x32_bf16 v[200:203], a[196:199], v[108:111], v[200:203]
  s_waitcnt lgkmcnt(3)
  ds_read_b128 a[216:219], v24 offset:36864
  v_add_f32 v37, v37, v239
  v_mfma_f32_16x16x32_bf16 v[160:163], a[200:203], v[112:115], v[160:163]
  v_exp_f32 v240, v240
  v_mfma_f32_16x16x32_bf16 v[168:171], a[200:203], v[116:119], v[168:171]
  v_add_f32 v38, v38, v240
  v_cvt_pk_bf16_f32 v235, v238, v239
  v_mfma_f32_16x16x32_bf16 v[176:179], a[200:203], v[120:123], v[176:179]
  v_exp_f32 v241, v241
  v_mfma_f32_16x16x32_bf16 v[184:187], a[200:203], v[124:127], v[184:187]
  ds_read_b128 a[220:223], v25 offset:36864
  v_add_f32 v38, v38, v241
  v_mfma_f32_16x16x32_bf16 v[192:195], a[200:203], v[128:131], v[192:195]
  s_getpc_b64 s[92:93]
L_jp2a:
  v_exp_f32 v242, v242
  v_mfma_f32_16x16x32_bf16 v[200:203], a[200:203], v[132:135], v[200:203]
  s_waitcnt lgkmcnt(4)
  v_add_f32 v38, v38, v242
  v_cvt_pk_bf16_f32 v240, v240, v241
  v_mfma_f32_16x16x32_bf16 v[160:163], a[204:207], v[136:139], v[160:163]
  s_add_u32 s92, s92, L_phase2-L_jp2a+0
  s_addc_u32 s93, s93, 0
  v_exp_f32 v243, v243
  v_mfma_f32_16x16x32_bf16 v[168:171], a[204:207], v[140:143], v[168:171]
  ds_read_b64_tr_b16 a[224:225], v26 offset:40960
  v_add_f32 v38, v38, v243
  v_mfma_f32_16x16x32_bf16 v[176:179], a[204:207], v[144:147], v[176:179]
  v_exp_f32 v244, v244
  v_mfma_f32_16x16x32_bf16 v[184:187], a[204:207], v[148:151], v[184:187]
  v_add_f32 v38, v38, v244
  v_cvt_pk_bf16_f32 v241, v242, v243
  v_mfma_f32_16x16x32_bf16 v[192:195], a[204:207], v[152:155], v[192:195]
  buffer_load_dword v21, v15, s[92:95], 0 offen
  v_exp_f32 v245, v245
  v_mfma_f32_16x16x32_bf16 v[200:203], a[204:207], v[156:159], v[200:203]
  s_waitcnt lgkmcnt(4)
  ds_read_b64_tr_b16 a[226:227], v26 offset:45056
  v_add_f32 v38, v38, v245
  v_mfma_f32_16x16x32_bf16 v[164:167], a[208:211], v[64:67], v[40:43]
  v_exp_f32 v246, v246
  v_mfma_f32_16x16x32_bf16 v[172:175], a[208:211], v[68:71], v[44:47]
  v_add_f32 v38, v38, v246
  v_cvt_pk_bf16_f32 v242, v244, v245
  v_mfma_f32_16x16x32_bf16 v[180:183], a[208:211], v[72:75], v[48:51]
  v_exp_f32 v247, v247
  v_mfma_f32_16x16x32_bf16 v[188:191], a[208:211], v[76:79], v[52:55]
  ds_read_b64_tr_b16 a[228:229], v27 offset:40960
  v_add_f32 v38, v38, v247
  v_mfma_f32_16x16x32_bf16 v[196:199], a[208:211], v[80:83], v[56:59]
  v_exp_f32 v248, v248
  v_mfma_f32_16x16x32_bf16 v[204:207], a[208:211], v[84:87], v[60:63]
  s_waitcnt lgkmcnt(5)
  v_add_f32 v39, v39, v248
  v_cvt_pk_bf16_f32 v243, v246, v247
  v_mfma_f32_16x16x32_bf16 v[164:167], a[212:215], v[88:91], v[164:167]
  v_exp_f32 v249, v249
  v_mfma_f32_16x16x32_bf16 v[172:175], a[212:215], v[92:95], v[172:175]
  ds_read_b64_tr_b16 a[230:231], v27 offset:45056
  v_add_f32 v39, v39, v249
  v_mfma_f32_16x16x32_bf16 v[180:183], a[212:215], v[96:99], v[180:183]
  v_exp_f32 v250, v250
  v_mfma_f32_16x16x32_bf16 v[188:191], a[212:215], v[100:103], v[188:191]
  v_add_f32 v39, v39, v250
  v_cvt_pk_bf16_f32 v248, v248, v249
  v_mfma_f32_16x16x32_bf16 v[196:199], a[212:215], v[104:107], v[196:199]
  v_exp_f32 v251, v251
  v_mfma_f32_16x16x32_bf16 v[204:207], a[212:215], v[108:111], v[204:207]
  s_waitcnt lgkmcnt(5)
  ds_read_b64_tr_b16 a[232:233], v28 offset:40960
  v_add_f32 v39, v39, v251
  v_mfma_f32_16x16x32_bf16 v[164:167], a[216:219], v[112:115], v[164:167]
  v_exp_f32 v252, v252
  v_mfma_f32_16x16x32_bf16 v[172:175], a[216:219], v[116:119], v[172:175]
  v_add_f32 v39, v39, v252
  v_cvt_pk_bf16_f32 v249, v250, v251
  v_mfma_f32_16x16x32_bf16 v[180:183], a[216:219], v[120:123], v[180:183]
  v_exp_f32 v253, v253
  v_mfma_f32_16x16x32_bf16 v[188:191], a[216:219], v[124:127], v[188:191]
  ds_read_b64_tr_b16 a[234:235], v28 offset:45056
  v_add_f32 v39, v39, v253
  v_mfma_f32_16x16x32_bf16 v[196:199], a[216:219], v[128:131], v[196:199]
  v_exp_f32 v254, v254
  v_mfma_f32_16x16x32_bf16 v[204:207], a[216:219], v[132:135], v[204:207]
  s_waitcnt lgkmcnt(6)
  v_add_f32 v39, v39, v254
  v_cvt_pk_bf16_f32 v250, v252, v253
  v_mfma_f32_16x16x32_bf16 v[164:167], a[220:223], v[136:139], v[164:167]
  v_exp_f32 v255, v255
  v_mfma_f32_16x16x32_bf16 v[172:175], a[220:223], v[140:143], v[172:175]
  ds_read_b64_tr_b16 a[236:237], v29 offset:40960
  v_add_f32 v39, v39, v255
  v_mfma_f32_16x16x32_bf16 v[180:183], a[220:223], v[144:147], v[180:183]
  v_exp_f32 v160, v160
  v_mfma_f32_16x16x32_bf16 v[188:191], a[220:223], v[148:151], v[188:191]
  v_cvt_pk_bf16_f32 v251, v254, v255
  v_add_f32 v34, v34, v160
  v_mfma_f32_16x16x32_bf16 v[196:199], a[220:223], v[152:155], v[196:199]
  v_exp_f32 v161, v161
  v_mfma_f32_16x16x32_bf16 v[204:207], a[220:223], v[156:159], v[204:207]
  s_waitcnt lgkmcnt(5)
  ds_read_b64_tr_b16 a[238:239], v29 offset:45056
  v_add_f32 v34, v34, v161
  v_mfma_f32_16x16x32_bf16 a[0:3], a[224:227], v[208:211], a[0:3]
  v_exp_f32 v162, v162
  v_mfma_f32_16x16x32_bf16 a[32:35], a[224:227], v[216:219], a[32:35]
  v_add_f32 v34, v34, v162
  v_cvt_pk_bf16_f32 v160, v160, v161
  v_mfma_f32_16x16x32_bf16 a[64:67], a[224:227], v[224:227], a[64:67]
  v_exp_f32 v163, v163
  v_mfma_f32_16x16x32_bf16 a[96:99], a[224:227], v[232:235], a[96:99]
  ds_read_b64_tr_b16 a[240:241], v30 offset:40960
  v_add_f32 v34, v34, v163
  v_mfma_f32_16x16x32_bf16 a[128:131], a[224:227], v[240:243], a[128:131]
  v_exp_f32 v164, v164
  v_mfma_f32_16x16x32_bf16 a[160:163], a[224:227], v[248:251], a[160:163]
  s_waitcnt lgkmcnt(5)
  v_add_f32 v34, v34, v164
  v_cvt_pk_bf16_f32 v161, v162, v163
  v_mfma_f32_16x16x32_bf16 a[4:7], a[228:231], v[208:211], a[4:7]
  v_exp_f32 v165, v165
  v_mfma_f32_16x16x32_bf16 a[36:39], a[228:231], v[216:219], a[36:39]
  ds_read_b64_tr_b16 a[242:243], v30 offset:45056
  v_add_f32 v34, v34, v165
  v_mfma_f32_16x16x32_bf16 a[68:71], a[228:231], v[224:227], a[68:71]
  v_exp_f32 v166, v166
  v_mfma_f32_16x16x32_bf16 a[100:103], a[228:231], v[232:235], a[100:103]
  v_add_f32 v34, v34, v166
  v_cvt_pk_bf16_f32 v162, v164, v165
  v_mfma_f32_16x16x32_bf16 a[132:135], a[228:231], v[240:243], a[132:135]
  v_exp_f32 v167, v167
  v_mfma_f32_16x16x32_bf16 a[164:167], a[228:231], v[248:251], a[164:167]
  s_waitcnt lgkmcnt(4)
  ds_read_b64_tr_b16 a[244:245], v31 offset:40960
  v_add_f32 v34, v34, v167
  v_mfma_f32_16x16x32_bf16 a[8:11], a[232:235], v[208:211], a[8:11]
  v_exp_f32 v168, v168
  v_mfma_f32_16x16x32_bf16 a[40:43], a[232:235], v[216:219], a[40:43]
  v_add_f32 v35, v35, v168
  v_cvt_pk_bf16_f32 v163, v166, v167
  v_mfma_f32_16x16x32_bf16 a[72:75], a[232:235], v[224:227], a[72:75]
  v_exp_f32 v169, v169
  v_mfma_f32_16x16x32_bf16 a[104:107], a[232:235], v[232:235], a[104:107]
  ds_read_b64_tr_b16 a[246:247], v31 offset:45056
  v_add_f32 v35, v35, v169
  v_mfma_f32_16x16x32_bf16 a[136:139], a[232:235], v[240:243], a[136:139]
  s_getpc_b64 s[92:93]
L_jp2b:
  v_exp_f32 v170, v170
  v_mfma_f32_16x16x32_bf16 a[168:171], a[232:235], v[248:251], a[168:171]
  s_waitcnt lgkmcnt(4)
  v_add_f32 v35, v35, v170
  v_cvt_pk_bf16_f32 v168, v168, v169
  v_mfma_f32_16x16x32_bf16 a[12:15], a[236:239], v[208:211], a[12:15]
  s_add_u32 s92, s92, L_phase2-L_jp2b+11264
  s_addc_u32 s93, s93, 0
  v_exp_f32 v171, v171
  v_mfma_f32_16x16x32_bf16 a[44:47], a[236:239], v[216:219], a[44:47]
  ds_read_b64_tr_b16 a[248:249], v32 offset:40960
  v_add_f32 v35, v35, v171
  v_mfma_f32_16x16x32_bf16 a[76:79], a[236:239], v[224:227], a[76:79]
  v_exp_f32 v172, v172
  v_mfma_f32_16x16x32_bf16 a[108:111], a[236:239], v[232:235], a[108:111]
  v_add_f32 v35, v35, v172
  v_cvt_pk_bf16_f32 v169, v170, v171
  v_mfma_f32_16x16x32_bf16 a[140:143], a[236:239], v[240:243], a[140:143]
  buffer_load_dword v21, v15, s[92:95], 0 offen
  v_exp_f32 v173, v173
  v_mfma_f32_16x16x32_bf16 a[172:175], a[236:239], v[248:251], a[172:175]
  s_waitcnt lgkmcnt(3)
  ds_read_b64_tr_b16 a[250:251], v32 offset:45056
  v_add_f32 v35, v35, v173
  v_mfma_f32_16x16x32_bf16 a[16:19], a[240:243], v[208:211], a[16:19]
  v_exp_f32 v174, v174
  v_mfma_f32_16x16x32_bf16 a[48:51], a[240:243], v[216:219], a[48:51]
  v_add_f32 v35, v35, v174
  v_cvt_pk_bf16_f32 v170, v172, v173
  v_mfma_f32_16x16x32_bf16 a[80:83], a[240:243], v[224:227], a[80:83]
  v_exp_f32 v175, v175
  v_mfma_f32_16x16x32_bf16 a[112:115], a[240:243], v[232:235], a[112:115]
  ds_read_b64_tr_b16 a[252:253], v33 offset:40960
  v_add_f32 v35, v35, v175
  v_mfma_f32_16x16x32_bf16 a[144:147], a[240:243], v[240:243], a[144:147]
  v_exp_f32 v176, v176
  v_mfma_f32_16x16x32_bf16 a[176:179], a[240:243], v[248:251], a[176:179]
  s_waitcnt lgkmcnt(3)
  v_add_f32 v36, v36, v176
  v_cvt_pk_bf16_f32 v171, v174, v175
  v_mfma_f32_16x16x32_bf16 a[20:23], a[244:247], v[208:211], a[20:23]
  v_exp_f32 v177, v177
  v_mfma_f32_16x16x32_bf16 a[52:55], a[244:247], v[216:219], a[52:55]
  ds_read_b64_tr_b16 a[254:255], v33 offset:45056
  v_add_f32 v36, v36, v177
  v_mfma_f32_16x16x32_bf16 a[84:87], a[244:247], v[224:227], a[84:87]
  v_exp_f32 v178, v178
  v_mfma_f32_16x16x32_bf16 a[116:119], a[244:247], v[232:235], a[116:119]
  v_add_f32 v36, v36, v178
  v_cvt_pk_bf16_f32 v176, v176, v177
  v_mfma_f32_16x16x32_bf16 a[148:151], a[244:247], v[240:243], a[148:151]
  v_exp_f32 v179, v179
  v_mfma_f32_16x16x32_bf16 a[180:183], a[244:247], v[248:251], a[180:183]
  s_waitcnt lgkmcnt(2)
  ds_read_b128 a[192:195], v22 offset:40960
  v_add_f32 v36, v36, v179
  v_mfma_f32_16x16x32_bf16 a[24:27], a[248:251], v[208:211], a[24:27]
  v_exp_f32 v180, v180
  v_mfma_f32_16x16x32_bf16 a[56:59], a[248:251], v[216:219], a[56:59]
  v_add_f32 v36, v36, v180
  v_cvt_pk_bf16_f32 v177, v178, v179
  v_mfma_f32_16x16x32_bf16 a[88:91], a[248:251], v[224:227], a[88:91]
  v_exp_f32 v181, v181
  v_mfma_f32_16x16x32_bf16 a[120:123], a[248:251], v[232:235], a[120:123]
  ds_read_b128 a[196:199], v23 offset:40960
  v_add_f32 v36, v36, v181
  v_mfma_f32_16x16x32_bf16 a[152:155], a[248:251], v[240:243], a[152:155]
  v_exp_f32 v182, v182
  v_mfma_f32_16x16x32_bf16 a[184:187], a[248:251], v[248:251], a[184:187]
  s_waitcnt lgkmcnt(2)
  v_add_f32 v36, v36, v182
  v_cvt_pk_bf16_f32 v178, v180, v181
  v_mfma_f32_16x16x32_bf16 a[28:31], a[252:255], v[208:211], a[28:31]
  v_exp_f32 v183, v183
  v_mfma_f32_16x16x32_bf16 a[60:63], a[252:255], v[216:219], a[60:63]
  ds_read_b128 a[200:203], v24 offset:40960
  v_add_f32 v36, v36, v183
  v_mfma_f32_16x16x32_bf16 a[92:95], a[252:255], v[224:227], a[92:95]
  v_exp_f32 v184, v184
  v_mfma_f32_16x16x32_bf16 a[124:127], a[252:255], v[232:235], a[124:127]
  v_add_f32 v37, v37, v184
  v_cvt_pk_bf16_f32 v179, v182, v183
  v_mfma_f32_16x16x32_bf16 a[156:159], a[252:255], v[240:243], a[156:159]
  s_barrier
  v_exp_f32 v185, v185
  v_mfma_f32_16x16x32_bf16 a[188:191], a[252:255], v[248:251], a[188:191]
  s_waitcnt lgkmcnt(2)
  ds_read_b128 a[204:207], v25 offset:40960
  v_add_f32 v37, v37, v185
  v_mfma_f32_16x16x32_bf16 v[208:211], a[192:195], v[64:67], v[40:43]
  v_exp_f32 v186, v186
  v_mfma_f32_16x16x32_bf16 v[216:219], a[192:195], v[68:71], v[44:47]
  v_add_f32 v37, v37, v186
  v_cvt_pk_bf16_f32 v184, v184, v185
  v_mfma_f32_16x16x32_bf16 v[224:227], a[192:195], v[72:75], v[48:51]
  v_exp_f32 v187, v187
  v_mfma_f32_16x16x32_bf16 v[232:235], a[192:195], v[76:79], v[52:55]
  ds_read_b128 a[208:211], v22 offset:45056
  v_add_f32 v37, v37, v187
  v_mfma_f32_16x16x32_bf16 v[240:243], a[192:195], v[80:83], v[56:59]
  v_exp_f32 v188, v188
  v_mfma_f32_16x16x32_bf16 v[248:251], a[192:195], v[84:87], v[60:63]
  s_waitcnt lgkmcnt(3)
  v_add_f32 v37, v37, v188
  v_cvt_pk_bf16_f32 v185, v186, v187
  v_mfma_f32_16x16x32_bf16 v[208:211], a[196:199], v[88:91], v[208:211]
  v_exp_f32 v189, v189
  v_mfma_f32_16x16x32_bf16 v[216:219], a[196:199], v[92:95], v[216:219]
  ds_read_b128 a[212:215], v23 offset:45056
  v_add_f32 v37, v37, v189
  v_mfma_f32_16x16x32_bf16 v[224:227], a[196:199], v[96:99], v[224:227]
  v_exp_f32 v190, v190
  v_mfma_f32_16x16x32_bf16 v[232:235], a[196:199], v[100:103], v[232:235]
  v_add_f32 v37, v37, v190
  v_cvt_pk_bf16_f32 v186, v188, v189
  v_mfma_f32_16x16x32_bf16 v[240:243], a[196:199], v[104:107], v[240:243]
  v_exp_f32 v191, v191
  v_mfma_f32_16x16x32_bf16 v[248:251], a[196:199], v[108:111], v[248:251]
  s_waitcnt lgkmcnt(3)
  ds_read_b128 a[216:219], v24 offset:45056
  v_add_f32 v37, v37, v191
  v_mfma_f32_16x16x32_bf16 v[208:211], a[200:203], v[112:115], v[208:211]
  v_exp_f32 v192, v192
  v_mfma_f32_16x16x32_bf16 v[216:219], a[200:203], v[116:119], v[216:219]
  v_add_f32 v38, v38, v192
  v_cvt_pk_bf16_f32 v187, v190, v191
  v_mfma_f32_16x16x32_bf16 v[224:227], a[200:203], v[120:123], v[224:227]
  v_exp_f32 v193, v193
  v_mfma_f32_16x16x32_bf16 v[232:235], a[200:203], v[124:127], v[232:235]
  ds_read_b128 a[220:223], v25 offset:45056
  v_add_f32 v38, v38, v193
  v_mfma_f32_16x16x32_bf16 v[240:243], a[200:203], v[128:131], v[240:243]
  v_exp_f32 v194, v194
  v_mfma_f32_16x16x32_bf16 v[248:251], a[200:203], v[132:135], v[248:251]
  s_waitcnt lgkmcnt(4)
  v_add_f32 v38, v38, v194
  v_cvt_pk_bf16_f32 v192, v192, v193
  v_mfma_f32_16x16x32_bf16 v[208:211], a[204:207], v[136:139], v[208:211]
  v_exp_f32 v195, v195
  v_mfma_f32_16x16x32_bf16 v[216:219], a[204:207], v[140:143], v[216:219]
  ds_read_b64_tr_b16 a[224:225], v26 offset:49152
  v_add_f32 v38, v38, v195
  v_mfma_f32_16x16x32_bf16 v[224:227], a[204:207], v[144:147], v[224:227]
  v_exp_f32 v196, v196
  v_mfma_f32_16x16x32_bf16 v[232:235], a[204:207], v[148:151], v[232:235]
  v_add_f32 v38, v38, v196
  v_cvt_pk_bf16_f32 v193, v194, v195
  v_mfma_f32_16x16x32_bf16 v[240:243], a[204:207], v[152:155], v[240:243]
  v_exp_f32 v197, v197
  v_mfma_f32_16x16x32_bf16 v[248:251], a[204:207], v[156:159], v[248:251]
  s_waitcnt lgkmcnt(4)
  ds_read_b64_tr_b16 a[226:227], v26 offset:53248
  v_add_f32 v38, v38, v197
  v_mfma_f32_16x16x32_bf16 v[212:215], a[208:211], v[64:67], v[40:43]
  v_exp_f32 v198, v198
  v_mfma_f32_16x16x32_bf16 v[220:223], a[208:211], v[68:71], v[44:47]
  v_add_f32 v38, v38, v198
  v_cvt_pk_bf16_f32 v194, v196, v197
  v_mfma_f32_16x16x32_bf16 v[228:231], a[208:211], v[72:75], v[48:51]
  v_exp_f32 v199, v199
  v_mfma_f32_16x16x32_bf16 v[236:239], a[208:211], v[76:79], v[52:55]
  ds_read_b64_tr_b16 a[228:229], v27 offset:49152
  v_add_f32 v38, v38, v199
  v_mfma_f32_16x16x32_bf16 v[244:247], a[208:211], v[80:83], v[56:59]
  v_exp_f32 v200, v200
  v_mfma_f32_16x16x32_bf16 v[252:255], a[208:211], v[84:87], v[60:63]
  s_waitcnt lgkmcnt(5)
  v_add_f32 v39, v39, v200
  v_cvt_pk_bf16_f32 v195, v198, v199
  v_mfma_f32_16x16x32_bf16 v[212:215], a[212:215], v[88:91], v[212:215]
  v_exp_f32 v201, v201
  v_mfma_f32_16x16x32_bf16 v[220:223], a[212:215], v[92:95], v[220:223]
  ds_read_b64_tr_b16 a[230:231], v27 offset:53248
  v_add_f32 v39, v39, v201
  v_mfma_f32_16x16x32_bf16 v[228:231], a[212:215], v[96:99], v[228:231]
  v_exp_f32 v202, v202
  v_mfma_f32_16x16x32_bf16 v[236:239], a[212:215], v[100:103], v[236:239]
  v_add_f32 v39, v39, v202
  v_cvt_pk_bf16_f32 v200, v200, v201
  v_mfma_f32_16x16x32_bf16 v[244:247], a[212:215], v[104:107], v[244:247]
  v_exp_f32 v203, v203
  v_mfma_f32_16x16x32_bf16 v[252:255], a[212:215], v[108:111], v[252:255]
  s_waitcnt lgkmcnt(5)
  ds_read_b64_tr_b16 a[232:233], v28 offset:49152
  v_add_f32 v39, v39, v203
  v_mfma_f32_16x16x32_bf16 v[212:215], a[216:219], v[112:115], v[212:215]
  v_exp_f32 v204, v204
  v_mfma_f32_16x16x32_bf16 v[220:223], a[216:219], v[116:119], v[220:223]
  v_add_f32 v39, v39, v204
  v_cvt_pk_bf16_f32 v201, v202, v203
  v_mfma_f32_16x16x32_bf16 v[228:231], a[216:219], v[120:123], v[228:231]
  v_exp_f32 v205, v205
  v_mfma_f32_16x16x32_bf16 v[236:239], a[216:219], v[124:127], v[236:239]
  ds_read_b64_tr_b16 a[234:235], v28 offset:53248
  v_add_f32 v39, v39, v205
  v_mfma_f32_16x16x32_bf16 v[244:247], a[216:219], v[128:131], v[244:247]
  v_exp_f32 v206, v206
  v_mfma_f32_16x16x32_bf16 v[252:255], a[216:219], v[132:135], v[252:255]
  s_waitcnt lgkmcnt(6)
  v_add_f32 v39, v39, v206
  v_cvt_pk_bf16_f32 v202, v204, v205
  v_mfma_f32_16x16x32_bf16 v[212:215], a[220:223], v[136:139], v[212:215]
  v_exp_f32 v207, v207
  v_mfma_f32_16x16x32_bf16 v[220:223], a[220:223], v[140:143], v[220:223]
  ds_read_b64_tr_b16 a[236:237], v29 offset:49152
  v_add_f32 v39, v39, v207
  v_mfma_f32_16x16x32_bf16 v[228:231], a[220:223], v[144:147], v[228:231]
  v_exp_f32 v208, v208
  v_mfma_f32_16x16x32_bf16 v[236:239], a[220:223], v[148:151], v[236:239]
  v_cvt_pk_bf16_f32 v203, v206, v207
  v_add_f32 v34, v34, v208
  v_mfma_f32_16x16x32_bf16 v[244:247], a[220:223], v[152:155], v[244:247]
  v_exp_f32 v209, v209
  v_mfma_f32_16x16x32_bf16 v[252:255], a[220:223], v[156:159], v[252:255]
  s_waitcnt lgkmcnt(5)
  ds_read_b64_tr_b16 a[238:239], v29 offset:53248
  v_add_f32 v34, v34, v209
  v_mfma_f32_16x16x32_bf16 a[0:3], a[224:227], v[160:163], a[0:3]
  ds_read_b64_tr_b16 a[240:241], v30 offset:49152
  v_exp_f32 v210, v210
  v_mfma_f32_16x16x32_bf16 a[32:35], a[224:227], v[168:171], a[32:35]
  ds_read_b64_tr_b16 a[242:243], v30 offset:53248
  v_cvt_pk_bf16_f32 v208, v208, v209
  v_mfma_f32_16x16x32_bf16 a[64:67], a[224:227], v[176:179], a[64:67]
  ds_read_b64_tr_b16 a[244:245], v31 offset:49152
  v_exp_f32 v211, v211
  v_mfma_f32_16x16x32_bf16 a[96:99], a[224:227], v[184:187], a[96:99]
  ds_read_b64_tr_b16 a[246:247], v31 offset:53248
  v_add_f32 v34, v34, v210
  v_mfma_f32_16x16x32_bf16 a[128:131], a[224:227], v[192:195], a[128:131]
  ds_read_b64_tr_b16 a[248:249], v32 offset:49152
  v_exp_f32 v212, v212
  v_mfma_f32_16x16x32_bf16 a[160:163], a[224:227], v[200:203], a[160:163]
  s_waitcnt lgkmcnt(9)
  ds_read_b64_tr_b16 a[250:251], v32 offset:53248
  v_add_f32 v34, v34, v211
  v_mfma_f32_16x16x32_bf16 a[4:7], a[228:231], v[160:163], a[4:7]
  ds_read_b64_tr_b16 a[252:253], v33 offset:49152
  v_cvt_pk_bf16_f32 v209, v210, v211
  v_mfma_f32_16x16x32_bf16 a[36:39], a[228:231], v[168:171], a[36:39]
  ds_read_b64_tr_b16 a[254:255], v33 offset:53248
  v_exp_f32 v213, v213
  v_mfma_f32_16x16x32_bf16 a[68:71], a[228:231], v[176:179], a[68:71]
  ds_read_b64_tr_b16 a[192:193], v26 offset:57344
  v_add_f32 v34, v34, v212
  v_mfma_f32_16x16x32_bf16 a[100:103], a[228:231], v[184:187], a[100:103]
  ds_read_b64_tr_b16 a[194:195], v26 offset:61440
  v_exp_f32 v214, v214
  v_mfma_f32_16x16x32_bf16 a[132:135], a[228:231], v[192:195], a[132:135]
  ds_read_b64_tr_b16 a[196:197], v27 offset:57344
  v_add_f32 v34, v34, v213
  v_mfma_f32_16x16x32_bf16 a[164:167], a[228:231], v[200:203], a[164:167]
  s_waitcnt lgkmcnt(13)
  ds_read_b64_tr_b16 a[198:199], v27 offset:61440
  v_cvt_pk_bf16_f32 v210, v212, v213
  v_mfma_f32_16x16x32_bf16 a[8:11], a[232:235], v[160:163], a[8:11]
  ds_read_b64_tr_b16 a[200:201], v28 offset:57344
  v_exp_f32 v215, v215
  v_mfma_f32_16x16x32_bf16 a[40:43], a[232:235], v[168:171], a[40:43]
  ds_read_b64_tr_b16 a[202:203], v28 offset:61440
  v_add_f32 v34, v34, v214
  v_mfma_f32_16x16x32_bf16 a[72:75], a[232:235], v[176:179], a[72:75]
  ds_read_b64_tr_b16 a[204:205], v29 offset:57344
  v_add_f32 v34, v34, v215
  v_mfma_f32_16x16x32_bf16 a[104:107], a[232:235], v[184:187], a[104:107]
  ds_read_b64_tr_b16 a[206:207], v29 offset:61440
  v_cvt_pk_bf16_f32 v211, v214, v215
  v_mfma_f32_16x16x32_bf16 a[136:139], a[232:235], v[192:195], a[136:139]
  ds_read_b64_tr_b16 a[208:209], v30 offset:57344
  v_mfma_f32_16x16x32_bf16 a[168:171], a[232:235], v[200:203], a[168:171]
  s_waitcnt lgkmcnt(15)
  ds_read_b64_tr_b16 a[210:211], v30 offset:61440
  v_mfma_f32_16x16x32_bf16 a[12:15], a[236:239], v[160:163], a[12:15]
  ds_read_b64_tr_b16 a[212:213], v31 offset:57344
  v_mfma_f32_16x16x32_bf16 a[44:47], a[236:239], v[168:171], a[44:47]
  ds_read_b64_tr_b16 a[214:215], v31 offset:61440
  v_mfma_f32_16x16x32_bf16 a[76:79], a[236:239], v[176:179], a[76:79]
  ds_read_b64_tr_b16 a[216:217], v32 offset:57344
  v_mfma_f32_16x16x32_bf16 a[108:111], a[236:239], v[184:187], a[108:111]
  ds_read_b64_tr_b16 a[218:219], v32 offset:61440
  v_mfma_f32_16x16x32_bf16 a[140:143], a[236:239], v[192:195], a[140:143]
  ds_read_b64_tr_b16 a[220:221], v33 offset:57344
  v_mfma_f32_16x16x32_bf16 a[172:175], a[236:239], v[200:203], a[172:175]
  ds_read_b64_tr_b16 a[222:223], v33 offset:61440
  s_waitcnt lgkmcnt(0)
  v_mfma_f32_16x16x32_bf16 a[16:19], a[240:243], v[160:163], a[16:19]
  v_cmp_nge_f32 vcc, 0x67800000, v34
  v_mfma_f32_16x16x32_bf16 a[20:23], a[244:247], v[160:163], a[20:23]
  v_exp_f32 v216, v216
  v_mfma_f32_16x16x32_bf16 a[24:27], a[248:251], v[160:163], a[24:27]
  v_exp_f32 v217, v217
  v_mfma_f32_16x16x32_bf16 a[28:31], a[252:255], v[160:163], a[28:31]
  v_mov_b32 v41, v34
  v_add_f32 v35, v35, v216
  v_mfma_f32_16x16x32_bf16 a[0:3], a[192:195], v[208:211], a[0:3]
  v_exp_f32 v218, v218
  v_mfma_f32_16x16x32_bf16 a[4:7], a[196:199], v[208:211], a[4:7]
  v_mov_b32 v40, v34
  v_add_f32 v35, v35, v217
  v_mfma_f32_16x16x32_bf16 a[8:11], a[200:203], v[208:211], a[8:11]
  v_cvt_pk_bf16_f32 v216, v216, v217
  v_permlane32_swap_b32 v40, v41
  v_mfma_f32_16x16x32_bf16 a[12:15], a[204:207], v[208:211], a[12:15]
  v_exp_f32 v219, v219
  v_mfma_f32_16x16x32_bf16 a[16:19], a[208:211], v[208:211], a[16:19]
  v_add_f32 v35, v35, v218
  v_add_f32 v40, v40, v41
  v_mfma_f32_16x16x32_bf16 a[20:23], a[212:215], v[208:211], a[20:23]
  v_exp_f32 v220, v220
  v_mfma_f32_16x16x32_bf16 a[24:27], a[216:219], v[208:211], a[24:27]
  v_add_f32 v35, v35, v219
  v_mov_b32 v41, v40
  v_mfma_f32_16x16x32_bf16 a[28:31], a[220:223], v[208:211], a[28:31]
  v_cvt_pk_bf16_f32 v217, v218, v219
  v_exp_f32 v221, v221
  v_permlane16_swap_b32 v40, v41
  v_add_f32 v35, v35, v220
  v_exp_f32 v222, v222
  v_add_f32 v40, v40, v41
  v_add_f32 v35, v35, v221
  v_cvt_pk_bf16_f32 v218, v220, v221
  v_rcp_f32 v40, v40
  v_exp_f32 v223, v223
  v_add_f32 v35, v35, v222
  v_add_f32 v35, v35, v223
  v_cvt_pk_bf16_f32 v219, v222, v223
  s_cbranch_vccnz L_slow
  v_accvgpr_read_b32 v160, a0
  v_accvgpr_read_b32 v161, a1
  v_accvgpr_read_b32 v162, a2
  v_accvgpr_read_b32 v163, a3
  v_accvgpr_read_b32 v164, a4
  v_accvgpr_read_b32 v165, a5
  v_accvgpr_read_b32 v166, a6
  v_accvgpr_read_b32 v167, a7
  v_pk_mul_f32 v[160:161], v[160:161], v[40:41] op_sel_hi:[1,0]
  v_pk_mul_f32 v[162:163], v[162:163], v[40:41] op_sel_hi:[1,0]
  v_pk_mul_f32 v[164:165], v[164:165], v[40:41] op_sel_hi:[1,0]
  v_pk_mul_f32 v[166:167], v[166:167], v[40:41] op_sel_hi:[1,0]
  v_cvt_pk_bf16_f32 v160, v160, v161
  v_cvt_pk_bf16_f32 v161, v162, v163
  v_cvt_pk_bf16_f32 v162, v164, v165
  v_cvt_pk_bf16_f32 v163, v166, v167
  s_add_u32 s3, s74, 0
  buffer_store_dwordx4 v[160:163], v6, s[24:27], s3 offen sc1
  v_accvgpr_read_b32 v208, a8
  v_accvgpr_read_b32 v209, a9
  v_accvgpr_read_b32 v210, a10
  v_accvgpr_read_b32 v211, a11
  v_accvgpr_read_b32 v212, a12
  v_accvgpr_read_b32 v213, a13
  v_accvgpr_read_b32 v214, a14
  v_accvgpr_read_b32 v215, a15
  v_pk_mul_f32 v[208:209], v[208:209], v[40:41] op_sel_hi:[1,0]
  v_pk_mul_f32 v[210:211], v[210:211], v[40:41] op_sel_hi:[1,0]
  v_pk_mul_f32 v[212:213], v[212:213], v[40:41] op_sel_hi:[1,0]
  v_pk_mul_f32 v[214:215], v[214:215], v[40:41] op_sel_hi:[1,0]
  v_cvt_pk_bf16_f32 v208, v208, v209
  v_cvt_pk_bf16_f32 v209, v210, v211
  v_cvt_pk_bf16_f32 v210, v212, v213
  v_cvt_pk_bf16_f32 v211, v214, v215
  s_add_u32 s3, s74, 131072
  buffer_store_dwordx4 v[208:211], v6, s[24:27], s3 offen sc1
  v_accvgpr_read_b32 v160, a16
  v_accvgpr_read_b32 v161, a17
  v_accvgpr_read_b32 v162, a18
  v_accvgpr_read_b32 v163, a19
  v_accvgpr_read_b32 v164, a20
  v_accvgpr_read_b32 v165, a21
  v_accvgpr_read_b32 v166, a22
  v_accvgpr_read_b32 v167, a23
  v_pk_mul_f32 v[160:161], v[160:161], v[40:41] op_sel_hi:[1,0]
  v_pk_mul_f32 v[162:163], v[162:163], v[40:41] op_sel_hi:[1,0]
  v_pk_mul_f32 v[164:165], v[164:165], v[40:41] op_sel_hi:[1,0]
  v_pk_mul_f32 v[166:167], v[166:167], v[40:41] op_sel_hi:[1,0]
  v_cvt_pk_bf16_f32 v160, v160, v161
  v_cvt_pk_bf16_f32 v161, v162, v163
  v_cvt_pk_bf16_f32 v162, v164, v165
  v_cvt_pk_bf16_f32 v163, v166, v167
  s_add_u32 s3, s74, 262144
  buffer_store_dwordx4 v[160:163], v6, s[24:27], s3 offen sc1
  v_accvgpr_read_b32 v208, a24
  v_accvgpr_read_b32 v209, a25
  v_accvgpr_read_b32 v210, a26
  v_accvgpr_read_b32 v211, a27
  v_accvgpr_read_b32 v212, a28
  v_accvgpr_read_b32 v213, a29
  v_accvgpr_read_b32 v214, a30
  v_accvgpr_read_b32 v215, a31
  v_pk_mul_f32 v[208:209], v[208:209], v[40:41] op_sel_hi:[1,0]
  v_pk_mul_f32 v[210:211], v[210:211], v[40:41] op_sel_hi:[1,0]
  v_pk_mul_f32 v[212:213], v[212:213], v[40:41] op_sel_hi:[1,0]
  v_pk_mul_f32 v[214:215], v[214:215], v[40:41] op_sel_hi:[1,0]
  v_cvt_pk_bf16_f32 v208, v208, v209
  v_cvt_pk_bf16_f32 v209, v210, v211
  v_cvt_pk_bf16_f32 v210, v212, v213
  v_cvt_pk_bf16_f32 v211, v214, v215
  s_add_u32 s3, s74, 393216
  buffer_store_dwordx4 v[208:211], v6, s[24:27], s3 offen sc1
  v_mfma_f32_16x16x32_bf16 a[48:51], a[240:243], v[168:171], a[48:51]
  v_cmp_nge_f32 vcc, 0x67800000, v35
  v_mfma_f32_16x16x32_bf16 a[52:55], a[244:247], v[168:171], a[52:55]
  v_exp_f32 v224, v224
  v_mfma_f32_16x16x32_bf16 a[56:59], a[248:251], v[168:171], a[56:59]
  v_exp_f32 v225, v225
  v_mfma_f32_16x16x32_bf16 a[60:63], a[252:255], v[168:171], a[60:63]
  v_mov_b32 v45, v35
  v_add_f32 v36, v36, v224
  v_mfma_f32_16x16x32_bf16 a[32:35], a[192:195], v[216:219], a[32:35]
  v_exp_f32 v226, v226
  v_mfma_f32_16x16x32_bf16 a[36:39], a[196:199], v[216:219], a[36:39]
  v_mov_b32 v44, v35
  v_add_f32 v36, v36, v225
  v_mfma_f32_16x16x32_bf16 a[40:43], a[200:203], v[216:219], a[40:43]
  v_cvt_pk_bf16_f32 v224, v224, v225
  v_permlane32_swap_b32 v44, v45
  v_mfma_f32_16x16x32_bf16 a[44:47], a[204:207], v[216:219], a[44:47]
  v_exp_f32 v227, v227
  v_mfma_f32_16x16x32_bf16 a[48:51], a[208:211], v[216:219], a[48:51]
  v_add_f32 v36, v36, v226
  v_add_f32 v44, v44, v45
  v_mfma_f32_16x16x32_bf16 a[52:55], a[212:215], v[216:219], a[52:55]
  v_exp_f32 v228, v228
  v_mfma_f32_16x16x32_bf16 a[56:59], a[216:219], v[216:219], a[56:59]
  v_add_f32 v36, v36, v227
  v_mov_b32 v45, v44
  v_mfma_f32_16x16x32_bf16 a[60:63], a[220:223], v[216:219], a[60:63]
  v_cvt_pk_bf16_f32 v225, v226, v227
  v_exp_f32 v229, v229
  v_permlane16_swap_b32 v44, v45
  v_add_f32 v36, v36, v228
  v_exp_f32 v230, v230
  v_add_f32 v44, v44, v45
  v_add_f32 v36, v36, v229
  v_cvt_pk_bf16_f32 v226, v228, v229
  v_rcp_f32 v44, v44
  v_exp_f32 v231, v231
  v_add_f32 v36, v36, v230
  v_add_f32 v36, v36, v231
  v_cvt_pk_bf16_f32 v227, v230, v231
  s_cbranch_vccnz L_slow
  v_accvgpr_read_b32 v168, a32
  v_accvgpr_read_b32 v169, a33
  v_accvgpr_read_b32 v170, a34
  v_accvgpr_read_b32 v171, a35
  v_accvgpr_read_b32 v172, a36
  v_accvgpr_read_b32 v173, a37
  v_accvgpr_read_b32 v174, a38
  v_accvgpr_read_b32 v175, a39
  v_pk_mul_f32 v[168:169], v[168:169], v[44:45] op_sel_hi:[1,0]
  v_pk_mul_f32 v[170:171], v[170:171], v[44:45] op_sel_hi:[1,0]
  v_pk_mul_f32 v[172:173], v[172:173], v[44:45] op_sel_hi:[1,0]
  v_pk_mul_f32 v[174:175], v[174:175], v[44:45] op_sel_hi:[1,0]
  v_cvt_pk_bf16_f32 v168, v168, v169
  v_cvt_pk_bf16_f32 v169, v170, v171
  v_cvt_pk_bf16_f32 v170, v172, v173
  v_cvt_pk_bf16_f32 v171, v174, v175
  s_add_u32 s3, s74, 1024
  buffer_store_dwordx4 v[168:171], v6, s[24:27], s3 offen sc1
  v_accvgpr_read_b32 v216, a40
  v_accvgpr_read_b32 v217, a41
  v_accvgpr_read_b32 v218, a42
  v_accvgpr_read_b32 v219, a43
  v_accvgpr_read_b32 v220, a44
  v_accvgpr_read_b32 v221, a45
  v_accvgpr_read_b32 v222, a46
  v_accvgpr_read_b32 v223, a47
  v_pk_mul_f32 v[216:217], v[216:217], v[44:45] op_sel_hi:[1,0]
  v_pk_mul_f32 v[218:219], v[218:219], v[44:45] op_sel_hi:[1,0]
  v_pk_mul_f32 v[220:221], v[220:221], v[44:45] op_sel_hi:[1,0]
  v_pk_mul_f32 v[222:223], v[222:223], v[44:45] op_sel_hi:[1,0]
  v_cvt_pk_bf16_f32 v216, v216, v217
  v_cvt_pk_bf16_f32 v217, v218, v219
  v_cvt_pk_bf16_f32 v218, v220, v221
  v_cvt_pk_bf16_f32 v219, v222, v223
  s_add_u32 s3, s74, 132096
  buffer_store_dwordx4 v[216:219], v6, s[24:27], s3 offen sc1
  v_accvgpr_read_b32 v168, a48
  v_accvgpr_read_b32 v169, a49
  v_accvgpr_read_b32 v170, a50
  v_accvgpr_read_b32 v171, a51
  v_accvgpr_read_b32 v172, a52
  v_accvgpr_read_b32 v173, a53
  v_accvgpr_read_b32 v174, a54
  v_accvgpr_read_b32 v175, a55
  v_pk_mul_f32 v[168:169], v[168:169], v[44:45] op_sel_hi:[1,0]
  v_pk_mul_f32 v[170:171], v[170:171], v[44:45] op_sel_hi:[1,0]
  v_pk_mul_f32 v[172:173], v[172:173], v[44:45] op_sel_hi:[1,0]
  v_pk_mul_f32 v[174:175], v[174:175], v[44:45] op_sel_hi:[1,0]
  v_cvt_pk_bf16_f32 v168, v168, v169
  v_cvt_pk_bf16_f32 v169, v170, v171
  v_cvt_pk_bf16_f32 v170, v172, v173
  v_cvt_pk_bf16_f32 v171, v174, v175
  s_add_u32 s3, s74, 263168
  buffer_store_dwordx4 v[168:171], v6, s[24:27], s3 offen sc1
  v_accvgpr_read_b32 v216, a56
  v_accvgpr_read_b32 v217, a57
  v_accvgpr_read_b32 v218, a58
  v_accvgpr_read_b32 v219, a59
  v_accvgpr_read_b32 v220, a60
  v_accvgpr_read_b32 v221, a61
  v_accvgpr_read_b32 v222, a62
  v_accvgpr_read_b32 v223, a63
  v_pk_mul_f32 v[216:217], v[216:217], v[44:45] op_sel_hi:[1,0]
  v_pk_mul_f32 v[218:219], v[218:219], v[44:45] op_sel_hi:[1,0]
  v_pk_mul_f32 v[220:221], v[220:221], v[44:45] op_sel_hi:[1,0]
  v_pk_mul_f32 v[222:223], v[222:223], v[44:45] op_sel_hi:[1,0]
  v_cvt_pk_bf16_f32 v216, v216, v217
  v_cvt_pk_bf16_f32 v217, v218, v219
  v_cvt_pk_bf16_f32 v218, v220, v221
  v_cvt_pk_bf16_f32 v219, v222, v223
  s_add_u32 s3, s74, 394240
  buffer_store_dwordx4 v[216:219], v6, s[24:27], s3 offen sc1
  s_cmp_le_u32 s75, 2
  s_cbranch_scc1 L_attn_done
  v_mfma_f32_16x16x32_bf16 a[80:83], a[240:243], v[176:179], a[80:83]
  v_cmp_nge_f32 vcc, 0x67800000, v36
  v_mfma_f32_16x16x32_bf16 a[84:87], a[244:247], v[176:179], a[84:87]
  v_exp_f32 v232, v232
  v_mfma_f32_16x16x32_bf16 a[88:91], a[248:251], v[176:179], a[88:91]
  v_exp_f32 v233, v233
  v_mfma_f32_16x16x32_bf16 a[92:95], a[252:255], v[176:179], a[92:95]
  v_mov_b32 v49, v36
  v_add_f32 v37, v37, v232
  v_mfma_f32_16x16x32_bf16 a[64:67], a[192:195], v[224:227], a[64:67]
  v_exp_f32 v234, v234
  v_mfma_f32_16x16x32_bf16 a[68:71], a[196:199], v[224:227], a[68:71]
  v_mov_b32 v48, v36
  v_add_f32 v37, v37, v233
  v_mfma_f32_16x16x32_bf16 a[72:75], a[200:203], v[224:227], a[72:75]
  v_cvt_pk_bf16_f32 v232, v232, v233
  v_permlane32_swap_b32 v48, v49
  v_mfma_f32_16x16x32_bf16 a[76:79], a[204:207], v[224:227], a[76:79]
  v_exp_f32 v235, v235
  v_mfma_f32_16x16x32_bf16 a[80:83], a[208:211], v[224:227], a[80:83]
  v_add_f32 v37, v37, v234
  v_add_f32 v48, v48, v49
  v_mfma_f32_16x16x32_bf16 a[84:87], a[212:215], v[224:227], a[84:87]
  v_exp_f32 v236, v236
  v_mfma_f32_16x16x32_bf16 a[88:91], a[216:219], v[224:227], a[88:91]
  v_add_f32 v37, v37, v235
  v_mov_b32 v49, v48
  v_mfma_f32_16x16x32_bf16 a[92:95], a[220:223], v[224:227], a[92:95]
  v_cvt_pk_bf16_f32 v233, v234, v235
  v_exp_f32 v237, v237
  v_permlane16_swap_b32 v48, v49
  v_add_f32 v37, v37, v236
  v_exp_f32 v238, v238
  v_add_f32 v48, v48, v49
  v_add_f32 v37, v37, v237
  v_cvt_pk_bf16_f32 v234, v236, v237
  v_rcp_f32 v48, v48
  v_exp_f32 v239, v239
  v_add_f32 v37, v37, v238
  v_add_f32 v37, v37, v239
  v_cvt_pk_bf16_f32 v235, v238, v239
  s_cbranch_vccnz L_slow
  v_accvgpr_read_b32 v176, a64
  v_accvgpr_read_b32 v177, a65
  v_accvgpr_read_b32 v178, a66
  v_accvgpr_read_b32 v179, a67
  v_accvgpr_read_b32 v180, a68
  v_accvgpr_read_b32 v181, a69
  v_accvgpr_read_b32 v182, a70
  v_accvgpr_read_b32 v183, a71
  v_pk_mul_f32 v[176:177], v[176:177], v[48:49] op_sel_hi:[1,0]
  v_pk_mul_f32 v[178:179], v[178:179], v[48:49] op_sel_hi:[1,0]
  v_pk_mul_f32 v[180:181], v[180:181], v[48:49] op_sel_hi:[1,0]
  v_pk_mul_f32 v[182:183], v[182:183], v[48:49] op_sel_hi:[1,0]
  v_cvt_pk_bf16_f32 v176, v176, v177
  v_cvt_pk_bf16_f32 v177, v178, v179
  v_cvt_pk_bf16_f32 v178, v180, v181
  v_cvt_pk_bf16_f32 v179, v182, v183
  s_add_u32 s3, s74, 2048
  buffer_store_dwordx4 v[176:179], v6, s[24:27], s3 offen sc1
  v_accvgpr_read_b32 v224, a72
  v_accvgpr_read_b32 v225, a73
  v_accvgpr_read_b32 v226, a74
  v_accvgpr_read_b32 v227, a75
  v_accvgpr_read_b32 v228, a76
  v_accvgpr_read_b32 v229, a77
  v_accvgpr_read_b32 v230, a78
  v_accvgpr_read_b32 v231, a79
  v_pk_mul_f32 v[224:225], v[224:225], v[48:49] op_sel_hi:[1,0]
  v_pk_mul_f32 v[226:227], v[226:227], v[48:49] op_sel_hi:[1,0]
  v_pk_mul_f32 v[228:229], v[228:229], v[48:49] op_sel_hi:[1,0]
  v_pk_mul_f32 v[230:231], v[230:231], v[48:49] op_sel_hi:[1,0]
  v_cvt_pk_bf16_f32 v224, v224, v225
  v_cvt_pk_bf16_f32 v225, v226, v227
  v_cvt_pk_bf16_f32 v226, v228, v229
  v_cvt_pk_bf16_f32 v227, v230, v231
  s_add_u32 s3, s74, 133120
  buffer_store_dwordx4 v[224:227], v6, s[24:27], s3 offen sc1
  v_accvgpr_read_b32 v176, a80
  v_accvgpr_read_b32 v177, a81
  v_accvgpr_read_b32 v178, a82
  v_accvgpr_read_b32 v179, a83
  v_accvgpr_read_b32 v180, a84
  v_accvgpr_read_b32 v181, a85
  v_accvgpr_read_b32 v182, a86
  v_accvgpr_read_b32 v183, a87
  v_pk_mul_f32 v[176:177], v[176:177], v[48:49] op_sel_hi:[1,0]
  v_pk_mul_f32 v[178:179], v[178:179], v[48:49] op_sel_hi:[1,0]
  v_pk_mul_f32 v[180:181], v[180:181], v[48:49] op_sel_hi:[1,0]
  v_pk_mul_f32 v[182:183], v[182:183], v[48:49] op_sel_hi:[1,0]
  v_cvt_pk_bf16_f32 v176, v176, v177
  v_cvt_pk_bf16_f32 v177, v178, v179
  v_cvt_pk_bf16_f32 v178, v180, v181
  v_cvt_pk_bf16_f32 v179, v182, v183
  s_add_u32 s3, s74, 264192
  buffer_store_dwordx4 v[176:179], v6, s[24:27], s3 offen sc1
  v_accvgpr_read_b32 v224, a88
  v_accvgpr_read_b32 v225, a89
  v_accvgpr_read_b32 v226, a90
  v_accvgpr_read_b32 v227, a91
  v_accvgpr_read_b32 v228, a92
  v_accvgpr_read_b32 v229, a93
  v_accvgpr_read_b32 v230, a94
  v_accvgpr_read_b32 v231, a95
  v_pk_mul_f32 v[224:225], v[224:225], v[48:49] op_sel_hi:[1,0]
  v_pk_mul_f32 v[226:227], v[226:227], v[48:49] op_sel_hi:[1,0]
  v_pk_mul_f32 v[228:229], v[228:229], v[48:49] op_sel_hi:[1,0]
  v_pk_mul_f32 v[230:231], v[230:231], v[48:49] op_sel_hi:[1,0]
  v_cvt_pk_bf16_f32 v224, v224, v225
  v_cvt_pk_bf16_f32 v225, v226, v227
  v_cvt_pk_bf16_f32 v226, v228, v229
  v_cvt_pk_bf16_f32 v227, v230, v231
  s_add_u32 s3, s74, 395264
  buffer_store_dwordx4 v[224:227], v6, s[24:27], s3 offen sc1
  s_cmp_le_u32 s75, 3
  s_cbranch_scc1 L_attn_done
  v_mfma_f32_16x16x32_bf16 a[112:115], a[240:243], v[184:187], a[112:115]
  v_cmp_nge_f32 vcc, 0x67800000, v37
  v_mfma_f32_16x16x32_bf16 a[116:119], a[244:247], v[184:187], a[116:119]
  v_exp_f32 v240, v240
  v_mfma_f32_16x16x32_bf16 a[120:123], a[248:251], v[184:187], a[120:123]
  v_exp_f32 v241, v241
  v_mfma_f32_16x16x32_bf16 a[124:127], a[252:255], v[184:187], a[124:127]
  v_mov_b32 v53, v37
  v_add_f32 v38, v38, v240
  v_mfma_f32_16x16x32_bf16 a[96:99], a[192:195], v[232:235], a[96:99]
  v_exp_f32 v242, v242
  v_mfma_f32_16x16x32_bf16 a[100:103], a[196:199], v[232:235], a[100:103]
  v_mov_b32 v52, v37
  v_add_f32 v38, v38, v241
  v_mfma_f32_16x16x32_bf16 a[104:107], a[200:203], v[232:235], a[104:107]
  v_cvt_pk_bf16_f32 v240, v240, v241
  v_permlane32_swap_b32 v52, v53
  v_mfma_f32_16x16x32_bf16 a[108:111], a[204:207], v[232:235], a[108:111]
  v_exp_f32 v243, v243
  v_mfma_f32_16x16x32_bf16 a[112:115], a[208:211], v[232:235], a[112:115]
  v_add_f32 v38, v38, v242
  v_add_f32 v52, v52, v53
  v_mfma_f32_16x16x32_bf16 a[116:119], a[212:215], v[232:235], a[116:119]
  v_exp_f32 v244, v244
  v_mfma_f32_16x16x32_bf16 a[120:123], a[216:219], v[232:235], a[120:123]
  v_add_f32 v38, v38, v243
  v_mov_b32 v53, v52
  v_mfma_f32_16x16x32_bf16 a[124:127], a[220:223], v[232:235], a[124:127]
  v_cvt_pk_bf16_f32 v241, v242, v243
  v_exp_f32 v245, v245
  v_permlane16_swap_b32 v52, v53
  v_add_f32 v38, v38, v244
  v_exp_f32 v246, v246
  v_add_f32 v52, v52, v53
  v_add_f32 v38, v38, v245
  v_cvt_pk_bf16_f32 v242, v244, v245
  v_rcp_f32 v52, v52
  v_exp_f32 v247, v247
  v_add_f32 v38, v38, v246
  v_add_f32 v38, v38, v247
  v_cvt_pk_bf16_f32 v243, v246, v247
  s_cbranch_vccnz L_slow
  v_accvgpr_read_b32 v184, a96
  v_accvgpr_read_b32 v185, a97
  v_accvgpr_read_b32 v186, a98
  v_accvgpr_read_b32 v187, a99
  v_accvgpr_read_b32 v188, a100
  v_accvgpr_read_b32 v189, a101
  v_accvgpr_read_b32 v190, a102
  v_accvgpr_read_b32 v191, a103
  v_pk_mul_f32 v[184:185], v[184:185], v[52:53] op_sel_hi:[1,0]
  v_pk_mul_f32 v[186:187], v[186:187], v[52:53] op_sel_hi:[1,0]
  v_pk_mul_f32 v[188:189], v[188:189], v[52:53] op_sel_hi:[1,0]
  v_pk_mul_f32 v[190:191], v[190:191], v[52:53] op_sel_hi:[1,0]
  v_cvt_pk_bf16_f32 v184, v184, v185
  v_cvt_pk_bf16_f32 v185, v186, v187
  v_cvt_pk_bf16_f32 v186, v188, v189
  v_cvt_pk_bf16_f32 v187, v190, v191
  s_add_u32 s3, s74, 3072
  buffer_store_dwordx4 v[184:187], v6, s[24:27], s3 offen sc1
  v_accvgpr_read_b32 v232, a104
  v_accvgpr_read_b32 v233, a105
  v_accvgpr_read_b32 v234, a106
  v_accvgpr_read_b32 v235, a107
  v_accvgpr_read_b32 v236, a108
  v_accvgpr_read_b32 v237, a109
  v_accvgpr_read_b32 v238, a110
  v_accvgpr_read_b32 v239, a111
  v_pk_mul_f32 v[232:233], v[232:233], v[52:53] op_sel_hi:[1,0]
  v_pk_mul_f32 v[234:235], v[234:235], v[52:53] op_sel_hi:[1,0]
  v_pk_mul_f32 v[236:237], v[236:237], v[52:53] op_sel_hi:[1,0]
  v_pk_mul_f32 v[238:239], v[238:239], v[52:53] op_sel_hi:[1,0]
  v_cvt_pk_bf16_f32 v232, v232, v233
  v_cvt_pk_bf16_f32 v233, v234, v235
  v_cvt_pk_bf16_f32 v234, v236, v237
  v_cvt_pk_bf16_f32 v235, v238, v239
  s_add_u32 s3, s74, 134144
  buffer_store_dwordx4 v[232:235], v6, s[24:27], s3 offen sc1
  v_accvgpr_read_b32 v184, a112
  v_accvgpr_read_b32 v185, a113
  v_accvgpr_read_b32 v186, a114
  v_accvgpr_read_b32 v187, a115
  v_accvgpr_read_b32 v188, a116
  v_accvgpr_read_b32 v189, a117
  v_accvgpr_read_b32 v190, a118
  v_accvgpr_read_b32 v191, a119
  v_pk_mul_f32 v[184:185], v[184:185], v[52:53] op_sel_hi:[1,0]
  v_pk_mul_f32 v[186:187], v[186:187], v[52:53] op_sel_hi:[1,0]
  v_pk_mul_f32 v[188:189], v[188:189], v[52:53] op_sel_hi:[1,0]
  v_pk_mul_f32 v[190:191], v[190:191], v[52:53] op_sel_hi:[1,0]
  v_cvt_pk_bf16_f32 v184, v184, v185
  v_cvt_pk_bf16_f32 v185, v186, v187
  v_cvt_pk_bf16_f32 v186, v188, v189
  v_cvt_pk_bf16_f32 v187, v190, v191
  s_add_u32 s3, s74, 265216
  buffer_store_dwordx4 v[184:187], v6, s[24:27], s3 offen sc1
  v_accvgpr_read_b32 v232, a120
  v_accvgpr_read_b32 v233, a121
  v_accvgpr_read_b32 v234, a122
  v_accvgpr_read_b32 v235, a123
  v_accvgpr_read_b32 v236, a124
  v_accvgpr_read_b32 v237, a125
  v_accvgpr_read_b32 v238, a126
  v_accvgpr_read_b32 v239, a127
  v_pk_mul_f32 v[232:233], v[232:233], v[52:53] op_sel_hi:[1,0]
  v_pk_mul_f32 v[234:235], v[234:235], v[52:53] op_sel_hi:[1,0]
  v_pk_mul_f32 v[236:237], v[236:237], v[52:53] op_sel_hi:[1,0]
  v_pk_mul_f32 v[238:239], v[238:239], v[52:53] op_sel_hi:[1,0]
  v_cvt_pk_bf16_f32 v232, v232, v233
  v_cvt_pk_bf16_f32 v233, v234, v235
  v_cvt_pk_bf16_f32 v234, v236, v237
  v_cvt_pk_bf16_f32 v235, v238, v239
  s_add_u32 s3, s74, 396288
  buffer_store_dwordx4 v[232:235], v6, s[24:27], s3 offen sc1
  s_cmp_le_u32 s75, 4
  s_cbranch_scc1 L_attn_done
  v_mfma_f32_16x16x32_bf16 a[144:147], a[240:243], v[192:195], a[144:147]
  v_cmp_nge_f32 vcc, 0x67800000, v38
  v_mfma_f32_16x16x32_bf16 a[148:151], a[244:247], v[192:195], a[148:151]
  v_exp_f32 v248, v248
  v_mfma_f32_16x16x32_bf16 a[152:155], a[248:251], v[192:195], a[152:155]
  v_exp_f32 v249, v249
  v_mfma_f32_16x16x32_bf16 a[156:159], a[252:255], v[192:195], a[156:159]
  v_mov_b32 v57, v38
  v_add_f32 v39, v39, v248
  v_mfma_f32_16x16x32_bf16 a[128:131], a[192:195], v[240:243], a[128:131]
  v_exp_f32 v250, v250
  v_mfma_f32_16x16x32_bf16 a[132:135], a[196:199], v[240:243], a[132:135]
  v_mov_b32 v56, v38
  v_add_f32 v39, v39, v249
  v_mfma_f32_16x16x32_bf16 a[136:139], a[200:203], v[240:243], a[136:139]
  v_cvt_pk_bf16_f32 v248, v248, v249
  v_permlane32_swap_b32 v56, v57
  v_mfma_f32_16x16x32_bf16 a[140:143], a[204:207], v[240:243], a[140:143]
  v_exp_f32 v251, v251
  v_mfma_f32_16x16x32_bf16 a[144:147], a[208:211], v[240:243], a[144:147]
  v_add_f32 v39, v39, v250
  v_add_f32 v56, v56, v57
  v_mfma_f32_16x16x32_bf16 a[148:151], a[212:215], v[240:243], a[148:151]
  v_exp_f32 v252, v252
  v_mfma_f32_16x16x32_bf16 a[152:155], a[216:219], v[240:243], a[152:155]
  v_add_f32 v39, v39, v251
  v_mov_b32 v57, v56
  v_mfma_f32_16x16x32_bf16 a[156:159], a[220:223], v[240:243], a[156:159]
  v_cvt_pk_bf16_f32 v249, v250, v251
  v_exp_f32 v253, v253
  v_permlane16_swap_b32 v56, v57
  v_add_f32 v39, v39, v252
  v_exp_f32 v254, v254
  v_add_f32 v56, v56, v57
  v_add_f32 v39, v39, v253
  v_cvt_pk_bf16_f32 v250, v252, v253
  v_rcp_f32 v56, v56
  v_exp_f32 v255, v255
  v_add_f32 v39, v39, v254
  v_add_f32 v39, v39, v255
  v_cvt_pk_bf16_f32 v251, v254, v255
  s_cbranch_vccnz L_slow
  v_accvgpr_read_b32 v192, a128
  v_accvgpr_read_b32 v193, a129
  v_accvgpr_read_b32 v194, a130
  v_accvgpr_read_b32 v195, a131
  v_accvgpr_read_b32 v196, a132
  v_accvgpr_read_b32 v197, a133
  v_accvgpr_read_b32 v198, a134
  v_accvgpr_read_b32 v199, a135
  v_pk_mul_f32 v[192:193], v[192:193], v[56:57] op_sel_hi:[1,0]
  v_pk_mul_f32 v[194:195], v[194:195], v[56:57] op_sel_hi:[1,0]
  v_pk_mul_f32 v[196:197], v[196:197], v[56:57] op_sel_hi:[1,0]
  v_pk_mul_f32 v[198:199], v[198:199], v[56:57] op_sel_hi:[1,0]
  v_cvt_pk_bf16_f32 v192, v192, v193
  v_cvt_pk_bf16_f32 v193, v194, v195
  v_cvt_pk_bf16_f32 v194, v196, v197
  v_cvt_pk_bf16_f32 v195, v198, v199
  s_add_u32 s3, s74, 4096
  buffer_store_dwordx4 v[192:195], v6, s[24:27], s3 offen sc1
  v_accvgpr_read_b32 v240, a136
  v_accvgpr_read_b32 v241, a137
  v_accvgpr_read_b32 v242, a138
  v_accvgpr_read_b32 v243, a139
  v_accvgpr_read_b32 v244, a140
  v_accvgpr_read_b32 v245, a141
  v_accvgpr_read_b32 v246, a142
  v_accvgpr_read_b32 v247, a143
  v_pk_mul_f32 v[240:241], v[240:241], v[56:57] op_sel_hi:[1,0]
  v_pk_mul_f32 v[242:243], v[242:243], v[56:57] op_sel_hi:[1,0]
  v_pk_mul_f32 v[244:245], v[244:245], v[56:57] op_sel_hi:[1,0]
  v_pk_mul_f32 v[246:247], v[246:247], v[56:57] op_sel_hi:[1,0]
  v_cvt_pk_bf16_f32 v240, v240, v241
  v_cvt_pk_bf16_f32 v241, v242, v243
  v_cvt_pk_bf16_f32 v242, v244, v245
  v_cvt_pk_bf16_f32 v243, v246, v247
  s_add_u32 s3, s74, 135168
  buffer_store_dwordx4 v[240:243], v6, s[24:27], s3 offen sc1
  v_accvgpr_read_b32 v192, a144
  v_accvgpr_read_b32 v193, a145
  v_accvgpr_read_b32 v194, a146
  v_accvgpr_read_b32 v195, a147
  v_accvgpr_read_b32 v196, a148
  v_accvgpr_read_b32 v197, a149
  v_accvgpr_read_b32 v198, a150
  v_accvgpr_read_b32 v199, a151
  v_pk_mul_f32 v[192:193], v[192:193], v[56:57] op_sel_hi:[1,0]
  v_pk_mul_f32 v[194:195], v[194:195], v[56:57] op_sel_hi:[1,0]
  v_pk_mul_f32 v[196:197], v[196:197], v[56:57] op_sel_hi:[1,0]
  v_pk_mul_f32 v[198:199], v[198:199], v[56:57] op_sel_hi:[1,0]
  v_cvt_pk_bf16_f32 v192, v192, v193
  v_cvt_pk_bf16_f32 v193, v194, v195
  v_cvt_pk_bf16_f32 v194, v196, v197
  v_cvt_pk_bf16_f32 v195, v198, v199
  s_add_u32 s3, s74, 266240
  buffer_store_dwordx4 v[192:195], v6, s[24:27], s3 offen sc1
  v_accvgpr_read_b32 v240, a152
  v_accvgpr_read_b32 v241, a153
  v_accvgpr_read_b32 v242, a154
  v_accvgpr_read_b32 v243, a155
  v_accvgpr_read_b32 v244, a156
  v_accvgpr_read_b32 v245, a157
  v_accvgpr_read_b32 v246, a158
  v_accvgpr_read_b32 v247, a159
  v_pk_mul_f32 v[240:241], v[240:241], v[56:57] op_sel_hi:[1,0]
  v_pk_mul_f32 v[242:243], v[242:243], v[56:57] op_sel_hi:[1,0]
  v_pk_mul_f32 v[244:245], v[244:245], v[56:57] op_sel_hi:[1,0]
  v_pk_mul_f32 v[246:247], v[246:247], v[56:57] op_sel_hi:[1,0]
  v_cvt_pk_bf16_f32 v240, v240, v241
  v_cvt_pk_bf16_f32 v241, v242, v243
  v_cvt_pk_bf16_f32 v242, v244, v245
  v_cvt_pk_bf16_f32 v243, v246, v247
  s_add_u32 s3, s74, 397312
  buffer_store_dwordx4 v[240:243], v6, s[24:27], s3 offen sc1
  s_cmp_le_u32 s75, 5
  s_cbranch_scc1 L_attn_done
  v_mfma_f32_16x16x32_bf16 a[176:179], a[240:243], v[200:203], a[176:179]
  v_cmp_nge_f32 vcc, 0x67800000, v39
  v_mov_b32 v61, v39
  v_mfma_f32_16x16x32_bf16 a[180:183], a[244:247], v[200:203], a[180:183]
  v_mov_b32 v60, v39
  s_nop 1
  v_permlane32_swap_b32 v60, v61
  v_mfma_f32_16x16x32_bf16 a[184:187], a[248:251], v[200:203], a[184:187]
  v_add_f32 v60, v60, v61
  v_mov_b32 v61, v60
  v_mfma_f32_16x16x32_bf16 a[188:191], a[252:255], v[200:203], a[188:191]
  s_nop 0
  v_permlane16_swap_b32 v60, v61
  v_add_f32 v60, v60, v61
  v_mfma_f32_16x16x32_bf16 a[160:163], a[192:195], v[248:251], a[160:163]
  v_rcp_f32 v60, v60
  v_mfma_f32_16x16x32_bf16 a[164:167], a[196:199], v[248:251], a[164:167]
  v_mfma_f32_16x16x32_bf16 a[168:171], a[200:203], v[248:251], a[168:171]
  v_mfma_f32_16x16x32_bf16 a[172:175], a[204:207], v[248:251], a[172:175]
  v_mfma_f32_16x16x32_bf16 a[176:179], a[208:211], v[248:251], a[176:179]
  v_mfma_f32_16x16x32_bf16 a[180:183], a[212:215], v[248:251], a[180:183]
  v_mfma_f32_16x16x32_bf16 a[184:187], a[216:219], v[248:251], a[184:187]
  v_mfma_f32_16x16x32_bf16 a[188:191], a[220:223], v[248:251], a[188:191]
  s_cbranch_vccnz L_slow
  v_accvgpr_read_b32 v200, a160
  v_accvgpr_read_b32 v201, a161
  v_accvgpr_read_b32 v202, a162
  v_accvgpr_read_b32 v203, a163
  v_accvgpr_read_b32 v204, a164
  v_accvgpr_read_b32 v205, a165
  v_accvgpr_read_b32 v206, a166
  v_accvgpr_read_b32 v207, a167
  v_pk_mul_f32 v[200:201], v[200:201], v[60:61] op_sel_hi:[1,0]
  v_pk_mul_f32 v[202:203], v[202:203], v[60:61] op_sel_hi:[1,0]
  v_pk_mul_f32 v[204:205], v[204:205], v[60:61] op_sel_hi:[1,0]
  v_pk_mul_f32 v[206:207], v[206:207], v[60:61] op_sel_hi:[1,0]
  v_cvt_pk_bf16_f32 v200, v200, v201
  v_cvt_pk_bf16_f32 v201, v202, v203
  v_cvt_pk_bf16_f32 v202, v204, v205
  v_cvt_pk_bf16_f32 v203, v206, v207
  s_add_u32 s3, s74, 5120
  buffer_store_dwordx4 v[200:203], v6, s[24:27], s3 offen sc1
  v_accvgpr_read_b32 v248, a168
  v_accvgpr_read_b32 v249, a169
  v_accvgpr_read_b32 v250, a170
  v_accvgpr_read_b32 v251, a171
  v_accvgpr_read_b32 v252, a172
  v_accvgpr_read_b32 v253, a173
  v_accvgpr_read_b32 v254, a174
  v_accvgpr_read_b32 v255, a175
  v_pk_mul_f32 v[248:249], v[248:249], v[60:61] op_sel_hi:[1,0]
  v_pk_mul_f32 v[250:251], v[250:251], v[60:61] op_sel_hi:[1,0]
  v_pk_mul_f32 v[252:253], v[252:253], v[60:61] op_sel_hi:[1,0]
  v_pk_mul_f32 v[254:255], v[254:255], v[60:61] op_sel_hi:[1,0]
  v_cvt_pk_bf16_f32 v248, v248, v249
  v_cvt_pk_bf16_f32 v249, v250, v251
  v_cvt_pk_bf16_f32 v250, v252, v253
  v_cvt_pk_bf16_f32 v251, v254, v255
  s_add_u32 s3, s74, 136192
  buffer_store_dwordx4 v[248:251], v6, s[24:27], s3 offen sc1
  v_accvgpr_read_b32 v200, a176
  v_accvgpr_read_b32 v201, a177
  v_accvgpr_read_b32 v202, a178
  v_accvgpr_read_b32 v203, a179
  v_accvgpr_read_b32 v204, a180
  v_accvgpr_read_b32 v205, a181
  v_accvgpr_read_b32 v206, a182
  v_accvgpr_read_b32 v207, a183
  v_pk_mul_f32 v[200:201], v[200:201], v[60:61] op_sel_hi:[1,0]
  v_pk_mul_f32 v[202:203], v[202:203], v[60:61] op_sel_hi:[1,0]
  v_pk_mul_f32 v[204:205], v[204:205], v[60:61] op_sel_hi:[1,0]
  v_pk_mul_f32 v[206:207], v[206:207], v[60:61] op_sel_hi:[1,0]
  v_cvt_pk_bf16_f32 v200, v200, v201
  v_cvt_pk_bf16_f32 v201, v202, v203
  v_cvt_pk_bf16_f32 v202, v204, v205
  v_cvt_pk_bf16_f32 v203, v206, v207
  s_add_u32 s3, s74, 267264
  buffer_store_dwordx4 v[200:203], v6, s[24:27], s3 offen sc1
  v_accvgpr_read_b32 v248, a184
  v_accvgpr_read_b32 v249, a185
  v_accvgpr_read_b32 v250, a186
  v_accvgpr_read_b32 v251, a187
  v_accvgpr_read_b32 v252, a188
  v_accvgpr_read_b32 v253, a189
  v_accvgpr_read_b32 v254, a190
  v_accvgpr_read_b32 v255, a191
  v_pk_mul_f32 v[248:249], v[248:249], v[60:61] op_sel_hi:[1,0]
  v_pk_mul_f32 v[250:251], v[250:251], v[60:61] op_sel_hi:[1,0]
  v_pk_mul_f32 v[252:253], v[252:253], v[60:61] op_sel_hi:[1,0]
  v_pk_mul_f32 v[254:255], v[254:255], v[60:61] op_sel_hi:[1,0]
  v_cvt_pk_bf16_f32 v248, v248, v249
  v_cvt_pk_bf16_f32 v249, v250, v251
  v_cvt_pk_bf16_f32 v250, v252, v253
  v_cvt_pk_bf16_f32 v251, v254, v255
  s_add_u32 s3, s74, 398336
  buffer_store_dwordx4 v[248:251], v6, s[24:27], s3 offen sc1
L_attn_done:
L_phase2:
  s_and_b32 s3, s2, 7
  s_lshl_b32 s3, s3, 7
  s_add_u32 s3, s3, 1024
  s_cmp_ge_u32 s2, 248
  s_cbranch_scc1 L_rk_poll
  s_load_dword s5, s[60:61], s3
  s_waitcnt lgkmcnt(0)
  s_sub_u32 s5, s5, s100
  s_cmp_lt_u32 s5, 8
  s_cbranch_scc1 L_rk_ok
L_rk_poll:
  v_mov_b32 v34, s3
  s_mov_b32 s7, 0x80000
L_rk_loop:
  buffer_load_dword v35, v34, s[64:67], 0 offen sc1
  s_waitcnt vmcnt(0)
  v_readfirstlane_b32 s5, v35
  s_sub_u32 s5, s5, s100
  s_cmp_lt_u32 s5, 8
  s_cbranch_scc1 L_rk_ok
  s_sleep 8
  s_sub_u32 s7, s7, 1
  s_cmp_lg_u32 s7, 0
  s_cbranch_scc1 L_rk_loop
L_rk_ok:
  s_and_b32 s5, s5, 7
  s_xor_b32 s5, s5, 4
  s_lshr_b32 s29, s5, 1
  s_and_b32 s3, s5, 1
  s_lshl_b32 s3, s3, 3
  s_lshr_b32 s4, s2, 5
  s_add_u32 s30, s3, s4
  s_bfe_u32 s31, s2, 0x20003
  s_lshl_b32 s34, s30, 2
  s_add_u32 s34, s34, s31
  s_and_b32 s32, s28, 1
  s_lshr_b32 s33, s28, 1
  v_lshlrev_b32 v4, 4, v1
  s_cmp_ge_u32 s29, 2
  s_cbranch_scc1 L_roleB
L_roleA:
  s_and_b32 s6, s29, 1
  s_mul_i32 s3, s6, 64
  s_mov_b32 s72, 7
  s_add_u32 s3, s3, s33
  s_mul_i32 s70, s33, 10240
  s_mul_i32 s4, s32, 5120
  s_add_u32 s70, s70, s4
  s_mov_b32 s8, s44
  s_mov_b32 s9, s45
  s_mov_b32 s10, 4718592
  s_mov_b32 s11, 0x20000
  s_add_u32 s12, s60, 4849664
  s_addc_u32 s13, s61, 0
  s_mov_b32 s14, 16777216
  s_mov_b32 s15, 0x20000
  s_mul_i32 s68, s3, 36864
  s_mul_i32 s4, s32, 18432
  s_add_u32 s68, s68, s4
  s_mul_i32 s4, s31, 288
  s_add_u32 s68, s68, s4
  v_add_u32 v34, 0, v1
  v_mul_u32_u24 v35, 3641, v34
  v_lshrrev_b32 v35, 16, v35
  v_mul_u32_u24 v35, 864, v35
  v_lshl_add_u32 v5, v1, 4, v35
  v_add_u32 v34, 64, v1
  v_mul_u32_u24 v35, 3641, v34
  v_lshrrev_b32 v35, 16, v35
  v_mul_u32_u24 v35, 864, v35
  v_lshl_add_u32 v6, v1, 4, v35
  v_add_u32 v34, 128, v1
  v_mul_u32_u24 v35, 3641, v34
  v_lshrrev_b32 v35, 16, v35
  v_mul_u32_u24 v35, 864, v35
  v_lshl_add_u32 v7, v1, 4, v35
  v_add_u32 v34, 192, v1
  v_mul_u32_u24 v35, 3641, v34
  v_lshrrev_b32 v35, 16, v35
  v_mul_u32_u24 v35, 864, v35
  v_lshl_add_u32 v8, v1, 4, v35
  v_add_u32 v34, 256, v1
  v_mul_u32_u24 v35, 3641, v34
  v_lshrrev_b32 v35, 16, v35
  v_mul_u32_u24 v35, 864, v35
  v_lshl_add_u32 v9, v34, 4, v35
  v_mov_b32 v36, 2130706176
  v_cmp_gt_u32 vcc, 32, v1
  s_nop 1
  v_cndmask_b32 v9, v36, v9, vcc
  s_lshl_b32 s4, s3, 7
  s_lshl_b32 s5, s30, 3
  s_add_u32 s4, s4, s5
  s_lshl_b32 s5, s32, 2
  s_add_u32 s4, s4, s5
  s_lshl_b32 s69, s4, 10
  s_barrier
  s_add_u32 m0, s70, 0
  s_nop 0
  buffer_load_dwordx4 v5, s[8:11], s68 offen offset:0 lds
  buffer_load_dwordx4 v6, s[8:11], s68 offen offset:1024 lds
  buffer_load_dwordx4 v7, s[8:11], s68 offen offset:2048 lds
  buffer_load_dwordx4 v8, s[8:11], s68 offen offset:3072 lds
  s_add_u32 m0, s70, 4096
  s_nop 0
  buffer_load_dwordx4 v9, s[8:11], s68 offen offset:0 lds
  s_add_u32 s68, s68, 73728
  s_lshl_b32 s4, s33, 11
  v_add_u32 v10, s4, v4
  v_xor_b32 v11, 2048, v10
  v_lshrrev_b32 v34, 2, v1
  v_mul_u32_u24 v34, 288, v34
  v_and_b32 v35, 3, v1
  v_lshl_add_u32 v34, v35, 3, v34
  s_mul_i32 s4, s33, 10240
  v_add_u32 v12, s4, v34
  v_add_u32 v13, 61440, v12
  s_lshl_b32 s3, s30, 7
  s_lshl_b32 s4, s32, 6
  s_add_u32 s3, s3, s4
  v_bfe_u32 v34, v1, 4, 1
  v_mul_u32_u24 v34, 63, v34
  v_add_u32 v34, s3, v34
  v_mul_u32_u24 v34, 1366, v34
  v_lshrrev_b32 v34, 18, v34
  v_and_b32 v36, 15, v1
  v_min_u32 v36, 7, v36
  s_lshl_b32 s3, s6, 3
  v_add_u32 v36, s3, v36
  v_min_u32 v36, 15, v36
  v_and_b32 v35, 1, v36
  v_mad_u32_u24 v34, v35, 11, v34
  v_lshrrev_b32 v35, 1, v36
  v_lshl_add_u32 v34, v34, 3, v35
  v_lshlrev_b32 v38, 7, v34
  v_add_u32 v38, 36864, v38
  s_mov_b32 s20, s36
  s_mov_b32 s21, s37
  s_mov_b32 s22, 2359296
  s_mov_b32 s23, 0x20000
  s_mov_b32 s24, s56
  s_mov_b32 s25, s57
  s_mov_b32 s26, 2359296
  s_mov_b32 s27, 0x20000
  s_lshl_b32 s3, s32, 1
  s_add_u32 s3, s3, s33
  s_cmp_eq_u32 s3, s29
  s_cselect_b32 s79, 1, 0
  s_lshl_b32 s5, s34, 2
  s_add_u32 s3, s3, s5
  s_lshl_b32 s4, s3, 7
  s_lshl_b32 s6, s29, 2
  s_add_u32 s77, s4, s6
  s_add_u32 s77, s77, 69632
  s_lshl_b32 s3, s3, 2
  s_add_u32 s3, s3, s29
  s_mul_i32 s75, s3, 9216
  s_add_u32 s5, s5, s29
  s_lshl_b32 s78, s5, 7
  s_add_u32 s78, s78, 69632
  s_mul_i32 s5, s5, 36864
  s_lshl_b32 s3, s28, 10
  s_add_u32 s76, s5, s3
  s_lshl_b32 s3, s30, 2
  s_add_u32 s3, s3, s29
  s_mul_i32 s3, s3, 36864
  s_mul_i32 s4, s31, 288
  s_add_u32 s3, s3, s4
  s_lshl_b32 s4, s28, 5
  s_add_u32 s35, s3, s4
  v_and_b32 v34, 15, v1
  v_mul_u32_u24 v34, 1152, v34
  v_lshrrev_b32 v35, 4, v1
  v_lshl_add_u32 v30, v35, 3, v34
  v_add_u32 v31, 18432, v30
  s_mul_i32 s3, s28, 18432
  v_add_u32 v32, s3, v4
  s_xor_b32 s4, s28, 2
  s_mul_i32 s3, s4, 18432
  v_add_u32 v33, s3, v4
  s_waitcnt vmcnt(5)
  s_barrier
  s_cmp_lg_u32 s28, 0
  s_cbranch_scc1 L_roleA_nf1
  s_lshl_b32 s3, s2, 7
  s_add_u32 s3, s3, 36864
  v_mov_b32 v2, s100
  v_mov_b32 v3, 0
  s_mov_b64 exec, 1
  buffer_store_dword v2, v3, s[64:67], s3 offen sc1
  s_mov_b64 exec, -1
L_roleA_nf1:
  s_add_u32 m0, s70, 20480
  s_nop 0
  buffer_load_dwordx4 v5, s[8:11], s68 offen offset:0 lds
  buffer_load_dwordx4 v6, s[8:11], s68 offen offset:1024 lds
  buffer_load_dwordx4 v7, s[8:11], s68 offen offset:2048 lds
  buffer_load_dwordx4 v8, s[8:11], s68 offen offset:3072 lds
  s_add_u32 m0, s70, 24576
  s_nop 0
  buffer_load_dwordx4 v9, s[8:11], s68 offen offset:0 lds
  s_add_u32 s68, s68, 73728
  s_add_u32 m0, s70, 40960
  s_nop 0
  buffer_load_dwordx4 v5, s[8:11], s68 offen offset:0 lds
  buffer_load_dwordx4 v6, s[8:11], s68 offen offset:1024 lds
  buffer_load_dwordx4 v7, s[8:11], s68 offen offset:2048 lds
  buffer_load_dwordx4 v8, s[8:11], s68 offen offset:3072 lds
  s_add_u32 m0, s70, 45056
  s_nop 0
  buffer_load_dwordx4 v9, s[8:11], s68 offen offset:0 lds
  s_add_u32 s68, s68, 73728
  s_add_u32 m0, s70, 61440
  s_nop 0
  buffer_load_dwordx4 v5, s[8:11], s68 offen offset:0 lds
  buffer_load_dwordx4 v6, s[8:11], s68 offen offset:1024 lds
  buffer_load_dwordx4 v7, s[8:11], s68 offen offset:2048 lds
  buffer_load_dwordx4 v8, s[8:11], s68 offen offset:3072 lds
  s_add_u32 m0, s70, 65536
  s_nop 0
  buffer_load_dwordx4 v9, s[8:11], s68 offen offset:0 lds
  s_add_u32 s68, s68, 73728
  v_pk_mov_b32 v[112:113], 0, 0
  v_pk_mov_b32 v[114:115], 0, 0
  v_pk_mov_b32 v[116:117], 0, 0
  v_pk_mov_b32 v[118:119], 0, 0
  v_pk_mov_b32 v[120:121], 0, 0
  v_pk_mov_b32 v[122:123], 0, 0
  v_pk_mov_b32 v[124:125], 0, 0
  v_pk_mov_b32 v[126:127], 0, 0
  v_pk_mov_b32 v[128:129], 0, 0
  v_pk_mov_b32 v[130:131], 0, 0
  v_pk_mov_b32 v[132:133], 0, 0
  v_pk_mov_b32 v[134:135], 0, 0
  v_pk_mov_b32 v[136:137], 0, 0
  v_pk_mov_b32 v[138:139], 0, 0
  v_pk_mov_b32 v[140:141], 0, 0
  v_pk_mov_b32 v[142:143], 0, 0
  v_pk_mov_b32 v[144:145], 0, 0
  v_pk_mov_b32 v[146:147], 0, 0
  v_pk_mov_b32 v[148:149], 0, 0
  v_pk_mov_b32 v[150:151], 0, 0
  v_pk_mov_b32 v[152:153], 0, 0
  v_pk_mov_b32 v[154:155], 0, 0
  v_pk_mov_b32 v[156:157], 0, 0
  v_pk_mov_b32 v[158:159], 0, 0
  v_pk_mov_b32 v[160:161], 0, 0
  v_pk_mov_b32 v[162:163], 0, 0
  v_pk_mov_b32 v[164:165], 0, 0
  v_pk_mov_b32 v[166:167], 0, 0
  v_pk_mov_b32 v[168:169], 0, 0
  v_pk_mov_b32 v[170:171], 0, 0
  v_pk_mov_b32 v[172:173], 0, 0
  v_pk_mov_b32 v[174:175], 0, 0
  v_pk_mov_b32 v[176:177], 0, 0
  v_pk_mov_b32 v[178:179], 0, 0
  v_pk_mov_b32 v[180:181], 0, 0
  v_pk_mov_b32 v[182:183], 0, 0
  v_pk_mov_b32 v[184:185], 0, 0
  v_pk_mov_b32 v[186:187], 0, 0
  v_pk_mov_b32 v[188:189], 0, 0
  v_pk_mov_b32 v[190:191], 0, 0
  v_pk_mov_b32 v[192:193], 0, 0
  v_pk_mov_b32 v[194:195], 0, 0
  v_pk_mov_b32 v[196:197], 0, 0
  v_pk_mov_b32 v[198:199], 0, 0
  v_pk_mov_b32 v[200:201], 0, 0
  v_pk_mov_b32 v[202:203], 0, 0
  v_pk_mov_b32 v[204:205], 0, 0
  v_pk_mov_b32 v[206:207], 0, 0
  v_pk_mov_b32 v[208:209], 0, 0
  v_pk_mov_b32 v[210:211], 0, 0
  v_pk_mov_b32 v[212:213], 0, 0
  v_pk_mov_b32 v[214:215], 0, 0
  v_pk_mov_b32 v[216:217], 0, 0
  v_pk_mov_b32 v[218:219], 0, 0
  v_pk_mov_b32 v[220:221], 0, 0
  v_pk_mov_b32 v[222:223], 0, 0
  v_pk_mov_b32 v[224:225], 0, 0
  v_pk_mov_b32 v[226:227], 0, 0
  v_pk_mov_b32 v[228:229], 0, 0
  v_pk_mov_b32 v[230:231], 0, 0
  v_pk_mov_b32 v[232:233], 0, 0
  v_pk_mov_b32 v[234:235], 0, 0
  v_pk_mov_b32 v[236:237], 0, 0
  v_pk_mov_b32 v[238:239], 0, 0
  v_pk_mov_b32 v[240:241], 0, 0
  v_pk_mov_b32 v[242:243], 0, 0
  v_pk_mov_b32 v[244:245], 0, 0
  v_pk_mov_b32 v[246:247], 0, 0
  v_pk_mov_b32 v[248:249], 0, 0
  v_pk_mov_b32 v[250:251], 0, 0
  v_pk_mov_b32 v[252:253], 0, 0
  v_pk_mov_b32 v[254:255], 0, 0
  s_mov_b32 s7, 0x80000
L_p1A:
  buffer_load_dword v37, v38, s[64:67], 0 offen sc1
L_p1A_chk:
  s_waitcnt vmcnt(0)
  v_cmp_ne_u32 vcc, s100, v37
  s_cbranch_vccz L_p1A_ok
  s_sleep 1
  s_sub_u32 s7, s7, 1
  s_cmp_lg_u32 s7, 0
  s_cbranch_scc1 L_p1A
L_p1A_ok:
  buffer_load_dwordx4 a[72:75], v10, s[12:15], s69 offen offset:0 sc1
  buffer_load_dwordx4 a[76:79], v10, s[12:15], s69 offen offset:1024 sc1
  buffer_load_dwordx4 a[80:83], v11, s[12:15], s69 offen offset:0 sc1
  buffer_load_dwordx4 a[84:87], v11, s[12:15], s69 offen offset:1024 sc1
  s_add_u32 s69, s69, 262144
  buffer_load_dwordx4 a[88:91], v10, s[12:15], s69 offen offset:0 sc1
  buffer_load_dwordx4 a[92:95], v10, s[12:15], s69 offen offset:1024 sc1
  buffer_load_dwordx4 a[96:99], v11, s[12:15], s69 offen offset:0 sc1
  buffer_load_dwordx4 a[100:103], v11, s[12:15], s69 offen offset:1024 sc1
  s_add_u32 s69, s69, 262144
  buffer_load_dwordx4 a[104:107], v10, s[12:15], s69 offen offset:0 sc1
  buffer_load_dwordx4 a[108:111], v10, s[12:15], s69 offen offset:1024 sc1
  buffer_load_dwordx4 a[112:115], v11, s[12:15], s69 offen offset:0 sc1
  buffer_load_dwordx4 a[116:119], v11, s[12:15], s69 offen offset:1024 sc1
  s_add_u32 s69, s69, 262144
  s_add_u32 s16, s60, 26935296
  s_addc_u32 s17, s61, 0
  s_mov_b32 s18, 18874368
  s_mov_b32 s19, 0x20000
  s_barrier
  ds_read_b64_tr_b16 a[0:1], v12 offset:0
  ds_read_b64_tr_b16 a[2:3], v12 offset:5120
  ds_read_b64_tr_b16 a[4:5], v12 offset:32
  ds_read_b64_tr_b16 a[6:7], v12 offset:5152
  ds_read_b64_tr_b16 a[8:9], v12 offset:64
  ds_read_b64_tr_b16 a[10:11], v12 offset:5184
  ds_read_b64_tr_b16 a[12:13], v12 offset:96
  ds_read_b64_tr_b16 a[14:15], v12 offset:5216
  ds_read_b64_tr_b16 a[16:17], v12 offset:128
  ds_read_b64_tr_b16 a[18:19], v12 offset:5248
  ds_read_b64_tr_b16 a[20:21], v12 offset:160
  ds_read_b64_tr_b16 a[22:23], v12 offset:5280
  ds_read_b64_tr_b16 a[24:25], v12 offset:192
  ds_read_b64_tr_b16 a[26:27], v12 offset:5312
  ds_read_b64_tr_b16 a[28:29], v12 offset:224
  ds_read_b64_tr_b16 a[30:31], v12 offset:5344
  ds_read_b64_tr_b16 a[32:33], v12 offset:256
  ds_read_b64_tr_b16 a[34:35], v12 offset:5376
  s_waitcnt vmcnt(4)
  s_waitcnt lgkmcnt(0)
  s_barrier
  s_getpc_b64 s[92:93]
L_j3A:
  s_add_u32 s92, s92, L_tailA-L_j3A
  s_addc_u32 s93, s93, 0
  s_mov_b32 s94, 16384
  s_mov_b32 s95, 0x20000
  s_lshr_b32 s3, s2, 3
  s_lshl_b32 s3, s3, 2
  s_add_u32 s3, s3, s28
  s_lshl_b32 s3, s3, 7
  v_mov_b32 v36, s3
  .p2align 6
L_loopA:
  v_mfma_f32_16x16x32_bf16 v[112:115], a[0:3], a[72:75], v[112:115]
  ds_read_b64_tr_b16 a[36:37], v12 offset:20480
  v_mfma_f32_16x16x32_bf16 v[116:119], a[0:3], a[76:79], v[116:119]
  ds_read_b64_tr_b16 a[38:39], v12 offset:25600
  v_mfma_f32_16x16x32_bf16 v[184:187], a[0:3], a[80:83], v[184:187]
  buffer_load_dwordx4 a[120:123], v10, s[12:15], s69 offen offset:0 sc1
  v_mfma_f32_16x16x32_bf16 v[188:191], a[0:3], a[84:87], v[188:191]
  ds_read_b64_tr_b16 a[40:41], v12 offset:20512
  v_mfma_f32_16x16x32_bf16 v[120:123], a[4:7], a[72:75], v[120:123]
  ds_read_b64_tr_b16 a[42:43], v12 offset:25632
  v_mfma_f32_16x16x32_bf16 v[124:127], a[4:7], a[76:79], v[124:127]
  ds_read_b64_tr_b16 a[44:45], v12 offset:20544
  v_mfma_f32_16x16x32_bf16 v[192:195], a[4:7], a[80:83], v[192:195]
  buffer_load_dwordx4 a[124:127], v10, s[12:15], s69 offen offset:1024 sc1
  v_mfma_f32_16x16x32_bf16 v[196:199], a[4:7], a[84:87], v[196:199]
  ds_read_b64_tr_b16 a[46:47], v12 offset:25664
  v_mfma_f32_16x16x32_bf16 v[128:131], a[8:11], a[72:75], v[128:131]
  ds_read_b64_tr_b16 a[48:49], v12 offset:20576
  v_mfma_f32_16x16x32_bf16 v[132:135], a[8:11], a[76:79], v[132:135]
  ds_read_b64_tr_b16 a[50:51], v12 offset:25696
  v_mfma_f32_16x16x32_bf16 v[200:203], a[8:11], a[80:83], v[200:203]
  buffer_load_dwordx4 a[128:131], v11, s[12:15], s69 offen offset:0 sc1
  v_mfma_f32_16x16x32_bf16 v[204:207], a[8:11], a[84:87], v[204:207]
  ds_read_b64_tr_b16 a[52:53], v12 offset:20608
  v_mfma_f32_16x16x32_bf16 v[136:139], a[12:15], a[72:75], v[136:139]
  ds_read_b64_tr_b16 a[54:55], v12 offset:25728
  v_mfma_f32_16x16x32_bf16 v[140:143], a[12:15], a[76:79], v[140:143]
  ds_read_b64_tr_b16 a[56:57], v12 offset:20640
  v_mfma_f32_16x16x32_bf16 v[208:211], a[12:15], a[80:83], v[208:211]
  buffer_load_dwordx4 a[132:135], v11, s[12:15], s69 offen offset:1024 sc1
  v_mfma_f32_16x16x32_bf16 v[212:215], a[12:15], a[84:87], v[212:215]
  s_add_u32 s69, s69, 262144
  ds_read_b64_tr_b16 a[58:59], v12 offset:25760
  v_mfma_f32_16x16x32_bf16 v[144:147], a[16:19], a[72:75], v[144:147]
  s_add_u32 m0, s70, 0
  ds_read_b64_tr_b16 a[60:61], v12 offset:20672
  v_mfma_f32_16x16x32_bf16 v[148:151], a[16:19], a[76:79], v[148:151]
  ds_read_b64_tr_b16 a[62:63], v12 offset:25792
  v_mfma_f32_16x16x32_bf16 v[216:219], a[16:19], a[80:83], v[216:219]
  buffer_load_dwordx4 v5, s[8:11], s68 offen offset:0 lds
  v_mfma_f32_16x16x32_bf16 v[220:223], a[16:19], a[84:87], v[220:223]
  ds_read_b64_tr_b16 a[64:65], v12 offset:20704
  v_mfma_f32_16x16x32_bf16 v[152:155], a[20:23], a[72:75], v[152:155]
  ds_read_b64_tr_b16 a[66:67], v12 offset:25824
  v_mfma_f32_16x16x32_bf16 v[156:159], a[20:23], a[76:79], v[156:159]
  ds_read_b64_tr_b16 a[68:69], v12 offset:20736
  v_mfma_f32_16x16x32_bf16 v[224:227], a[20:23], a[80:83], v[224:227]
  buffer_load_dwordx4 v6, s[8:11], s68 offen offset:1024 lds
  v_mfma_f32_16x16x32_bf16 v[228:231], a[20:23], a[84:87], v[228:231]
  ds_read_b64_tr_b16 a[70:71], v12 offset:25856
  v_mfma_f32_16x16x32_bf16 v[160:163], a[24:27], a[72:75], v[160:163]
  v_mfma_f32_16x16x32_bf16 v[164:167], a[24:27], a[76:79], v[164:167]
  v_mfma_f32_16x16x32_bf16 v[232:235], a[24:27], a[80:83], v[232:235]
  buffer_load_dwordx4 v7, s[8:11], s68 offen offset:2048 lds
  v_mfma_f32_16x16x32_bf16 v[236:239], a[24:27], a[84:87], v[236:239]
  v_mfma_f32_16x16x32_bf16 v[168:171], a[28:31], a[72:75], v[168:171]
  v_mfma_f32_16x16x32_bf16 v[172:175], a[28:31], a[76:79], v[172:175]
  v_mfma_f32_16x16x32_bf16 v[240:243], a[28:31], a[80:83], v[240:243]
  buffer_load_dwordx4 v8, s[8:11], s68 offen offset:3072 lds
  v_mfma_f32_16x16x32_bf16 v[244:247], a[28:31], a[84:87], v[244:247]
  s_add_u32 m0, s70, 4096
  v_mfma_f32_16x16x32_bf16 v[176:179], a[32:35], a[72:75], v[176:179]
  buffer_load_dword v37, v36, s[92:95], 0 offen
  v_mfma_f32_16x16x32_bf16 v[180:183], a[32:35], a[76:79], v[180:183]
  v_mfma_f32_16x16x32_bf16 v[248:251], a[32:35], a[80:83], v[248:251]
  buffer_load_dwordx4 v9, s[8:11], s68 offen offset:0 lds
  v_mfma_f32_16x16x32_bf16 v[252:255], a[32:35], a[84:87], v[252:255]
  s_add_u32 s68, s68, 73728
  s_waitcnt vmcnt(18) lgkmcnt(0)
  s_barrier
  v_mfma_f32_16x16x32_bf16 v[112:115], a[36:39], a[88:91], v[112:115]
  ds_read_b64_tr_b16 a[0:1], v12 offset:40960
  v_mfma_f32_16x16x32_bf16 v[116:119], a[36:39], a[92:95], v[116:119]
  ds_read_b64_tr_b16 a[2:3], v12 offset:46080
  v_mfma_f32_16x16x32_bf16 v[184:187], a[36:39], a[96:99], v[184:187]
  buffer_load_dwordx4 a[72:75], v10, s[12:15], s69 offen offset:0 sc1
  v_mfma_f32_16x16x32_bf16 v[188:191], a[36:39], a[100:103], v[188:191]
  ds_read_b64_tr_b16 a[4:5], v12 offset:40992
  v_mfma_f32_16x16x32_bf16 v[120:123], a[40:43], a[88:91], v[120:123]
  ds_read_b64_tr_b16 a[6:7], v12 offset:46112
  v_mfma_f32_16x16x32_bf16 v[124:127], a[40:43], a[92:95], v[124:127]
  ds_read_b64_tr_b16 a[8:9], v12 offset:41024
  v_mfma_f32_16x16x32_bf16 v[192:195], a[40:43], a[96:99], v[192:195]
  buffer_load_dwordx4 a[76:79], v10, s[12:15], s69 offen offset:1024 sc1
  v_mfma_f32_16x16x32_bf16 v[196:199], a[40:43], a[100:103], v[196:199]
  ds_read_b64_tr_b16 a[10:11], v12 offset:46144
  v_mfma_f32_16x16x32_bf16 v[128:131], a[44:47], a[88:91], v[128:131]
  ds_read_b64_tr_b16 a[12:13], v12 offset:41056
  v_mfma_f32_16x16x32_bf16 v[132:135], a[44:47], a[92:95], v[132:135]
  ds_read_b64_tr_b16 a[14:15], v12 offset:46176
  v_mfma_f32_16x16x32_bf16 v[200:203], a[44:47], a[96:99], v[200:203]
  buffer_load_dwordx4 a[80:83], v11, s[12:15], s69 offen offset:0 sc1
  v_mfma_f32_16x16x32_bf16 v[204:207], a[44:47], a[100:103], v[204:207]
  ds_read_b64_tr_b16 a[16:17], v12 offset:41088
  v_mfma_f32_16x16x32_bf16 v[136:139], a[48:51], a[88:91], v[136:139]
  ds_read_b64_tr_b16 a[18:19], v12 offset:46208
  v_mfma_f32_16x16x32_bf16 v[140:143], a[48:51], a[92:95], v[140:143]
  ds_read_b64_tr_b16 a[20:21], v12 offset:41120
  v_mfma_f32_16x16x32_bf16 v[208:211], a[48:51], a[96:99], v[208:211]
  buffer_load_dwordx4 a[84:87], v11, s[12:15], s69 offen offset:1024 sc1
  v_mfma_f32_16x16x32_bf16 v[212:215], a[48:51], a[100:103], v[212:215]
  s_add_u32 s69, s69, 262144
  ds_read_b64_tr_b16 a[22:23], v12 offset:46240
  v_mfma_f32_16x16x32_bf16 v[144:147], a[52:55], a[88:91], v[144:147]
  s_add_u32 m0, s70, 20480
  ds_read_b64_tr_b16 a[24:25], v12 offset:41152
  v_mfma_f32_16x16x32_bf16 v[148:151], a[52:55], a[92:95], v[148:151]
  ds_read_b64_tr_b16 a[26:27], v12 offset:46272
  v_mfma_f32_16x16x32_bf16 v[216:219], a[52:55], a[96:99], v[216:219]
  buffer_load_dwordx4 v5, s[8:11], s68 offen offset:0 lds
  v_mfma_f32_16x16x32_bf16 v[220:223], a[52:55], a[100:103], v[220:223]
  ds_read_b64_tr_b16 a[28:29], v12 offset:41184
  v_mfma_f32_16x16x32_bf16 v[152:155], a[56:59], a[88:91], v[152:155]
  ds_read_b64_tr_b16 a[30:31], v12 offset:46304
  v_mfma_f32_16x16x32_bf16 v[156:159], a[56:59], a[92:95], v[156:159]
  ds_read_b64_tr_b16 a[32:33], v12 offset:41216
  v_mfma_f32_16x16x32_bf16 v[224:227], a[56:59], a[96:99], v[224:227]
  buffer_load_dwordx4 v6, s[8:11], s68 offen offset:1024 lds
  v_mfma_f32_16x16x32_bf16 v[228:231], a[56:59], a[100:103], v[228:231]
  ds_read_b64_tr_b16 a[34:35], v12 offset:46336
  v_mfma_f32_16x16x32_bf16 v[160:163], a[60:63], a[88:91], v[160:163]
  v_mfma_f32_16x16x32_bf16 v[164:167], a[60:63], a[92:95], v[164:167]
  v_mfma_f32_16x16x32_bf16 v[232:235], a[60:63], a[96:99], v[232:235]
  buffer_load_dwordx4 v7, s[8:11], s68 offen offset:2048 lds
  v_mfma_f32_16x16x32_bf16 v[236:239], a[60:63], a[100:103], v[236:239]
  v_mfma_f32_16x16x32_bf16 v[168:171], a[64:67], a[88:91], v[168:171]
  v_mfma_f32_16x16x32_bf16 v[172:175], a[64:67], a[92:95], v[172:175]
  v_mfma_f32_16x16x32_bf16 v[240:243], a[64:67], a[96:99], v[240:243]
  buffer_load_dwordx4 v8, s[8:11], s68 offen offset:3072 lds
  v_mfma_f32_16x16x32_bf16 v[244:247], a[64:67], a[100:103], v[244:247]
  s_add_u32 m0, s70, 24576
  v_mfma_f32_16x16x32_bf16 v[176:179], a[68:71], a[88:91], v[176:179]
  v_mfma_f32_16x16x32_bf16 v[180:183], a[68:71], a[92:95], v[180:183]
  v_mfma_f32_16x16x32_bf16 v[248:251], a[68:71], a[96:99], v[248:251]
  buffer_load_dwordx4 v9, s[8:11], s68 offen offset:0 lds
  v_mfma_f32_16x16x32_bf16 v[252:255], a[68:71], a[100:103], v[252:255]
  s_add_u32 s68, s68, 73728
  s_waitcnt vmcnt(18) lgkmcnt(0)
  s_barrier
  v_mfma_f32_16x16x32_bf16 v[112:115], a[0:3], a[104:107], v[112:115]
  ds_read_b64_tr_b16 a[36:37], v13 offset:0
  v_mfma_f32_16x16x32_bf16 v[116:119], a[0:3], a[108:111], v[116:119]
  ds_read_b64_tr_b16 a[38:39], v13 offset:5120
  v_mfma_f32_16x16x32_bf16 v[184:187], a[0:3], a[112:115], v[184:187]
  buffer_load_dwordx4 a[88:91], v10, s[12:15], s69 offen offset:0 sc1
  v_mfma_f32_16x16x32_bf16 v[188:191], a[0:3], a[116:119], v[188:191]
  ds_read_b64_tr_b16 a[40:41], v13 offset:32
  v_mfma_f32_16x16x32_bf16 v[120:123], a[4:7], a[104:107], v[120:123]
  ds_read_b64_tr_b16 a[42:43], v13 offset:5152
  v_mfma_f32_16x16x32_bf16 v[124:127], a[4:7], a[108:111], v[124:127]
  ds_read_b64_tr_b16 a[44:45], v13 offset:64
  v_mfma_f32_16x16x32_bf16 v[192:195], a[4:7], a[112:115], v[192:195]
  buffer_load_dwordx4 a[92:95], v10, s[12:15], s69 offen offset:1024 sc1
  v_mfma_f32_16x16x32_bf16 v[196:199], a[4:7], a[116:119], v[196:199]
  ds_read_b64_tr_b16 a[46:47], v13 offset:5184
  v_mfma_f32_16x16x32_bf16 v[128:131], a[8:11], a[104:107], v[128:131]
  ds_read_b64_tr_b16 a[48:49], v13 offset:96
  v_mfma_f32_16x16x32_bf16 v[132:135], a[8:11], a[108:111], v[132:135]
  ds_read_b64_tr_b16 a[50:51], v13 offset:5216
  v_mfma_f32_16x16x32_bf16 v[200:203], a[8:11], a[112:115], v[200:203]
  buffer_load_dwordx4 a[96:99], v11, s[12:15], s69 offen offset:0 sc1
  v_mfma_f32_16x16x32_bf16 v[204:207], a[8:11], a[116:119], v[204:207]
  ds_read_b64_tr_b16 a[52:53], v13 offset:128
  v_mfma_f32_16x16x32_bf16 v[136:139], a[12:15], a[104:107], v[136:139]
  ds_read_b64_tr_b16 a[54:55], v13 offset:5248
  v_mfma_f32_16x16x32_bf16 v[140:143], a[12:15], a[108:111], v[140:143]
  ds_read_b64_tr_b16 a[56:57], v13 offset:160
  v_mfma_f32_16x16x32_bf16 v[208:211], a[12:15], a[112:115], v[208:211]
  buffer_load_dwordx4 a[100:103], v11, s[12:15], s69 offen offset:1024 sc1
  v_mfma_f32_16x16x32_bf16 v[212:215], a[12:15], a[116:119], v[212:215]
  s_add_u32 s69, s69, 262144
  ds_read_b64_tr_b16 a[58:59], v13 offset:5280
  v_mfma_f32_16x16x32_bf16 v[144:147], a[16:19], a[104:107], v[144:147]
  s_add_u32 m0, s70, 40960
  ds_read_b64_tr_b16 a[60:61], v13 offset:192
  v_mfma_f32_16x16x32_bf16 v[148:151], a[16:19], a[108:111], v[148:151]
  ds_read_b64_tr_b16 a[62:63], v13 offset:5312
  v_mfma_f32_16x16x32_bf16 v[216:219], a[16:19], a[112:115], v[216:219]
  buffer_load_dwordx4 v5, s[8:11], s68 offen offset:0 lds
  v_mfma_f32_16x16x32_bf16 v[220:223], a[16:19], a[116:119], v[220:223]
  ds_read_b64_tr_b16 a[64:65], v13 offset:224
  v_mfma_f32_16x16x32_bf16 v[152:155], a[20:23], a[104:107], v[152:155]
  ds_read_b64_tr_b16 a[66:67], v13 offset:5344
  v_mfma_f32_16x16x32_bf16 v[156:159], a[20:23], a[108:111], v[156:159]
  ds_read_b64_tr_b16 a[68:69], v13 offset:256
  v_mfma_f32_16x16x32_bf16 v[224:227], a[20:23], a[112:115], v[224:227]
  buffer_load_dwordx4 v6, s[8:11], s68 offen offset:1024 lds
  v_mfma_f32_16x16x32_bf16 v[228:231], a[20:23], a[116:119], v[228:231]
  ds_read_b64_tr_b16 a[70:71], v13 offset:5376
  v_mfma_f32_16x16x32_bf16 v[160:163], a[24:27], a[104:107], v[160:163]
  v_mfma_f32_16x16x32_bf16 v[164:167], a[24:27], a[108:111], v[164:167]
  v_mfma_f32_16x16x32_bf16 v[232:235], a[24:27], a[112:115], v[232:235]
  buffer_load_dwordx4 v7, s[8:11], s68 offen offset:2048 lds
  v_mfma_f32_16x16x32_bf16 v[236:239], a[24:27], a[116:119], v[236:239]
  v_mfma_f32_16x16x32_bf16 v[168:171], a[28:31], a[104:107], v[168:171]
  v_mfma_f32_16x16x32_bf16 v[172:175], a[28:31], a[108:111], v[172:175]
  v_mfma_f32_16x16x32_bf16 v[240:243], a[28:31], a[112:115], v[240:243]
  buffer_load_dwordx4 v8, s[8:11], s68 offen offset:3072 lds
  v_mfma_f32_16x16x32_bf16 v[244:247], a[28:31], a[116:119], v[244:247]
  s_add_u32 m0, s70, 45056
  v_mfma_f32_16x16x32_bf16 v[176:179], a[32:35], a[104:107], v[176:179]
  v_mfma_f32_16x16x32_bf16 v[180:183], a[32:35], a[108:111], v[180:183]
  v_mfma_f32_16x16x32_bf16 v[248:251], a[32:35], a[112:115], v[248:251]
  buffer_load_dwordx4 v9, s[8:11], s68 offen offset:0 lds
  v_mfma_f32_16x16x32_bf16 v[252:255], a[32:35], a[116:119], v[252:255]
  s_add_u32 s68, s68, 73728
  s_waitcnt vmcnt(18) lgkmcnt(0)
  s_barrier
  v_mfma_f32_16x16x32_bf16 v[112:115], a[36:39], a[120:123], v[112:115]
  ds_read_b64_tr_b16 a[0:1], v12 offset:0
  v_mfma_f32_16x16x32_bf16 v[116:119], a[36:39], a[124:127], v[116:119]
  ds_read_b64_tr_b16 a[2:3], v12 offset:5120
  v_mfma_f32_16x16x32_bf16 v[184:187], a[36:39], a[128:131], v[184:187]
  buffer_load_dwordx4 a[104:107], v10, s[12:15], s69 offen offset:0 sc1
  v_mfma_f32_16x16x32_bf16 v[188:191], a[36:39], a[132:135], v[188:191]
  ds_read_b64_tr_b16 a[4:5], v12 offset:32
  v_mfma_f32_16x16x32_bf16 v[120:123], a[40:43], a[120:123], v[120:123]
  ds_read_b64_tr_b16 a[6:7], v12 offset:5152
  v_mfma_f32_16x16x32_bf16 v[124:127], a[40:43], a[124:127], v[124:127]
  ds_read_b64_tr_b16 a[8:9], v12 offset:64
  v_mfma_f32_16x16x32_bf16 v[192:195], a[40:43], a[128:131], v[192:195]
  buffer_load_dwordx4 a[108:111], v10, s[12:15], s69 offen offset:1024 sc1
  v_mfma_f32_16x16x32_bf16 v[196:199], a[40:43], a[132:135], v[196:199]
  ds_read_b64_tr_b16 a[10:11], v12 offset:5184
  v_mfma_f32_16x16x32_bf16 v[128:131], a[44:47], a[120:123], v[128:131]
  ds_read_b64_tr_b16 a[12:13], v12 offset:96
  v_mfma_f32_16x16x32_bf16 v[132:135], a[44:47], a[124:127], v[132:135]
  ds_read_b64_tr_b16 a[14:15], v12 offset:5216
  v_mfma_f32_16x16x32_bf16 v[200:203], a[44:47], a[128:131], v[200:203]
  buffer_load_dwordx4 a[112:115], v11, s[12:15], s69 offen offset:0 sc1
  v_mfma_f32_16x16x32_bf16 v[204:207], a[44:47], a[132:135], v[204:207]
  ds_read_b64_tr_b16 a[16:17], v12 offset:128
  v_mfma_f32_16x16x32_bf16 v[136:139], a[48:51], a[120:123], v[136:139]
  ds_read_b64_tr_b16 a[18:19], v12 offset:5248
  v_mfma_f32_16x16x32_bf16 v[140:143], a[48:51], a[124:127], v[140:143]
  ds_read_b64_tr_b16 a[20:21], v12 offset:160
  v_mfma_f32_16x16x32_bf16 v[208:211], a[48:51], a[128:131], v[208:211]
  buffer_load_dwordx4 a[116:119], v11, s[12:15], s69 offen offset:1024 sc1
  v_mfma_f32_16x16x32_bf16 v[212:215], a[48:51], a[132:135], v[212:215]
  s_add_u32 s69, s69, 262144
  ds_read_b64_tr_b16 a[22:23], v12 offset:5280
  v_mfma_f32_16x16x32_bf16 v[144:147], a[52:55], a[120:123], v[144:147]
  s_add_u32 m0, s70, 61440
  ds_read_b64_tr_b16 a[24:25], v12 offset:192
  v_mfma_f32_16x16x32_bf16 v[148:151], a[52:55], a[124:127], v[148:151]
  ds_read_b64_tr_b16 a[26:27], v12 offset:5312
  v_mfma_f32_16x16x32_bf16 v[216:219], a[52:55], a[128:131], v[216:219]
  buffer_load_dwordx4 v5, s[8:11], s68 offen offset:0 lds
  v_mfma_f32_16x16x32_bf16 v[220:223], a[52:55], a[132:135], v[220:223]
  ds_read_b64_tr_b16 a[28:29], v12 offset:224
  v_mfma_f32_16x16x32_bf16 v[152:155], a[56:59], a[120:123], v[152:155]
  ds_read_b64_tr_b16 a[30:31], v12 offset:5344
  v_mfma_f32_16x16x32_bf16 v[156:159], a[56:59], a[124:127], v[156:159]
  ds_read_b64_tr_b16 a[32:33], v12 offset:256
  v_mfma_f32_16x16x32_bf16 v[224:227], a[56:59], a[128:131], v[224:227]
  buffer_load_dwordx4 v6, s[8:11], s68 offen offset:1024 lds
  v_mfma_f32_16x16x32_bf16 v[228:231], a[56:59], a[132:135], v[228:231]
  ds_read_b64_tr_b16 a[34:35], v12 offset:5376
  v_mfma_f32_16x16x32_bf16 v[160:163], a[60:63], a[120:123], v[160:163]
  v_mfma_f32_16x16x32_bf16 v[164:167], a[60:63], a[124:127], v[164:167]
  v_mfma_f32_16x16x32_bf16 v[232:235], a[60:63], a[128:131], v[232:235]
  buffer_load_dwordx4 v7, s[8:11], s68 offen offset:2048 lds
  v_mfma_f32_16x16x32_bf16 v[236:239], a[60:63], a[132:135], v[236:239]
  v_mfma_f32_16x16x32_bf16 v[168:171], a[64:67], a[120:123], v[168:171]
  s_sub_u32 s72, s72, 1
  v_mfma_f32_16x16x32_bf16 v[172:175], a[64:67], a[124:127], v[172:175]
  v_mfma_f32_16x16x32_bf16 v[240:243], a[64:67], a[128:131], v[240:243]
  buffer_load_dwordx4 v8, s[8:11], s68 offen offset:3072 lds
  v_mfma_f32_16x16x32_bf16 v[244:247], a[64:67], a[132:135], v[244:247]
  s_add_u32 m0, s70, 65536
  v_mfma_f32_16x16x32_bf16 v[176:179], a[68:71], a[120:123], v[176:179]
  v_mfma_f32_16x16x32_bf16 v[180:183], a[68:71], a[124:127], v[180:183]
  v_mfma_f32_16x16x32_bf16 v[248:251], a[68:71], a[128:131], v[248:251]
  buffer_load_dwordx4 v9, s[8:11], s68 offen offset:0 lds
  v_mfma_f32_16x16x32_bf16 v[252:255], a[68:71], a[132:135], v[252:255]
  s_add_u32 s68, s68, 73728
  s_waitcnt vmcnt(18) lgkmcnt(0)
  s_barrier
  s_cmp_lg_u32 s72, 0
  s_cbranch_scc1 L_loopA
L_tailA:
  v_mfma_f32_16x16x32_bf16 v[184:187], a[0:3], a[80:83], v[184:187]
  ds_read_b64_tr_b16 a[36:37], v12 offset:20480
  v_mfma_f32_16x16x32_bf16 v[188:191], a[0:3], a[84:87], v[188:191]
  ds_read_b64_tr_b16 a[38:39], v12 offset:25600
  buffer_load_dwordx4 a[120:123], v10, s[12:15], s69 offen offset:0 sc1
  v_mfma_f32_16x16x32_bf16 v[192:195], a[4:7], a[80:83], v[192:195]
  ds_read_b64_tr_b16 a[40:41], v12 offset:20512
  v_mfma_f32_16x16x32_bf16 v[196:199], a[4:7], a[84:87], v[196:199]
  ds_read_b64_tr_b16 a[42:43], v12 offset:25632
  v_mfma_f32_16x16x32_bf16 v[200:203], a[8:11], a[80:83], v[200:203]
  ds_read_b64_tr_b16 a[44:45], v12 offset:20544
  v_mfma_f32_16x16x32_bf16 v[204:207], a[8:11], a[84:87], v[204:207]
  ds_read_b64_tr_b16 a[46:47], v12 offset:25664
  buffer_load_dwordx4 a[124:127], v10, s[12:15], s69 offen offset:1024 sc1
  v_mfma_f32_16x16x32_bf16 v[208:211], a[12:15], a[80:83], v[208:211]
  ds_read_b64_tr_b16 a[48:49], v12 offset:20576
  v_mfma_f32_16x16x32_bf16 v[212:215], a[12:15], a[84:87], v[212:215]
  ds_read_b64_tr_b16 a[50:51], v12 offset:25696
  v_mfma_f32_16x16x32_bf16 v[216:219], a[16:19], a[80:83], v[216:219]
  ds_read_b64_tr_b16 a[52:53], v12 offset:20608
  v_mfma_f32_16x16x32_bf16 v[220:223], a[16:19], a[84:87], v[220:223]
  ds_read_b64_tr_b16 a[54:55], v12 offset:25728
  buffer_load_dwordx4 a[128:131], v11, s[12:15], s69 offen offset:0 sc1
  v_mfma_f32_16x16x32_bf16 v[224:227], a[20:23], a[80:83], v[224:227]
  ds_read_b64_tr_b16 a[56:57], v12 offset:20640
  v_mfma_f32_16x16x32_bf16 v[228:231], a[20:23], a[84:87], v[228:231]
  ds_read_b64_tr_b16 a[58:59], v12 offset:25760
  v_mfma_f32_16x16x32_bf16 v[232:235], a[24:27], a[80:83], v[232:235]
  ds_read_b64_tr_b16 a[60:61], v12 offset:20672
  v_mfma_f32_16x16x32_bf16 v[236:239], a[24:27], a[84:87], v[236:239]
  ds_read_b64_tr_b16 a[62:63], v12 offset:25792
  buffer_load_dwordx4 a[132:135], v11, s[12:15], s69 offen offset:1024 sc1
  v_mfma_f32_16x16x32_bf16 v[240:243], a[28:31], a[80:83], v[240:243]
  ds_read_b64_tr_b16 a[64:65], v12 offset:20704
  v_mfma_f32_16x16x32_bf16 v[244:247], a[28:31], a[84:87], v[244:247]
  ds_read_b64_tr_b16 a[66:67], v12 offset:25824
  v_mfma_f32_16x16x32_bf16 v[248:251], a[32:35], a[80:83], v[248:251]
  s_waitcnt vmcnt(13)
  s_barrier
  ds_read_b64_tr_b16 a[68:69], v12 offset:20736
  v_mfma_f32_16x16x32_bf16 v[252:255], a[32:35], a[84:87], v[252:255]
  s_waitcnt lgkmcnt(15)
  ds_read_b64_tr_b16 a[70:71], v12 offset:25856
  v_mfma_f32_16x16x32_bf16 v[184:187], a[36:39], a[96:99], v[184:187]
  ds_read_b64_tr_b16 a[136:137], v12 offset:40960
  v_mfma_f32_16x16x32_bf16 v[188:191], a[36:39], a[100:103], v[188:191]
  s_waitcnt lgkmcnt(15)
  ds_read_b64_tr_b16 a[138:139], v12 offset:46080
  v_mfma_f32_16x16x32_bf16 v[192:195], a[40:43], a[96:99], v[192:195]
  ds_read_b64_tr_b16 a[140:141], v12 offset:40992
  v_mfma_f32_16x16x32_bf16 v[196:199], a[40:43], a[100:103], v[196:199]
  s_waitcnt lgkmcnt(15)
  ds_read_b64_tr_b16 a[142:143], v12 offset:46112
  v_mfma_f32_16x16x32_bf16 v[200:203], a[44:47], a[96:99], v[200:203]
  ds_read_b64_tr_b16 a[144:145], v12 offset:41024
  v_mfma_f32_16x16x32_bf16 v[204:207], a[44:47], a[100:103], v[204:207]
  s_waitcnt lgkmcnt(15)
  ds_read_b64_tr_b16 a[146:147], v12 offset:46144
  v_mfma_f32_16x16x32_bf16 v[208:211], a[48:51], a[96:99], v[208:211]
  ds_read_b64_tr_b16 a[148:149], v12 offset:41056
  v_mfma_f32_16x16x32_bf16 v[212:215], a[48:51], a[100:103], v[212:215]
  s_waitcnt lgkmcnt(15)
  ds_read_b64_tr_b16 a[150:151], v12 offset:46176
  v_mfma_f32_16x16x32_bf16 v[216:219], a[52:55], a[96:99], v[216:219]
  ds_read_b64_tr_b16 a[152:153], v12 offset:41088
  v_mfma_f32_16x16x32_bf16 v[220:223], a[52:55], a[100:103], v[220:223]
  s_waitcnt lgkmcnt(15)
  ds_read_b64_tr_b16 a[154:155], v12 offset:46208
  v_mfma_f32_16x16x32_bf16 v[224:227], a[56:59], a[96:99], v[224:227]
  ds_read_b64_tr_b16 a[156:157], v12 offset:41120
  v_mfma_f32_16x16x32_bf16 v[228:231], a[56:59], a[100:103], v[228:231]
  s_waitcnt lgkmcnt(15)
  ds_read_b64_tr_b16 a[158:159], v12 offset:46240
  v_mfma_f32_16x16x32_bf16 v[232:235], a[60:63], a[96:99], v[232:235]
  ds_read_b64_tr_b16 a[160:161], v12 offset:41152
  v_mfma_f32_16x16x32_bf16 v[236:239], a[60:63], a[100:103], v[236:239]
  s_waitcnt lgkmcnt(15)
  ds_read_b64_tr_b16 a[162:163], v12 offset:46272
  v_mfma_f32_16x16x32_bf16 v[240:243], a[64:67], a[96:99], v[240:243]
  ds_read_b64_tr_b16 a[164:165], v12 offset:41184
  v_mfma_f32_16x16x32_bf16 v[244:247], a[64:67], a[100:103], v[244:247]
  s_waitcnt lgkmcnt(15)
  ds_read_b64_tr_b16 a[166:167], v12 offset:46304
  v_mfma_f32_16x16x32_bf16 v[248:251], a[68:71], a[96:99], v[248:251]
  s_waitcnt vmcnt(4)
  s_barrier
  ds_read_b64_tr_b16 a[168:169], v12 offset:41216
  v_mfma_f32_16x16x32_bf16 v[252:255], a[68:71], a[100:103], v[252:255]
  s_waitcnt lgkmcnt(15)
  ds_read_b64_tr_b16 a[170:171], v12 offset:46336
  v_mfma_f32_16x16x32_bf16 v[184:187], a[136:139], a[112:115], v[184:187]
  ds_read_b64_tr_b16 a[172:173], v13 offset:0
  v_mfma_f32_16x16x32_bf16 v[188:191], a[136:139], a[116:119], v[188:191]
  s_waitcnt lgkmcnt(15)
  ds_read_b64_tr_b16 a[174:175], v13 offset:5120
  v_mfma_f32_16x16x32_bf16 v[192:195], a[140:143], a[112:115], v[192:195]
  ds_read_b64_tr_b16 a[176:177], v13 offset:32
  v_mfma_f32_16x16x32_bf16 v[196:199], a[140:143], a[116:119], v[196:199]
  s_waitcnt lgkmcnt(15)
  ds_read_b64_tr_b16 a[178:179], v13 offset:5152
  v_mfma_f32_16x16x32_bf16 v[200:203], a[144:147], a[112:115], v[200:203]
  ds_read_b64_tr_b16 a[180:181], v13 offset:64
  v_mfma_f32_16x16x32_bf16 v[204:207], a[144:147], a[116:119], v[204:207]
  s_waitcnt lgkmcnt(15)
  ds_read_b64_tr_b16 a[182:183], v13 offset:5184
  v_mfma_f32_16x16x32_bf16 v[208:211], a[148:151], a[112:115], v[208:211]
  ds_read_b64_tr_b16 a[184:185], v13 offset:96
  v_mfma_f32_16x16x32_bf16 v[212:215], a[148:151], a[116:119], v[212:215]
  s_waitcnt lgkmcnt(15)
  ds_read_b64_tr_b16 a[186:187], v13 offset:5216
  v_mfma_f32_16x16x32_bf16 v[216:219], a[152:155], a[112:115], v[216:219]
  ds_read_b64_tr_b16 a[188:189], v13 offset:128
  v_mfma_f32_16x16x32_bf16 v[220:223], a[152:155], a[116:119], v[220:223]
  s_waitcnt lgkmcnt(15)
  ds_read_b64_tr_b16 a[190:191], v13 offset:5248
  v_mfma_f32_16x16x32_bf16 v[224:227], a[156:159], a[112:115], v[224:227]
  ds_read_b64_tr_b16 a[192:193], v13 offset:160
  v_mfma_f32_16x16x32_bf16 v[228:231], a[156:159], a[116:119], v[228:231]
  s_waitcnt lgkmcnt(15)
  ds_read_b64_tr_b16 a[194:195], v13 offset:5280
  v_mfma_f32_16x16x32_bf16 v[232:235], a[160:163], a[112:115], v[232:235]
  ds_read_b64_tr_b16 a[196:197], v13 offset:192
  v_mfma_f32_16x16x32_bf16 v[236:239], a[160:163], a[116:119], v[236:239]
  s_waitcnt lgkmcnt(15)
  ds_read_b64_tr_b16 a[198:199], v13 offset:5312
  v_mfma_f32_16x16x32_bf16 v[240:243], a[164:167], a[112:115], v[240:243]
  ds_read_b64_tr_b16 a[200:201], v13 offset:224
  v_mfma_f32_16x16x32_bf16 v[244:247], a[164:167], a[116:119], v[244:247]
  s_waitcnt lgkmcnt(15)
  ds_read_b64_tr_b16 a[202:203], v13 offset:5344
  v_mfma_f32_16x16x32_bf16 v[248:251], a[168:171], a[112:115], v[248:251]
  ds_read_b64_tr_b16 a[204:205], v13 offset:256
  v_mfma_f32_16x16x32_bf16 v[252:255], a[168:171], a[116:119], v[252:255]
  s_waitcnt vmcnt(0) lgkmcnt(15)
  ds_read_b64_tr_b16 a[206:207], v13 offset:5376
  v_mfma_f32_16x16x32_bf16 v[184:187], a[172:175], a[128:131], v[184:187]
  v_mfma_f32_16x16x32_bf16 v[188:191], a[172:175], a[132:135], v[188:191]
  s_waitcnt lgkmcnt(14)
  v_mfma_f32_16x16x32_bf16 v[192:195], a[176:179], a[128:131], v[192:195]
  v_mfma_f32_16x16x32_bf16 v[196:199], a[176:179], a[132:135], v[196:199]
  s_waitcnt lgkmcnt(12)
  v_mfma_f32_16x16x32_bf16 v[200:203], a[180:183], a[128:131], v[200:203]
  v_mfma_f32_16x16x32_bf16 v[204:207], a[180:183], a[132:135], v[204:207]
  s_waitcnt lgkmcnt(10)
  v_mfma_f32_16x16x32_bf16 v[208:211], a[184:187], a[128:131], v[208:211]
  v_mfma_f32_16x16x32_bf16 v[212:215], a[184:187], a[132:135], v[212:215]
  s_waitcnt lgkmcnt(8)
  v_mfma_f32_16x16x32_bf16 v[216:219], a[188:191], a[128:131], v[216:219]
  s_waitcnt lgkmcnt(0)
  s_barrier
  v_mfma_f32_16x16x32_bf16 v[220:223], a[188:191], a[132:135], v[220:223]
  ds_write_b128 v32, v[184:187] offset:0
  v_mfma_f32_16x16x32_bf16 v[224:227], a[192:195], a[128:131], v[224:227]
  v_mfma_f32_16x16x32_bf16 v[228:231], a[192:195], a[132:135], v[228:231]
  v_mfma_f32_16x16x32_bf16 v[232:235], a[196:199], a[128:131], v[232:235]
  ds_write_b128 v32, v[188:191] offset:1024
  v_mfma_f32_16x16x32_bf16 v[236:239], a[196:199], a[132:135], v[236:239]
  v_mfma_f32_16x16x32_bf16 v[240:243], a[200:203], a[128:131], v[240:243]
  v_mfma_f32_16x16x32_bf16 v[244:247], a[200:203], a[132:135], v[244:247]
  ds_write_b128 v32, v[192:195] offset:2048
  v_mfma_f32_16x16x32_bf16 v[248:251], a[204:207], a[128:131], v[248:251]
  v_mfma_f32_16x16x32_bf16 v[252:255], a[204:207], a[132:135], v[252:255]
  v_mfma_f32_16x16x32_bf16 v[112:115], a[0:3], a[72:75], v[112:115]
  v_mfma_f32_16x16x32_bf16 v[116:119], a[0:3], a[76:79], v[116:119]
  ds_write_b128 v32, v[196:199] offset:3072
  v_mfma_f32_16x16x32_bf16 v[112:115], a[36:39], a[88:91], v[112:115]
  v_mfma_f32_16x16x32_bf16 v[116:119], a[36:39], a[92:95], v[116:119]
  v_mfma_f32_16x16x32_bf16 v[112:115], a[136:139], a[104:107], v[112:115]
  ds_write_b128 v32, v[200:203] offset:4096
  v_mfma_f32_16x16x32_bf16 v[116:119], a[136:139], a[108:111], v[116:119]
  v_mfma_f32_16x16x32_bf16 v[112:115], a[172:175], a[120:123], v[112:115]
  buffer_load_dwordx2 v[18:19], v30, s[20:23], s35 offen offset:0
  v_mfma_f32_16x16x32_bf16 v[116:119], a[172:175], a[124:127], v[116:119]
  ds_write_b128 v32, v[204:207] offset:5120
  v_mfma_f32_16x16x32_bf16 v[120:123], a[4:7], a[72:75], v[120:123]
  v_mfma_f32_16x16x32_bf16 v[124:127], a[4:7], a[76:79], v[124:127]
  v_mfma_f32_16x16x32_bf16 v[120:123], a[40:43], a[88:91], v[120:123]
  buffer_load_dwordx2 v[20:21], v31, s[20:23], s35 offen offset:0
  v_mfma_f32_16x16x32_bf16 v[124:127], a[40:43], a[92:95], v[124:127]
  ds_write_b128 v32, v[208:211] offset:6144
  v_mfma_f32_16x16x32_bf16 v[120:123], a[140:143], a[104:107], v[120:123]
  v_mfma_f32_16x16x32_bf16 v[124:127], a[140:143], a[108:111], v[124:127]
  v_mfma_f32_16x16x32_bf16 v[120:123], a[176:179], a[120:123], v[120:123]
  ds_write_b128 v32, v[212:215] offset:7168
  v_mfma_f32_16x16x32_bf16 v[124:127], a[176:179], a[124:127], v[124:127]
  v_mfma_f32_16x16x32_bf16 v[128:131], a[8:11], a[72:75], v[128:131]
  buffer_load_dwordx2 v[22:23], v30, s[20:23], s35 offen offset:128
  v_mfma_f32_16x16x32_bf16 v[132:135], a[8:11], a[76:79], v[132:135]
  ds_write_b128 v32, v[216:219] offset:8192
  v_mfma_f32_16x16x32_bf16 v[128:131], a[44:47], a[88:91], v[128:131]
  v_mfma_f32_16x16x32_bf16 v[132:135], a[44:47], a[92:95], v[132:135]
  v_mfma_f32_16x16x32_bf16 v[128:131], a[144:147], a[104:107], v[128:131]
  buffer_load_dwordx2 v[24:25], v31, s[20:23], s35 offen offset:128
  v_mfma_f32_16x16x32_bf16 v[132:135], a[144:147], a[108:111], v[132:135]
  ds_write_b128 v32, v[220:223] offset:9216
  v_mfma_f32_16x16x32_bf16 v[128:131], a[180:183], a[120:123], v[128:131]
  v_mfma_f32_16x16x32_bf16 v[132:135], a[180:183], a[124:127], v[132:135]
  v_mfma_f32_16x16x32_bf16 v[136:139], a[12:15], a[72:75], v[136:139]
  ds_write_b128 v32, v[224:227] offset:10240
  v_mfma_f32_16x16x32_bf16 v[140:143], a[12:15], a[76:79], v[140:143]
  v_mfma_f32_16x16x32_bf16 v[136:139], a[48:51], a[88:91], v[136:139]
  buffer_load_dwordx2 v[26:27], v30, s[20:23], s35 offen offset:256
  v_mfma_f32_16x16x32_bf16 v[140:143], a[48:51], a[92:95], v[140:143]
  ds_write_b128 v32, v[228:231] offset:11264
  v_mfma_f32_16x16x32_bf16 v[136:139], a[148:151], a[104:107], v[136:139]
  v_mfma_f32_16x16x32_bf16 v[140:143], a[148:151], a[108:111], v[140:143]
  v_mfma_f32_16x16x32_bf16 v[136:139], a[184:187], a[120:123], v[136:139]
  buffer_load_dwordx2 v[28:29], v31, s[20:23], s35 offen offset:256
  v_mfma_f32_16x16x32_bf16 v[140:143], a[184:187], a[124:127], v[140:143]
  ds_write_b128 v32, v[232:235] offset:12288
  v_mfma_f32_16x16x32_bf16 v[144:147], a[16:19], a[72:75], v[144:147]
  v_mfma_f32_16x16x32_bf16 v[148:151], a[16:19], a[76:79], v[148:151]
  v_mfma_f32_16x16x32_bf16 v[144:147], a[52:55], a[88:91], v[144:147]
  ds_write_b128 v32, v[236:239] offset:13312
  v_mfma_f32_16x16x32_bf16 v[148:151], a[52:55], a[92:95], v[148:151]
  v_mfma_f32_16x16x32_bf16 v[144:147], a[152:155], a[104:107], v[144:147]
  v_mfma_f32_16x16x32_bf16 v[148:151], a[152:155], a[108:111], v[148:151]
  ds_write_b128 v32, v[240:243] offset:14336
  v_mfma_f32_16x16x32_bf16 v[144:147], a[188:191], a[120:123], v[144:147]
  v_mfma_f32_16x16x32_bf16 v[148:151], a[188:191], a[124:127], v[148:151]
  v_mfma_f32_16x16x32_bf16 v[152:155], a[20:23], a[72:75], v[152:155]
  v_mfma_f32_16x16x32_bf16 v[156:159], a[20:23], a[76:79], v[156:159]
  ds_write_b128 v32, v[244:247] offset:15360
  v_mfma_f32_16x16x32_bf16 v[152:155], a[56:59], a[88:91], v[152:155]
  v_mfma_f32_16x16x32_bf16 v[156:159], a[56:59], a[92:95], v[156:159]
  v_mfma_f32_16x16x32_bf16 v[152:155], a[156:159], a[104:107], v[152:155]
  ds_write_b128 v32, v[248:251] offset:16384
  v_mfma_f32_16x16x32_bf16 v[156:159], a[156:159], a[108:111], v[156:159]
  v_mfma_f32_16x16x32_bf16 v[152:155], a[192:195], a[120:123], v[152:155]
  v_mfma_f32_16x16x32_bf16 v[156:159], a[192:195], a[124:127], v[156:159]
  ds_write_b128 v32, v[252:255] offset:17408
  v_mfma_f32_16x16x32_bf16 v[160:163], a[24:27], a[72:75], v[160:163]
  v_mfma_f32_16x16x32_bf16 v[164:167], a[24:27], a[76:79], v[164:167]
  v_mfma_f32_16x16x32_bf16 v[160:163], a[60:63], a[88:91], v[160:163]
  v_mfma_f32_16x16x32_bf16 v[164:167], a[60:63], a[92:95], v[164:167]
  s_waitcnt lgkmcnt(0)
  s_barrier
  v_mfma_f32_16x16x32_bf16 v[160:163], a[160:163], a[104:107], v[160:163]
  ds_read_b128 v[40:43], v33 offset:0
  v_mfma_f32_16x16x32_bf16 v[164:167], a[160:163], a[108:111], v[164:167]
  ds_read_b128 v[44:47], v33 offset:1024
  v_mfma_f32_16x16x32_bf16 v[160:163], a[196:199], a[120:123], v[160:163]
  ds_read_b128 v[48:51], v33 offset:2048
  v_mfma_f32_16x16x32_bf16 v[164:167], a[196:199], a[124:127], v[164:167]
  ds_read_b128 v[52:55], v33 offset:3072
  v_mfma_f32_16x16x32_bf16 v[168:171], a[28:31], a[72:75], v[168:171]
  ds_read_b128 v[56:59], v33 offset:4096
  v_mfma_f32_16x16x32_bf16 v[172:175], a[28:31], a[76:79], v[172:175]
  ds_read_b128 v[60:63], v33 offset:5120
  v_mfma_f32_16x16x32_bf16 v[168:171], a[64:67], a[88:91], v[168:171]
  ds_read_b128 v[64:67], v33 offset:6144
  v_mfma_f32_16x16x32_bf16 v[172:175], a[64:67], a[92:95], v[172:175]
  ds_read_b128 v[68:71], v33 offset:7168
  v_mfma_f32_16x16x32_bf16 v[168:171], a[164:167], a[104:107], v[168:171]
  ds_read_b128 v[72:75], v33 offset:8192
  v_mfma_f32_16x16x32_bf16 v[172:175], a[164:167], a[108:111], v[172:175]
  ds_read_b128 v[76:79], v33 offset:9216
  v_mfma_f32_16x16x32_bf16 v[168:171], a[200:203], a[120:123], v[168:171]
  ds_read_b128 v[80:83], v33 offset:10240
  v_mfma_f32_16x16x32_bf16 v[172:175], a[200:203], a[124:127], v[172:175]
  ds_read_b128 v[84:87], v33 offset:11264
  v_mfma_f32_16x16x32_bf16 v[176:179], a[32:35], a[72:75], v[176:179]
  ds_read_b128 v[88:91], v33 offset:12288
  v_mfma_f32_16x16x32_bf16 v[180:183], a[32:35], a[76:79], v[180:183]
  ds_read_b128 v[92:95], v33 offset:13312
  v_mfma_f32_16x16x32_bf16 v[176:179], a[68:71], a[88:91], v[176:179]
  ds_read_b128 v[96:99], v33 offset:14336
  v_mfma_f32_16x16x32_bf16 v[180:183], a[68:71], a[92:95], v[180:183]
  ds_read_b128 v[100:103], v33 offset:15360
  v_mfma_f32_16x16x32_bf16 v[176:179], a[168:171], a[104:107], v[176:179]
  ds_read_b128 v[104:107], v33 offset:16384
  v_mfma_f32_16x16x32_bf16 v[180:183], a[168:171], a[108:111], v[180:183]
  ds_read_b128 v[108:111], v33 offset:17408
  v_mfma_f32_16x16x32_bf16 v[176:179], a[204:207], a[120:123], v[176:179]
  v_mfma_f32_16x16x32_bf16 v[180:183], a[204:207], a[124:127], v[180:183]
  s_branch L_epi
L_roleB:
  s_and_b32 s6, s29, 1
  s_mul_i32 s3, s6, 72
  s_mov_b32 s72, 8
  s_add_u32 s3, s3, s33
  s_mul_i32 s70, s33, 10240
  s_mul_i32 s4, s32, 5120
  s_add_u32 s70, s70, s4
  s_add_u32 s8, s60, 21626880
  s_addc_u32 s9, s61, 0
  s_mov_b32 s10, 5308416
  s_mov_b32 s11, 0x20000
  s_mov_b32 s12, s52
  s_mov_b32 s13, s53
  s_mov_b32 s14, 18874368
  s_mov_b32 s15, 0x20000
  s_mul_i32 s4, s3, 36
  s_mul_i32 s5, s31, 9
  s_add_u32 s4, s4, s5
  s_mul_i32 s5, s32, 5
  s_add_u32 s4, s4, s5
  s_lshl_b32 s68, s4, 10
  s_lshl_b32 s69, s3, 17
  s_lshl_b32 s4, s30, 8
  s_add_u32 s69, s69, s4
  s_lshl_b32 s4, s32, 7
  s_add_u32 s69, s69, s4
  v_lshrrev_b32 v34, 3, v1
  v_and_b32 v35, 6, v34
  v_and_b32 v36, 7, v1
  v_xor_b32 v35, v35, v36
  v_lshlrev_b32 v35, 4, v35
  v_lshl_add_u32 v10, v34, 12, v35
  v_add_u32 v11, 31744, v10
  s_lshl_b32 s71, s28, 12
  s_add_u32 s71, s71, 81920
  s_barrier
  s_add_u32 m0, s71, 0
  s_nop 0
  buffer_load_dwordx4 v10, s[12:15], s69 offen offset:0 lds
  buffer_load_dwordx4 v11, s[12:15], s69 offen offset:1024 lds
  s_add_u32 s69, s69, 63488
  buffer_load_dwordx4 v10, s[12:15], s69 offen offset:2048 lds
  buffer_load_dwordx4 v11, s[12:15], s69 offen offset:3072 lds
  s_add_u32 s69, s69, 198656
  s_mov_b32 s5, 2130706176
  s_cmp_eq_u32 s32, 0
  s_cselect_b32 s4, 4096, s5
  v_add_u32 v6, s4, v4
  s_mul_i32 s4, s33, 10240
  v_add_u32 v12, s4, v4
  v_add_u32 v13, 61440, v12
  v_lshrrev_b32 v34, 2, v1
  v_bfe_u32 v35, v34, 1, 2
  s_lshl_b32 s4, s33, 1
  v_xor_b32 v35, s4, v35
  v_lshlrev_b32 v35, 5, v35
  v_lshl_add_u32 v35, v34, 7, v35
  v_and_b32 v36, 3, v1
  v_lshl_add_u32 v35, v36, 3, v35
  v_add_u32 v35, s71, v35
  v_xor_b32 v14, 0, v35
  v_xor_b32 v15, 32, v35
  v_xor_b32 v16, 64, v35
  v_xor_b32 v17, 96, v35
  s_mov_b32 s16, s54
  s_mov_b32 s17, s55
  s_mov_b32 s18, 4096
  s_mov_b32 s19, 0x20000
  s_lshl_b32 s4, s33, 2
  s_or_b32 s4, s4, s29
  s_cmp_eq_u32 s4, 2
  s_cselect_b32 s18, s18, 0
  s_lshl_b32 s4, s30, 8
  s_lshl_b32 s5, s32, 7
  s_add_u32 s4, s4, s5
  v_and_b32 v28, 15, v1
  v_lshlrev_b32 v28, 1, v28
  buffer_load_ushort v24, v28, s[16:19], s4 offen offset:0
  buffer_load_ushort v25, v28, s[16:19], s4 offen offset:32
  buffer_load_ushort v26, v28, s[16:19], s4 offen offset:64
  buffer_load_ushort v27, v28, s[16:19], s4 offen offset:96
  s_mul_i32 s3, s31, 144
  v_bfe_u32 v34, v1, 4, 1
  v_mul_u32_u24 v34, 143, v34
  v_add_u32 v34, s3, v34
  v_mul_u32_u24 v34, 1366, v34
  v_lshrrev_b32 v34, 18, v34
  v_and_b32 v35, 15, v1
  v_min_u32 v35, 11, v35
  v_mul_u32_u24 v36, 43, v35
  v_lshrrev_b32 v36, 7, v36
  v_mul_u32_u24 v37, 3, v36
  v_sub_u32 v35, v35, v37
  v_mad_u32_u24 v34, v35, 3, v34
  v_add_u32 v34, 22, v34
  v_lshl_add_u32 v34, v34, 3, v36
  s_lshl_b32 s3, s6, 2
  v_add_u32 v34, s3, v34
  v_lshlrev_b32 v38, 7, v34
  v_add_u32 v38, 36864, v38
  s_mov_b32 s20, s36
  s_mov_b32 s21, s37
  s_mov_b32 s22, 2359296
  s_mov_b32 s23, 0x20000
  s_mov_b32 s24, s56
  s_mov_b32 s25, s57
  s_mov_b32 s26, 2359296
  s_mov_b32 s27, 0x20000
  s_lshl_b32 s3, s32, 1
  s_add_u32 s3, s3, s33
  s_cmp_eq_u32 s3, s29
  s_cselect_b32 s79, 1, 0
  s_lshl_b32 s5, s34, 2
  s_add_u32 s3, s3, s5
  s_lshl_b32 s4, s3, 7
  s_lshl_b32 s6, s29, 2
  s_add_u32 s77, s4, s6
  s_add_u32 s77, s77, 69632
  s_lshl_b32 s3, s3, 2
  s_add_u32 s3, s3, s29
  s_mul_i32 s75, s3, 9216
  s_add_u32 s5, s5, s29
  s_lshl_b32 s78, s5, 7
  s_add_u32 s78, s78, 69632
  s_mul_i32 s5, s5, 36864
  s_lshl_b32 s3, s28, 10
  s_add_u32 s76, s5, s3
  s_lshl_b32 s3, s30, 2
  s_add_u32 s3, s3, s29
  s_mul_i32 s3, s3, 36864
  s_mul_i32 s4, s31, 288
  s_add_u32 s3, s3, s4
  s_lshl_b32 s4, s28, 5
  s_add_u32 s35, s3, s4
  v_and_b32 v34, 15, v1
  v_mul_u32_u24 v34, 1152, v34
  v_lshrrev_b32 v35, 4, v1
  v_lshl_add_u32 v30, v35, 3, v34
  v_add_u32 v31, 18432, v30
  s_mul_i32 s3, s28, 18432
  v_add_u32 v32, s3, v4
  s_xor_b32 s4, s28, 2
  s_mul_i32 s3, s4, 18432
  v_add_u32 v33, s3, v4
  s_waitcnt vmcnt(8)
  s_barrier
  s_cmp_lg_u32 s28, 0
  s_cbranch_scc1 L_roleB_nf1
  s_lshl_b32 s3, s2, 7
  s_add_u32 s3, s3, 36864
  v_mov_b32 v2, s100
  v_mov_b32 v3, 0
  s_mov_b64 exec, 1
  buffer_store_dword v2, v3, s[64:67], s3 offen sc1
  s_mov_b64 exec, -1
L_roleB_nf1:
  s_add_u32 m0, s71, 16384
  s_nop 0
  buffer_load_dwordx4 v10, s[12:15], s69 offen offset:0 lds
  buffer_load_dwordx4 v11, s[12:15], s69 offen offset:1024 lds
  s_add_u32 s69, s69, 63488
  buffer_load_dwordx4 v10, s[12:15], s69 offen offset:2048 lds
  buffer_load_dwordx4 v11, s[12:15], s69 offen offset:3072 lds
  s_add_u32 s69, s69, 198656
  s_add_u32 m0, s71, 32768
  s_nop 0
  buffer_load_dwordx4 v10, s[12:15], s69 offen offset:0 lds
  buffer_load_dwordx4 v11, s[12:15], s69 offen offset:1024 lds
  s_add_u32 s69, s69, 63488
  buffer_load_dwordx4 v10, s[12:15], s69 offen offset:2048 lds
  buffer_load_dwordx4 v11, s[12:15], s69 offen offset:3072 lds
  s_add_u32 s69, s69, 198656
  s_waitcnt vmcnt(8)
  v_lshlrev_b32 v40, 16, v24
  v_lshlrev_b32 v42, 16, v25
  v_lshlrev_b32 v44, 16, v26
  v_lshlrev_b32 v46, 16, v27
  v_pk_mov_b32 v[112:113], v[40:41], v[40:41]
  v_pk_mov_b32 v[114:115], v[40:41], v[40:41]
  v_pk_mov_b32 v[116:117], v[42:43], v[42:43]
  v_pk_mov_b32 v[118:119], v[42:43], v[42:43]
  v_pk_mov_b32 v[184:185], v[44:45], v[44:45]
  v_pk_mov_b32 v[186:187], v[44:45], v[44:45]
  v_pk_mov_b32 v[188:189], v[46:47], v[46:47]
  v_pk_mov_b32 v[190:191], v[46:47], v[46:47]
  v_pk_mov_b32 v[120:121], v[40:41], v[40:41]
  v_pk_mov_b32 v[122:123], v[40:41], v[40:41]
  v_pk_mov_b32 v[124:125], v[42:43], v[42:43]
  v_pk_mov_b32 v[126:127], v[42:43], v[42:43]
  v_pk_mov_b32 v[192:193], v[44:45], v[44:45]
  v_pk_mov_b32 v[194:195], v[44:45], v[44:45]
  v_pk_mov_b32 v[196:197], v[46:47], v[46:47]
  v_pk_mov_b32 v[198:199], v[46:47], v[46:47]
  v_pk_mov_b32 v[128:129], v[40:41], v[40:41]
  v_pk_mov_b32 v[130:131], v[40:41], v[40:41]
  v_pk_mov_b32 v[132:133], v[42:43], v[42:43]
  v_pk_mov_b32 v[134:135], v[42:43], v[42:43]
  v_pk_mov_b32 v[200:201], v[44:45], v[44:45]
  v_pk_mov_b32 v[202:203], v[44:45], v[44:45]
  v_pk_mov_b32 v[204:205], v[46:47], v[46:47]
  v_pk_mov_b32 v[206:207], v[46:47], v[46:47]
  v_pk_mov_b32 v[136:137], v[40:41], v[40:41]
  v_pk_mov_b32 v[138:139], v[40:41], v[40:41]
  v_pk_mov_b32 v[140:141], v[42:43], v[42:43]
  v_pk_mov_b32 v[142:143], v[42:43], v[42:43]
  v_pk_mov_b32 v[208:209], v[44:45], v[44:45]
  v_pk_mov_b32 v[210:211], v[44:45], v[44:45]
  v_pk_mov_b32 v[212:213], v[46:47], v[46:47]
  v_pk_mov_b32 v[214:215], v[46:47], v[46:47]
  v_pk_mov_b32 v[144:145], v[40:41], v[40:41]
  v_pk_mov_b32 v[146:147], v[40:41], v[40:41]
  v_pk_mov_b32 v[148:149], v[42:43], v[42:43]
  v_pk_mov_b32 v[150:151], v[42:43], v[42:43]
  v_pk_mov_b32 v[216:217], v[44:45], v[44:45]
  v_pk_mov_b32 v[218:219], v[44:45], v[44:45]
  v_pk_mov_b32 v[220:221], v[46:47], v[46:47]
  v_pk_mov_b32 v[222:223], v[46:47], v[46:47]
  v_pk_mov_b32 v[152:153], v[40:41], v[40:41]
  v_pk_mov_b32 v[154:155], v[40:41], v[40:41]
  v_pk_mov_b32 v[156:157], v[42:43], v[42:43]
  v_pk_mov_b32 v[158:159], v[42:43], v[42:43]
  v_pk_mov_b32 v[224:225], v[44:45], v[44:45]
  v_pk_mov_b32 v[226:227], v[44:45], v[44:45]
  v_pk_mov_b32 v[228:229], v[46:47], v[46:47]
  v_pk_mov_b32 v[230:231], v[46:47], v[46:47]
  v_pk_mov_b32 v[160:161], v[40:41], v[40:41]
  v_pk_mov_b32 v[162:163], v[40:41], v[40:41]
  v_pk_mov_b32 v[164:165], v[42:43], v[42:43]
  v_pk_mov_b32 v[166:167], v[42:43], v[42:43]
  v_pk_mov_b32 v[232:233], v[44:45], v[44:45]
  v_pk_mov_b32 v[234:235], v[44:45], v[44:45]
  v_pk_mov_b32 v[236:237], v[46:47], v[46:47]
  v_pk_mov_b32 v[238:239], v[46:47], v[46:47]
  v_pk_mov_b32 v[168:169], v[40:41], v[40:41]
  v_pk_mov_b32 v[170:171], v[40:41], v[40:41]
  v_pk_mov_b32 v[172:173], v[42:43], v[42:43]
  v_pk_mov_b32 v[174:175], v[42:43], v[42:43]
  v_pk_mov_b32 v[240:241], v[44:45], v[44:45]
  v_pk_mov_b32 v[242:243], v[44:45], v[44:45]
  v_pk_mov_b32 v[244:245], v[46:47], v[46:47]
  v_pk_mov_b32 v[246:247], v[46:47], v[46:47]
  v_pk_mov_b32 v[176:177], v[40:41], v[40:41]
  v_pk_mov_b32 v[178:179], v[40:41], v[40:41]
  v_pk_mov_b32 v[180:181], v[42:43], v[42:43]
  v_pk_mov_b32 v[182:183], v[42:43], v[42:43]
  v_pk_mov_b32 v[248:249], v[44:45], v[44:45]
  v_pk_mov_b32 v[250:251], v[44:45], v[44:45]
  v_pk_mov_b32 v[252:253], v[46:47], v[46:47]
  v_pk_mov_b32 v[254:255], v[46:47], v[46:47]
  s_mov_b32 s7, 0x80000
L_p1B:
  buffer_load_dword v37, v38, s[64:67], 0 offen sc1
L_p1B_chk:
  s_waitcnt vmcnt(0)
  v_cmp_ne_u32 vcc, s100, v37
  s_cbranch_vccz L_p1B_ok
  s_sleep 1
  s_sub_u32 s7, s7, 1
  s_cmp_lg_u32 s7, 0
  s_cbranch_scc1 L_p1B
L_p1B_ok:
  s_add_u32 m0, s70, 0
  s_nop 0
  buffer_load_dwordx4 v4, s[8:11], s68 offen offset:0 sc1 lds
  buffer_load_dwordx4 v4, s[8:11], s68 offen offset:1024 sc1 lds
  buffer_load_dwordx4 v4, s[8:11], s68 offen offset:2048 sc1 lds
  buffer_load_dwordx4 v4, s[8:11], s68 offen offset:3072 sc1 lds
  s_add_u32 m0, s70, 4096
  s_nop 0
  buffer_load_dwordx4 v6, s[8:11], s68 offen offset:0 sc1 lds
  s_add_u32 s68, s68, 73728
  s_add_u32 m0, s70, 20480
  s_nop 0
  buffer_load_dwordx4 v4, s[8:11], s68 offen offset:0 sc1 lds
  buffer_load_dwordx4 v4, s[8:11], s68 offen offset:1024 sc1 lds
  buffer_load_dwordx4 v4, s[8:11], s68 offen offset:2048 sc1 lds
  buffer_load_dwordx4 v4, s[8:11], s68 offen offset:3072 sc1 lds
  s_add_u32 m0, s70, 24576
  s_nop 0
  buffer_load_dwordx4 v6, s[8:11], s68 offen offset:0 sc1 lds
  s_add_u32 s68, s68, 73728
  s_add_u32 s16, s60, 26935296
  s_addc_u32 s17, s61, 0
  s_mov_b32 s18, 18874368
  s_mov_b32 s19, 0x20000
  s_waitcnt vmcnt(5)
  s_barrier
  ds_read_b64_tr_b16 a[72:73], v14 offset:0
  ds_read_b64_tr_b16 a[74:75], v14 offset:2048
  ds_read_b64_tr_b16 a[76:77], v15 offset:0
  ds_read_b64_tr_b16 a[78:79], v15 offset:2048
  ds_read_b64_tr_b16 a[80:81], v16 offset:0
  ds_read_b64_tr_b16 a[82:83], v16 offset:2048
  ds_read_b64_tr_b16 a[84:85], v17 offset:0
  ds_read_b64_tr_b16 a[86:87], v17 offset:2048
  ds_read_b128 a[0:3], v12 offset:0
  ds_read_b128 a[4:7], v12 offset:1024
  ds_read_b128 a[8:11], v12 offset:2048
  ds_read_b128 a[12:15], v12 offset:3072
  ds_read_b128 a[16:19], v12 offset:4096
  ds_read_b128 a[20:23], v12 offset:5120
  ds_read_b128 a[24:27], v12 offset:6144
  ds_read_b128 a[28:31], v12 offset:7168
  ds_read_b128 a[32:35], v12 offset:8192
  s_add_u32 m0, s70, 40960
  s_nop 0
  buffer_load_dwordx4 v4, s[8:11], s68 offen offset:0 sc1 lds
  buffer_load_dwordx4 v4, s[8:11], s68 offen offset:1024 sc1 lds
  buffer_load_dwordx4 v4, s[8:11], s68 offen offset:2048 sc1 lds
  buffer_load_dwordx4 v4, s[8:11], s68 offen offset:3072 sc1 lds
  s_add_u32 m0, s70, 45056
  s_nop 0
  buffer_load_dwordx4 v6, s[8:11], s68 offen offset:0 sc1 lds
  s_add_u32 s68, s68, 73728
  s_add_u32 m0, s71, 49152
  s_nop 0
  buffer_load_dwordx4 v10, s[12:15], s69 offen offset:0 lds
  buffer_load_dwordx4 v11, s[12:15], s69 offen offset:1024 lds
  s_add_u32 s69, s69, 63488
  buffer_load_dwordx4 v10, s[12:15], s69 offen offset:2048 lds
  buffer_load_dwordx4 v11, s[12:15], s69 offen offset:3072 lds
  s_add_u32 s69, s69, 198656
  s_add_u32 m0, s70, 61440
  s_nop 0
  buffer_load_dwordx4 v4, s[8:11], s68 offen offset:0 sc1 lds
  buffer_load_dwordx4 v4, s[8:11], s68 offen offset:1024 sc1 lds
  buffer_load_dwordx4 v4, s[8:11], s68 offen offset:2048 sc1 lds
  buffer_load_dwordx4 v4, s[8:11], s68 offen offset:3072 sc1 lds
  s_add_u32 m0, s70, 65536
  s_nop 0
  buffer_load_dwordx4 v6, s[8:11], s68 offen offset:0 sc1 lds
  s_add_u32 s68, s68, 73728
  s_waitcnt vmcnt(14)
  s_waitcnt lgkmcnt(0)
  s_barrier
  s_getpc_b64 s[92:93]
L_j3B:
  s_add_u32 s92, s92, L_tailB-L_j3B
  s_addc_u32 s93, s93, 0
  s_mov_b32 s94, 16384
  s_mov_b32 s95, 0x20000
  s_lshr_b32 s3, s2, 3
  s_lshl_b32 s3, s3, 2
  s_add_u32 s3, s3, s28
  s_lshl_b32 s3, s3, 7
  v_mov_b32 v36, s3
  .p2align 6
L_loopB:
  v_mfma_f32_16x16x32_bf16 v[112:115], a[0:3], a[72:75], v[112:115]
  s_add_u32 m0, s71, 0
  ds_read_b64_tr_b16 a[88:89], v14 offset:16384
  v_mfma_f32_16x16x32_bf16 v[116:119], a[0:3], a[76:79], v[116:119]
  ds_read_b64_tr_b16 a[90:91], v14 offset:18432
  v_mfma_f32_16x16x32_bf16 v[184:187], a[0:3], a[80:83], v[184:187]
  buffer_load_dwordx4 v10, s[12:15], s69 offen offset:0 lds
  v_mfma_f32_16x16x32_bf16 v[188:191], a[0:3], a[84:87], v[188:191]
  ds_read_b64_tr_b16 a[92:93], v15 offset:16384
  v_mfma_f32_16x16x32_bf16 v[120:123], a[4:7], a[72:75], v[120:123]
  ds_read_b64_tr_b16 a[94:95], v15 offset:18432
  v_mfma_f32_16x16x32_bf16 v[124:127], a[4:7], a[76:79], v[124:127]
  ds_read_b64_tr_b16 a[96:97], v16 offset:16384
  v_mfma_f32_16x16x32_bf16 v[192:195], a[4:7], a[80:83], v[192:195]
  buffer_load_dwordx4 v11, s[12:15], s69 offen offset:1024 lds
  v_mfma_f32_16x16x32_bf16 v[196:199], a[4:7], a[84:87], v[196:199]
  s_add_u32 s69, s69, 63488
  ds_read_b64_tr_b16 a[98:99], v16 offset:18432
  v_mfma_f32_16x16x32_bf16 v[128:131], a[8:11], a[72:75], v[128:131]
  ds_read_b64_tr_b16 a[100:101], v17 offset:16384
  v_mfma_f32_16x16x32_bf16 v[132:135], a[8:11], a[76:79], v[132:135]
  ds_read_b64_tr_b16 a[102:103], v17 offset:18432
  v_mfma_f32_16x16x32_bf16 v[200:203], a[8:11], a[80:83], v[200:203]
  buffer_load_dwordx4 v10, s[12:15], s69 offen offset:2048 lds
  v_mfma_f32_16x16x32_bf16 v[204:207], a[8:11], a[84:87], v[204:207]
  ds_read_b128 a[36:39], v12 offset:20480
  v_mfma_f32_16x16x32_bf16 v[136:139], a[12:15], a[72:75], v[136:139]
  ds_read_b128 a[40:43], v12 offset:21504
  v_mfma_f32_16x16x32_bf16 v[140:143], a[12:15], a[76:79], v[140:143]
  ds_read_b128 a[44:47], v12 offset:22528
  v_mfma_f32_16x16x32_bf16 v[208:211], a[12:15], a[80:83], v[208:211]
  buffer_load_dwordx4 v11, s[12:15], s69 offen offset:3072 lds
  v_mfma_f32_16x16x32_bf16 v[212:215], a[12:15], a[84:87], v[212:215]
  s_add_u32 s69, s69, 198656
  ds_read_b128 a[48:51], v12 offset:23552
  v_mfma_f32_16x16x32_bf16 v[144:147], a[16:19], a[72:75], v[144:147]
  s_add_u32 m0, s70, 0
  ds_read_b128 a[52:55], v12 offset:24576
  v_mfma_f32_16x16x32_bf16 v[148:151], a[16:19], a[76:79], v[148:151]
  ds_read_b128 a[56:59], v12 offset:25600
  v_mfma_f32_16x16x32_bf16 v[216:219], a[16:19], a[80:83], v[216:219]
  buffer_load_dwordx4 v4, s[8:11], s68 offen offset:0 sc1 lds
  v_mfma_f32_16x16x32_bf16 v[220:223], a[16:19], a[84:87], v[220:223]
  ds_read_b128 a[60:63], v12 offset:26624
  v_mfma_f32_16x16x32_bf16 v[152:155], a[20:23], a[72:75], v[152:155]
  ds_read_b128 a[64:67], v12 offset:27648
  v_mfma_f32_16x16x32_bf16 v[156:159], a[20:23], a[76:79], v[156:159]
  ds_read_b128 a[68:71], v12 offset:28672
  v_mfma_f32_16x16x32_bf16 v[224:227], a[20:23], a[80:83], v[224:227]
  buffer_load_dwordx4 v4, s[8:11], s68 offen offset:1024 sc1 lds
  v_mfma_f32_16x16x32_bf16 v[228:231], a[20:23], a[84:87], v[228:231]
  v_mfma_f32_16x16x32_bf16 v[160:163], a[24:27], a[72:75], v[160:163]
  v_mfma_f32_16x16x32_bf16 v[164:167], a[24:27], a[76:79], v[164:167]
  v_mfma_f32_16x16x32_bf16 v[232:235], a[24:27], a[80:83], v[232:235]
  buffer_load_dwordx4 v4, s[8:11], s68 offen offset:2048 sc1 lds
  v_mfma_f32_16x16x32_bf16 v[236:239], a[24:27], a[84:87], v[236:239]
  v_mfma_f32_16x16x32_bf16 v[168:171], a[28:31], a[72:75], v[168:171]
  v_mfma_f32_16x16x32_bf16 v[172:175], a[28:31], a[76:79], v[172:175]
  v_mfma_f32_16x16x32_bf16 v[240:243], a[28:31], a[80:83], v[240:243]
  buffer_load_dwordx4 v4, s[8:11], s68 offen offset:3072 sc1 lds
  v_mfma_f32_16x16x32_bf16 v[244:247], a[28:31], a[84:87], v[244:247]
  s_add_u32 m0, s70, 4096
  v_mfma_f32_16x16x32_bf16 v[176:179], a[32:35], a[72:75], v[176:179]
  buffer_load_dword v37, v36, s[92:95], 0 offen
  v_mfma_f32_16x16x32_bf16 v[180:183], a[32:35], a[76:79], v[180:183]
  v_mfma_f32_16x16x32_bf16 v[248:251], a[32:35], a[80:83], v[248:251]
  buffer_load_dwordx4 v6, s[8:11], s68 offen offset:0 sc1 lds
  v_mfma_f32_16x16x32_bf16 v[252:255], a[32:35], a[84:87], v[252:255]
  s_add_u32 s68, s68, 73728
  s_waitcnt vmcnt(18) lgkmcnt(0)
  s_barrier
  v_mfma_f32_16x16x32_bf16 v[112:115], a[36:39], a[88:91], v[112:115]
  s_add_u32 m0, s71, 16384
  ds_read_b64_tr_b16 a[72:73], v14 offset:32768
  v_mfma_f32_16x16x32_bf16 v[116:119], a[36:39], a[92:95], v[116:119]
  ds_read_b64_tr_b16 a[74:75], v14 offset:34816
  v_mfma_f32_16x16x32_bf16 v[184:187], a[36:39], a[96:99], v[184:187]
  buffer_load_dwordx4 v10, s[12:15], s69 offen offset:0 lds
  v_mfma_f32_16x16x32_bf16 v[188:191], a[36:39], a[100:103], v[188:191]
  ds_read_b64_tr_b16 a[76:77], v15 offset:32768
  v_mfma_f32_16x16x32_bf16 v[120:123], a[40:43], a[88:91], v[120:123]
  ds_read_b64_tr_b16 a[78:79], v15 offset:34816
  v_mfma_f32_16x16x32_bf16 v[124:127], a[40:43], a[92:95], v[124:127]
  ds_read_b64_tr_b16 a[80:81], v16 offset:32768
  v_mfma_f32_16x16x32_bf16 v[192:195], a[40:43], a[96:99], v[192:195]
  buffer_load_dwordx4 v11, s[12:15], s69 offen offset:1024 lds
  v_mfma_f32_16x16x32_bf16 v[196:199], a[40:43], a[100:103], v[196:199]
  s_add_u32 s69, s69, 63488
  ds_read_b64_tr_b16 a[82:83], v16 offset:34816
  v_mfma_f32_16x16x32_bf16 v[128:131], a[44:47], a[88:91], v[128:131]
  ds_read_b64_tr_b16 a[84:85], v17 offset:32768
  v_mfma_f32_16x16x32_bf16 v[132:135], a[44:47], a[92:95], v[132:135]
  ds_read_b64_tr_b16 a[86:87], v17 offset:34816
  v_mfma_f32_16x16x32_bf16 v[200:203], a[44:47], a[96:99], v[200:203]
  buffer_load_dwordx4 v10, s[12:15], s69 offen offset:2048 lds
  v_mfma_f32_16x16x32_bf16 v[204:207], a[44:47], a[100:103], v[204:207]
  ds_read_b128 a[0:3], v12 offset:40960
  v_mfma_f32_16x16x32_bf16 v[136:139], a[48:51], a[88:91], v[136:139]
  ds_read_b128 a[4:7], v12 offset:41984
  v_mfma_f32_16x16x32_bf16 v[140:143], a[48:51], a[92:95], v[140:143]
  ds_read_b128 a[8:11], v12 offset:43008
  v_mfma_f32_16x16x32_bf16 v[208:211], a[48:51], a[96:99], v[208:211]
  buffer_load_dwordx4 v11, s[12:15], s69 offen offset:3072 lds
  v_mfma_f32_16x16x32_bf16 v[212:215], a[48:51], a[100:103], v[212:215]
  s_add_u32 s69, s69, 198656
  ds_read_b128 a[12:15], v12 offset:44032
  v_mfma_f32_16x16x32_bf16 v[144:147], a[52:55], a[88:91], v[144:147]
  s_add_u32 m0, s70, 20480
  ds_read_b128 a[16:19], v12 offset:45056
  v_mfma_f32_16x16x32_bf16 v[148:151], a[52:55], a[92:95], v[148:151]
  ds_read_b128 a[20:23], v12 offset:46080
  v_mfma_f32_16x16x32_bf16 v[216:219], a[52:55], a[96:99], v[216:219]
  buffer_load_dwordx4 v4, s[8:11], s68 offen offset:0 sc1 lds
  v_mfma_f32_16x16x32_bf16 v[220:223], a[52:55], a[100:103], v[220:223]
  ds_read_b128 a[24:27], v12 offset:47104
  v_mfma_f32_16x16x32_bf16 v[152:155], a[56:59], a[88:91], v[152:155]
  ds_read_b128 a[28:31], v12 offset:48128
  v_mfma_f32_16x16x32_bf16 v[156:159], a[56:59], a[92:95], v[156:159]
  ds_read_b128 a[32:35], v12 offset:49152
  v_mfma_f32_16x16x32_bf16 v[224:227], a[56:59], a[96:99], v[224:227]
  buffer_load_dwordx4 v4, s[8:11], s68 offen offset:1024 sc1 lds
  v_mfma_f32_16x16x32_bf16 v[228:231], a[56:59], a[100:103], v[228:231]
  v_mfma_f32_16x16x32_bf16 v[160:163], a[60:63], a[88:91], v[160:163]
  v_mfma_f32_16x16x32_bf16 v[164:167], a[60:63], a[92:95], v[164:167]
  v_mfma_f32_16x16x32_bf16 v[232:235], a[60:63], a[96:99], v[232:235]
  buffer_load_dwordx4 v4, s[8:11], s68 offen offset:2048 sc1 lds
  v_mfma_f32_16x16x32_bf16 v[236:239], a[60:63], a[100:103], v[236:239]
  v_mfma_f32_16x16x32_bf16 v[168:171], a[64:67], a[88:91], v[168:171]
  v_mfma_f32_16x16x32_bf16 v[172:175], a[64:67], a[92:95], v[172:175]
  v_mfma_f32_16x16x32_bf16 v[240:243], a[64:67], a[96:99], v[240:243]
  buffer_load_dwordx4 v4, s[8:11], s68 offen offset:3072 sc1 lds
  v_mfma_f32_16x16x32_bf16 v[244:247], a[64:67], a[100:103], v[244:247]
  s_add_u32 m0, s70, 24576
  v_mfma_f32_16x16x32_bf16 v[176:179], a[68:71], a[88:91], v[176:179]
  v_mfma_f32_16x16x32_bf16 v[180:183], a[68:71], a[92:95], v[180:183]
  v_mfma_f32_16x16x32_bf16 v[248:251], a[68:71], a[96:99], v[248:251]
  buffer_load_dwordx4 v6, s[8:11], s68 offen offset:0 sc1 lds
  v_mfma_f32_16x16x32_bf16 v[252:255], a[68:71], a[100:103], v[252:255]
  s_add_u32 s68, s68, 73728
  s_waitcnt vmcnt(18) lgkmcnt(0)
  s_barrier
  v_mfma_f32_16x16x32_bf16 v[112:115], a[0:3], a[72:75], v[112:115]
  s_add_u32 m0, s71, 32768
  ds_read_b64_tr_b16 a[88:89], v14 offset:49152
  v_mfma_f32_16x16x32_bf16 v[116:119], a[0:3], a[76:79], v[116:119]
  ds_read_b64_tr_b16 a[90:91], v14 offset:51200
  v_mfma_f32_16x16x32_bf16 v[184:187], a[0:3], a[80:83], v[184:187]
  buffer_load_dwordx4 v10, s[12:15], s69 offen offset:0 lds
  v_mfma_f32_16x16x32_bf16 v[188:191], a[0:3], a[84:87], v[188:191]
  ds_read_b64_tr_b16 a[92:93], v15 offset:49152
  v_mfma_f32_16x16x32_bf16 v[120:123], a[4:7], a[72:75], v[120:123]
  ds_read_b64_tr_b16 a[94:95], v15 offset:51200
  v_mfma_f32_16x16x32_bf16 v[124:127], a[4:7], a[76:79], v[124:127]
  ds_read_b64_tr_b16 a[96:97], v16 offset:49152
  v_mfma_f32_16x16x32_bf16 v[192:195], a[4:7], a[80:83], v[192:195]
  buffer_load_dwordx4 v11, s[12:15], s69 offen offset:1024 lds
  v_mfma_f32_16x16x32_bf16 v[196:199], a[4:7], a[84:87], v[196:199]
  s_add_u32 s69, s69, 63488
  ds_read_b64_tr_b16 a[98:99], v16 offset:51200
  v_mfma_f32_16x16x32_bf16 v[128:131], a[8:11], a[72:75], v[128:131]
  ds_read_b64_tr_b16 a[100:101], v17 offset:49152
  v_mfma_f32_16x16x32_bf16 v[132:135], a[8:11], a[76:79], v[132:135]
  ds_read_b64_tr_b16 a[102:103], v17 offset:51200
  v_mfma_f32_16x16x32_bf16 v[200:203], a[8:11], a[80:83], v[200:203]
  buffer_load_dwordx4 v10, s[12:15], s69 offen offset:2048 lds
  v_mfma_f32_16x16x32_bf16 v[204:207], a[8:11], a[84:87], v[204:207]
  ds_read_b128 a[36:39], v13 offset:0
  v_mfma_f32_16x16x32_bf16 v[136:139], a[12:15], a[72:75], v[136:139]
  ds_read_b128 a[40:43], v13 offset:1024
  v_mfma_f32_16x16x32_bf16 v[140:143], a[12:15], a[76:79], v[140:143]
  ds_read_b128 a[44:47], v13 offset:2048
  v_mfma_f32_16x16x32_bf16 v[208:211], a[12:15], a[80:83], v[208:211]
  buffer_load_dwordx4 v11, s[12:15], s69 offen offset:3072 lds
  v_mfma_f32_16x16x32_bf16 v[212:215], a[12:15], a[84:87], v[212:215]
  s_add_u32 s69, s69, 198656
  ds_read_b128 a[48:51], v13 offset:3072
  v_mfma_f32_16x16x32_bf16 v[144:147], a[16:19], a[72:75], v[144:147]
  s_add_u32 m0, s70, 40960
  ds_read_b128 a[52:55], v13 offset:4096
  v_mfma_f32_16x16x32_bf16 v[148:151], a[16:19], a[76:79], v[148:151]
  ds_read_b128 a[56:59], v13 offset:5120
  v_mfma_f32_16x16x32_bf16 v[216:219], a[16:19], a[80:83], v[216:219]
  buffer_load_dwordx4 v4, s[8:11], s68 offen offset:0 sc1 lds
  v_mfma_f32_16x16x32_bf16 v[220:223], a[16:19], a[84:87], v[220:223]
  ds_read_b128 a[60:63], v13 offset:6144
  v_mfma_f32_16x16x32_bf16 v[152:155], a[20:23], a[72:75], v[152:155]
  ds_read_b128 a[64:67], v13 offset:7168
  v_mfma_f32_16x16x32_bf16 v[156:159], a[20:23], a[76:79], v[156:159]
  ds_read_b128 a[68:71], v13 offset:8192
  v_mfma_f32_16x16x32_bf16 v[224:227], a[20:23], a[80:83], v[224:227]
  buffer_load_dwordx4 v4, s[8:11], s68 offen offset:1024 sc1 lds
  v_mfma_f32_16x16x32_bf16 v[228:231], a[20:23], a[84:87], v[228:231]
  v_mfma_f32_16x16x32_bf16 v[160:163], a[24:27], a[72:75], v[160:163]
  v_mfma_f32_16x16x32_bf16 v[164:167], a[24:27], a[76:79], v[164:167]
  v_mfma_f32_16x16x32_bf16 v[232:235], a[24:27], a[80:83], v[232:235]
  buffer_load_dwordx4 v4, s[8:11], s68 offen offset:2048 sc1 lds
  v_mfma_f32_16x16x32_bf16 v[236:239], a[24:27], a[84:87], v[236:239]
  v_mfma_f32_16x16x32_bf16 v[168:171], a[28:31], a[72:75], v[168:171]
  v_mfma_f32_16x16x32_bf16 v[172:175], a[28:31], a[76:79], v[172:175]
  v_mfma_f32_16x16x32_bf16 v[240:243], a[28:31], a[80:83], v[240:243]
  buffer_load_dwordx4 v4, s[8:11], s68 offen offset:3072 sc1 lds
  v_mfma_f32_16x16x32_bf16 v[244:247], a[28:31], a[84:87], v[244:247]
  s_add_u32 m0, s70, 45056
  v_mfma_f32_16x16x32_bf16 v[176:179], a[32:35], a[72:75], v[176:179]
  v_mfma_f32_16x16x32_bf16 v[180:183], a[32:35], a[76:79], v[180:183]
  v_mfma_f32_16x16x32_bf16 v[248:251], a[32:35], a[80:83], v[248:251]
  buffer_load_dwordx4 v6, s[8:11], s68 offen offset:0 sc1 lds
  v_mfma_f32_16x16x32_bf16 v[252:255], a[32:35], a[84:87], v[252:255]
  s_add_u32 s68, s68, 73728
  s_waitcnt vmcnt(18) lgkmcnt(0)
  s_barrier
  v_mfma_f32_16x16x32_bf16 v[112:115], a[36:39], a[88:91], v[112:115]
  s_add_u32 m0, s71, 49152
  ds_read_b64_tr_b16 a[72:73], v14 offset:0
  v_mfma_f32_16x16x32_bf16 v[116:119], a[36:39], a[92:95], v[116:119]
  ds_read_b64_tr_b16 a[74:75], v14 offset:2048
  v_mfma_f32_16x16x32_bf16 v[184:187], a[36:39], a[96:99], v[184:187]
  buffer_load_dwordx4 v10, s[12:15], s69 offen offset:0 lds
  v_mfma_f32_16x16x32_bf16 v[188:191], a[36:39], a[100:103], v[188:191]
  ds_read_b64_tr_b16 a[76:77], v15 offset:0
  v_mfma_f32_16x16x32_bf16 v[120:123], a[40:43], a[88:91], v[120:123]
  ds_read_b64_tr_b16 a[78:79], v15 offset:2048
  v_mfma_f32_16x16x32_bf16 v[124:127], a[40:43], a[92:95], v[124:127]
  ds_read_b64_tr_b16 a[80:81], v16 offset:0
  v_mfma_f32_16x16x32_bf16 v[192:195], a[40:43], a[96:99], v[192:195]
  buffer_load_dwordx4 v11, s[12:15], s69 offen offset:1024 lds
  v_mfma_f32_16x16x32_bf16 v[196:199], a[40:43], a[100:103], v[196:199]
  s_add_u32 s69, s69, 63488
  ds_read_b64_tr_b16 a[82:83], v16 offset:2048
  v_mfma_f32_16x16x32_bf16 v[128:131], a[44:47], a[88:91], v[128:131]
  ds_read_b64_tr_b16 a[84:85], v17 offset:0
  v_mfma_f32_16x16x32_bf16 v[132:135], a[44:47], a[92:95], v[132:135]
  ds_read_b64_tr_b16 a[86:87], v17 offset:2048
  v_mfma_f32_16x16x32_bf16 v[200:203], a[44:47], a[96:99], v[200:203]
  buffer_load_dwordx4 v10, s[12:15], s69 offen offset:2048 lds
  v_mfma_f32_16x16x32_bf16 v[204:207], a[44:47], a[100:103], v[204:207]
  ds_read_b128 a[0:3], v12 offset:0
  v_mfma_f32_16x16x32_bf16 v[136:139], a[48:51], a[88:91], v[136:139]
  ds_read_b128 a[4:7], v12 offset:1024
  v_mfma_f32_16x16x32_bf16 v[140:143], a[48:51], a[92:95], v[140:143]
  ds_read_b128 a[8:11], v12 offset:2048
  v_mfma_f32_16x16x32_bf16 v[208:211], a[48:51], a[96:99], v[208:211]
  buffer_load_dwordx4 v11, s[12:15], s69 offen offset:3072 lds
  v_mfma_f32_16x16x32_bf16 v[212:215], a[48:51], a[100:103], v[212:215]
  s_add_u32 s69, s69, 198656
  ds_read_b128 a[12:15], v12 offset:3072
  v_mfma_f32_16x16x32_bf16 v[144:147], a[52:55], a[88:91], v[144:147]
  s_add_u32 m0, s70, 61440
  ds_read_b128 a[16:19], v12 offset:4096
  v_mfma_f32_16x16x32_bf16 v[148:151], a[52:55], a[92:95], v[148:151]
  ds_read_b128 a[20:23], v12 offset:5120
  v_mfma_f32_16x16x32_bf16 v[216:219], a[52:55], a[96:99], v[216:219]
  buffer_load_dwordx4 v4, s[8:11], s68 offen offset:0 sc1 lds
  v_mfma_f32_16x16x32_bf16 v[220:223], a[52:55], a[100:103], v[220:223]
  ds_read_b128 a[24:27], v12 offset:6144
  v_mfma_f32_16x16x32_bf16 v[152:155], a[56:59], a[88:91], v[152:155]
  ds_read_b128 a[28:31], v12 offset:7168
  v_mfma_f32_16x16x32_bf16 v[156:159], a[56:59], a[92:95], v[156:159]
  ds_read_b128 a[32:35], v12 offset:8192
  v_mfma_f32_16x16x32_bf16 v[224:227], a[56:59], a[96:99], v[224:227]
  buffer_load_dwordx4 v4, s[8:11], s68 offen offset:1024 sc1 lds
  v_mfma_f32_16x16x32_bf16 v[228:231], a[56:59], a[100:103], v[228:231]
  v_mfma_f32_16x16x32_bf16 v[160:163], a[60:63], a[88:91], v[160:163]
  v_mfma_f32_16x16x32_bf16 v[164:167], a[60:63], a[92:95], v[164:167]
  v_mfma_f32_16x16x32_bf16 v[232:235], a[60:63], a[96:99], v[232:235]
  buffer_load_dwordx4 v4, s[8:11], s68 offen offset:2048 sc1 lds
  v_mfma_f32_16x16x32_bf16 v[236:239], a[60:63], a[100:103], v[236:239]
  v_mfma_f32_16x16x32_bf16 v[168:171], a[64:67], a[88:91], v[168:171]
  s_sub_u32 s72, s72, 1
  v_mfma_f32_16x16x32_bf16 v[172:175], a[64:67], a[92:95], v[172:175]
  v_mfma_f32_16x16x32_bf16 v[240:243], a[64:67], a[96:99], v[240:243]
  buffer_load_dwordx4 v4, s[8:11], s68 offen offset:3072 sc1 lds
  v_mfma_f32_16x16x32_bf16 v[244:247], a[64:67], a[100:103], v[244:247]
  s_add_u32 m0, s70, 65536
  v_mfma_f32_16x16x32_bf16 v[176:179], a[68:71], a[88:91], v[176:179]
  v_mfma_f32_16x16x32_bf16 v[180:183], a[68:71], a[92:95], v[180:183]
  v_mfma_f32_16x16x32_bf16 v[248:251], a[68:71], a[96:99], v[248:251]
  buffer_load_dwordx4 v6, s[8:11], s68 offen offset:0 sc1 lds
  v_mfma_f32_16x16x32_bf16 v[252:255], a[68:71], a[100:103], v[252:255]
  s_add_u32 s68, s68, 73728
  s_waitcnt vmcnt(18) lgkmcnt(0)
  s_barrier
  s_cmp_lg_u32 s72, 0
  s_cbranch_scc1 L_loopB
L_tailB:
  v_mfma_f32_16x16x32_bf16 v[184:187], a[0:3], a[80:83], v[184:187]
  ds_read_b64_tr_b16 a[96:97], v16 offset:16384
  v_mfma_f32_16x16x32_bf16 v[188:191], a[0:3], a[84:87], v[188:191]
  ds_read_b64_tr_b16 a[98:99], v16 offset:18432
  v_mfma_f32_16x16x32_bf16 v[192:195], a[4:7], a[80:83], v[192:195]
  ds_read_b64_tr_b16 a[100:101], v17 offset:16384
  v_mfma_f32_16x16x32_bf16 v[196:199], a[4:7], a[84:87], v[196:199]
  ds_read_b64_tr_b16 a[102:103], v17 offset:18432
  v_mfma_f32_16x16x32_bf16 v[200:203], a[8:11], a[80:83], v[200:203]
  ds_read_b128 a[36:39], v12 offset:20480
  v_mfma_f32_16x16x32_bf16 v[204:207], a[8:11], a[84:87], v[204:207]
  ds_read_b128 a[40:43], v12 offset:21504
  v_mfma_f32_16x16x32_bf16 v[208:211], a[12:15], a[80:83], v[208:211]
  ds_read_b128 a[44:47], v12 offset:22528
  v_mfma_f32_16x16x32_bf16 v[212:215], a[12:15], a[84:87], v[212:215]
  ds_read_b128 a[48:51], v12 offset:23552
  v_mfma_f32_16x16x32_bf16 v[216:219], a[16:19], a[80:83], v[216:219]
  ds_read_b128 a[52:55], v12 offset:24576
  v_mfma_f32_16x16x32_bf16 v[220:223], a[16:19], a[84:87], v[220:223]
  ds_read_b128 a[56:59], v12 offset:25600
  v_mfma_f32_16x16x32_bf16 v[224:227], a[20:23], a[80:83], v[224:227]
  ds_read_b128 a[60:63], v12 offset:26624
  v_mfma_f32_16x16x32_bf16 v[228:231], a[20:23], a[84:87], v[228:231]
  ds_read_b128 a[64:67], v12 offset:27648
  v_mfma_f32_16x16x32_bf16 v[232:235], a[24:27], a[80:83], v[232:235]
  ds_read_b128 a[68:71], v12 offset:28672
  v_mfma_f32_16x16x32_bf16 v[236:239], a[24:27], a[84:87], v[236:239]
  ds_read_b64_tr_b16 a[88:89], v14 offset:16384
  v_mfma_f32_16x16x32_bf16 v[240:243], a[28:31], a[80:83], v[240:243]
  ds_read_b64_tr_b16 a[90:91], v14 offset:18432
  v_mfma_f32_16x16x32_bf16 v[244:247], a[28:31], a[84:87], v[244:247]
  ds_read_b64_tr_b16 a[92:93], v15 offset:16384
  v_mfma_f32_16x16x32_bf16 v[248:251], a[32:35], a[80:83], v[248:251]
  s_waitcnt vmcnt(9)
  s_barrier
  ds_read_b64_tr_b16 a[94:95], v15 offset:18432
  v_mfma_f32_16x16x32_bf16 v[252:255], a[32:35], a[84:87], v[252:255]
  s_waitcnt lgkmcnt(12)
  v_mfma_f32_16x16x32_bf16 v[184:187], a[36:39], a[96:99], v[184:187]
  ds_read_b64_tr_b16 a[112:113], v16 offset:32768
  v_mfma_f32_16x16x32_bf16 v[188:191], a[36:39], a[100:103], v[188:191]
  s_waitcnt lgkmcnt(12)
  ds_read_b64_tr_b16 a[114:115], v16 offset:34816
  v_mfma_f32_16x16x32_bf16 v[192:195], a[40:43], a[96:99], v[192:195]
  ds_read_b64_tr_b16 a[116:117], v17 offset:32768
  v_mfma_f32_16x16x32_bf16 v[196:199], a[40:43], a[100:103], v[196:199]
  s_waitcnt lgkmcnt(13)
  ds_read_b64_tr_b16 a[118:119], v17 offset:34816
  v_mfma_f32_16x16x32_bf16 v[200:203], a[44:47], a[96:99], v[200:203]
  ds_read_b128 a[136:139], v12 offset:40960
  v_mfma_f32_16x16x32_bf16 v[204:207], a[44:47], a[100:103], v[204:207]
  s_waitcnt lgkmcnt(14)
  ds_read_b128 a[140:143], v12 offset:41984
  v_mfma_f32_16x16x32_bf16 v[208:211], a[48:51], a[96:99], v[208:211]
  ds_read_b128 a[144:147], v12 offset:43008
  v_mfma_f32_16x16x32_bf16 v[212:215], a[48:51], a[100:103], v[212:215]
  s_waitcnt lgkmcnt(15)
  ds_read_b128 a[148:151], v12 offset:44032
  v_mfma_f32_16x16x32_bf16 v[216:219], a[52:55], a[96:99], v[216:219]
  ds_read_b128 a[152:155], v12 offset:45056
  v_mfma_f32_16x16x32_bf16 v[220:223], a[52:55], a[100:103], v[220:223]
  s_waitcnt lgkmcnt(15)
  ds_read_b128 a[156:159], v12 offset:46080
  v_mfma_f32_16x16x32_bf16 v[224:227], a[56:59], a[96:99], v[224:227]
  ds_read_b128 a[160:163], v12 offset:47104
  v_mfma_f32_16x16x32_bf16 v[228:231], a[56:59], a[100:103], v[228:231]
  s_waitcnt lgkmcnt(15)
  ds_read_b128 a[164:167], v12 offset:48128
  v_mfma_f32_16x16x32_bf16 v[232:235], a[60:63], a[96:99], v[232:235]
  ds_read_b128 a[168:171], v12 offset:49152
  v_mfma_f32_16x16x32_bf16 v[236:239], a[60:63], a[100:103], v[236:239]
  s_waitcnt lgkmcnt(15)
  ds_read_b64_tr_b16 a[104:105], v14 offset:32768
  v_mfma_f32_16x16x32_bf16 v[240:243], a[64:67], a[96:99], v[240:243]
  ds_read_b64_tr_b16 a[106:107], v14 offset:34816
  v_mfma_f32_16x16x32_bf16 v[244:247], a[64:67], a[100:103], v[244:247]
  s_waitcnt lgkmcnt(15)
  ds_read_b64_tr_b16 a[108:109], v15 offset:32768
  v_mfma_f32_16x16x32_bf16 v[248:251], a[68:71], a[96:99], v[248:251]
  s_waitcnt vmcnt(0)
  s_barrier
  ds_read_b64_tr_b16 a[110:111], v15 offset:34816
  v_mfma_f32_16x16x32_bf16 v[252:255], a[68:71], a[100:103], v[252:255]
  s_waitcnt lgkmcnt(12)
  v_mfma_f32_16x16x32_bf16 v[184:187], a[136:139], a[112:115], v[184:187]
  ds_read_b64_tr_b16 a[128:129], v16 offset:49152
  v_mfma_f32_16x16x32_bf16 v[188:191], a[136:139], a[116:119], v[188:191]
  s_waitcnt lgkmcnt(12)
  ds_read_b64_tr_b16 a[130:131], v16 offset:51200
  v_mfma_f32_16x16x32_bf16 v[192:195], a[140:143], a[112:115], v[192:195]
  ds_read_b64_tr_b16 a[132:133], v17 offset:49152
  v_mfma_f32_16x16x32_bf16 v[196:199], a[140:143], a[116:119], v[196:199]
  s_waitcnt lgkmcnt(13)
  ds_read_b64_tr_b16 a[134:135], v17 offset:51200
  v_mfma_f32_16x16x32_bf16 v[200:203], a[144:147], a[112:115], v[200:203]
  ds_read_b128 a[172:175], v13 offset:0
  v_mfma_f32_16x16x32_bf16 v[204:207], a[144:147], a[116:119], v[204:207]
  s_waitcnt lgkmcnt(14)
  ds_read_b128 a[176:179], v13 offset:1024
  v_mfma_f32_16x16x32_bf16 v[208:211], a[148:151], a[112:115], v[208:211]
  ds_read_b128 a[180:183], v13 offset:2048
  v_mfma_f32_16x16x32_bf16 v[212:215], a[148:151], a[116:119], v[212:215]
  s_waitcnt lgkmcnt(15)
  ds_read_b128 a[184:187], v13 offset:3072
  v_mfma_f32_16x16x32_bf16 v[216:219], a[152:155], a[112:115], v[216:219]
  ds_read_b128 a[188:191], v13 offset:4096
  v_mfma_f32_16x16x32_bf16 v[220:223], a[152:155], a[116:119], v[220:223]
  s_waitcnt lgkmcnt(15)
  ds_read_b128 a[192:195], v13 offset:5120
  v_mfma_f32_16x16x32_bf16 v[224:227], a[156:159], a[112:115], v[224:227]
  ds_read_b128 a[196:199], v13 offset:6144
  v_mfma_f32_16x16x32_bf16 v[228:231], a[156:159], a[116:119], v[228:231]
  s_waitcnt lgkmcnt(15)
  ds_read_b128 a[200:203], v13 offset:7168
  v_mfma_f32_16x16x32_bf16 v[232:235], a[160:163], a[112:115], v[232:235]
  ds_read_b128 a[204:207], v13 offset:8192
  v_mfma_f32_16x16x32_bf16 v[236:239], a[160:163], a[116:119], v[236:239]
  s_waitcnt lgkmcnt(15)
  ds_read_b64_tr_b16 a[120:121], v14 offset:49152
  v_mfma_f32_16x16x32_bf16 v[240:243], a[164:167], a[112:115], v[240:243]
  ds_read_b64_tr_b16 a[122:123], v14 offset:51200
  v_mfma_f32_16x16x32_bf16 v[244:247], a[164:167], a[116:119], v[244:247]
  s_waitcnt lgkmcnt(15)
  ds_read_b64_tr_b16 a[124:125], v15 offset:49152
  v_mfma_f32_16x16x32_bf16 v[248:251], a[168:171], a[112:115], v[248:251]
  ds_read_b64_tr_b16 a[126:127], v15 offset:51200
  v_mfma_f32_16x16x32_bf16 v[252:255], a[168:171], a[116:119], v[252:255]
  s_waitcnt lgkmcnt(12)
  v_mfma_f32_16x16x32_bf16 v[184:187], a[172:175], a[128:131], v[184:187]
  v_mfma_f32_16x16x32_bf16 v[188:191], a[172:175], a[132:135], v[188:191]
  s_waitcnt lgkmcnt(11)
  v_mfma_f32_16x16x32_bf16 v[192:195], a[176:179], a[128:131], v[192:195]
  v_mfma_f32_16x16x32_bf16 v[196:199], a[176:179], a[132:135], v[196:199]
  s_waitcnt lgkmcnt(10)
  v_mfma_f32_16x16x32_bf16 v[200:203], a[180:183], a[128:131], v[200:203]
  v_mfma_f32_16x16x32_bf16 v[204:207], a[180:183], a[132:135], v[204:207]
  s_waitcnt lgkmcnt(9)
  v_mfma_f32_16x16x32_bf16 v[208:211], a[184:187], a[128:131], v[208:211]
  v_mfma_f32_16x16x32_bf16 v[212:215], a[184:187], a[132:135], v[212:215]
  s_waitcnt lgkmcnt(8)
  v_mfma_f32_16x16x32_bf16 v[216:219], a[188:191], a[128:131], v[216:219]
  s_waitcnt lgkmcnt(0)
  s_barrier
  v_mfma_f32_16x16x32_bf16 v[220:223], a[188:191], a[132:135], v[220:223]
  ds_write_b128 v32, v[184:187] offset:0
  v_mfma_f32_16x16x32_bf16 v[224:227], a[192:195], a[128:131], v[224:227]
  v_mfma_f32_16x16x32_bf16 v[228:231], a[192:195], a[132:135], v[228:231]
  v_mfma_f32_16x16x32_bf16 v[232:235], a[196:199], a[128:131], v[232:235]
  ds_write_b128 v32, v[188:191] offset:1024
  v_mfma_f32_16x16x32_bf16 v[236:239], a[196:199], a[132:135], v[236:239]
  v_mfma_f32_16x16x32_bf16 v[240:243], a[200:203], a[128:131], v[240:243]
  v_mfma_f32_16x16x32_bf16 v[244:247], a[200:203], a[132:135], v[244:247]
  ds_write_b128 v32, v[192:195] offset:2048
  v_mfma_f32_16x16x32_bf16 v[248:251], a[204:207], a[128:131], v[248:251]
  v_mfma_f32_16x16x32_bf16 v[252:255], a[204:207], a[132:135], v[252:255]
  v_mfma_f32_16x16x32_bf16 v[112:115], a[0:3], a[72:75], v[112:115]
  v_mfma_f32_16x16x32_bf16 v[116:119], a[0:3], a[76:79], v[116:119]
  ds_write_b128 v32, v[196:199] offset:3072
  v_mfma_f32_16x16x32_bf16 v[112:115], a[36:39], a[88:91], v[112:115]
  v_mfma_f32_16x16x32_bf16 v[116:119], a[36:39], a[92:95], v[116:119]
  v_mfma_f32_16x16x32_bf16 v[112:115], a[136:139], a[104:107], v[112:115]
  ds_write_b128 v32, v[200:203] offset:4096
  v_mfma_f32_16x16x32_bf16 v[116:119], a[136:139], a[108:111], v[116:119]
  v_mfma_f32_16x16x32_bf16 v[112:115], a[172:175], a[120:123], v[112:115]
  buffer_load_dwordx2 v[18:19], v30, s[20:23], s35 offen offset:0
  v_mfma_f32_16x16x32_bf16 v[116:119], a[172:175], a[124:127], v[116:119]
  ds_write_b128 v32, v[204:207] offset:5120
  v_mfma_f32_16x16x32_bf16 v[120:123], a[4:7], a[72:75], v[120:123]
  v_mfma_f32_16x16x32_bf16 v[124:127], a[4:7], a[76:79], v[124:127]
  v_mfma_f32_16x16x32_bf16 v[120:123], a[40:43], a[88:91], v[120:123]
  buffer_load_dwordx2 v[20:21], v31, s[20:23], s35 offen offset:0
  v_mfma_f32_16x16x32_bf16 v[124:127], a[40:43], a[92:95], v[124:127]
  ds_write_b128 v32, v[208:211] offset:6144
  v_mfma_f32_16x16x32_bf16 v[120:123], a[140:143], a[104:107], v[120:123]
  v_mfma_f32_16x16x32_bf16 v[124:127], a[140:143], a[108:111], v[124:127]
  v_mfma_f32_16x16x32_bf16 v[120:123], a[176:179], a[120:123], v[120:123]
  ds_write_b128 v32, v[212:215] offset:7168
  v_mfma_f32_16x16x32_bf16 v[124:127], a[176:179], a[124:127], v[124:127]
  v_mfma_f32_16x16x32_bf16 v[128:131], a[8:11], a[72:75], v[128:131]
  buffer_load_dwordx2 v[22:23], v30, s[20:23], s35 offen offset:128
  v_mfma_f32_16x16x32_bf16 v[132:135], a[8:11], a[76:79], v[132:135]
  ds_write_b128 v32, v[216:219] offset:8192
  v_mfma_f32_16x16x32_bf16 v[128:131], a[44:47], a[88:91], v[128:131]
  v_mfma_f32_16x16x32_bf16 v[132:135], a[44:47], a[92:95], v[132:135]
  v_mfma_f32_16x16x32_bf16 v[128:131], a[144:147], a[104:107], v[128:131]
  buffer_load_dwordx2 v[24:25], v31, s[20:23], s35 offen offset:128
  v_mfma_f32_16x16x32_bf16 v[132:135], a[144:147], a[108:111], v[132:135]
  ds_write_b128 v32, v[220:223] offset:9216
  v_mfma_f32_16x16x32_bf16 v[128:131], a[180:183], a[120:123], v[128:131]
  v_mfma_f32_16x16x32_bf16 v[132:135], a[180:183], a[124:127], v[132:135]
  v_mfma_f32_16x16x32_bf16 v[136:139], a[12:15], a[72:75], v[136:139]
  ds_write_b128 v32, v[224:227] offset:10240
  v_mfma_f32_16x16x32_bf16 v[140:143], a[12:15], a[76:79], v[140:143]
  v_mfma_f32_16x16x32_bf16 v[136:139], a[48:51], a[88:91], v[136:139]
  buffer_load_dwordx2 v[26:27], v30, s[20:23], s35 offen offset:256
  v_mfma_f32_16x16x32_bf16 v[140:143], a[48:51], a[92:95], v[140:143]
  ds_write_b128 v32, v[228:231] offset:11264
  v_mfma_f32_16x16x32_bf16 v[136:139], a[148:151], a[104:107], v[136:139]
  v_mfma_f32_16x16x32_bf16 v[140:143], a[148:151], a[108:111], v[140:143]
  v_mfma_f32_16x16x32_bf16 v[136:139], a[184:187], a[120:123], v[136:139]
  buffer_load_dwordx2 v[28:29], v31, s[20:23], s35 offen offset:256
  v_mfma_f32_16x16x32_bf16 v[140:143], a[184:187], a[124:127], v[140:143]
  ds_write_b128 v32, v[232:235] offset:12288
  v_mfma_f32_16x16x32_bf16 v[144:147], a[16:19], a[72:75], v[144:147]
  v_mfma_f32_16x16x32_bf16 v[148:151], a[16:19], a[76:79], v[148:151]
  v_mfma_f32_16x16x32_bf16 v[144:147], a[52:55], a[88:91], v[144:147]
  ds_write_b128 v32, v[236:239] offset:13312
  v_mfma_f32_16x16x32_bf16 v[148:151], a[52:55], a[92:95], v[148:151]
  v_mfma_f32_16x16x32_bf16 v[144:147], a[152:155], a[104:107], v[144:147]
  v_mfma_f32_16x16x32_bf16 v[148:151], a[152:155], a[108:111], v[148:151]
  ds_write_b128 v32, v[240:243] offset:14336
  v_mfma_f32_16x16x32_bf16 v[144:147], a[188:191], a[120:123], v[144:147]
  v_mfma_f32_16x16x32_bf16 v[148:151], a[188:191], a[124:127], v[148:151]
  v_mfma_f32_16x16x32_bf16 v[152:155], a[20:23], a[72:75], v[152:155]
  v_mfma_f32_16x16x32_bf16 v[156:159], a[20:23], a[76:79], v[156:159]
  ds_write_b128 v32, v[244:247] offset:15360
  v_mfma_f32_16x16x32_bf16 v[152:155], a[56:59], a[88:91], v[152:155]
  v_mfma_f32_16x16x32_bf16 v[156:159], a[56:59], a[92:95], v[156:159]
  v_mfma_f32_16x16x32_bf16 v[152:155], a[156:159], a[104:107], v[152:155]
  ds_write_b128 v32, v[248:251] offset:16384
  v_mfma_f32_16x16x32_bf16 v[156:159], a[156:159], a[108:111], v[156:159]
  v_mfma_f32_16x16x32_bf16 v[152:155], a[192:195], a[120:123], v[152:155]
  v_mfma_f32_16x16x32_bf16 v[156:159], a[192:195], a[124:127], v[156:159]
  ds_write_b128 v32, v[252:255] offset:17408
  v_mfma_f32_16x16x32_bf16 v[160:163], a[24:27], a[72:75], v[160:163]
  v_mfma_f32_16x16x32_bf16 v[164:167], a[24:27], a[76:79], v[164:167]
  v_mfma_f32_16x16x32_bf16 v[160:163], a[60:63], a[88:91], v[160:163]
  v_mfma_f32_16x16x32_bf16 v[164:167], a[60:63], a[92:95], v[164:167]
  s_waitcnt lgkmcnt(0)
  s_barrier
  v_mfma_f32_16x16x32_bf16 v[160:163], a[160:163], a[104:107], v[160:163]
  ds_read_b128 v[40:43], v33 offset:0
  v_mfma_f32_16x16x32_bf16 v[164:167], a[160:163], a[108:111], v[164:167]
  ds_read_b128 v[44:47], v33 offset:1024
  v_mfma_f32_16x16x32_bf16 v[160:163], a[196:199], a[120:123], v[160:163]
  ds_read_b128 v[48:51], v33 offset:2048
  v_mfma_f32_16x16x32_bf16 v[164:167], a[196:199], a[124:127], v[164:167]
  ds_read_b128 v[52:55], v33 offset:3072
  v_mfma_f32_16x16x32_bf16 v[168:171], a[28:31], a[72:75], v[168:171]
  ds_read_b128 v[56:59], v33 offset:4096
  v_mfma_f32_16x16x32_bf16 v[172:175], a[28:31], a[76:79], v[172:175]
  ds_read_b128 v[60:63], v33 offset:5120
  v_mfma_f32_16x16x32_bf16 v[168:171], a[64:67], a[88:91], v[168:171]
  ds_read_b128 v[64:67], v33 offset:6144
  v_mfma_f32_16x16x32_bf16 v[172:175], a[64:67], a[92:95], v[172:175]
  ds_read_b128 v[68:71], v33 offset:7168
  v_mfma_f32_16x16x32_bf16 v[168:171], a[164:167], a[104:107], v[168:171]
  ds_read_b128 v[72:75], v33 offset:8192
  v_mfma_f32_16x16x32_bf16 v[172:175], a[164:167], a[108:111], v[172:175]
  ds_read_b128 v[76:79], v33 offset:9216
  v_mfma_f32_16x16x32_bf16 v[168:171], a[200:203], a[120:123], v[168:171]
  ds_read_b128 v[80:83], v33 offset:10240
  v_mfma_f32_16x16x32_bf16 v[172:175], a[200:203], a[124:127], v[172:175]
  ds_read_b128 v[84:87], v33 offset:11264
  v_mfma_f32_16x16x32_bf16 v[176:179], a[32:35], a[72:75], v[176:179]
  ds_read_b128 v[88:91], v33 offset:12288
  v_mfma_f32_16x16x32_bf16 v[180:183], a[32:35], a[76:79], v[180:183]
  ds_read_b128 v[92:95], v33 offset:13312
  v_mfma_f32_16x16x32_bf16 v[176:179], a[68:71], a[88:91], v[176:179]
  ds_read_b128 v[96:99], v33 offset:14336
  v_mfma_f32_16x16x32_bf16 v[180:183], a[68:71], a[92:95], v[180:183]
  ds_read_b128 v[100:103], v33 offset:15360
  v_mfma_f32_16x16x32_bf16 v[176:179], a[168:171], a[104:107], v[176:179]
  ds_read_b128 v[104:107], v33 offset:16384
  v_mfma_f32_16x16x32_bf16 v[180:183], a[168:171], a[108:111], v[180:183]
  ds_read_b128 v[108:111], v33 offset:17408
  v_mfma_f32_16x16x32_bf16 v[176:179], a[204:207], a[120:123], v[176:179]
  v_mfma_f32_16x16x32_bf16 v[180:183], a[204:207], a[124:127], v[180:183]
L_epi:
  v_add_u32 v32, 73728, v4
  s_cmp_eq_u32 s79, 1
  s_cbranch_scc1 L_own
  s_waitcnt lgkmcnt(15)
  v_pk_add_f32 v[112:113], v[112:113], v[40:41]
  v_pk_add_f32 v[114:115], v[114:115], v[42:43]
  v_pk_add_f32 v[116:117], v[116:117], v[44:45]
  v_pk_add_f32 v[118:119], v[118:119], v[46:47]
  v_cvt_pk_bf16_f32 v112, v112, v113
  v_cvt_pk_bf16_f32 v113, v114, v115
  v_cvt_pk_bf16_f32 v114, v116, v117
  v_cvt_pk_bf16_f32 v115, v118, v119
  buffer_store_dwordx4 v[112:115], v4, s[16:19], s75 offen offset:0 sc1
  s_waitcnt lgkmcnt(14)
  v_pk_add_f32 v[120:121], v[120:121], v[48:49]
  v_pk_add_f32 v[122:123], v[122:123], v[50:51]
  v_pk_add_f32 v[124:125], v[124:125], v[52:53]
  v_pk_add_f32 v[126:127], v[126:127], v[54:55]
  v_cvt_pk_bf16_f32 v120, v120, v121
  v_cvt_pk_bf16_f32 v121, v122, v123
  v_cvt_pk_bf16_f32 v122, v124, v125
  v_cvt_pk_bf16_f32 v123, v126, v127
  buffer_store_dwordx4 v[120:123], v4, s[16:19], s75 offen offset:1024 sc1
  s_waitcnt lgkmcnt(12)
  v_pk_add_f32 v[128:129], v[128:129], v[56:57]
  v_pk_add_f32 v[130:131], v[130:131], v[58:59]
  v_pk_add_f32 v[132:133], v[132:133], v[60:61]
  v_pk_add_f32 v[134:135], v[134:135], v[62:63]
  v_cvt_pk_bf16_f32 v128, v128, v129
  v_cvt_pk_bf16_f32 v129, v130, v131
  v_cvt_pk_bf16_f32 v130, v132, v133
  v_cvt_pk_bf16_f32 v131, v134, v135
  buffer_store_dwordx4 v[128:131], v4, s[16:19], s75 offen offset:2048 sc1
  s_waitcnt lgkmcnt(10)
  v_pk_add_f32 v[136:137], v[136:137], v[64:65]
  v_pk_add_f32 v[138:139], v[138:139], v[66:67]
  v_pk_add_f32 v[140:141], v[140:141], v[68:69]
  v_pk_add_f32 v[142:143], v[142:143], v[70:71]
  v_cvt_pk_bf16_f32 v136, v136, v137
  v_cvt_pk_bf16_f32 v137, v138, v139
  v_cvt_pk_bf16_f32 v138, v140, v141
  v_cvt_pk_bf16_f32 v139, v142, v143
  buffer_store_dwordx4 v[136:139], v4, s[16:19], s75 offen offset:3072 sc1
  s_waitcnt lgkmcnt(8)
  v_pk_add_f32 v[144:145], v[144:145], v[72:73]
  v_pk_add_f32 v[146:147], v[146:147], v[74:75]
  v_pk_add_f32 v[148:149], v[148:149], v[76:77]
  v_pk_add_f32 v[150:151], v[150:151], v[78:79]
  v_cvt_pk_bf16_f32 v144, v144, v145
  v_cvt_pk_bf16_f32 v145, v146, v147
  v_cvt_pk_bf16_f32 v146, v148, v149
  v_cvt_pk_bf16_f32 v147, v150, v151
  s_add_u32 s75, s75, 4096
  buffer_store_dwordx4 v[144:147], v4, s[16:19], s75 offen offset:0 sc1
  s_waitcnt lgkmcnt(6)
  v_pk_add_f32 v[152:153], v[152:153], v[80:81]
  v_pk_add_f32 v[154:155], v[154:155], v[82:83]
  v_pk_add_f32 v[156:157], v[156:157], v[84:85]
  v_pk_add_f32 v[158:159], v[158:159], v[86:87]
  v_cvt_pk_bf16_f32 v152, v152, v153
  v_cvt_pk_bf16_f32 v153, v154, v155
  v_cvt_pk_bf16_f32 v154, v156, v157
  v_cvt_pk_bf16_f32 v155, v158, v159
  buffer_store_dwordx4 v[152:155], v4, s[16:19], s75 offen offset:1024 sc1
  s_waitcnt lgkmcnt(4)
  v_pk_add_f32 v[160:161], v[160:161], v[88:89]
  v_pk_add_f32 v[162:163], v[162:163], v[90:91]
  v_pk_add_f32 v[164:165], v[164:165], v[92:93]
  v_pk_add_f32 v[166:167], v[166:167], v[94:95]
  v_cvt_pk_bf16_f32 v160, v160, v161
  v_cvt_pk_bf16_f32 v161, v162, v163
  v_cvt_pk_bf16_f32 v162, v164, v165
  v_cvt_pk_bf16_f32 v163, v166, v167
  buffer_store_dwordx4 v[160:163], v4, s[16:19], s75 offen offset:2048 sc1
  s_waitcnt lgkmcnt(2)
  v_pk_add_f32 v[168:169], v[168:169], v[96:97]
  v_pk_add_f32 v[170:171], v[170:171], v[98:99]
  v_pk_add_f32 v[172:173], v[172:173], v[100:101]
  v_pk_add_f32 v[174:175], v[174:175], v[102:103]
  v_cvt_pk_bf16_f32 v168, v168, v169
  v_cvt_pk_bf16_f32 v169, v170, v171
  v_cvt_pk_bf16_f32 v170, v172, v173
  v_cvt_pk_bf16_f32 v171, v174, v175
  buffer_store_dwordx4 v[168:171], v4, s[16:19], s75 offen offset:3072 sc1
  s_waitcnt lgkmcnt(0)
  v_pk_add_f32 v[176:177], v[176:177], v[104:105]
  v_pk_add_f32 v[178:179], v[178:179], v[106:107]
  v_pk_add_f32 v[180:181], v[180:181], v[108:109]
  v_pk_add_f32 v[182:183], v[182:183], v[110:111]
  v_cvt_pk_bf16_f32 v176, v176, v177
  v_cvt_pk_bf16_f32 v177, v178, v179
  v_cvt_pk_bf16_f32 v178, v180, v181
  v_cvt_pk_bf16_f32 v179, v182, v183
  s_add_u32 s75, s75, 4096
  buffer_store_dwordx4 v[176:179], v4, s[16:19], s75 offen offset:0 sc1
  v_mov_b32 v8, s100
  v_mov_b32 v9, 0
  s_barrier
  s_waitcnt vmcnt(0)
  s_mov_b64 exec, 1
  buffer_store_dword v8, v9, s[64:67], s77 offen sc1
  s_mov_b64 exec, -1
  s_branch L_pub
L_own:
  s_waitcnt lgkmcnt(15)
  v_pk_add_f32 v[112:113], v[112:113], v[40:41]
  v_pk_add_f32 v[114:115], v[114:115], v[42:43]
  v_pk_add_f32 v[116:117], v[116:117], v[44:45]
  v_pk_add_f32 v[118:119], v[118:119], v[46:47]
  v_cvt_pk_bf16_f32 v112, v112, v113
  v_cvt_pk_bf16_f32 v113, v114, v115
  v_cvt_pk_bf16_f32 v114, v116, v117
  v_cvt_pk_bf16_f32 v115, v118, v119
  ds_write_b128 v32, v[112:115] offset:0
  s_waitcnt lgkmcnt(15)
  v_pk_add_f32 v[120:121], v[120:121], v[48:49]
  v_pk_add_f32 v[122:123], v[122:123], v[50:51]
  v_pk_add_f32 v[124:125], v[124:125], v[52:53]
  v_pk_add_f32 v[126:127], v[126:127], v[54:55]
  v_cvt_pk_bf16_f32 v120, v120, v121
  v_cvt_pk_bf16_f32 v121, v122, v123
  v_cvt_pk_bf16_f32 v122, v124, v125
  v_cvt_pk_bf16_f32 v123, v126, v127
  ds_write_b128 v32, v[120:123] offset:1024
  s_waitcnt lgkmcnt(14)
  v_pk_add_f32 v[128:129], v[128:129], v[56:57]
  v_pk_add_f32 v[130:131], v[130:131], v[58:59]
  v_pk_add_f32 v[132:133], v[132:133], v[60:61]
  v_pk_add_f32 v[134:135], v[134:135], v[62:63]
  v_cvt_pk_bf16_f32 v128, v128, v129
  v_cvt_pk_bf16_f32 v129, v130, v131
  v_cvt_pk_bf16_f32 v130, v132, v133
  v_cvt_pk_bf16_f32 v131, v134, v135
  ds_write_b128 v32, v[128:131] offset:2048
  s_waitcnt lgkmcnt(13)
  v_pk_add_f32 v[136:137], v[136:137], v[64:65]
  v_pk_add_f32 v[138:139], v[138:139], v[66:67]
  v_pk_add_f32 v[140:141], v[140:141], v[68:69]
  v_pk_add_f32 v[142:143], v[142:143], v[70:71]
  v_cvt_pk_bf16_f32 v136, v136, v137
  v_cvt_pk_bf16_f32 v137, v138, v139
  v_cvt_pk_bf16_f32 v138, v140, v141
  v_cvt_pk_bf16_f32 v139, v142, v143
  ds_write_b128 v32, v[136:139] offset:3072
  s_waitcnt lgkmcnt(12)
  v_pk_add_f32 v[144:145], v[144:145], v[72:73]
  v_pk_add_f32 v[146:147], v[146:147], v[74:75]
  v_pk_add_f32 v[148:149], v[148:149], v[76:77]
  v_pk_add_f32 v[150:151], v[150:151], v[78:79]
  v_cvt_pk_bf16_f32 v144, v144, v145
  v_cvt_pk_bf16_f32 v145, v146, v147
  v_cvt_pk_bf16_f32 v146, v148, v149
  v_cvt_pk_bf16_f32 v147, v150, v151
  ds_write_b128 v32, v[144:147] offset:4096
  s_waitcnt lgkmcnt(11)
  v_pk_add_f32 v[152:153], v[152:153], v[80:81]
  v_pk_add_f32 v[154:155], v[154:155], v[82:83]
  v_pk_add_f32 v[156:157], v[156:157], v[84:85]
  v_pk_add_f32 v[158:159], v[158:159], v[86:87]
  v_cvt_pk_bf16_f32 v152, v152, v153
  v_cvt_pk_bf16_f32 v153, v154, v155
  v_cvt_pk_bf16_f32 v154, v156, v157
  v_cvt_pk_bf16_f32 v155, v158, v159
  ds_write_b128 v32, v[152:155] offset:5120
  s_waitcnt lgkmcnt(10)
  v_pk_add_f32 v[160:161], v[160:161], v[88:89]
  v_pk_add_f32 v[162:163], v[162:163], v[90:91]
  v_pk_add_f32 v[164:165], v[164:165], v[92:93]
  v_pk_add_f32 v[166:167], v[166:167], v[94:95]
  v_cvt_pk_bf16_f32 v160, v160, v161
  v_cvt_pk_bf16_f32 v161, v162, v163
  v_cvt_pk_bf16_f32 v162, v164, v165
  v_cvt_pk_bf16_f32 v163, v166, v167
  ds_write_b128 v32, v[160:163] offset:6144
  s_waitcnt lgkmcnt(9)
  v_pk_add_f32 v[168:169], v[168:169], v[96:97]
  v_pk_add_f32 v[170:171], v[170:171], v[98:99]
  v_pk_add_f32 v[172:173], v[172:173], v[100:101]
  v_pk_add_f32 v[174:175], v[174:175], v[102:103]
  v_cvt_pk_bf16_f32 v168, v168, v169
  v_cvt_pk_bf16_f32 v169, v170, v171
  v_cvt_pk_bf16_f32 v170, v172, v173
  v_cvt_pk_bf16_f32 v171, v174, v175
  ds_write_b128 v32, v[168:171] offset:7168
  s_waitcnt lgkmcnt(8)
  v_pk_add_f32 v[176:177], v[176:177], v[104:105]
  v_pk_add_f32 v[178:179], v[178:179], v[106:107]
  v_pk_add_f32 v[180:181], v[180:181], v[108:109]
  v_pk_add_f32 v[182:183], v[182:183], v[110:111]
  v_cvt_pk_bf16_f32 v176, v176, v177
  v_cvt_pk_bf16_f32 v177, v178, v179
  v_cvt_pk_bf16_f32 v178, v180, v181
  v_cvt_pk_bf16_f32 v179, v182, v183
  ds_write_b128 v32, v[176:179] offset:8192
  s_waitcnt lgkmcnt(0)
  s_barrier
L_pub:
  s_lshl_b32 s3, s28, 10
  v_add_u32 v32, s3, v32
  ds_read_b128 v[184:187], v32 offset:0
  ds_read_b128 v[188:191], v32 offset:4096
  ds_read_b128 v[192:195], v32 offset:8192
  s_mov_b32 s4, 0xffff0000
  v_mov_b32 v12, 0xbfb8aa3b
  v_mov_b32 v14, 1.0
  v_and_b32 v10, 3, v1
  v_cmp_ne_u32 s[62:63], s29, v10
  v_lshlrev_b32 v10, 2, v10
  v_add_u32 v10, s78, v10
  s_xor_b32 s3, s29, 1
  s_mul_i32 s3, s3, 9216
  s_add_u32 s68, s3, s76
  s_xor_b32 s3, s29, 2
  s_mul_i32 s3, s3, 9216
  s_add_u32 s69, s3, s76
  s_xor_b32 s3, s29, 3
  s_mul_i32 s3, s3, 9216
  s_add_u32 s70, s3, s76
  s_lshl_b32 s6, 1, s29
  s_xor_b32 s6, s6, 15
  s_mov_b32 s7, 0x80000
  v_add_u32 v16, 4096, v4
  s_cmp_eq_u32 s28, 0
  s_cselect_b32 s3, 0, 2080374528
  s_add_u32 s3, s3, 8192
  v_add_u32 v17, s3, v4
L_p2:
  buffer_load_dword v11, v10, s[64:67], 0 offen sc1
  s_waitcnt vmcnt(0)
  v_cmp_eq_u32 vcc, s100, v11
  s_and_b32 s5, vcc_lo, s6
  s_cbranch_scc0 L_p2_none
  s_xor_b32 s6, s6, s5
  s_xor_b32 s3, s29, 1
  s_bitcmp1_b32 s5, s3
  s_cbranch_scc0 L_p2_s0
  buffer_load_dwordx4 v[128:131], v4, s[16:19], s68 offen sc1
  buffer_load_dwordx4 v[140:143], v16, s[16:19], s68 offen sc1
  buffer_load_dwordx4 v[152:155], v17, s[16:19], s68 offen sc1
L_p2_s0:
  s_xor_b32 s3, s29, 2
  s_bitcmp1_b32 s5, s3
  s_cbranch_scc0 L_p2_s1
  buffer_load_dwordx4 v[132:135], v4, s[16:19], s69 offen sc1
  buffer_load_dwordx4 v[144:147], v16, s[16:19], s69 offen sc1
  buffer_load_dwordx4 v[156:159], v17, s[16:19], s69 offen sc1
L_p2_s1:
  s_xor_b32 s3, s29, 3
  s_bitcmp1_b32 s5, s3
  s_cbranch_scc0 L_p2_s2
  buffer_load_dwordx4 v[136:139], v4, s[16:19], s70 offen sc1
  buffer_load_dwordx4 v[148:151], v16, s[16:19], s70 offen sc1
  buffer_load_dwordx4 v[160:163], v17, s[16:19], s70 offen sc1
L_p2_s2:
  s_cmp_eq_u32 s6, 0
  s_cbranch_scc1 L_p2_ok
L_p2_none:
  s_sub_u32 s7, s7, 1
  s_cmp_lg_u32 s7, 0
  s_cbranch_scc1 L_p2
L_p2_ok:
  s_waitcnt lgkmcnt(0)
  s_cmp_ge_u32 s29, 2
  s_cbranch_scc1 L_finB
  s_waitcnt vmcnt(2)
  v_lshlrev_b32 v40, 16, v132
  v_and_b32 v41, s4, v132
  v_lshlrev_b32 v42, 16, v133
  v_and_b32 v43, s4, v133
  v_lshlrev_b32 v44, 16, v134
  v_and_b32 v45, s4, v134
  v_lshlrev_b32 v46, 16, v135
  v_and_b32 v47, s4, v135
  v_lshlrev_b32 v48, 16, v136
  v_and_b32 v49, s4, v136
  v_lshlrev_b32 v50, 16, v137
  v_and_b32 v51, s4, v137
  v_lshlrev_b32 v52, 16, v138
  v_and_b32 v53, s4, v138
  v_lshlrev_b32 v54, 16, v139
  v_and_b32 v55, s4, v139
  v_pk_add_f32 v[40:41], v[40:41], v[48:49]
  v_pk_add_f32 v[42:43], v[42:43], v[50:51]
  v_pk_add_f32 v[44:45], v[44:45], v[52:53]
  v_pk_add_f32 v[46:47], v[46:47], v[54:55]
  v_pk_mul_f32 v[48:49], v[40:41], v[12:13] op_sel_hi:[1,0]
  v_pk_mul_f32 v[50:51], v[42:43], v[12:13] op_sel_hi:[1,0]
  v_pk_mul_f32 v[52:53], v[44:45], v[12:13] op_sel_hi:[1,0]
  v_pk_mul_f32 v[54:55], v[46:47], v[12:13] op_sel_hi:[1,0]
  v_exp_f32 v48, v48
  v_exp_f32 v49, v49
  v_exp_f32 v50, v50
  v_exp_f32 v51, v51
  v_exp_f32 v52, v52
  v_exp_f32 v53, v53
  v_exp_f32 v54, v54
  v_exp_f32 v55, v55
  v_lshlrev_b32 v56, 16, v184
  v_and_b32 v57, s4, v184
  v_lshlrev_b32 v58, 16, v185
  v_and_b32 v59, s4, v185
  v_lshlrev_b32 v60, 16, v186
  v_and_b32 v61, s4, v186
  v_lshlrev_b32 v62, 16, v187
  v_and_b32 v63, s4, v187
  v_lshlrev_b32 v64, 16, v128
  v_and_b32 v65, s4, v128
  v_lshlrev_b32 v66, 16, v129
  v_and_b32 v67, s4, v129
  v_lshlrev_b32 v68, 16, v130
  v_and_b32 v69, s4, v130
  v_lshlrev_b32 v70, 16, v131
  v_and_b32 v71, s4, v131
  v_pk_add_f32 v[56:57], v[56:57], v[64:65]
  v_pk_add_f32 v[58:59], v[58:59], v[66:67]
  v_pk_add_f32 v[60:61], v[60:61], v[68:69]
  v_pk_add_f32 v[62:63], v[62:63], v[70:71]
  v_pk_add_f32 v[48:49], v[48:49], v[14:15] op_sel_hi:[1,0]
  v_pk_add_f32 v[50:51], v[50:51], v[14:15] op_sel_hi:[1,0]
  v_pk_add_f32 v[52:53], v[52:53], v[14:15] op_sel_hi:[1,0]
  v_pk_add_f32 v[54:55], v[54:55], v[14:15] op_sel_hi:[1,0]
  v_rcp_f32 v48, v48
  v_rcp_f32 v49, v49
  v_rcp_f32 v50, v50
  v_rcp_f32 v51, v51
  v_rcp_f32 v52, v52
  v_rcp_f32 v53, v53
  v_rcp_f32 v54, v54
  v_rcp_f32 v55, v55
  v_lshlrev_b32 v64, 16, v18
  v_and_b32 v65, s4, v18
  v_lshlrev_b32 v66, 16, v19
  v_and_b32 v67, s4, v19
  v_lshlrev_b32 v68, 16, v20
  v_and_b32 v69, s4, v20
  v_lshlrev_b32 v70, 16, v21
  v_and_b32 v71, s4, v21
  v_pk_mul_f32 v[40:41], v[40:41], v[48:49]
  v_pk_mul_f32 v[42:43], v[42:43], v[50:51]
  v_pk_mul_f32 v[44:45], v[44:45], v[52:53]
  v_pk_mul_f32 v[46:47], v[46:47], v[54:55]
  v_pk_fma_f32 v[40:41], v[40:41], v[56:57], v[64:65]
  v_pk_fma_f32 v[42:43], v[42:43], v[58:59], v[66:67]
  v_pk_fma_f32 v[44:45], v[44:45], v[60:61], v[68:69]
  v_pk_fma_f32 v[46:47], v[46:47], v[62:63], v[70:71]
  v_cvt_pk_bf16_f32 v40, v40, v41
  v_cvt_pk_bf16_f32 v41, v42, v43
  v_cvt_pk_bf16_f32 v42, v44, v45
  v_cvt_pk_bf16_f32 v43, v46, v47
  buffer_store_dwordx2 v[40:41], v30, s[24:27], s35 offen offset:0
  buffer_store_dwordx2 v[42:43], v31, s[24:27], s35 offen offset:0
  s_waitcnt vmcnt(3)
  v_lshlrev_b32 v72, 16, v144
  v_and_b32 v73, s4, v144
  v_lshlrev_b32 v74, 16, v145
  v_and_b32 v75, s4, v145
  v_lshlrev_b32 v76, 16, v146
  v_and_b32 v77, s4, v146
  v_lshlrev_b32 v78, 16, v147
  v_and_b32 v79, s4, v147
  v_lshlrev_b32 v80, 16, v148
  v_and_b32 v81, s4, v148
  v_lshlrev_b32 v82, 16, v149
  v_and_b32 v83, s4, v149
  v_lshlrev_b32 v84, 16, v150
  v_and_b32 v85, s4, v150
  v_lshlrev_b32 v86, 16, v151
  v_and_b32 v87, s4, v151
  v_pk_add_f32 v[72:73], v[72:73], v[80:81]
  v_pk_add_f32 v[74:75], v[74:75], v[82:83]
  v_pk_add_f32 v[76:77], v[76:77], v[84:85]
  v_pk_add_f32 v[78:79], v[78:79], v[86:87]
  v_pk_mul_f32 v[80:81], v[72:73], v[12:13] op_sel_hi:[1,0]
  v_pk_mul_f32 v[82:83], v[74:75], v[12:13] op_sel_hi:[1,0]
  v_pk_mul_f32 v[84:85], v[76:77], v[12:13] op_sel_hi:[1,0]
  v_pk_mul_f32 v[86:87], v[78:79], v[12:13] op_sel_hi:[1,0]
  v_exp_f32 v80, v80
  v_exp_f32 v81, v81
  v_exp_f32 v82, v82
  v_exp_f32 v83, v83
  v_exp_f32 v84, v84
  v_exp_f32 v85, v85
  v_exp_f32 v86, v86
  v_exp_f32 v87, v87
  v_lshlrev_b32 v88, 16, v188
  v_and_b32 v89, s4, v188
  v_lshlrev_b32 v90, 16, v189
  v_and_b32 v91, s4, v189
  v_lshlrev_b32 v92, 16, v190
  v_and_b32 v93, s4, v190
  v_lshlrev_b32 v94, 16, v191
  v_and_b32 v95, s4, v191
  v_lshlrev_b32 v96, 16, v140
  v_and_b32 v97, s4, v140
  v_lshlrev_b32 v98, 16, v141
  v_and_b32 v99, s4, v141
  v_lshlrev_b32 v100, 16, v142
  v_and_b32 v101, s4, v142
  v_lshlrev_b32 v102, 16, v143
  v_and_b32 v103, s4, v143
  v_pk_add_f32 v[88:89], v[88:89], v[96:97]
  v_pk_add_f32 v[90:91], v[90:91], v[98:99]
  v_pk_add_f32 v[92:93], v[92:93], v[100:101]
  v_pk_add_f32 v[94:95], v[94:95], v[102:103]
  v_pk_add_f32 v[80:81], v[80:81], v[14:15] op_sel_hi:[1,0]
  v_pk_add_f32 v[82:83], v[82:83], v[14:15] op_sel_hi:[1,0]
  v_pk_add_f32 v[84:85], v[84:85], v[14:15] op_sel_hi:[1,0]
  v_pk_add_f32 v[86:87], v[86:87], v[14:15] op_sel_hi:[1,0]
  v_rcp_f32 v80, v80
  v_rcp_f32 v81, v81
  v_rcp_f32 v82, v82
  v_rcp_f32 v83, v83
  v_rcp_f32 v84, v84
  v_rcp_f32 v85, v85
  v_rcp_f32 v86, v86
  v_rcp_f32 v87, v87
  v_lshlrev_b32 v96, 16, v22
  v_and_b32 v97, s4, v22
  v_lshlrev_b32 v98, 16, v23
  v_and_b32 v99, s4, v23
  v_lshlrev_b32 v100, 16, v24
  v_and_b32 v101, s4, v24
  v_lshlrev_b32 v102, 16, v25
  v_and_b32 v103, s4, v25
  v_pk_mul_f32 v[72:73], v[72:73], v[80:81]
  v_pk_mul_f32 v[74:75], v[74:75], v[82:83]
  v_pk_mul_f32 v[76:77], v[76:77], v[84:85]
  v_pk_mul_f32 v[78:79], v[78:79], v[86:87]
  v_pk_fma_f32 v[72:73], v[72:73], v[88:89], v[96:97]
  v_pk_fma_f32 v[74:75], v[74:75], v[90:91], v[98:99]
  v_pk_fma_f32 v[76:77], v[76:77], v[92:93], v[100:101]
  v_pk_fma_f32 v[78:79], v[78:79], v[94:95], v[102:103]
  v_cvt_pk_bf16_f32 v72, v72, v73
  v_cvt_pk_bf16_f32 v73, v74, v75
  v_cvt_pk_bf16_f32 v74, v76, v77
  v_cvt_pk_bf16_f32 v75, v78, v79
  buffer_store_dwordx2 v[72:73], v30, s[24:27], s35 offen offset:128
  buffer_store_dwordx2 v[74:75], v31, s[24:27], s35 offen offset:128
  s_cmp_lg_u32 s28, 0
  s_cbranch_scc1 L_fin
  s_waitcnt vmcnt(4)
  v_lshlrev_b32 v40, 16, v156
  v_and_b32 v41, s4, v156
  v_lshlrev_b32 v42, 16, v157
  v_and_b32 v43, s4, v157
  v_lshlrev_b32 v44, 16, v158
  v_and_b32 v45, s4, v158
  v_lshlrev_b32 v46, 16, v159
  v_and_b32 v47, s4, v159
  v_lshlrev_b32 v48, 16, v160
  v_and_b32 v49, s4, v160
  v_lshlrev_b32 v50, 16, v161
  v_and_b32 v51, s4, v161
  v_lshlrev_b32 v52, 16, v162
  v_and_b32 v53, s4, v162
  v_lshlrev_b32 v54, 16, v163
  v_and_b32 v55, s4, v163
  v_pk_add_f32 v[40:41], v[40:41], v[48:49]
  v_pk_add_f32 v[42:43], v[42:43], v[50:51]
  v_pk_add_f32 v[44:45], v[44:45], v[52:53]
  v_pk_add_f32 v[46:47], v[46:47], v[54:55]
  v_pk_mul_f32 v[48:49], v[40:41], v[12:13] op_sel_hi:[1,0]
  v_pk_mul_f32 v[50:51], v[42:43], v[12:13] op_sel_hi:[1,0]
  v_pk_mul_f32 v[52:53], v[44:45], v[12:13] op_sel_hi:[1,0]
  v_pk_mul_f32 v[54:55], v[46:47], v[12:13] op_sel_hi:[1,0]
  v_exp_f32 v48, v48
  v_exp_f32 v49, v49
  v_exp_f32 v50, v50
  v_exp_f32 v51, v51
  v_exp_f32 v52, v52
  v_exp_f32 v53, v53
  v_exp_f32 v54, v54
  v_exp_f32 v55, v55
  v_lshlrev_b32 v56, 16, v192
  v_and_b32 v57, s4, v192
  v_lshlrev_b32 v58, 16, v193
  v_and_b32 v59, s4, v193
  v_lshlrev_b32 v60, 16, v194
  v_and_b32 v61, s4, v194
  v_lshlrev_b32 v62, 16, v195
  v_and_b32 v63, s4, v195
  v_lshlrev_b32 v64, 16, v152
  v_and_b32 v65, s4, v152
  v_lshlrev_b32 v66, 16, v153
  v_and_b32 v67, s4, v153
  v_lshlrev_b32 v68, 16, v154
  v_and_b32 v69, s4, v154
  v_lshlrev_b32 v70, 16, v155
  v_and_b32 v71, s4, v155
  v_pk_add_f32 v[56:57], v[56:57], v[64:65]
  v_pk_add_f32 v[58:59], v[58:59], v[66:67]
  v_pk_add_f32 v[60:61], v[60:61], v[68:69]
  v_pk_add_f32 v[62:63], v[62:63], v[70:71]
  v_pk_add_f32 v[48:49], v[48:49], v[14:15] op_sel_hi:[1,0]
  v_pk_add_f32 v[50:51], v[50:51], v[14:15] op_sel_hi:[1,0]
  v_pk_add_f32 v[52:53], v[52:53], v[14:15] op_sel_hi:[1,0]
  v_pk_add_f32 v[54:55], v[54:55], v[14:15] op_sel_hi:[1,0]
  v_rcp_f32 v48, v48
  v_rcp_f32 v49, v49
  v_rcp_f32 v50, v50
  v_rcp_f32 v51, v51
  v_rcp_f32 v52, v52
  v_rcp_f32 v53, v53
  v_rcp_f32 v54, v54
  v_rcp_f32 v55, v55
  v_lshlrev_b32 v64, 16, v26
  v_and_b32 v65, s4, v26
  v_lshlrev_b32 v66, 16, v27
  v_and_b32 v67, s4, v27
  v_lshlrev_b32 v68, 16, v28
  v_and_b32 v69, s4, v28
  v_lshlrev_b32 v70, 16, v29
  v_and_b32 v71, s4, v29
  v_pk_mul_f32 v[40:41], v[40:41], v[48:49]
  v_pk_mul_f32 v[42:43], v[42:43], v[50:51]
  v_pk_mul_f32 v[44:45], v[44:45], v[52:53]
  v_pk_mul_f32 v[46:47], v[46:47], v[54:55]
  v_pk_fma_f32 v[40:41], v[40:41], v[56:57], v[64:65]
  v_pk_fma_f32 v[42:43], v[42:43], v[58:59], v[66:67]
  v_pk_fma_f32 v[44:45], v[44:45], v[60:61], v[68:69]
  v_pk_fma_f32 v[46:47], v[46:47], v[62:63], v[70:71]
  v_cvt_pk_bf16_f32 v40, v40, v41
  v_cvt_pk_bf16_f32 v41, v42, v43
  v_cvt_pk_bf16_f32 v42, v44, v45
  v_cvt_pk_bf16_f32 v43, v46, v47
  buffer_store_dwordx2 v[40:41], v30, s[24:27], s35 offen offset:256
  buffer_store_dwordx2 v[42:43], v31, s[24:27], s35 offen offset:256
  s_branch L_fin
L_finB:
  s_waitcnt vmcnt(2)
  v_lshlrev_b32 v40, 16, v184
  v_and_b32 v41, s4, v184
  v_lshlrev_b32 v42, 16, v185
  v_and_b32 v43, s4, v185
  v_lshlrev_b32 v44, 16, v186
  v_and_b32 v45, s4, v186
  v_lshlrev_b32 v46, 16, v187
  v_and_b32 v47, s4, v187
  v_lshlrev_b32 v48, 16, v128
  v_and_b32 v49, s4, v128
  v_lshlrev_b32 v50, 16, v129
  v_and_b32 v51, s4, v129
  v_lshlrev_b32 v52, 16, v130
  v_and_b32 v53, s4, v130
  v_lshlrev_b32 v54, 16, v131
  v_and_b32 v55, s4, v131
  v_pk_add_f32 v[40:41], v[40:41], v[48:49]
  v_pk_add_f32 v[42:43], v[42:43], v[50:51]
  v_pk_add_f32 v[44:45], v[44:45], v[52:53]
  v_pk_add_f32 v[46:47], v[46:47], v[54:55]
  v_pk_mul_f32 v[48:49], v[40:41], v[12:13] op_sel_hi:[1,0]
  v_pk_mul_f32 v[50:51], v[42:43], v[12:13] op_sel_hi:[1,0]
  v_pk_mul_f32 v[52:53], v[44:45], v[12:13] op_sel_hi:[1,0]
  v_pk_mul_f32 v[54:55], v[46:47], v[12:13] op_sel_hi:[1,0]
  v_exp_f32 v48, v48
  v_exp_f32 v49, v49
  v_exp_f32 v50, v50
  v_exp_f32 v51, v51
  v_exp_f32 v52, v52
  v_exp_f32 v53, v53
  v_exp_f32 v54, v54
  v_exp_f32 v55, v55
  v_lshlrev_b32 v56, 16, v132
  v_and_b32 v57, s4, v132
  v_lshlrev_b32 v58, 16, v133
  v_and_b32 v59, s4, v133
  v_lshlrev_b32 v60, 16, v134
  v_and_b32 v61, s4, v134
  v_lshlrev_b32 v62, 16, v135
  v_and_b32 v63, s4, v135
  v_lshlrev_b32 v64, 16, v136
  v_and_b32 v65, s4, v136
  v_lshlrev_b32 v66, 16, v137
  v_and_b32 v67, s4, v137
  v_lshlrev_b32 v68, 16, v138
  v_and_b32 v69, s4, v138
  v_lshlrev_b32 v70, 16, v139
  v_and_b32 v71, s4, v139
  v_pk_add_f32 v[56:57], v[56:57], v[64:65]
  v_pk_add_f32 v[58:59], v[58:59], v[66:67]
  v_pk_add_f32 v[60:61], v[60:61], v[68:69]
  v_pk_add_f32 v[62:63], v[62:63], v[70:71]
  v_pk_add_f32 v[48:49], v[48:49], v[14:15] op_sel_hi:[1,0]
  v_pk_add_f32 v[50:51], v[50:51], v[14:15] op_sel_hi:[1,0]
  v_pk_add_f32 v[52:53], v[52:53], v[14:15] op_sel_hi:[1,0]
  v_pk_add_f32 v[54:55], v[54:55], v[14:15] op_sel_hi:[1,0]
  v_rcp_f32 v48, v48
  v_rcp_f32 v49, v49
  v_rcp_f32 v50, v50
  v_rcp_f32 v51, v51
  v_rcp_f32 v52, v52
  v_rcp_f32 v53, v53
  v_rcp_f32 v54, v54
  v_rcp_f32 v55, v55
  v_lshlrev_b32 v64, 16, v18
  v_and_b32 v65, s4, v18
  v_lshlrev_b32 v66, 16, v19
  v_and_b32 v67, s4, v19
  v_lshlrev_b32 v68, 16, v20
  v_and_b32 v69, s4, v20
  v_lshlrev_b32 v70, 16, v21
  v_and_b32 v71, s4, v21
  v_pk_mul_f32 v[40:41], v[40:41], v[48:49]
  v_pk_mul_f32 v[42:43], v[42:43], v[50:51]
  v_pk_mul_f32 v[44:45], v[44:45], v[52:53]
  v_pk_mul_f32 v[46:47], v[46:47], v[54:55]
  v_pk_fma_f32 v[40:41], v[40:41], v[56:57], v[64:65]
  v_pk_fma_f32 v[42:43], v[42:43], v[58:59], v[66:67]
  v_pk_fma_f32 v[44:45], v[44:45], v[60:61], v[68:69]
  v_pk_fma_f32 v[46:47], v[46:47], v[62:63], v[70:71]
  v_cvt_pk_bf16_f32 v40, v40, v41
  v_cvt_pk_bf16_f32 v41, v42, v43
  v_cvt_pk_bf16_f32 v42, v44, v45
  v_cvt_pk_bf16_f32 v43, v46, v47
  buffer_store_dwordx2 v[40:41], v30, s[24:27], s35 offen offset:0
  buffer_store_dwordx2 v[42:43], v31, s[24:27], s35 offen offset:0
  s_waitcnt vmcnt(3)
  v_lshlrev_b32 v72, 16, v188
  v_and_b32 v73, s4, v188
  v_lshlrev_b32 v74, 16, v189
  v_and_b32 v75, s4, v189
  v_lshlrev_b32 v76, 16, v190
  v_and_b32 v77, s4, v190
  v_lshlrev_b32 v78, 16, v191
  v_and_b32 v79, s4, v191
  v_lshlrev_b32 v80, 16, v140
  v_and_b32 v81, s4, v140
  v_lshlrev_b32 v82, 16, v141
  v_and_b32 v83, s4, v141
  v_lshlrev_b32 v84, 16, v142
  v_and_b32 v85, s4, v142
  v_lshlrev_b32 v86, 16, v143
  v_and_b32 v87, s4, v143
  v_pk_add_f32 v[72:73], v[72:73], v[80:81]
  v_pk_add_f32 v[74:75], v[74:75], v[82:83]
  v_pk_add_f32 v[76:77], v[76:77], v[84:85]
  v_pk_add_f32 v[78:79], v[78:79], v[86:87]
  v_pk_mul_f32 v[80:81], v[72:73], v[12:13] op_sel_hi:[1,0]
  v_pk_mul_f32 v[82:83], v[74:75], v[12:13] op_sel_hi:[1,0]
  v_pk_mul_f32 v[84:85], v[76:77], v[12:13] op_sel_hi:[1,0]
  v_pk_mul_f32 v[86:87], v[78:79], v[12:13] op_sel_hi:[1,0]
  v_exp_f32 v80, v80
  v_exp_f32 v81, v81
  v_exp_f32 v82, v82
  v_exp_f32 v83, v83
  v_exp_f32 v84, v84
  v_exp_f32 v85, v85
  v_exp_f32 v86, v86
  v_exp_f32 v87, v87
  v_lshlrev_b32 v88, 16, v144
  v_and_b32 v89, s4, v144
  v_lshlrev_b32 v90, 16, v145
  v_and_b32 v91, s4, v145
  v_lshlrev_b32 v92, 16, v146
  v_and_b32 v93, s4, v146
  v_lshlrev_b32 v94, 16, v147
  v_and_b32 v95, s4, v147
  v_lshlrev_b32 v96, 16, v148
  v_and_b32 v97, s4, v148
  v_lshlrev_b32 v98, 16, v149
  v_and_b32 v99, s4, v149
  v_lshlrev_b32 v100, 16, v150
  v_and_b32 v101, s4, v150
  v_lshlrev_b32 v102, 16, v151
  v_and_b32 v103, s4, v151
  v_pk_add_f32 v[88:89], v[88:89], v[96:97]
  v_pk_add_f32 v[90:91], v[90:91], v[98:99]
  v_pk_add_f32 v[92:93], v[92:93], v[100:101]
  v_pk_add_f32 v[94:95], v[94:95], v[102:103]
  v_pk_add_f32 v[80:81], v[80:81], v[14:15] op_sel_hi:[1,0]
  v_pk_add_f32 v[82:83], v[82:83], v[14:15] op_sel_hi:[1,0]
  v_pk_add_f32 v[84:85], v[84:85], v[14:15] op_sel_hi:[1,0]
  v_pk_add_f32 v[86:87], v[86:87], v[14:15] op_sel_hi:[1,0]
  v_rcp_f32 v80, v80
  v_rcp_f32 v81, v81
  v_rcp_f32 v82, v82
  v_rcp_f32 v83, v83
  v_rcp_f32 v84, v84
  v_rcp_f32 v85, v85
  v_rcp_f32 v86, v86
  v_rcp_f32 v87, v87
  v_lshlrev_b32 v96, 16, v22
  v_and_b32 v97, s4, v22
  v_lshlrev_b32 v98, 16, v23
  v_and_b32 v99, s4, v23
  v_lshlrev_b32 v100, 16, v24
  v_and_b32 v101, s4, v24
  v_lshlrev_b32 v102, 16, v25
  v_and_b32 v103, s4, v25
  v_pk_mul_f32 v[72:73], v[72:73], v[80:81]
  v_pk_mul_f32 v[74:75], v[74:75], v[82:83]
  v_pk_mul_f32 v[76:77], v[76:77], v[84:85]
  v_pk_mul_f32 v[78:79], v[78:79], v[86:87]
  v_pk_fma_f32 v[72:73], v[72:73], v[88:89], v[96:97]
  v_pk_fma_f32 v[74:75], v[74:75], v[90:91], v[98:99]
  v_pk_fma_f32 v[76:77], v[76:77], v[92:93], v[100:101]
  v_pk_fma_f32 v[78:79], v[78:79], v[94:95], v[102:103]
  v_cvt_pk_bf16_f32 v72, v72, v73
  v_cvt_pk_bf16_f32 v73, v74, v75
  v_cvt_pk_bf16_f32 v74, v76, v77
  v_cvt_pk_bf16_f32 v75, v78, v79
  buffer_store_dwordx2 v[72:73], v30, s[24:27], s35 offen offset:128
  buffer_store_dwordx2 v[74:75], v31, s[24:27], s35 offen offset:128
  s_cmp_lg_u32 s28, 0
  s_cbranch_scc1 L_fin
  s_waitcnt vmcnt(4)
  v_lshlrev_b32 v40, 16, v192
  v_and_b32 v41, s4, v192
  v_lshlrev_b32 v42, 16, v193
  v_and_b32 v43, s4, v193
  v_lshlrev_b32 v44, 16, v194
  v_and_b32 v45, s4, v194
  v_lshlrev_b32 v46, 16, v195
  v_and_b32 v47, s4, v195
  v_lshlrev_b32 v48, 16, v152
  v_and_b32 v49, s4, v152
  v_lshlrev_b32 v50, 16, v153
  v_and_b32 v51, s4, v153
  v_lshlrev_b32 v52, 16, v154
  v_and_b32 v53, s4, v154
  v_lshlrev_b32 v54, 16, v155
  v_and_b32 v55, s4, v155
  v_pk_add_f32 v[40:41], v[40:41], v[48:49]
  v_pk_add_f32 v[42:43], v[42:43], v[50:51]
  v_pk_add_f32 v[44:45], v[44:45], v[52:53]
  v_pk_add_f32 v[46:47], v[46:47], v[54:55]
  v_pk_mul_f32 v[48:49], v[40:41], v[12:13] op_sel_hi:[1,0]
  v_pk_mul_f32 v[50:51], v[42:43], v[12:13] op_sel_hi:[1,0]
  v_pk_mul_f32 v[52:53], v[44:45], v[12:13] op_sel_hi:[1,0]
  v_pk_mul_f32 v[54:55], v[46:47], v[12:13] op_sel_hi:[1,0]
  v_exp_f32 v48, v48
  v_exp_f32 v49, v49
  v_exp_f32 v50, v50
  v_exp_f32 v51, v51
  v_exp_f32 v52, v52
  v_exp_f32 v53, v53
  v_exp_f32 v54, v54
  v_exp_f32 v55, v55
  v_lshlrev_b32 v56, 16, v156
  v_and_b32 v57, s4, v156
  v_lshlrev_b32 v58, 16, v157
  v_and_b32 v59, s4, v157
  v_lshlrev_b32 v60, 16, v158
  v_and_b32 v61, s4, v158
  v_lshlrev_b32 v62, 16, v159
  v_and_b32 v63, s4, v159
  v_lshlrev_b32 v64, 16, v160
  v_and_b32 v65, s4, v160
  v_lshlrev_b32 v66, 16, v161
  v_and_b32 v67, s4, v161
  v_lshlrev_b32 v68, 16, v162
  v_and_b32 v69, s4, v162
  v_lshlrev_b32 v70, 16, v163
  v_and_b32 v71, s4, v163
  v_pk_add_f32 v[56:57], v[56:57], v[64:65]
  v_pk_add_f32 v[58:59], v[58:59], v[66:67]
  v_pk_add_f32 v[60:61], v[60:61], v[68:69]
  v_pk_add_f32 v[62:63], v[62:63], v[70:71]
  v_pk_add_f32 v[48:49], v[48:49], v[14:15] op_sel_hi:[1,0]
  v_pk_add_f32 v[50:51], v[50:51], v[14:15] op_sel_hi:[1,0]
  v_pk_add_f32 v[52:53], v[52:53], v[14:15] op_sel_hi:[1,0]
  v_pk_add_f32 v[54:55], v[54:55], v[14:15] op_sel_hi:[1,0]
  v_rcp_f32 v48, v48
  v_rcp_f32 v49, v49
  v_rcp_f32 v50, v50
  v_rcp_f32 v51, v51
  v_rcp_f32 v52, v52
  v_rcp_f32 v53, v53
  v_rcp_f32 v54, v54
  v_rcp_f32 v55, v55
  v_lshlrev_b32 v64, 16, v26
  v_and_b32 v65, s4, v26
  v_lshlrev_b32 v66, 16, v27
  v_and_b32 v67, s4, v27
  v_lshlrev_b32 v68, 16, v28
  v_and_b32 v69, s4, v28
  v_lshlrev_b32 v70, 16, v29
  v_and_b32 v71, s4, v29
  v_pk_mul_f32 v[40:41], v[40:41], v[48:49]
  v_pk_mul_f32 v[42:43], v[42:43], v[50:51]
  v_pk_mul_f32 v[44:45], v[44:45], v[52:53]
  v_pk_mul_f32 v[46:47], v[46:47], v[54:55]
  v_pk_fma_f32 v[40:41], v[40:41], v[56:57], v[64:65]
  v_pk_fma_f32 v[42:43], v[42:43], v[58:59], v[66:67]
  v_pk_fma_f32 v[44:45], v[44:45], v[60:61], v[68:69]
  v_pk_fma_f32 v[46:47], v[46:47], v[62:63], v[70:71]
  v_cvt_pk_bf16_f32 v40, v40, v41
  v_cvt_pk_bf16_f32 v41, v42, v43
  v_cvt_pk_bf16_f32 v42, v44, v45
  v_cvt_pk_bf16_f32 v43, v46, v47
  buffer_store_dwordx2 v[40:41], v30, s[24:27], s35 offen offset:256
  buffer_store_dwordx2 v[42:43], v31, s[24:27], s35 offen offset:256
L_fin:
  s_endpgm
L_exit:
  s_endpgm
  .p2align 6
L_mlp1:
  s_getpc_b64 s[8:9]
  s_mov_b32 s10, 5120
  s_mov_b32 s11, 0x20000
  v_lshlrev_b32 v30, 5, v0
  buffer_load_dword v31, v30, s[8:11], 0 offen
  s_sub_u32 s3, s30, 22
  s_mul_i32 s4, s3, 11
  s_lshr_b32 s4, s4, 5
  s_mul_i32 s5, s4, 3
  s_sub_u32 s33, s3, s5
  s_mul_i32 s6, s29, 3
  s_add_u32 s32, s6, s4
  s_mul_i32 s69, s32, 384
  s_mul_i32 s70, s33, 384
  s_add_u32 s71, s69, 18579456
  s_add_u32 s72, s70, 2322432
  s_mul_i32 s75, s28, 3072
  s_lshl_b32 s7, s28, 3
  v_add_u32 v26, 0, v1
  v_mul_u32_u24 v27, 2731, v26
  v_lshrrev_b32 v27, 16, v27
  v_mul_u32_u24 v28, 24, v27
  v_sub_u32 v28, v26, v28
  v_and_b32 v29, 6, v27
  v_xor_b32 v28, v28, v29
  v_add_u32 v27, s7, v27
  v_lshlrev_b32 v28, 4, v28
  v_mul_u32_u24 v29, 9216, v27
  v_add_u32 v4, v29, v28
  v_mul_u32_u24 v29, 1152, v27
  v_add_u32 v7, v29, v28
  v_add_u32 v26, 64, v1
  v_mul_u32_u24 v27, 2731, v26
  v_lshrrev_b32 v27, 16, v27
  v_mul_u32_u24 v28, 24, v27
  v_sub_u32 v28, v26, v28
  v_and_b32 v29, 6, v27
  v_xor_b32 v28, v28, v29
  v_add_u32 v27, s7, v27
  v_lshlrev_b32 v28, 4, v28
  v_subrev_u32 v28, 1024, v28
  v_mul_u32_u24 v29, 9216, v27
  v_add_u32 v5, v29, v28
  v_mul_u32_u24 v29, 1152, v27
  v_add_u32 v8, v29, v28
  v_add_u32 v26, 128, v1
  v_mul_u32_u24 v27, 2731, v26
  v_lshrrev_b32 v27, 16, v27
  v_mul_u32_u24 v28, 24, v27
  v_sub_u32 v28, v26, v28
  v_and_b32 v29, 6, v27
  v_xor_b32 v28, v28, v29
  v_add_u32 v27, s7, v27
  v_lshlrev_b32 v28, 4, v28
  v_subrev_u32 v28, 2048, v28
  v_mul_u32_u24 v29, 9216, v27
  v_add_u32 v6, v29, v28
  v_mul_u32_u24 v29, 1152, v27
  v_add_u32 v9, v29, v28
  s_mul_i32 s4, s28, 786432
  v_lshrrev_b32 v178, 2, v177
  v_lshlrev_b32 v178, 17, v178
  v_and_b32 v179, 3, v177
  v_lshl_add_u32 v178, v179, 8, v178
  v_lshl_add_u32 v178, v176, 4, v178
  s_lshr_b32 s3, s2, 1
  s_lshl_b32 s3, s3, 10
  s_add_u32 s4, s4, s3
  s_and_b32 s3, s2, 1
  s_lshl_b32 s3, s3, 7
  s_add_u32 s4, s4, s3
  v_add_u32 v171, s4, v178
  v_lshlrev_b32 v172, 3, v176
  v_add_u32 v172, 163584, v172
  s_lshl_b32 s3, s28, 6
  v_add_u32 v173, s3, v172
  s_barrier
  s_load_dword s100, s[60:61], 0
  s_mov_b32 s8, s48
  s_mov_b32 s9, s49
  s_mov_b32 s10, 18874368
  s_mov_b32 s11, 0x20000
  s_add_u32 m0, s75, 0
  s_nop 0
  buffer_load_dwordx4 v4, s[8:11], s69 offen offset:0 nt lds
  buffer_load_dwordx4 v5, s[8:11], s69 offen offset:1024 nt lds
  buffer_load_dwordx4 v6, s[8:11], s69 offen offset:2048 nt lds
  s_add_u32 s69, s69, 294912
  s_getpc_b64 s[24:25]
L_mlp1_pc:
  s_sub_u32 s24, s24, L_mlp1_pc-recurrent_scan__sliding_block_cached__mixer_token_mlp__prompt_kernel
  s_subb_u32 s25, s25, 0
  s_mov_b32 s26, L_end-recurrent_scan__sliding_block_cached__mixer_token_mlp__prompt_kernel
  s_mov_b32 s27, 0x20000
  s_lshl_b32 s3, s30, 2
  s_add_u32 s3, s3, s28
  s_mul_i32 s3, s3, 896
  v_min_u32 v174, 6, v1
  v_lshlrev_b32 v174, 7, v174
  v_add_u32 v174, s3, v174
  buffer_load_dword v175, v174, s[24:27], 0 offen
  s_add_u32 s16, s60, 131072
  s_addc_u32 s17, s61, 0
  s_mov_b32 s18, 2359296
  s_mov_b32 s19, 0x20000
  s_add_u32 s20, s60, 2490368
  s_addc_u32 s21, s61, 0
  s_mov_b32 s22, 2359296
  s_mov_b32 s23, 0x20000
  s_mov_b32 s64, s60
  s_mov_b32 s65, s61
  s_mov_b32 s66, 131072
  s_mov_b32 s67, 0x20000
  s_lshl_b32 s3, s2, 2
  s_add_u32 s3, s3, s28
  s_lshl_b32 s3, s3, 7
  v_mov_b32 v174, s3
  buffer_load_dword v175, v174, s[64:67], 0 offen sc1
  s_cmp_lg_u32 s28, 3
  s_cbranch_scc1 L_mlp1_ln
  s_waitcnt lgkmcnt(0)
  s_barrier
  s_mul_i32 s100, s100, 0x9e3779b1
  s_add_u32 s100, s100, 0x7f4a7c15
  s_branch L_mlp1_st
L_mlp1_ln:
  s_mov_b32 s3, 0xffff0000
  s_waitcnt vmcnt(6)
  v_lshlrev_b32 v112, 16, v100
  v_and_b32 v113, s3, v100
  v_lshlrev_b32 v114, 16, v101
  v_and_b32 v115, s3, v101
  v_lshlrev_b32 v116, 16, v102
  v_and_b32 v117, s3, v102
  v_lshlrev_b32 v118, 16, v103
  v_and_b32 v119, s3, v103
  v_lshlrev_b32 v120, 16, v104
  v_and_b32 v121, s3, v104
  v_lshlrev_b32 v122, 16, v105
  v_and_b32 v123, s3, v105
  v_lshlrev_b32 v124, 16, v106
  v_and_b32 v125, s3, v106
  v_lshlrev_b32 v126, 16, v107
  v_and_b32 v127, s3, v107
  v_lshlrev_b32 v128, 16, v108
  v_and_b32 v129, s3, v108
  v_lshlrev_b32 v130, 16, v109
  v_and_b32 v131, s3, v109
  v_lshlrev_b32 v132, 16, v110
  v_and_b32 v133, s3, v110
  v_lshlrev_b32 v134, 16, v111
  v_and_b32 v135, s3, v111
  v_pk_add_f32 v[140:141], v[112:113], v[114:115]
  v_pk_add_f32 v[142:143], v[116:117], v[118:119]
  v_pk_add_f32 v[140:141], v[140:141], v[120:121]
  v_pk_add_f32 v[142:143], v[142:143], v[122:123]
  v_pk_add_f32 v[140:141], v[140:141], v[124:125]
  v_pk_add_f32 v[142:143], v[142:143], v[126:127]
  v_pk_add_f32 v[140:141], v[140:141], v[128:129]
  v_pk_add_f32 v[142:143], v[142:143], v[130:131]
  v_pk_add_f32 v[140:141], v[140:141], v[132:133]
  v_pk_add_f32 v[142:143], v[142:143], v[134:135]
  v_pk_add_f32 v[140:141], v[140:141], v[142:143]
  v_add_f32 v140, v140, v141
  s_nop 1
  v_add_f32_dpp v140, v140, v140 row_ror:8 row_mask:0xf bank_mask:0xf
  v_mov_b32 v141, v140
  s_nop 1
  v_permlane16_swap_b32 v140, v141
  v_add_f32 v140, v140, v141
  v_mov_b32 v141, v140
  s_nop 1
  v_permlane32_swap_b32 v140, v141
  v_add_f32 v140, v140, v141
  v_mul_f32 v144, 0x3baaaaab, v140
  v_pk_add_f32 v[112:113], v[112:113], v[144:145] op_sel_hi:[1,0] neg_lo:[0,1] neg_hi:[0,1]
  v_pk_add_f32 v[114:115], v[114:115], v[144:145] op_sel_hi:[1,0] neg_lo:[0,1] neg_hi:[0,1]
  v_pk_add_f32 v[116:117], v[116:117], v[144:145] op_sel_hi:[1,0] neg_lo:[0,1] neg_hi:[0,1]
  v_pk_add_f32 v[118:119], v[118:119], v[144:145] op_sel_hi:[1,0] neg_lo:[0,1] neg_hi:[0,1]
  v_pk_add_f32 v[120:121], v[120:121], v[144:145] op_sel_hi:[1,0] neg_lo:[0,1] neg_hi:[0,1]
  v_pk_add_f32 v[122:123], v[122:123], v[144:145] op_sel_hi:[1,0] neg_lo:[0,1] neg_hi:[0,1]
  v_pk_add_f32 v[124:125], v[124:125], v[144:145] op_sel_hi:[1,0] neg_lo:[0,1] neg_hi:[0,1]
  v_pk_add_f32 v[126:127], v[126:127], v[144:145] op_sel_hi:[1,0] neg_lo:[0,1] neg_hi:[0,1]
  v_pk_add_f32 v[128:129], v[128:129], v[144:145] op_sel_hi:[1,0] neg_lo:[0,1] neg_hi:[0,1]
  v_pk_add_f32 v[130:131], v[130:131], v[144:145] op_sel_hi:[1,0] neg_lo:[0,1] neg_hi:[0,1]
  v_pk_add_f32 v[132:133], v[132:133], v[144:145] op_sel_hi:[1,0] neg_lo:[0,1] neg_hi:[0,1]
  v_pk_add_f32 v[134:135], v[134:135], v[144:145] op_sel_hi:[1,0] neg_lo:[0,1] neg_hi:[0,1]
  v_pk_mul_f32 v[140:141], v[112:113], v[112:113]
  v_pk_mul_f32 v[142:143], v[114:115], v[114:115]
  v_pk_fma_f32 v[140:141], v[116:117], v[116:117], v[140:141]
  v_pk_fma_f32 v[142:143], v[118:119], v[118:119], v[142:143]
  v_pk_fma_f32 v[140:141], v[120:121], v[120:121], v[140:141]
  v_pk_fma_f32 v[142:143], v[122:123], v[122:123], v[142:143]
  v_pk_fma_f32 v[140:141], v[124:125], v[124:125], v[140:141]
  v_pk_fma_f32 v[142:143], v[126:127], v[126:127], v[142:143]
  v_pk_fma_f32 v[140:141], v[128:129], v[128:129], v[140:141]
  v_pk_fma_f32 v[142:143], v[130:131], v[130:131], v[142:143]
  v_pk_fma_f32 v[140:141], v[132:133], v[132:133], v[140:141]
  v_pk_fma_f32 v[142:143], v[134:135], v[134:135], v[142:143]
  v_pk_add_f32 v[140:141], v[140:141], v[142:143]
  v_add_f32 v140, v140, v141
  s_nop 1
  v_add_f32_dpp v140, v140, v140 row_ror:8 row_mask:0xf bank_mask:0xf
  v_mov_b32 v141, v140
  s_nop 1
  v_permlane16_swap_b32 v140, v141
  v_add_f32 v140, v140, v141
  v_mov_b32 v141, v140
  s_nop 1
  v_permlane32_swap_b32 v140, v141
  v_add_f32 v140, v140, v141
  v_mov_b32 v145, v140
  ds_write_b64 v173, v[144:145]
  s_waitcnt lgkmcnt(0)
  s_barrier
  ds_read_b64 v[148:149], v172 offset:0
  ds_read_b64 v[150:151], v172 offset:64
  ds_read_b64 v[152:153], v172 offset:128
  s_mul_i32 s100, s100, 0x9e3779b1
  s_add_u32 s100, s100, 0x7f4a7c15
  s_waitcnt lgkmcnt(0)
  v_add_f32 v140, v148, v150
  v_add_f32 v142, v149, v151
  v_add_f32 v140, v140, v152
  v_add_f32 v142, v142, v153
  v_mul_f32 v140, 0x3eaaaaab, v140
  v_sub_f32 v148, v148, v140
  v_sub_f32 v150, v150, v140
  v_sub_f32 v152, v152, v140
  v_mul_f32 v141, v148, v148
  v_fmac_f32 v141, v150, v150
  v_fmac_f32 v141, v152, v152
  v_fmac_f32 v142, 0x43400000, v141
  v_mul_f32 v142, 0x3ae38e39, v142
  v_sub_f32 v144, v144, v140
  v_add_f32 v140, 0x3727c5ac, v142
  v_rsq_f32 v140, v140
  s_nop 0
  v_mul_f32 v142, v142, v140
  v_mul_f32 v142, v142, v140
  v_add_f32 v142, 0x3727c5ac, v142
  v_rsq_f32 v142, v142
  v_mul_f32 v148, 0x3e0293ee, v140
  v_mul_f32 v152, v144, v148
  v_mul_f32 v150, v142, v140
  v_mul_f32 v154, v144, v150
  s_mov_b32 s3, 262144
  s_mov_b32 s4, 524288
  v_pk_fma_f32 v[180:181], v[112:113], v[148:149], v[152:153] op_sel_hi:[1,0,0]
  v_pk_fma_f32 v[182:183], v[114:115], v[148:149], v[152:153] op_sel_hi:[1,0,0]
  v_pk_fma_f32 v[184:185], v[116:117], v[148:149], v[152:153] op_sel_hi:[1,0,0]
  v_pk_fma_f32 v[186:187], v[118:119], v[148:149], v[152:153] op_sel_hi:[1,0,0]
  v_cvt_pk_bf16_f32 v100, v180, v181
  v_cvt_pk_bf16_f32 v101, v182, v183
  v_cvt_pk_bf16_f32 v102, v184, v185
  v_cvt_pk_bf16_f32 v103, v186, v187
  buffer_store_dwordx4 v[100:103], v171, s[16:19], 0 offen sc1
  v_pk_fma_f32 v[188:189], v[112:113], v[150:151], v[154:155] op_sel_hi:[1,0,0]
  v_pk_fma_f32 v[190:191], v[114:115], v[150:151], v[154:155] op_sel_hi:[1,0,0]
  v_pk_fma_f32 v[192:193], v[116:117], v[150:151], v[154:155] op_sel_hi:[1,0,0]
  v_pk_fma_f32 v[194:195], v[118:119], v[150:151], v[154:155] op_sel_hi:[1,0,0]
  v_cvt_pk_bf16_f32 v156, v188, v189
  v_cvt_pk_bf16_f32 v157, v190, v191
  v_cvt_pk_bf16_f32 v158, v192, v193
  v_cvt_pk_bf16_f32 v159, v194, v195
  buffer_store_dwordx4 v[156:159], v170, s[20:23], 0 offen offset:0 sc1
  v_pk_fma_f32 v[180:181], v[120:121], v[148:149], v[152:153] op_sel_hi:[1,0,0]
  v_pk_fma_f32 v[182:183], v[122:123], v[148:149], v[152:153] op_sel_hi:[1,0,0]
  v_pk_fma_f32 v[184:185], v[124:125], v[148:149], v[152:153] op_sel_hi:[1,0,0]
  v_pk_fma_f32 v[186:187], v[126:127], v[148:149], v[152:153] op_sel_hi:[1,0,0]
  v_cvt_pk_bf16_f32 v104, v180, v181
  v_cvt_pk_bf16_f32 v105, v182, v183
  v_cvt_pk_bf16_f32 v106, v184, v185
  v_cvt_pk_bf16_f32 v107, v186, v187
  buffer_store_dwordx4 v[104:107], v171, s[16:19], s3 offen sc1
  v_pk_fma_f32 v[188:189], v[120:121], v[150:151], v[154:155] op_sel_hi:[1,0,0]
  v_pk_fma_f32 v[190:191], v[122:123], v[150:151], v[154:155] op_sel_hi:[1,0,0]
  v_pk_fma_f32 v[192:193], v[124:125], v[150:151], v[154:155] op_sel_hi:[1,0,0]
  v_pk_fma_f32 v[194:195], v[126:127], v[150:151], v[154:155] op_sel_hi:[1,0,0]
  v_cvt_pk_bf16_f32 v160, v188, v189
  v_cvt_pk_bf16_f32 v161, v190, v191
  v_cvt_pk_bf16_f32 v162, v192, v193
  v_cvt_pk_bf16_f32 v163, v194, v195
  buffer_store_dwordx4 v[160:163], v170, s[20:23], 0 offen offset:128 sc1
  v_pk_fma_f32 v[180:181], v[128:129], v[148:149], v[152:153] op_sel_hi:[1,0,0]
  v_pk_fma_f32 v[182:183], v[130:131], v[148:149], v[152:153] op_sel_hi:[1,0,0]
  v_pk_fma_f32 v[184:185], v[132:133], v[148:149], v[152:153] op_sel_hi:[1,0,0]
  v_pk_fma_f32 v[186:187], v[134:135], v[148:149], v[152:153] op_sel_hi:[1,0,0]
  v_cvt_pk_bf16_f32 v108, v180, v181
  v_cvt_pk_bf16_f32 v109, v182, v183
  v_cvt_pk_bf16_f32 v110, v184, v185
  v_cvt_pk_bf16_f32 v111, v186, v187
  buffer_store_dwordx4 v[108:111], v171, s[16:19], s4 offen sc1
  v_pk_fma_f32 v[188:189], v[128:129], v[150:151], v[154:155] op_sel_hi:[1,0,0]
  v_pk_fma_f32 v[190:191], v[130:131], v[150:151], v[154:155] op_sel_hi:[1,0,0]
  v_pk_fma_f32 v[192:193], v[132:133], v[150:151], v[154:155] op_sel_hi:[1,0,0]
  v_pk_fma_f32 v[194:195], v[134:135], v[150:151], v[154:155] op_sel_hi:[1,0,0]
  v_cvt_pk_bf16_f32 v164, v188, v189
  v_cvt_pk_bf16_f32 v165, v190, v191
  v_cvt_pk_bf16_f32 v166, v192, v193
  v_cvt_pk_bf16_f32 v167, v194, v195
  buffer_store_dwordx4 v[164:167], v170, s[20:23], 0 offen offset:256 sc1
L_mlp1_st:
  s_sub_u32 s4, s30, 22
  s_lshl_b32 s4, s4, 2
  s_add_u32 s4, s4, s28
  s_mul_i32 s4, s4, 63
  v_add_u32 v2, s4, v1
  v_mul_u32_u24 v3, 1821, v2
  v_lshrrev_b32 v3, 14, v3
  v_mul_u32_u24 v3, 8064, v3
  v_lshl_add_u32 v2, v2, 7, v3
  s_mul_i32 s3, s29, 1152
  s_add_u32 s3, s3, 0
  v_add_u32 v2, s3, v2
  s_and_b32 s4, s28, 1
  s_lshr_b32 s7, s28, 1
  v_lshrrev_b32 v27, 2, v1
  v_bfe_u32 v28, v27, 1, 2
  v_mul_u32_u24 v27, 384, v27
  v_and_b32 v29, 3, v1
  v_lshl_add_u32 v27, v29, 3, v27
  s_mul_i32 s5, s4, 6
  s_mul_i32 s6, s7, 6
  s_add_u32 s3, s5, 0
  v_xor_b32 v29, s3, v28
  v_lshl_add_u32 v10, v29, 5, v27
  s_add_u32 s3, s6, 0
  v_xor_b32 v29, s3, v28
  v_lshl_add_u32 v14, v29, 5, v27
  v_add_u32 v14, 12288, v14
  s_add_u32 s3, s5, 1
  v_xor_b32 v29, s3, v28
  v_lshl_add_u32 v11, v29, 5, v27
  s_add_u32 s3, s6, 1
  v_xor_b32 v29, s3, v28
  v_lshl_add_u32 v15, v29, 5, v27
  v_add_u32 v15, 12288, v15
  s_add_u32 s3, s5, 2
  v_xor_b32 v29, s3, v28
  v_lshl_add_u32 v12, v29, 5, v27
  s_add_u32 s3, s6, 2
  v_xor_b32 v29, s3, v28
  v_lshl_add_u32 v16, v29, 5, v27
  v_add_u32 v16, 12288, v16
  s_add_u32 s3, s5, 3
  v_xor_b32 v29, s3, v28
  v_lshl_add_u32 v13, v29, 5, v27
  s_add_u32 s3, s6, 3
  v_xor_b32 v29, s3, v28
  v_lshl_add_u32 v17, v29, 5, v27
  v_add_u32 v17, 12288, v17
  s_mul_i32 s3, s32, 6
  s_mul_i32 s31, s4, 3
  s_add_u32 s3, s3, s31
  s_mul_i32 s3, s3, 36
  s_mul_i32 s31, s33, 12
  s_add_u32 s3, s3, s31
  s_add_u32 s3, s3, s6
  s_lshl_b32 s68, s3, 10
  v_lshlrev_b32 v176, 12, v1
  s_lshl_b32 s3, s2, 4
  s_add_u32 s3, s3, 4096
  v_mov_b32 v177, s100
  s_waitcnt vmcnt(0)
  s_barrier
  s_cmp_lg_u32 s28, 0
  s_cbranch_scc1 L_mlp1_nf
  s_mov_b64 exec, 0xff
  buffer_store_dword v177, v176, s[64:67], s3 offen sc1
  s_mov_b64 exec, -1
L_mlp1_nf:
  s_mov_b32 s24, s50
  s_mov_b32 s25, s51
  s_mov_b32 s26, 9216
  s_mov_b32 s27, 0x20000
  s_and_b32 s4, s28, 1
  s_mul_i32 s3, s32, 384
  s_mul_i32 s31, s4, 192
  s_add_u32 s3, s3, s31
  v_lshrrev_b32 v26, 4, v1
  v_lshlrev_b32 v27, 3, v26
  buffer_load_dwordx2 v[56:57], v27, s[24:27], s3 offen offset:0
  buffer_load_dwordx2 v[58:59], v27, s[24:27], s3 offen offset:32
  buffer_load_dwordx2 v[60:61], v27, s[24:27], s3 offen offset:64
  buffer_load_dwordx2 v[62:63], v27, s[24:27], s3 offen offset:96
  buffer_load_dwordx2 v[64:65], v27, s[24:27], s3 offen offset:128
  buffer_load_dwordx2 v[66:67], v27, s[24:27], s3 offen offset:160
  s_add_u32 m0, s75, 24576
  s_nop 0
  buffer_load_dwordx4 v4, s[8:11], s69 offen offset:0 nt lds
  buffer_load_dwordx4 v5, s[8:11], s69 offen offset:1024 nt lds
  buffer_load_dwordx4 v6, s[8:11], s69 offen offset:2048 nt lds
  s_add_u32 s69, s69, 294912
  s_add_u32 m0, s75, 49152
  s_nop 0
  buffer_load_dwordx4 v4, s[8:11], s69 offen offset:0 nt lds
  buffer_load_dwordx4 v5, s[8:11], s69 offen offset:1024 nt lds
  buffer_load_dwordx4 v6, s[8:11], s69 offen offset:2048 nt lds
  s_add_u32 s69, s69, 294912
  s_add_u32 s12, s60, 2490368
  s_addc_u32 s13, s61, 0
  s_mov_b32 s14, 2359296
  s_mov_b32 s15, 0x20000
  s_add_u32 s16, s60, 21626880
  s_addc_u32 s17, s61, 0
  s_mov_b32 s18, 5308416
  s_mov_b32 s19, 0x20000
  s_lshl_b32 s3, s29, 12
  s_lshl_b32 s4, s28, 4
  s_add_u32 s3, s3, s4
  s_add_u32 s3, s3, 4096
  v_lshlrev_b32 v26, 6, v1
  v_add_u32 v26, s3, v26
  s_mov_b32 s7, 0x80000
L_mlp1_p0:
  buffer_load_dword v27, v26, s[64:67], 0 offen sc1
L_mlp1_p0_chk:
  s_waitcnt vmcnt(0)
  v_cmp_ne_u32 vcc, s100, v27
  s_cbranch_vccz L_mlp1_p0_ok
  s_sleep 6
  s_sub_u32 s7, s7, 1
  s_cmp_lg_u32 s7, 0
  s_cbranch_scc1 L_mlp1_p0
L_mlp1_p0_ok:
  s_add_u32 m0, s75, 12288
  s_nop 0
  buffer_load_dwordx4 v7, s[12:15], s70 offen offset:0 sc1 lds
  buffer_load_dwordx4 v8, s[12:15], s70 offen offset:1024 sc1 lds
  buffer_load_dwordx4 v9, s[12:15], s70 offen offset:2048 sc1 lds
  s_add_u32 s70, s70, 36864
  s_add_u32 m0, s75, 36864
  s_nop 0
  buffer_load_dwordx4 v7, s[12:15], s70 offen offset:0 sc1 lds
  buffer_load_dwordx4 v8, s[12:15], s70 offen offset:1024 sc1 lds
  buffer_load_dwordx4 v9, s[12:15], s70 offen offset:2048 sc1 lds
  s_add_u32 s70, s70, 36864
  s_mov_b32 s3, 0xffff0000
  v_lshlrev_b32 v32, 16, v56
  v_and_b32 v33, s3, v56
  v_lshlrev_b32 v34, 16, v57
  v_and_b32 v35, s3, v57
  v_lshlrev_b32 v36, 16, v58
  v_and_b32 v37, s3, v58
  v_lshlrev_b32 v38, 16, v59
  v_and_b32 v39, s3, v59
  v_lshlrev_b32 v40, 16, v60
  v_and_b32 v41, s3, v60
  v_lshlrev_b32 v42, 16, v61
  v_and_b32 v43, s3, v61
  v_lshlrev_b32 v44, 16, v62
  v_and_b32 v45, s3, v62
  v_lshlrev_b32 v46, 16, v63
  v_and_b32 v47, s3, v63
  v_lshlrev_b32 v48, 16, v64
  v_and_b32 v49, s3, v64
  v_lshlrev_b32 v50, 16, v65
  v_and_b32 v51, s3, v65
  v_lshlrev_b32 v52, 16, v66
  v_and_b32 v53, s3, v66
  v_lshlrev_b32 v54, 16, v67
  v_and_b32 v55, s3, v67
  v_pk_mov_b32 v[112:113], v[32:33], v[32:33] op_sel:[0,1]
  v_pk_mov_b32 v[114:115], v[34:35], v[34:35] op_sel:[0,1]
  v_pk_mov_b32 v[120:121], v[32:33], v[32:33] op_sel:[0,1]
  v_pk_mov_b32 v[122:123], v[34:35], v[34:35] op_sel:[0,1]
  v_pk_mov_b32 v[128:129], v[32:33], v[32:33] op_sel:[0,1]
  v_pk_mov_b32 v[130:131], v[34:35], v[34:35] op_sel:[0,1]
  v_pk_mov_b32 v[136:137], v[32:33], v[32:33] op_sel:[0,1]
  v_pk_mov_b32 v[138:139], v[34:35], v[34:35] op_sel:[0,1]
  v_pk_mov_b32 v[144:145], v[32:33], v[32:33] op_sel:[0,1]
  v_pk_mov_b32 v[146:147], v[34:35], v[34:35] op_sel:[0,1]
  v_pk_mov_b32 v[152:153], v[32:33], v[32:33] op_sel:[0,1]
  v_pk_mov_b32 v[154:155], v[34:35], v[34:35] op_sel:[0,1]
  v_pk_mov_b32 v[116:117], v[36:37], v[36:37] op_sel:[0,1]
  v_pk_mov_b32 v[118:119], v[38:39], v[38:39] op_sel:[0,1]
  v_pk_mov_b32 v[124:125], v[36:37], v[36:37] op_sel:[0,1]
  v_pk_mov_b32 v[126:127], v[38:39], v[38:39] op_sel:[0,1]
  v_pk_mov_b32 v[132:133], v[36:37], v[36:37] op_sel:[0,1]
  v_pk_mov_b32 v[134:135], v[38:39], v[38:39] op_sel:[0,1]
  v_pk_mov_b32 v[140:141], v[36:37], v[36:37] op_sel:[0,1]
  v_pk_mov_b32 v[142:143], v[38:39], v[38:39] op_sel:[0,1]
  v_pk_mov_b32 v[148:149], v[36:37], v[36:37] op_sel:[0,1]
  v_pk_mov_b32 v[150:151], v[38:39], v[38:39] op_sel:[0,1]
  v_pk_mov_b32 v[156:157], v[36:37], v[36:37] op_sel:[0,1]
  v_pk_mov_b32 v[158:159], v[38:39], v[38:39] op_sel:[0,1]
  v_pk_mov_b32 v[160:161], v[40:41], v[40:41] op_sel:[0,1]
  v_pk_mov_b32 v[162:163], v[42:43], v[42:43] op_sel:[0,1]
  v_pk_mov_b32 v[168:169], v[40:41], v[40:41] op_sel:[0,1]
  v_pk_mov_b32 v[170:171], v[42:43], v[42:43] op_sel:[0,1]
  v_pk_mov_b32 v[176:177], v[40:41], v[40:41] op_sel:[0,1]
  v_pk_mov_b32 v[178:179], v[42:43], v[42:43] op_sel:[0,1]
  v_pk_mov_b32 v[184:185], v[40:41], v[40:41] op_sel:[0,1]
  v_pk_mov_b32 v[186:187], v[42:43], v[42:43] op_sel:[0,1]
  v_pk_mov_b32 v[192:193], v[40:41], v[40:41] op_sel:[0,1]
  v_pk_mov_b32 v[194:195], v[42:43], v[42:43] op_sel:[0,1]
  v_pk_mov_b32 v[200:201], v[40:41], v[40:41] op_sel:[0,1]
  v_pk_mov_b32 v[202:203], v[42:43], v[42:43] op_sel:[0,1]
  v_pk_mov_b32 v[164:165], v[44:45], v[44:45] op_sel:[0,1]
  v_pk_mov_b32 v[166:167], v[46:47], v[46:47] op_sel:[0,1]
  v_pk_mov_b32 v[172:173], v[44:45], v[44:45] op_sel:[0,1]
  v_pk_mov_b32 v[174:175], v[46:47], v[46:47] op_sel:[0,1]
  v_pk_mov_b32 v[180:181], v[44:45], v[44:45] op_sel:[0,1]
  v_pk_mov_b32 v[182:183], v[46:47], v[46:47] op_sel:[0,1]
  v_pk_mov_b32 v[188:189], v[44:45], v[44:45] op_sel:[0,1]
  v_pk_mov_b32 v[190:191], v[46:47], v[46:47] op_sel:[0,1]
  v_pk_mov_b32 v[196:197], v[44:45], v[44:45] op_sel:[0,1]
  v_pk_mov_b32 v[198:199], v[46:47], v[46:47] op_sel:[0,1]
  v_pk_mov_b32 v[204:205], v[44:45], v[44:45] op_sel:[0,1]
  v_pk_mov_b32 v[206:207], v[46:47], v[46:47] op_sel:[0,1]
  v_pk_mov_b32 v[208:209], v[48:49], v[48:49] op_sel:[0,1]
  v_pk_mov_b32 v[210:211], v[50:51], v[50:51] op_sel:[0,1]
  v_pk_mov_b32 v[216:217], v[48:49], v[48:49] op_sel:[0,1]
  v_pk_mov_b32 v[218:219], v[50:51], v[50:51] op_sel:[0,1]
  v_pk_mov_b32 v[224:225], v[48:49], v[48:49] op_sel:[0,1]
  v_pk_mov_b32 v[226:227], v[50:51], v[50:51] op_sel:[0,1]
  v_pk_mov_b32 v[232:233], v[48:49], v[48:49] op_sel:[0,1]
  v_pk_mov_b32 v[234:235], v[50:51], v[50:51] op_sel:[0,1]
  v_pk_mov_b32 v[240:241], v[48:49], v[48:49] op_sel:[0,1]
  v_pk_mov_b32 v[242:243], v[50:51], v[50:51] op_sel:[0,1]
  v_pk_mov_b32 v[248:249], v[48:49], v[48:49] op_sel:[0,1]
  v_pk_mov_b32 v[250:251], v[50:51], v[50:51] op_sel:[0,1]
  v_pk_mov_b32 v[212:213], v[52:53], v[52:53] op_sel:[0,1]
  v_pk_mov_b32 v[214:215], v[54:55], v[54:55] op_sel:[0,1]
  v_pk_mov_b32 v[220:221], v[52:53], v[52:53] op_sel:[0,1]
  v_pk_mov_b32 v[222:223], v[54:55], v[54:55] op_sel:[0,1]
  v_pk_mov_b32 v[228:229], v[52:53], v[52:53] op_sel:[0,1]
  v_pk_mov_b32 v[230:231], v[54:55], v[54:55] op_sel:[0,1]
  v_pk_mov_b32 v[236:237], v[52:53], v[52:53] op_sel:[0,1]
  v_pk_mov_b32 v[238:239], v[54:55], v[54:55] op_sel:[0,1]
  v_pk_mov_b32 v[244:245], v[52:53], v[52:53] op_sel:[0,1]
  v_pk_mov_b32 v[246:247], v[54:55], v[54:55] op_sel:[0,1]
  v_pk_mov_b32 v[252:253], v[52:53], v[52:53] op_sel:[0,1]
  v_pk_mov_b32 v[254:255], v[54:55], v[54:55] op_sel:[0,1]
  s_add_u32 m0, s75, 61440
  s_nop 0
  buffer_load_dwordx4 v7, s[12:15], s70 offen offset:0 sc1 lds
  buffer_load_dwordx4 v8, s[12:15], s70 offen offset:1024 sc1 lds
  buffer_load_dwordx4 v9, s[12:15], s70 offen offset:2048 sc1 lds
  s_add_u32 s70, s70, 36864
  s_waitcnt vmcnt(6)
  s_barrier
  ds_read_b64_tr_b16 a[24:25], v14 offset:0
  ds_read_b64_tr_b16 a[26:27], v14 offset:6144
  ds_read_b64_tr_b16 a[28:29], v15 offset:0
  ds_read_b64_tr_b16 a[30:31], v15 offset:6144
  ds_read_b64_tr_b16 a[32:33], v16 offset:0
  ds_read_b64_tr_b16 a[34:35], v16 offset:6144
  ds_read_b64_tr_b16 a[36:37], v17 offset:0
  ds_read_b64_tr_b16 a[38:39], v17 offset:6144
  ds_read_b64_tr_b16 a[40:41], v14 offset:128
  ds_read_b64_tr_b16 a[42:43], v14 offset:6272
  ds_read_b64_tr_b16 a[44:45], v15 offset:128
  ds_read_b64_tr_b16 a[46:47], v15 offset:6272
  ds_read_b64_tr_b16 a[0:1], v10 offset:0
  ds_read_b64_tr_b16 a[2:3], v10 offset:6144
  ds_read_b64_tr_b16 a[4:5], v11 offset:0
  ds_read_b64_tr_b16 a[6:7], v11 offset:6144
  ds_read_b64_tr_b16 a[8:9], v12 offset:0
  ds_read_b64_tr_b16 a[10:11], v12 offset:6144
  ds_read_b64_tr_b16 a[12:13], v13 offset:0
  ds_read_b64_tr_b16 a[14:15], v13 offset:6144
  ds_read_b64_tr_b16 a[16:17], v10 offset:128
  ds_read_b64_tr_b16 a[18:19], v10 offset:6272
  ds_read_b64_tr_b16 a[20:21], v11 offset:128
  ds_read_b64_tr_b16 a[22:23], v11 offset:6272
  s_add_u32 m0, s75, 73728
  s_nop 0
  buffer_load_dwordx4 v4, s[8:11], s69 offen offset:0 nt lds
  buffer_load_dwordx4 v5, s[8:11], s69 offen offset:1024 nt lds
  buffer_load_dwordx4 v6, s[8:11], s69 offen offset:2048 nt lds
  s_add_u32 s69, s69, 294912
  s_add_u32 m0, s75, 86016
  s_nop 0
  buffer_load_dwordx4 v7, s[12:15], s70 offen offset:0 sc1 lds
  buffer_load_dwordx4 v8, s[12:15], s70 offen offset:1024 sc1 lds
  buffer_load_dwordx4 v9, s[12:15], s70 offen offset:2048 sc1 lds
  s_add_u32 s70, s70, 36864
  s_add_u32 m0, s75, 98304
  s_nop 0
  buffer_load_dwordx4 v4, s[8:11], s69 offen offset:0 nt lds
  buffer_load_dwordx4 v5, s[8:11], s69 offen offset:1024 nt lds
  buffer_load_dwordx4 v6, s[8:11], s69 offen offset:2048 nt lds
  s_add_u32 s69, s69, 294912
  s_add_u32 m0, s75, 122880
  s_nop 0
  buffer_load_dwordx4 v4, s[8:11], s69 offen offset:0 nt lds
  buffer_load_dwordx4 v5, s[8:11], s69 offen offset:1024 nt lds
  buffer_load_dwordx4 v6, s[8:11], s69 offen offset:2048 nt lds
  s_add_u32 s69, s69, 294912
  s_waitcnt vmcnt(12)
  s_lshl_b32 s3, s2, 2
  s_add_u32 s3, s3, s28
  s_cmp_eq_u32 s3, 704
  s_cselect_b32 s3, 0, 2147483392
  v_mov_b32 v26, s3
  v_mov_b32 v27, s100
  buffer_store_dword v27, v26, s[64:67], 0 offen sc1
  v_add_u32 v18, 24576, v10
  v_add_u32 v22, 24576, v14
  v_add_u32 v19, 24576, v11
  v_add_u32 v23, 24576, v15
  v_add_u32 v20, 24576, v12
  v_add_u32 v24, 24576, v16
  v_add_u32 v21, 24576, v13
  v_add_u32 v25, 24576, v17
  s_mov_b32 s74, 0
  s_mov_b32 s78, 98304
  s_mov_b32 s73, 24576
  s_add_u32 s79, s75, 12288
  s_waitcnt lgkmcnt(0)
  s_barrier
  s_mov_b32 s76, 8
  s_getpc_b64 s[92:93]
  s_add_u32 s92, s92, 4608
  s_addc_u32 s93, s93, 0
  s_mov_b32 s94, 9216
  s_mov_b32 s95, 0x20000
  s_sub_u32 s3, s30, 22
  s_lshl_b32 s3, s3, 2
  s_add_u32 s3, s3, s28
  s_lshl_b32 s3, s3, 8
  v_and_b32 v2, 1, v1
  v_lshlrev_b32 v2, 7, v2
  v_add_u32 v2, s3, v2
  .p2align 6
L_mlp1_loop:
  v_mfma_f32_16x16x32_bf16 v[112:115], a[0:3], a[24:27], v[112:115]
  s_add_u32 m0, s74, s75
  ds_read_b64_tr_b16 a[72:73], v22 offset:0
  v_mfma_f32_16x16x32_bf16 v[120:123], a[0:3], a[28:31], v[120:123]
  s_min_u32 s69, s69, s71
  ds_read_b64_tr_b16 a[74:75], v22 offset:6144
  v_mfma_f32_16x16x32_bf16 v[128:131], a[0:3], a[32:35], v[128:131]
  buffer_load_dwordx4 v4, s[8:11], s69 offen offset:0 lds
  v_mfma_f32_16x16x32_bf16 v[136:139], a[0:3], a[36:39], v[136:139]
  s_add_u32 s74, s74, 24576
  ds_read_b64_tr_b16 a[76:77], v23 offset:0
  v_mfma_f32_16x16x32_bf16 v[144:147], a[0:3], a[40:43], v[144:147]
  s_cmp_eq_u32 s74, 147456
  ds_read_b64_tr_b16 a[78:79], v23 offset:6144
  v_mfma_f32_16x16x32_bf16 v[152:155], a[0:3], a[44:47], v[152:155]
  s_cselect_b32 s74, 0, s74
  ds_read_b64_tr_b16 a[80:81], v24 offset:0
  v_mfma_f32_16x16x32_bf16 v[116:119], a[4:7], a[24:27], v[116:119]
  ds_read_b64_tr_b16 a[82:83], v24 offset:6144
  v_mfma_f32_16x16x32_bf16 v[124:127], a[4:7], a[28:31], v[124:127]
  ds_read_b64_tr_b16 a[84:85], v25 offset:0
  v_mfma_f32_16x16x32_bf16 v[132:135], a[4:7], a[32:35], v[132:135]
  buffer_load_dwordx4 v5, s[8:11], s69 offen offset:1024 lds
  v_mfma_f32_16x16x32_bf16 v[140:143], a[4:7], a[36:39], v[140:143]
  s_add_u32 s73, s73, 24576
  ds_read_b64_tr_b16 a[86:87], v25 offset:6144
  v_mfma_f32_16x16x32_bf16 v[148:151], a[4:7], a[40:43], v[148:151]
  s_cmp_eq_u32 s73, 147456
  ds_read_b64_tr_b16 a[88:89], v22 offset:128
  v_mfma_f32_16x16x32_bf16 v[156:159], a[4:7], a[44:47], v[156:159]
  s_cselect_b32 s73, 0, s73
  ds_read_b64_tr_b16 a[90:91], v22 offset:6272
  v_mfma_f32_16x16x32_bf16 v[160:163], a[8:11], a[24:27], v[160:163]
  ds_read_b64_tr_b16 a[92:93], v23 offset:128
  v_mfma_f32_16x16x32_bf16 v[168:171], a[8:11], a[28:31], v[168:171]
  ds_read_b64_tr_b16 a[94:95], v23 offset:6272
  v_mfma_f32_16x16x32_bf16 v[176:179], a[8:11], a[32:35], v[176:179]
  buffer_load_dwordx4 v6, s[8:11], s69 offen offset:2048 lds
  v_mfma_f32_16x16x32_bf16 v[184:187], a[8:11], a[36:39], v[184:187]
  s_add_u32 m0, s78, s79
  ds_read_b64_tr_b16 a[48:49], v18 offset:0
  v_add_u32 v22, s73, v14
  v_mfma_f32_16x16x32_bf16 v[192:195], a[8:11], a[40:43], v[192:195]
  s_add_u32 s69, s69, 294912
  ds_read_b64_tr_b16 a[50:51], v18 offset:6144
  v_add_u32 v23, s73, v15
  v_mfma_f32_16x16x32_bf16 v[200:203], a[8:11], a[44:47], v[200:203]
  s_min_u32 s70, s70, s72
  ds_read_b64_tr_b16 a[52:53], v19 offset:0
  v_add_u32 v24, s73, v16
  v_mfma_f32_16x16x32_bf16 v[164:167], a[12:15], a[24:27], v[164:167]
  ds_read_b64_tr_b16 a[54:55], v19 offset:6144
  v_add_u32 v25, s73, v17
  v_mfma_f32_16x16x32_bf16 v[172:175], a[12:15], a[28:31], v[172:175]
  ds_read_b64_tr_b16 a[56:57], v20 offset:0
  v_mfma_f32_16x16x32_bf16 v[180:183], a[12:15], a[32:35], v[180:183]
  buffer_load_dwordx4 v7, s[12:15], s70 offen offset:0 sc1 lds
  v_mfma_f32_16x16x32_bf16 v[188:191], a[12:15], a[36:39], v[188:191]
  s_add_u32 s78, s78, 24576
  ds_read_b64_tr_b16 a[58:59], v20 offset:6144
  v_mfma_f32_16x16x32_bf16 v[196:199], a[12:15], a[40:43], v[196:199]
  s_cmp_eq_u32 s78, 147456
  ds_read_b64_tr_b16 a[60:61], v21 offset:0
  v_mfma_f32_16x16x32_bf16 v[204:207], a[12:15], a[44:47], v[204:207]
  s_cselect_b32 s78, 0, s78
  ds_read_b64_tr_b16 a[62:63], v21 offset:6144
  v_mfma_f32_16x16x32_bf16 v[208:211], a[16:19], a[24:27], v[208:211]
  ds_read_b64_tr_b16 a[64:65], v18 offset:128
  v_mfma_f32_16x16x32_bf16 v[216:219], a[16:19], a[28:31], v[216:219]
  ds_read_b64_tr_b16 a[66:67], v18 offset:6272
  v_mfma_f32_16x16x32_bf16 v[224:227], a[16:19], a[32:35], v[224:227]
  buffer_load_dwordx4 v8, s[12:15], s70 offen offset:1024 sc1 lds
  v_mfma_f32_16x16x32_bf16 v[232:235], a[16:19], a[36:39], v[232:235]
  ds_read_b64_tr_b16 a[68:69], v19 offset:128
  v_mfma_f32_16x16x32_bf16 v[240:243], a[16:19], a[40:43], v[240:243]
  ds_read_b64_tr_b16 a[70:71], v19 offset:6272
  v_mfma_f32_16x16x32_bf16 v[248:251], a[16:19], a[44:47], v[248:251]
  buffer_load_dword v3, v2, s[92:95], 0 offen
  v_mfma_f32_16x16x32_bf16 v[212:215], a[20:23], a[24:27], v[212:215]
  v_add_u32 v18, s73, v10
  v_add_u32 v19, s73, v11
  v_mfma_f32_16x16x32_bf16 v[220:223], a[20:23], a[28:31], v[220:223]
  v_add_u32 v20, s73, v12
  v_add_u32 v21, s73, v13
  v_mfma_f32_16x16x32_bf16 v[228:231], a[20:23], a[32:35], v[228:231]
  buffer_load_dwordx4 v9, s[12:15], s70 offen offset:2048 sc1 lds
  v_mfma_f32_16x16x32_bf16 v[236:239], a[20:23], a[36:39], v[236:239]
  s_add_u32 s70, s70, 36864
  v_mfma_f32_16x16x32_bf16 v[244:247], a[20:23], a[40:43], v[244:247]
  v_mfma_f32_16x16x32_bf16 v[252:255], a[20:23], a[44:47], v[252:255]
  s_waitcnt vmcnt(12) lgkmcnt(0)
  s_barrier
  v_mfma_f32_16x16x32_bf16 v[112:115], a[48:51], a[72:75], v[112:115]
  s_add_u32 m0, s74, s75
  ds_read_b64_tr_b16 a[24:25], v22 offset:0
  v_mfma_f32_16x16x32_bf16 v[120:123], a[48:51], a[76:79], v[120:123]
  s_min_u32 s69, s69, s71
  ds_read_b64_tr_b16 a[26:27], v22 offset:6144
  v_mfma_f32_16x16x32_bf16 v[128:131], a[48:51], a[80:83], v[128:131]
  buffer_load_dwordx4 v4, s[8:11], s69 offen offset:0 lds
  v_mfma_f32_16x16x32_bf16 v[136:139], a[48:51], a[84:87], v[136:139]
  s_add_u32 s74, s74, 24576
  ds_read_b64_tr_b16 a[28:29], v23 offset:0
  v_mfma_f32_16x16x32_bf16 v[144:147], a[48:51], a[88:91], v[144:147]
  s_cmp_eq_u32 s74, 147456
  ds_read_b64_tr_b16 a[30:31], v23 offset:6144
  v_mfma_f32_16x16x32_bf16 v[152:155], a[48:51], a[92:95], v[152:155]
  s_cselect_b32 s74, 0, s74
  ds_read_b64_tr_b16 a[32:33], v24 offset:0
  v_mfma_f32_16x16x32_bf16 v[116:119], a[52:55], a[72:75], v[116:119]
  ds_read_b64_tr_b16 a[34:35], v24 offset:6144
  v_mfma_f32_16x16x32_bf16 v[124:127], a[52:55], a[76:79], v[124:127]
  ds_read_b64_tr_b16 a[36:37], v25 offset:0
  v_mfma_f32_16x16x32_bf16 v[132:135], a[52:55], a[80:83], v[132:135]
  buffer_load_dwordx4 v5, s[8:11], s69 offen offset:1024 lds
  v_mfma_f32_16x16x32_bf16 v[140:143], a[52:55], a[84:87], v[140:143]
  s_add_u32 s73, s73, 24576
  ds_read_b64_tr_b16 a[38:39], v25 offset:6144
  v_mfma_f32_16x16x32_bf16 v[148:151], a[52:55], a[88:91], v[148:151]
  s_cmp_eq_u32 s73, 147456
  ds_read_b64_tr_b16 a[40:41], v22 offset:128
  v_mfma_f32_16x16x32_bf16 v[156:159], a[52:55], a[92:95], v[156:159]
  s_cselect_b32 s73, 0, s73
  ds_read_b64_tr_b16 a[42:43], v22 offset:6272
  v_mfma_f32_16x16x32_bf16 v[160:163], a[56:59], a[72:75], v[160:163]
  ds_read_b64_tr_b16 a[44:45], v23 offset:128
  v_mfma_f32_16x16x32_bf16 v[168:171], a[56:59], a[76:79], v[168:171]
  ds_read_b64_tr_b16 a[46:47], v23 offset:6272
  v_mfma_f32_16x16x32_bf16 v[176:179], a[56:59], a[80:83], v[176:179]
  buffer_load_dwordx4 v6, s[8:11], s69 offen offset:2048 lds
  v_mfma_f32_16x16x32_bf16 v[184:187], a[56:59], a[84:87], v[184:187]
  s_add_u32 m0, s78, s79
  ds_read_b64_tr_b16 a[0:1], v18 offset:0
  v_add_u32 v22, s73, v14
  v_mfma_f32_16x16x32_bf16 v[192:195], a[56:59], a[88:91], v[192:195]
  s_add_u32 s69, s69, 294912
  ds_read_b64_tr_b16 a[2:3], v18 offset:6144
  v_add_u32 v23, s73, v15
  v_mfma_f32_16x16x32_bf16 v[200:203], a[56:59], a[92:95], v[200:203]
  s_min_u32 s70, s70, s72
  ds_read_b64_tr_b16 a[4:5], v19 offset:0
  v_add_u32 v24, s73, v16
  v_mfma_f32_16x16x32_bf16 v[164:167], a[60:63], a[72:75], v[164:167]
  ds_read_b64_tr_b16 a[6:7], v19 offset:6144
  v_add_u32 v25, s73, v17
  v_mfma_f32_16x16x32_bf16 v[172:175], a[60:63], a[76:79], v[172:175]
  ds_read_b64_tr_b16 a[8:9], v20 offset:0
  v_mfma_f32_16x16x32_bf16 v[180:183], a[60:63], a[80:83], v[180:183]
  buffer_load_dwordx4 v7, s[12:15], s70 offen offset:0 sc1 lds
  v_mfma_f32_16x16x32_bf16 v[188:191], a[60:63], a[84:87], v[188:191]
  s_add_u32 s78, s78, 24576
  ds_read_b64_tr_b16 a[10:11], v20 offset:6144
  v_mfma_f32_16x16x32_bf16 v[196:199], a[60:63], a[88:91], v[196:199]
  s_cmp_eq_u32 s78, 147456
  ds_read_b64_tr_b16 a[12:13], v21 offset:0
  v_mfma_f32_16x16x32_bf16 v[204:207], a[60:63], a[92:95], v[204:207]
  s_cselect_b32 s78, 0, s78
  ds_read_b64_tr_b16 a[14:15], v21 offset:6144
  v_mfma_f32_16x16x32_bf16 v[208:211], a[64:67], a[72:75], v[208:211]
  ds_read_b64_tr_b16 a[16:17], v18 offset:128
  v_mfma_f32_16x16x32_bf16 v[216:219], a[64:67], a[76:79], v[216:219]
  ds_read_b64_tr_b16 a[18:19], v18 offset:6272
  v_mfma_f32_16x16x32_bf16 v[224:227], a[64:67], a[80:83], v[224:227]
  buffer_load_dwordx4 v8, s[12:15], s70 offen offset:1024 sc1 lds
  v_mfma_f32_16x16x32_bf16 v[232:235], a[64:67], a[84:87], v[232:235]
  ds_read_b64_tr_b16 a[20:21], v19 offset:128
  v_mfma_f32_16x16x32_bf16 v[240:243], a[64:67], a[88:91], v[240:243]
  ds_read_b64_tr_b16 a[22:23], v19 offset:6272
  v_mfma_f32_16x16x32_bf16 v[248:251], a[64:67], a[92:95], v[248:251]
  v_mfma_f32_16x16x32_bf16 v[212:215], a[68:71], a[72:75], v[212:215]
  v_add_u32 v18, s73, v10
  v_add_u32 v19, s73, v11
  v_mfma_f32_16x16x32_bf16 v[220:223], a[68:71], a[76:79], v[220:223]
  v_add_u32 v20, s73, v12
  v_add_u32 v21, s73, v13
  v_mfma_f32_16x16x32_bf16 v[228:231], a[68:71], a[80:83], v[228:231]
  buffer_load_dwordx4 v9, s[12:15], s70 offen offset:2048 sc1 lds
  v_mfma_f32_16x16x32_bf16 v[236:239], a[68:71], a[84:87], v[236:239]
  s_add_u32 s70, s70, 36864
  v_mfma_f32_16x16x32_bf16 v[244:247], a[68:71], a[88:91], v[244:247]
  v_mfma_f32_16x16x32_bf16 v[252:255], a[68:71], a[92:95], v[252:255]
  s_waitcnt vmcnt(12) lgkmcnt(0)
  s_barrier
  v_mfma_f32_16x16x32_bf16 v[112:115], a[0:3], a[24:27], v[112:115]
  s_add_u32 m0, s74, s75
  ds_read_b64_tr_b16 a[72:73], v22 offset:0
  v_mfma_f32_16x16x32_bf16 v[120:123], a[0:3], a[28:31], v[120:123]
  s_min_u32 s69, s69, s71
  ds_read_b64_tr_b16 a[74:75], v22 offset:6144
  v_mfma_f32_16x16x32_bf16 v[128:131], a[0:3], a[32:35], v[128:131]
  buffer_load_dwordx4 v4, s[8:11], s69 offen offset:0 lds
  v_mfma_f32_16x16x32_bf16 v[136:139], a[0:3], a[36:39], v[136:139]
  s_add_u32 s74, s74, 24576
  ds_read_b64_tr_b16 a[76:77], v23 offset:0
  v_mfma_f32_16x16x32_bf16 v[144:147], a[0:3], a[40:43], v[144:147]
  s_cmp_eq_u32 s74, 147456
  ds_read_b64_tr_b16 a[78:79], v23 offset:6144
  v_mfma_f32_16x16x32_bf16 v[152:155], a[0:3], a[44:47], v[152:155]
  s_cselect_b32 s74, 0, s74
  ds_read_b64_tr_b16 a[80:81], v24 offset:0
  v_mfma_f32_16x16x32_bf16 v[116:119], a[4:7], a[24:27], v[116:119]
  ds_read_b64_tr_b16 a[82:83], v24 offset:6144
  v_mfma_f32_16x16x32_bf16 v[124:127], a[4:7], a[28:31], v[124:127]
  ds_read_b64_tr_b16 a[84:85], v25 offset:0
  v_mfma_f32_16x16x32_bf16 v[132:135], a[4:7], a[32:35], v[132:135]
  buffer_load_dwordx4 v5, s[8:11], s69 offen offset:1024 lds
  v_mfma_f32_16x16x32_bf16 v[140:143], a[4:7], a[36:39], v[140:143]
  s_add_u32 s73, s73, 24576
  ds_read_b64_tr_b16 a[86:87], v25 offset:6144
  v_mfma_f32_16x16x32_bf16 v[148:151], a[4:7], a[40:43], v[148:151]
  s_cmp_eq_u32 s73, 147456
  ds_read_b64_tr_b16 a[88:89], v22 offset:128
  v_mfma_f32_16x16x32_bf16 v[156:159], a[4:7], a[44:47], v[156:159]
  s_cselect_b32 s73, 0, s73
  ds_read_b64_tr_b16 a[90:91], v22 offset:6272
  v_mfma_f32_16x16x32_bf16 v[160:163], a[8:11], a[24:27], v[160:163]
  ds_read_b64_tr_b16 a[92:93], v23 offset:128
  v_mfma_f32_16x16x32_bf16 v[168:171], a[8:11], a[28:31], v[168:171]
  ds_read_b64_tr_b16 a[94:95], v23 offset:6272
  v_mfma_f32_16x16x32_bf16 v[176:179], a[8:11], a[32:35], v[176:179]
  buffer_load_dwordx4 v6, s[8:11], s69 offen offset:2048 lds
  v_mfma_f32_16x16x32_bf16 v[184:187], a[8:11], a[36:39], v[184:187]
  s_add_u32 m0, s78, s79
  ds_read_b64_tr_b16 a[48:49], v18 offset:0
  v_add_u32 v22, s73, v14
  v_mfma_f32_16x16x32_bf16 v[192:195], a[8:11], a[40:43], v[192:195]
  s_add_u32 s69, s69, 294912
  ds_read_b64_tr_b16 a[50:51], v18 offset:6144
  v_add_u32 v23, s73, v15
  v_mfma_f32_16x16x32_bf16 v[200:203], a[8:11], a[44:47], v[200:203]
  s_min_u32 s70, s70, s72
  ds_read_b64_tr_b16 a[52:53], v19 offset:0
  v_add_u32 v24, s73, v16
  v_mfma_f32_16x16x32_bf16 v[164:167], a[12:15], a[24:27], v[164:167]
  ds_read_b64_tr_b16 a[54:55], v19 offset:6144
  v_add_u32 v25, s73, v17
  v_mfma_f32_16x16x32_bf16 v[172:175], a[12:15], a[28:31], v[172:175]
  ds_read_b64_tr_b16 a[56:57], v20 offset:0
  v_mfma_f32_16x16x32_bf16 v[180:183], a[12:15], a[32:35], v[180:183]
  buffer_load_dwordx4 v7, s[12:15], s70 offen offset:0 sc1 lds
  v_mfma_f32_16x16x32_bf16 v[188:191], a[12:15], a[36:39], v[188:191]
  s_add_u32 s78, s78, 24576
  ds_read_b64_tr_b16 a[58:59], v20 offset:6144
  v_mfma_f32_16x16x32_bf16 v[196:199], a[12:15], a[40:43], v[196:199]
  s_cmp_eq_u32 s78, 147456
  ds_read_b64_tr_b16 a[60:61], v21 offset:0
  v_mfma_f32_16x16x32_bf16 v[204:207], a[12:15], a[44:47], v[204:207]
  s_cselect_b32 s78, 0, s78
  ds_read_b64_tr_b16 a[62:63], v21 offset:6144
  v_mfma_f32_16x16x32_bf16 v[208:211], a[16:19], a[24:27], v[208:211]
  ds_read_b64_tr_b16 a[64:65], v18 offset:128
  v_mfma_f32_16x16x32_bf16 v[216:219], a[16:19], a[28:31], v[216:219]
  ds_read_b64_tr_b16 a[66:67], v18 offset:6272
  v_mfma_f32_16x16x32_bf16 v[224:227], a[16:19], a[32:35], v[224:227]
  buffer_load_dwordx4 v8, s[12:15], s70 offen offset:1024 sc1 lds
  v_mfma_f32_16x16x32_bf16 v[232:235], a[16:19], a[36:39], v[232:235]
  ds_read_b64_tr_b16 a[68:69], v19 offset:128
  v_mfma_f32_16x16x32_bf16 v[240:243], a[16:19], a[40:43], v[240:243]
  ds_read_b64_tr_b16 a[70:71], v19 offset:6272
  v_mfma_f32_16x16x32_bf16 v[248:251], a[16:19], a[44:47], v[248:251]
  v_mfma_f32_16x16x32_bf16 v[212:215], a[20:23], a[24:27], v[212:215]
  v_add_u32 v18, s73, v10
  v_add_u32 v19, s73, v11
  v_mfma_f32_16x16x32_bf16 v[220:223], a[20:23], a[28:31], v[220:223]
  v_add_u32 v20, s73, v12
  v_add_u32 v21, s73, v13
  v_mfma_f32_16x16x32_bf16 v[228:231], a[20:23], a[32:35], v[228:231]
  buffer_load_dwordx4 v9, s[12:15], s70 offen offset:2048 sc1 lds
  v_mfma_f32_16x16x32_bf16 v[236:239], a[20:23], a[36:39], v[236:239]
  s_add_u32 s70, s70, 36864
  v_mfma_f32_16x16x32_bf16 v[244:247], a[20:23], a[40:43], v[244:247]
  v_mfma_f32_16x16x32_bf16 v[252:255], a[20:23], a[44:47], v[252:255]
  s_waitcnt vmcnt(12) lgkmcnt(0)
  s_barrier
  v_mfma_f32_16x16x32_bf16 v[112:115], a[48:51], a[72:75], v[112:115]
  s_add_u32 m0, s74, s75
  ds_read_b64_tr_b16 a[24:25], v22 offset:0
  v_mfma_f32_16x16x32_bf16 v[120:123], a[48:51], a[76:79], v[120:123]
  s_min_u32 s69, s69, s71
  ds_read_b64_tr_b16 a[26:27], v22 offset:6144
  v_mfma_f32_16x16x32_bf16 v[128:131], a[48:51], a[80:83], v[128:131]
  buffer_load_dwordx4 v4, s[8:11], s69 offen offset:0 lds
  v_mfma_f32_16x16x32_bf16 v[136:139], a[48:51], a[84:87], v[136:139]
  s_add_u32 s74, s74, 24576
  ds_read_b64_tr_b16 a[28:29], v23 offset:0
  v_mfma_f32_16x16x32_bf16 v[144:147], a[48:51], a[88:91], v[144:147]
  s_cmp_eq_u32 s74, 147456
  ds_read_b64_tr_b16 a[30:31], v23 offset:6144
  v_mfma_f32_16x16x32_bf16 v[152:155], a[48:51], a[92:95], v[152:155]
  s_cselect_b32 s74, 0, s74
  ds_read_b64_tr_b16 a[32:33], v24 offset:0
  v_mfma_f32_16x16x32_bf16 v[116:119], a[52:55], a[72:75], v[116:119]
  ds_read_b64_tr_b16 a[34:35], v24 offset:6144
  v_mfma_f32_16x16x32_bf16 v[124:127], a[52:55], a[76:79], v[124:127]
  ds_read_b64_tr_b16 a[36:37], v25 offset:0
  v_mfma_f32_16x16x32_bf16 v[132:135], a[52:55], a[80:83], v[132:135]
  buffer_load_dwordx4 v5, s[8:11], s69 offen offset:1024 lds
  v_mfma_f32_16x16x32_bf16 v[140:143], a[52:55], a[84:87], v[140:143]
  s_add_u32 s73, s73, 24576
  ds_read_b64_tr_b16 a[38:39], v25 offset:6144
  v_mfma_f32_16x16x32_bf16 v[148:151], a[52:55], a[88:91], v[148:151]
  s_cmp_eq_u32 s73, 147456
  ds_read_b64_tr_b16 a[40:41], v22 offset:128
  v_mfma_f32_16x16x32_bf16 v[156:159], a[52:55], a[92:95], v[156:159]
  s_cselect_b32 s73, 0, s73
  ds_read_b64_tr_b16 a[42:43], v22 offset:6272
  v_mfma_f32_16x16x32_bf16 v[160:163], a[56:59], a[72:75], v[160:163]
  ds_read_b64_tr_b16 a[44:45], v23 offset:128
  v_mfma_f32_16x16x32_bf16 v[168:171], a[56:59], a[76:79], v[168:171]
  ds_read_b64_tr_b16 a[46:47], v23 offset:6272
  v_mfma_f32_16x16x32_bf16 v[176:179], a[56:59], a[80:83], v[176:179]
  buffer_load_dwordx4 v6, s[8:11], s69 offen offset:2048 lds
  v_mfma_f32_16x16x32_bf16 v[184:187], a[56:59], a[84:87], v[184:187]
  s_add_u32 m0, s78, s79
  ds_read_b64_tr_b16 a[0:1], v18 offset:0
  v_add_u32 v22, s73, v14
  v_mfma_f32_16x16x32_bf16 v[192:195], a[56:59], a[88:91], v[192:195]
  s_add_u32 s69, s69, 294912
  ds_read_b64_tr_b16 a[2:3], v18 offset:6144
  v_add_u32 v23, s73, v15
  v_mfma_f32_16x16x32_bf16 v[200:203], a[56:59], a[92:95], v[200:203]
  s_min_u32 s70, s70, s72
  ds_read_b64_tr_b16 a[4:5], v19 offset:0
  v_add_u32 v24, s73, v16
  v_mfma_f32_16x16x32_bf16 v[164:167], a[60:63], a[72:75], v[164:167]
  ds_read_b64_tr_b16 a[6:7], v19 offset:6144
  v_add_u32 v25, s73, v17
  v_mfma_f32_16x16x32_bf16 v[172:175], a[60:63], a[76:79], v[172:175]
  ds_read_b64_tr_b16 a[8:9], v20 offset:0
  v_mfma_f32_16x16x32_bf16 v[180:183], a[60:63], a[80:83], v[180:183]
  buffer_load_dwordx4 v7, s[12:15], s70 offen offset:0 sc1 lds
  v_mfma_f32_16x16x32_bf16 v[188:191], a[60:63], a[84:87], v[188:191]
  s_add_u32 s78, s78, 24576
  ds_read_b64_tr_b16 a[10:11], v20 offset:6144
  v_mfma_f32_16x16x32_bf16 v[196:199], a[60:63], a[88:91], v[196:199]
  s_cmp_eq_u32 s78, 147456
  ds_read_b64_tr_b16 a[12:13], v21 offset:0
  v_mfma_f32_16x16x32_bf16 v[204:207], a[60:63], a[92:95], v[204:207]
  s_cselect_b32 s78, 0, s78
  ds_read_b64_tr_b16 a[14:15], v21 offset:6144
  v_mfma_f32_16x16x32_bf16 v[208:211], a[64:67], a[72:75], v[208:211]
  ds_read_b64_tr_b16 a[16:17], v18 offset:128
  v_mfma_f32_16x16x32_bf16 v[216:219], a[64:67], a[76:79], v[216:219]
  ds_read_b64_tr_b16 a[18:19], v18 offset:6272
  v_mfma_f32_16x16x32_bf16 v[224:227], a[64:67], a[80:83], v[224:227]
  buffer_load_dwordx4 v8, s[12:15], s70 offen offset:1024 sc1 lds
  v_mfma_f32_16x16x32_bf16 v[232:235], a[64:67], a[84:87], v[232:235]
  ds_read_b64_tr_b16 a[20:21], v19 offset:128
  v_mfma_f32_16x16x32_bf16 v[240:243], a[64:67], a[88:91], v[240:243]
  ds_read_b64_tr_b16 a[22:23], v19 offset:6272
  v_mfma_f32_16x16x32_bf16 v[248:251], a[64:67], a[92:95], v[248:251]
  v_mfma_f32_16x16x32_bf16 v[212:215], a[68:71], a[72:75], v[212:215]
  v_add_u32 v18, s73, v10
  v_add_u32 v19, s73, v11
  v_mfma_f32_16x16x32_bf16 v[220:223], a[68:71], a[76:79], v[220:223]
  v_add_u32 v20, s73, v12
  v_add_u32 v21, s73, v13
  v_mfma_f32_16x16x32_bf16 v[228:231], a[68:71], a[80:83], v[228:231]
  buffer_load_dwordx4 v9, s[12:15], s70 offen offset:2048 sc1 lds
  v_mfma_f32_16x16x32_bf16 v[236:239], a[68:71], a[84:87], v[236:239]
  s_add_u32 s70, s70, 36864
  v_mfma_f32_16x16x32_bf16 v[244:247], a[68:71], a[88:91], v[244:247]
  v_mfma_f32_16x16x32_bf16 v[252:255], a[68:71], a[92:95], v[252:255]
  s_waitcnt vmcnt(12) lgkmcnt(0)
  s_barrier
  v_mfma_f32_16x16x32_bf16 v[112:115], a[0:3], a[24:27], v[112:115]
  s_add_u32 m0, s74, s75
  ds_read_b64_tr_b16 a[72:73], v22 offset:0
  v_mfma_f32_16x16x32_bf16 v[120:123], a[0:3], a[28:31], v[120:123]
  s_min_u32 s69, s69, s71
  ds_read_b64_tr_b16 a[74:75], v22 offset:6144
  v_mfma_f32_16x16x32_bf16 v[128:131], a[0:3], a[32:35], v[128:131]
  buffer_load_dwordx4 v4, s[8:11], s69 offen offset:0 lds
  v_mfma_f32_16x16x32_bf16 v[136:139], a[0:3], a[36:39], v[136:139]
  s_add_u32 s74, s74, 24576
  ds_read_b64_tr_b16 a[76:77], v23 offset:0
  v_mfma_f32_16x16x32_bf16 v[144:147], a[0:3], a[40:43], v[144:147]
  s_cmp_eq_u32 s74, 147456
  ds_read_b64_tr_b16 a[78:79], v23 offset:6144
  v_mfma_f32_16x16x32_bf16 v[152:155], a[0:3], a[44:47], v[152:155]
  s_cselect_b32 s74, 0, s74
  ds_read_b64_tr_b16 a[80:81], v24 offset:0
  v_mfma_f32_16x16x32_bf16 v[116:119], a[4:7], a[24:27], v[116:119]
  ds_read_b64_tr_b16 a[82:83], v24 offset:6144
  v_mfma_f32_16x16x32_bf16 v[124:127], a[4:7], a[28:31], v[124:127]
  ds_read_b64_tr_b16 a[84:85], v25 offset:0
  v_mfma_f32_16x16x32_bf16 v[132:135], a[4:7], a[32:35], v[132:135]
  buffer_load_dwordx4 v5, s[8:11], s69 offen offset:1024 lds
  v_mfma_f32_16x16x32_bf16 v[140:143], a[4:7], a[36:39], v[140:143]
  s_add_u32 s73, s73, 24576
  ds_read_b64_tr_b16 a[86:87], v25 offset:6144
  v_mfma_f32_16x16x32_bf16 v[148:151], a[4:7], a[40:43], v[148:151]
  s_cmp_eq_u32 s73, 147456
  ds_read_b64_tr_b16 a[88:89], v22 offset:128
  v_mfma_f32_16x16x32_bf16 v[156:159], a[4:7], a[44:47], v[156:159]
  s_cselect_b32 s73, 0, s73
  ds_read_b64_tr_b16 a[90:91], v22 offset:6272
  v_mfma_f32_16x16x32_bf16 v[160:163], a[8:11], a[24:27], v[160:163]
  ds_read_b64_tr_b16 a[92:93], v23 offset:128
  v_mfma_f32_16x16x32_bf16 v[168:171], a[8:11], a[28:31], v[168:171]
  ds_read_b64_tr_b16 a[94:95], v23 offset:6272
  v_mfma_f32_16x16x32_bf16 v[176:179], a[8:11], a[32:35], v[176:179]
  buffer_load_dwordx4 v6, s[8:11], s69 offen offset:2048 lds
  v_mfma_f32_16x16x32_bf16 v[184:187], a[8:11], a[36:39], v[184:187]
  s_add_u32 m0, s78, s79
  ds_read_b64_tr_b16 a[48:49], v18 offset:0
  v_add_u32 v22, s73, v14
  v_mfma_f32_16x16x32_bf16 v[192:195], a[8:11], a[40:43], v[192:195]
  s_add_u32 s69, s69, 294912
  ds_read_b64_tr_b16 a[50:51], v18 offset:6144
  v_add_u32 v23, s73, v15
  v_mfma_f32_16x16x32_bf16 v[200:203], a[8:11], a[44:47], v[200:203]
  s_min_u32 s70, s70, s72
  ds_read_b64_tr_b16 a[52:53], v19 offset:0
  v_add_u32 v24, s73, v16
  v_mfma_f32_16x16x32_bf16 v[164:167], a[12:15], a[24:27], v[164:167]
  ds_read_b64_tr_b16 a[54:55], v19 offset:6144
  v_add_u32 v25, s73, v17
  v_mfma_f32_16x16x32_bf16 v[172:175], a[12:15], a[28:31], v[172:175]
  ds_read_b64_tr_b16 a[56:57], v20 offset:0
  v_mfma_f32_16x16x32_bf16 v[180:183], a[12:15], a[32:35], v[180:183]
  buffer_load_dwordx4 v7, s[12:15], s70 offen offset:0 sc1 lds
  v_mfma_f32_16x16x32_bf16 v[188:191], a[12:15], a[36:39], v[188:191]
  s_add_u32 s78, s78, 24576
  ds_read_b64_tr_b16 a[58:59], v20 offset:6144
  v_mfma_f32_16x16x32_bf16 v[196:199], a[12:15], a[40:43], v[196:199]
  s_cmp_eq_u32 s78, 147456
  ds_read_b64_tr_b16 a[60:61], v21 offset:0
  v_mfma_f32_16x16x32_bf16 v[204:207], a[12:15], a[44:47], v[204:207]
  s_cselect_b32 s78, 0, s78
  ds_read_b64_tr_b16 a[62:63], v21 offset:6144
  v_mfma_f32_16x16x32_bf16 v[208:211], a[16:19], a[24:27], v[208:211]
  ds_read_b64_tr_b16 a[64:65], v18 offset:128
  v_mfma_f32_16x16x32_bf16 v[216:219], a[16:19], a[28:31], v[216:219]
  ds_read_b64_tr_b16 a[66:67], v18 offset:6272
  v_mfma_f32_16x16x32_bf16 v[224:227], a[16:19], a[32:35], v[224:227]
  buffer_load_dwordx4 v8, s[12:15], s70 offen offset:1024 sc1 lds
  v_mfma_f32_16x16x32_bf16 v[232:235], a[16:19], a[36:39], v[232:235]
  ds_read_b64_tr_b16 a[68:69], v19 offset:128
  v_mfma_f32_16x16x32_bf16 v[240:243], a[16:19], a[40:43], v[240:243]
  ds_read_b64_tr_b16 a[70:71], v19 offset:6272
  v_mfma_f32_16x16x32_bf16 v[248:251], a[16:19], a[44:47], v[248:251]
  v_mfma_f32_16x16x32_bf16 v[212:215], a[20:23], a[24:27], v[212:215]
  v_add_u32 v18, s73, v10
  v_add_u32 v19, s73, v11
  v_mfma_f32_16x16x32_bf16 v[220:223], a[20:23], a[28:31], v[220:223]
  v_add_u32 v20, s73, v12
  v_add_u32 v21, s73, v13
  v_mfma_f32_16x16x32_bf16 v[228:231], a[20:23], a[32:35], v[228:231]
  buffer_load_dwordx4 v9, s[12:15], s70 offen offset:2048 sc1 lds
  v_mfma_f32_16x16x32_bf16 v[236:239], a[20:23], a[36:39], v[236:239]
  s_add_u32 s70, s70, 36864
  v_mfma_f32_16x16x32_bf16 v[244:247], a[20:23], a[40:43], v[244:247]
  v_mfma_f32_16x16x32_bf16 v[252:255], a[20:23], a[44:47], v[252:255]
  s_waitcnt vmcnt(12) lgkmcnt(0)
  s_barrier
  v_mfma_f32_16x16x32_bf16 v[112:115], a[48:51], a[72:75], v[112:115]
  s_add_u32 m0, s74, s75
  ds_read_b64_tr_b16 a[24:25], v22 offset:0
  v_mfma_f32_16x16x32_bf16 v[120:123], a[48:51], a[76:79], v[120:123]
  s_min_u32 s69, s69, s71
  ds_read_b64_tr_b16 a[26:27], v22 offset:6144
  v_mfma_f32_16x16x32_bf16 v[128:131], a[48:51], a[80:83], v[128:131]
  buffer_load_dwordx4 v4, s[8:11], s69 offen offset:0 lds
  v_mfma_f32_16x16x32_bf16 v[136:139], a[48:51], a[84:87], v[136:139]
  s_add_u32 s74, s74, 24576
  ds_read_b64_tr_b16 a[28:29], v23 offset:0
  v_mfma_f32_16x16x32_bf16 v[144:147], a[48:51], a[88:91], v[144:147]
  s_cmp_eq_u32 s74, 147456
  ds_read_b64_tr_b16 a[30:31], v23 offset:6144
  v_mfma_f32_16x16x32_bf16 v[152:155], a[48:51], a[92:95], v[152:155]
  s_cselect_b32 s74, 0, s74
  ds_read_b64_tr_b16 a[32:33], v24 offset:0
  v_mfma_f32_16x16x32_bf16 v[116:119], a[52:55], a[72:75], v[116:119]
  ds_read_b64_tr_b16 a[34:35], v24 offset:6144
  v_mfma_f32_16x16x32_bf16 v[124:127], a[52:55], a[76:79], v[124:127]
  ds_read_b64_tr_b16 a[36:37], v25 offset:0
  v_mfma_f32_16x16x32_bf16 v[132:135], a[52:55], a[80:83], v[132:135]
  buffer_load_dwordx4 v5, s[8:11], s69 offen offset:1024 lds
  v_mfma_f32_16x16x32_bf16 v[140:143], a[52:55], a[84:87], v[140:143]
  s_add_u32 s73, s73, 24576
  ds_read_b64_tr_b16 a[38:39], v25 offset:6144
  v_mfma_f32_16x16x32_bf16 v[148:151], a[52:55], a[88:91], v[148:151]
  s_cmp_eq_u32 s73, 147456
  ds_read_b64_tr_b16 a[40:41], v22 offset:128
  v_mfma_f32_16x16x32_bf16 v[156:159], a[52:55], a[92:95], v[156:159]
  s_cselect_b32 s73, 0, s73
  ds_read_b64_tr_b16 a[42:43], v22 offset:6272
  v_mfma_f32_16x16x32_bf16 v[160:163], a[56:59], a[72:75], v[160:163]
  ds_read_b64_tr_b16 a[44:45], v23 offset:128
  v_mfma_f32_16x16x32_bf16 v[168:171], a[56:59], a[76:79], v[168:171]
  ds_read_b64_tr_b16 a[46:47], v23 offset:6272
  v_mfma_f32_16x16x32_bf16 v[176:179], a[56:59], a[80:83], v[176:179]
  buffer_load_dwordx4 v6, s[8:11], s69 offen offset:2048 lds
  v_mfma_f32_16x16x32_bf16 v[184:187], a[56:59], a[84:87], v[184:187]
  s_add_u32 m0, s78, s79
  ds_read_b64_tr_b16 a[0:1], v18 offset:0
  v_add_u32 v22, s73, v14
  v_mfma_f32_16x16x32_bf16 v[192:195], a[56:59], a[88:91], v[192:195]
  s_add_u32 s69, s69, 294912
  ds_read_b64_tr_b16 a[2:3], v18 offset:6144
  v_add_u32 v23, s73, v15
  v_mfma_f32_16x16x32_bf16 v[200:203], a[56:59], a[92:95], v[200:203]
  s_min_u32 s70, s70, s72
  ds_read_b64_tr_b16 a[4:5], v19 offset:0
  v_add_u32 v24, s73, v16
  v_mfma_f32_16x16x32_bf16 v[164:167], a[60:63], a[72:75], v[164:167]
  ds_read_b64_tr_b16 a[6:7], v19 offset:6144
  v_add_u32 v25, s73, v17
  v_mfma_f32_16x16x32_bf16 v[172:175], a[60:63], a[76:79], v[172:175]
  ds_read_b64_tr_b16 a[8:9], v20 offset:0
  v_mfma_f32_16x16x32_bf16 v[180:183], a[60:63], a[80:83], v[180:183]
  buffer_load_dwordx4 v7, s[12:15], s70 offen offset:0 sc1 lds
  v_mfma_f32_16x16x32_bf16 v[188:191], a[60:63], a[84:87], v[188:191]
  s_add_u32 s78, s78, 24576
  ds_read_b64_tr_b16 a[10:11], v20 offset:6144
  v_mfma_f32_16x16x32_bf16 v[196:199], a[60:63], a[88:91], v[196:199]
  s_cmp_eq_u32 s78, 147456
  ds_read_b64_tr_b16 a[12:13], v21 offset:0
  v_mfma_f32_16x16x32_bf16 v[204:207], a[60:63], a[92:95], v[204:207]
  s_cselect_b32 s78, 0, s78
  ds_read_b64_tr_b16 a[14:15], v21 offset:6144
  v_mfma_f32_16x16x32_bf16 v[208:211], a[64:67], a[72:75], v[208:211]
  ds_read_b64_tr_b16 a[16:17], v18 offset:128
  v_mfma_f32_16x16x32_bf16 v[216:219], a[64:67], a[76:79], v[216:219]
  ds_read_b64_tr_b16 a[18:19], v18 offset:6272
  v_mfma_f32_16x16x32_bf16 v[224:227], a[64:67], a[80:83], v[224:227]
  buffer_load_dwordx4 v8, s[12:15], s70 offen offset:1024 sc1 lds
  v_mfma_f32_16x16x32_bf16 v[232:235], a[64:67], a[84:87], v[232:235]
  ds_read_b64_tr_b16 a[20:21], v19 offset:128
  v_mfma_f32_16x16x32_bf16 v[240:243], a[64:67], a[88:91], v[240:243]
  ds_read_b64_tr_b16 a[22:23], v19 offset:6272
  v_mfma_f32_16x16x32_bf16 v[248:251], a[64:67], a[92:95], v[248:251]
  v_mfma_f32_16x16x32_bf16 v[212:215], a[68:71], a[72:75], v[212:215]
  v_add_u32 v18, s73, v10
  v_add_u32 v19, s73, v11
  v_mfma_f32_16x16x32_bf16 v[220:223], a[68:71], a[76:79], v[220:223]
  v_add_u32 v20, s73, v12
  v_add_u32 v21, s73, v13
  v_mfma_f32_16x16x32_bf16 v[228:231], a[68:71], a[80:83], v[228:231]
  buffer_load_dwordx4 v9, s[12:15], s70 offen offset:2048 sc1 lds
  v_mfma_f32_16x16x32_bf16 v[236:239], a[68:71], a[84:87], v[236:239]
  s_add_u32 s70, s70, 36864
  v_mfma_f32_16x16x32_bf16 v[244:247], a[68:71], a[88:91], v[244:247]
  v_mfma_f32_16x16x32_bf16 v[252:255], a[68:71], a[92:95], v[252:255]
  s_waitcnt vmcnt(12) lgkmcnt(0)
  s_barrier
  v_mfma_f32_16x16x32_bf16 v[112:115], a[0:3], a[24:27], v[112:115]
  s_add_u32 m0, s74, s75
  ds_read_b64_tr_b16 a[72:73], v22 offset:0
  v_mfma_f32_16x16x32_bf16 v[120:123], a[0:3], a[28:31], v[120:123]
  s_min_u32 s69, s69, s71
  ds_read_b64_tr_b16 a[74:75], v22 offset:6144
  v_mfma_f32_16x16x32_bf16 v[128:131], a[0:3], a[32:35], v[128:131]
  buffer_load_dwordx4 v4, s[8:11], s69 offen offset:0 lds
  v_mfma_f32_16x16x32_bf16 v[136:139], a[0:3], a[36:39], v[136:139]
  s_add_u32 s74, s74, 24576
  ds_read_b64_tr_b16 a[76:77], v23 offset:0
  v_mfma_f32_16x16x32_bf16 v[144:147], a[0:3], a[40:43], v[144:147]
  s_cmp_eq_u32 s74, 147456
  ds_read_b64_tr_b16 a[78:79], v23 offset:6144
  v_mfma_f32_16x16x32_bf16 v[152:155], a[0:3], a[44:47], v[152:155]
  s_cselect_b32 s74, 0, s74
  ds_read_b64_tr_b16 a[80:81], v24 offset:0
  v_mfma_f32_16x16x32_bf16 v[116:119], a[4:7], a[24:27], v[116:119]
  ds_read_b64_tr_b16 a[82:83], v24 offset:6144
  v_mfma_f32_16x16x32_bf16 v[124:127], a[4:7], a[28:31], v[124:127]
  ds_read_b64_tr_b16 a[84:85], v25 offset:0
  v_mfma_f32_16x16x32_bf16 v[132:135], a[4:7], a[32:35], v[132:135]
  buffer_load_dwordx4 v5, s[8:11], s69 offen offset:1024 lds
  v_mfma_f32_16x16x32_bf16 v[140:143], a[4:7], a[36:39], v[140:143]
  s_add_u32 s73, s73, 24576
  ds_read_b64_tr_b16 a[86:87], v25 offset:6144
  v_mfma_f32_16x16x32_bf16 v[148:151], a[4:7], a[40:43], v[148:151]
  s_cmp_eq_u32 s73, 147456
  ds_read_b64_tr_b16 a[88:89], v22 offset:128
  v_mfma_f32_16x16x32_bf16 v[156:159], a[4:7], a[44:47], v[156:159]
  s_cselect_b32 s73, 0, s73
  ds_read_b64_tr_b16 a[90:91], v22 offset:6272
  v_mfma_f32_16x16x32_bf16 v[160:163], a[8:11], a[24:27], v[160:163]
  ds_read_b64_tr_b16 a[92:93], v23 offset:128
  v_mfma_f32_16x16x32_bf16 v[168:171], a[8:11], a[28:31], v[168:171]
  ds_read_b64_tr_b16 a[94:95], v23 offset:6272
  v_mfma_f32_16x16x32_bf16 v[176:179], a[8:11], a[32:35], v[176:179]
  buffer_load_dwordx4 v6, s[8:11], s69 offen offset:2048 lds
  v_mfma_f32_16x16x32_bf16 v[184:187], a[8:11], a[36:39], v[184:187]
  s_add_u32 m0, s78, s79
  ds_read_b64_tr_b16 a[48:49], v18 offset:0
  v_add_u32 v22, s73, v14
  v_mfma_f32_16x16x32_bf16 v[192:195], a[8:11], a[40:43], v[192:195]
  s_add_u32 s69, s69, 294912
  ds_read_b64_tr_b16 a[50:51], v18 offset:6144
  v_add_u32 v23, s73, v15
  v_mfma_f32_16x16x32_bf16 v[200:203], a[8:11], a[44:47], v[200:203]
  s_min_u32 s70, s70, s72
  ds_read_b64_tr_b16 a[52:53], v19 offset:0
  v_add_u32 v24, s73, v16
  v_mfma_f32_16x16x32_bf16 v[164:167], a[12:15], a[24:27], v[164:167]
  ds_read_b64_tr_b16 a[54:55], v19 offset:6144
  v_add_u32 v25, s73, v17
  v_mfma_f32_16x16x32_bf16 v[172:175], a[12:15], a[28:31], v[172:175]
  ds_read_b64_tr_b16 a[56:57], v20 offset:0
  v_mfma_f32_16x16x32_bf16 v[180:183], a[12:15], a[32:35], v[180:183]
  buffer_load_dwordx4 v7, s[12:15], s70 offen offset:0 sc1 lds
  v_mfma_f32_16x16x32_bf16 v[188:191], a[12:15], a[36:39], v[188:191]
  s_add_u32 s78, s78, 24576
  ds_read_b64_tr_b16 a[58:59], v20 offset:6144
  v_mfma_f32_16x16x32_bf16 v[196:199], a[12:15], a[40:43], v[196:199]
  s_cmp_eq_u32 s78, 147456
  ds_read_b64_tr_b16 a[60:61], v21 offset:0
  v_mfma_f32_16x16x32_bf16 v[204:207], a[12:15], a[44:47], v[204:207]
  s_cselect_b32 s78, 0, s78
  ds_read_b64_tr_b16 a[62:63], v21 offset:6144
  v_mfma_f32_16x16x32_bf16 v[208:211], a[16:19], a[24:27], v[208:211]
  ds_read_b64_tr_b16 a[64:65], v18 offset:128
  v_mfma_f32_16x16x32_bf16 v[216:219], a[16:19], a[28:31], v[216:219]
  ds_read_b64_tr_b16 a[66:67], v18 offset:6272
  v_mfma_f32_16x16x32_bf16 v[224:227], a[16:19], a[32:35], v[224:227]
  buffer_load_dwordx4 v8, s[12:15], s70 offen offset:1024 sc1 lds
  v_mfma_f32_16x16x32_bf16 v[232:235], a[16:19], a[36:39], v[232:235]
  ds_read_b64_tr_b16 a[68:69], v19 offset:128
  v_mfma_f32_16x16x32_bf16 v[240:243], a[16:19], a[40:43], v[240:243]
  ds_read_b64_tr_b16 a[70:71], v19 offset:6272
  v_mfma_f32_16x16x32_bf16 v[248:251], a[16:19], a[44:47], v[248:251]
  v_mfma_f32_16x16x32_bf16 v[212:215], a[20:23], a[24:27], v[212:215]
  v_add_u32 v18, s73, v10
  v_add_u32 v19, s73, v11
  v_mfma_f32_16x16x32_bf16 v[220:223], a[20:23], a[28:31], v[220:223]
  v_add_u32 v20, s73, v12
  v_add_u32 v21, s73, v13
  v_mfma_f32_16x16x32_bf16 v[228:231], a[20:23], a[32:35], v[228:231]
  buffer_load_dwordx4 v9, s[12:15], s70 offen offset:2048 sc1 lds
  v_mfma_f32_16x16x32_bf16 v[236:239], a[20:23], a[36:39], v[236:239]
  s_add_u32 s70, s70, 36864
  v_mfma_f32_16x16x32_bf16 v[244:247], a[20:23], a[40:43], v[244:247]
  v_mfma_f32_16x16x32_bf16 v[252:255], a[20:23], a[44:47], v[252:255]
  s_waitcnt vmcnt(12) lgkmcnt(0)
  s_barrier
  v_mfma_f32_16x16x32_bf16 v[112:115], a[48:51], a[72:75], v[112:115]
  s_add_u32 m0, s74, s75
  ds_read_b64_tr_b16 a[24:25], v22 offset:0
  v_mfma_f32_16x16x32_bf16 v[120:123], a[48:51], a[76:79], v[120:123]
  s_min_u32 s69, s69, s71
  ds_read_b64_tr_b16 a[26:27], v22 offset:6144
  v_mfma_f32_16x16x32_bf16 v[128:131], a[48:51], a[80:83], v[128:131]
  buffer_load_dwordx4 v4, s[8:11], s69 offen offset:0 lds
  v_mfma_f32_16x16x32_bf16 v[136:139], a[48:51], a[84:87], v[136:139]
  s_add_u32 s74, s74, 24576
  ds_read_b64_tr_b16 a[28:29], v23 offset:0
  v_mfma_f32_16x16x32_bf16 v[144:147], a[48:51], a[88:91], v[144:147]
  s_cmp_eq_u32 s74, 147456
  ds_read_b64_tr_b16 a[30:31], v23 offset:6144
  v_mfma_f32_16x16x32_bf16 v[152:155], a[48:51], a[92:95], v[152:155]
  s_cselect_b32 s74, 0, s74
  ds_read_b64_tr_b16 a[32:33], v24 offset:0
  v_mfma_f32_16x16x32_bf16 v[116:119], a[52:55], a[72:75], v[116:119]
  ds_read_b64_tr_b16 a[34:35], v24 offset:6144
  v_mfma_f32_16x16x32_bf16 v[124:127], a[52:55], a[76:79], v[124:127]
  ds_read_b64_tr_b16 a[36:37], v25 offset:0
  v_mfma_f32_16x16x32_bf16 v[132:135], a[52:55], a[80:83], v[132:135]
  buffer_load_dwordx4 v5, s[8:11], s69 offen offset:1024 lds
  v_mfma_f32_16x16x32_bf16 v[140:143], a[52:55], a[84:87], v[140:143]
  s_add_u32 s73, s73, 24576
  ds_read_b64_tr_b16 a[38:39], v25 offset:6144
  v_mfma_f32_16x16x32_bf16 v[148:151], a[52:55], a[88:91], v[148:151]
  s_cmp_eq_u32 s73, 147456
  ds_read_b64_tr_b16 a[40:41], v22 offset:128
  v_mfma_f32_16x16x32_bf16 v[156:159], a[52:55], a[92:95], v[156:159]
  s_cselect_b32 s73, 0, s73
  ds_read_b64_tr_b16 a[42:43], v22 offset:6272
  v_mfma_f32_16x16x32_bf16 v[160:163], a[56:59], a[72:75], v[160:163]
  ds_read_b64_tr_b16 a[44:45], v23 offset:128
  v_mfma_f32_16x16x32_bf16 v[168:171], a[56:59], a[76:79], v[168:171]
  ds_read_b64_tr_b16 a[46:47], v23 offset:6272
  v_mfma_f32_16x16x32_bf16 v[176:179], a[56:59], a[80:83], v[176:179]
  buffer_load_dwordx4 v6, s[8:11], s69 offen offset:2048 lds
  v_mfma_f32_16x16x32_bf16 v[184:187], a[56:59], a[84:87], v[184:187]
  s_add_u32 m0, s78, s79
  ds_read_b64_tr_b16 a[0:1], v18 offset:0
  v_add_u32 v22, s73, v14
  v_mfma_f32_16x16x32_bf16 v[192:195], a[56:59], a[88:91], v[192:195]
  s_add_u32 s69, s69, 294912
  ds_read_b64_tr_b16 a[2:3], v18 offset:6144
  v_add_u32 v23, s73, v15
  v_mfma_f32_16x16x32_bf16 v[200:203], a[56:59], a[92:95], v[200:203]
  s_min_u32 s70, s70, s72
  ds_read_b64_tr_b16 a[4:5], v19 offset:0
  v_add_u32 v24, s73, v16
  v_mfma_f32_16x16x32_bf16 v[164:167], a[60:63], a[72:75], v[164:167]
  ds_read_b64_tr_b16 a[6:7], v19 offset:6144
  v_add_u32 v25, s73, v17
  v_mfma_f32_16x16x32_bf16 v[172:175], a[60:63], a[76:79], v[172:175]
  ds_read_b64_tr_b16 a[8:9], v20 offset:0
  v_mfma_f32_16x16x32_bf16 v[180:183], a[60:63], a[80:83], v[180:183]
  buffer_load_dwordx4 v7, s[12:15], s70 offen offset:0 sc1 lds
  v_mfma_f32_16x16x32_bf16 v[188:191], a[60:63], a[84:87], v[188:191]
  s_add_u32 s78, s78, 24576
  ds_read_b64_tr_b16 a[10:11], v20 offset:6144
  v_mfma_f32_16x16x32_bf16 v[196:199], a[60:63], a[88:91], v[196:199]
  s_cmp_eq_u32 s78, 147456
  ds_read_b64_tr_b16 a[12:13], v21 offset:0
  v_mfma_f32_16x16x32_bf16 v[204:207], a[60:63], a[92:95], v[204:207]
  s_cselect_b32 s78, 0, s78
  ds_read_b64_tr_b16 a[14:15], v21 offset:6144
  v_mfma_f32_16x16x32_bf16 v[208:211], a[64:67], a[72:75], v[208:211]
  ds_read_b64_tr_b16 a[16:17], v18 offset:128
  v_mfma_f32_16x16x32_bf16 v[216:219], a[64:67], a[76:79], v[216:219]
  ds_read_b64_tr_b16 a[18:19], v18 offset:6272
  v_mfma_f32_16x16x32_bf16 v[224:227], a[64:67], a[80:83], v[224:227]
  buffer_load_dwordx4 v8, s[12:15], s70 offen offset:1024 sc1 lds
  v_mfma_f32_16x16x32_bf16 v[232:235], a[64:67], a[84:87], v[232:235]
  ds_read_b64_tr_b16 a[20:21], v19 offset:128
  v_mfma_f32_16x16x32_bf16 v[240:243], a[64:67], a[88:91], v[240:243]
  ds_read_b64_tr_b16 a[22:23], v19 offset:6272
  v_mfma_f32_16x16x32_bf16 v[248:251], a[64:67], a[92:95], v[248:251]
  v_mfma_f32_16x16x32_bf16 v[212:215], a[68:71], a[72:75], v[212:215]
  v_add_u32 v18, s73, v10
  v_add_u32 v19, s73, v11
  v_mfma_f32_16x16x32_bf16 v[220:223], a[68:71], a[76:79], v[220:223]
  s_sub_u32 s76, s76, 1
  v_add_u32 v20, s73, v12
  v_add_u32 v21, s73, v13
  v_mfma_f32_16x16x32_bf16 v[228:231], a[68:71], a[80:83], v[228:231]
  buffer_load_dwordx4 v9, s[12:15], s70 offen offset:2048 sc1 lds
  v_mfma_f32_16x16x32_bf16 v[236:239], a[68:71], a[84:87], v[236:239]
  s_add_u32 s70, s70, 36864
  v_mfma_f32_16x16x32_bf16 v[244:247], a[68:71], a[88:91], v[244:247]
  s_cmp_lg_u32 s76, 0
  v_mfma_f32_16x16x32_bf16 v[252:255], a[68:71], a[92:95], v[252:255]
  s_waitcnt vmcnt(12) lgkmcnt(0)
  s_barrier
  s_cbranch_scc1 L_mlp1_loop
  v_mov_b32 v26, 0xc0135761
  v_mov_b32 v28, 0xbdd2d3e8
  v_mov_b32 v30, 1.0
  v_mov_b32 v27, 0xc0135761
  v_mov_b32 v29, 0xbdd2d3e8
  v_mov_b32 v31, 1.0
  v_lshlrev_b32 v4, 4, v1
  v_pk_mul_f32 v[40:41], v[112:113], v[112:113]
  v_pk_mul_f32 v[42:43], v[114:115], v[114:115]
  v_pk_mul_f32 v[44:45], v[116:117], v[116:117]
  v_pk_mul_f32 v[46:47], v[118:119], v[118:119]
  v_pk_mul_f32 v[48:49], v[120:121], v[120:121]
  v_pk_mul_f32 v[50:51], v[122:123], v[122:123]
  v_pk_mul_f32 v[52:53], v[124:125], v[124:125]
  v_pk_mul_f32 v[54:55], v[126:127], v[126:127]
  v_pk_fma_f32 v[40:41], v[40:41], v[28:29], v[26:27]
  v_pk_fma_f32 v[42:43], v[42:43], v[28:29], v[26:27]
  v_pk_fma_f32 v[44:45], v[44:45], v[28:29], v[26:27]
  v_pk_fma_f32 v[46:47], v[46:47], v[28:29], v[26:27]
  v_pk_fma_f32 v[48:49], v[48:49], v[28:29], v[26:27]
  v_pk_fma_f32 v[50:51], v[50:51], v[28:29], v[26:27]
  v_pk_fma_f32 v[52:53], v[52:53], v[28:29], v[26:27]
  v_pk_fma_f32 v[54:55], v[54:55], v[28:29], v[26:27]
  v_pk_mul_f32 v[40:41], v[40:41], v[112:113]
  v_pk_mul_f32 v[42:43], v[42:43], v[114:115]
  v_pk_mul_f32 v[44:45], v[44:45], v[116:117]
  v_pk_mul_f32 v[46:47], v[46:47], v[118:119]
  v_pk_mul_f32 v[48:49], v[48:49], v[120:121]
  v_pk_mul_f32 v[50:51], v[50:51], v[122:123]
  v_pk_mul_f32 v[52:53], v[52:53], v[124:125]
  v_pk_mul_f32 v[54:55], v[54:55], v[126:127]
  v_exp_f32 v40, v40
  v_exp_f32 v41, v41
  v_exp_f32 v42, v42
  v_exp_f32 v43, v43
  v_exp_f32 v44, v44
  v_exp_f32 v45, v45
  v_exp_f32 v46, v46
  v_exp_f32 v47, v47
  v_exp_f32 v48, v48
  v_exp_f32 v49, v49
  v_exp_f32 v50, v50
  v_exp_f32 v51, v51
  v_exp_f32 v52, v52
  v_exp_f32 v53, v53
  v_exp_f32 v54, v54
  v_exp_f32 v55, v55
  v_pk_add_f32 v[40:41], v[40:41], v[30:31]
  v_pk_add_f32 v[42:43], v[42:43], v[30:31]
  v_pk_add_f32 v[44:45], v[44:45], v[30:31]
  v_pk_add_f32 v[46:47], v[46:47], v[30:31]
  v_pk_add_f32 v[48:49], v[48:49], v[30:31]
  v_pk_add_f32 v[50:51], v[50:51], v[30:31]
  v_pk_add_f32 v[52:53], v[52:53], v[30:31]
  v_pk_add_f32 v[54:55], v[54:55], v[30:31]
  v_rcp_f32 v40, v40
  v_rcp_f32 v41, v41
  v_rcp_f32 v42, v42
  v_rcp_f32 v43, v43
  v_rcp_f32 v44, v44
  v_rcp_f32 v45, v45
  v_rcp_f32 v46, v46
  v_rcp_f32 v47, v47
  v_rcp_f32 v48, v48
  v_rcp_f32 v49, v49
  v_rcp_f32 v50, v50
  v_rcp_f32 v51, v51
  v_rcp_f32 v52, v52
  v_rcp_f32 v53, v53
  v_rcp_f32 v54, v54
  v_rcp_f32 v55, v55
  v_pk_mul_f32 v[40:41], v[40:41], v[112:113]
  v_pk_mul_f32 v[42:43], v[42:43], v[114:115]
  v_pk_mul_f32 v[44:45], v[44:45], v[116:117]
  v_pk_mul_f32 v[46:47], v[46:47], v[118:119]
  v_pk_mul_f32 v[48:49], v[48:49], v[120:121]
  v_pk_mul_f32 v[50:51], v[50:51], v[122:123]
  v_pk_mul_f32 v[52:53], v[52:53], v[124:125]
  v_pk_mul_f32 v[54:55], v[54:55], v[126:127]
  v_cvt_pk_bf16_f32 v112, v40, v41
  v_cvt_pk_bf16_f32 v113, v42, v43
  v_cvt_pk_bf16_f32 v114, v44, v45
  v_cvt_pk_bf16_f32 v115, v46, v47
  v_cvt_pk_bf16_f32 v120, v48, v49
  v_cvt_pk_bf16_f32 v121, v50, v51
  v_cvt_pk_bf16_f32 v122, v52, v53
  v_cvt_pk_bf16_f32 v123, v54, v55
  buffer_store_dwordx4 v[112:115], v4, s[16:19], s68 offen offset:0 sc1
  buffer_store_dwordx4 v[120:123], v4, s[16:19], s68 offen offset:1024 sc1
  v_pk_mul_f32 v[56:57], v[128:129], v[128:129]
  v_pk_mul_f32 v[58:59], v[130:131], v[130:131]
  v_pk_mul_f32 v[60:61], v[132:133], v[132:133]
  v_pk_mul_f32 v[62:63], v[134:135], v[134:135]
  v_pk_mul_f32 v[64:65], v[136:137], v[136:137]
  v_pk_mul_f32 v[66:67], v[138:139], v[138:139]
  v_pk_mul_f32 v[68:69], v[140:141], v[140:141]
  v_pk_mul_f32 v[70:71], v[142:143], v[142:143]
  v_pk_fma_f32 v[56:57], v[56:57], v[28:29], v[26:27]
  v_pk_fma_f32 v[58:59], v[58:59], v[28:29], v[26:27]
  v_pk_fma_f32 v[60:61], v[60:61], v[28:29], v[26:27]
  v_pk_fma_f32 v[62:63], v[62:63], v[28:29], v[26:27]
  v_pk_fma_f32 v[64:65], v[64:65], v[28:29], v[26:27]
  v_pk_fma_f32 v[66:67], v[66:67], v[28:29], v[26:27]
  v_pk_fma_f32 v[68:69], v[68:69], v[28:29], v[26:27]
  v_pk_fma_f32 v[70:71], v[70:71], v[28:29], v[26:27]
  v_pk_mul_f32 v[56:57], v[56:57], v[128:129]
  v_pk_mul_f32 v[58:59], v[58:59], v[130:131]
  v_pk_mul_f32 v[60:61], v[60:61], v[132:133]
  v_pk_mul_f32 v[62:63], v[62:63], v[134:135]
  v_pk_mul_f32 v[64:65], v[64:65], v[136:137]
  v_pk_mul_f32 v[66:67], v[66:67], v[138:139]
  v_pk_mul_f32 v[68:69], v[68:69], v[140:141]
  v_pk_mul_f32 v[70:71], v[70:71], v[142:143]
  v_exp_f32 v56, v56
  v_exp_f32 v57, v57
  v_exp_f32 v58, v58
  v_exp_f32 v59, v59
  v_exp_f32 v60, v60
  v_exp_f32 v61, v61
  v_exp_f32 v62, v62
  v_exp_f32 v63, v63
  v_exp_f32 v64, v64
  v_exp_f32 v65, v65
  v_exp_f32 v66, v66
  v_exp_f32 v67, v67
  v_exp_f32 v68, v68
  v_exp_f32 v69, v69
  v_exp_f32 v70, v70
  v_exp_f32 v71, v71
  v_pk_add_f32 v[56:57], v[56:57], v[30:31]
  v_pk_add_f32 v[58:59], v[58:59], v[30:31]
  v_pk_add_f32 v[60:61], v[60:61], v[30:31]
  v_pk_add_f32 v[62:63], v[62:63], v[30:31]
  v_pk_add_f32 v[64:65], v[64:65], v[30:31]
  v_pk_add_f32 v[66:67], v[66:67], v[30:31]
  v_pk_add_f32 v[68:69], v[68:69], v[30:31]
  v_pk_add_f32 v[70:71], v[70:71], v[30:31]
  v_rcp_f32 v56, v56
  v_rcp_f32 v57, v57
  v_rcp_f32 v58, v58
  v_rcp_f32 v59, v59
  v_rcp_f32 v60, v60
  v_rcp_f32 v61, v61
  v_rcp_f32 v62, v62
  v_rcp_f32 v63, v63
  v_rcp_f32 v64, v64
  v_rcp_f32 v65, v65
  v_rcp_f32 v66, v66
  v_rcp_f32 v67, v67
  v_rcp_f32 v68, v68
  v_rcp_f32 v69, v69
  v_rcp_f32 v70, v70
  v_rcp_f32 v71, v71
  v_pk_mul_f32 v[56:57], v[56:57], v[128:129]
  v_pk_mul_f32 v[58:59], v[58:59], v[130:131]
  v_pk_mul_f32 v[60:61], v[60:61], v[132:133]
  v_pk_mul_f32 v[62:63], v[62:63], v[134:135]
  v_pk_mul_f32 v[64:65], v[64:65], v[136:137]
  v_pk_mul_f32 v[66:67], v[66:67], v[138:139]
  v_pk_mul_f32 v[68:69], v[68:69], v[140:141]
  v_pk_mul_f32 v[70:71], v[70:71], v[142:143]
  v_cvt_pk_bf16_f32 v128, v56, v57
  v_cvt_pk_bf16_f32 v129, v58, v59
  v_cvt_pk_bf16_f32 v130, v60, v61
  v_cvt_pk_bf16_f32 v131, v62, v63
  v_cvt_pk_bf16_f32 v136, v64, v65
  v_cvt_pk_bf16_f32 v137, v66, v67
  v_cvt_pk_bf16_f32 v138, v68, v69
  v_cvt_pk_bf16_f32 v139, v70, v71
  buffer_store_dwordx4 v[128:131], v4, s[16:19], s68 offen offset:2048 sc1
  buffer_store_dwordx4 v[136:139], v4, s[16:19], s68 offen offset:3072 sc1
  v_pk_mul_f32 v[40:41], v[144:145], v[144:145]
  v_pk_mul_f32 v[42:43], v[146:147], v[146:147]
  v_pk_mul_f32 v[44:45], v[148:149], v[148:149]
  v_pk_mul_f32 v[46:47], v[150:151], v[150:151]
  v_pk_mul_f32 v[48:49], v[152:153], v[152:153]
  v_pk_mul_f32 v[50:51], v[154:155], v[154:155]
  v_pk_mul_f32 v[52:53], v[156:157], v[156:157]
  v_pk_mul_f32 v[54:55], v[158:159], v[158:159]
  v_pk_fma_f32 v[40:41], v[40:41], v[28:29], v[26:27]
  v_pk_fma_f32 v[42:43], v[42:43], v[28:29], v[26:27]
  v_pk_fma_f32 v[44:45], v[44:45], v[28:29], v[26:27]
  v_pk_fma_f32 v[46:47], v[46:47], v[28:29], v[26:27]
  v_pk_fma_f32 v[48:49], v[48:49], v[28:29], v[26:27]
  v_pk_fma_f32 v[50:51], v[50:51], v[28:29], v[26:27]
  v_pk_fma_f32 v[52:53], v[52:53], v[28:29], v[26:27]
  v_pk_fma_f32 v[54:55], v[54:55], v[28:29], v[26:27]
  v_pk_mul_f32 v[40:41], v[40:41], v[144:145]
  v_pk_mul_f32 v[42:43], v[42:43], v[146:147]
  v_pk_mul_f32 v[44:45], v[44:45], v[148:149]
  v_pk_mul_f32 v[46:47], v[46:47], v[150:151]
  v_pk_mul_f32 v[48:49], v[48:49], v[152:153]
  v_pk_mul_f32 v[50:51], v[50:51], v[154:155]
  v_pk_mul_f32 v[52:53], v[52:53], v[156:157]
  v_pk_mul_f32 v[54:55], v[54:55], v[158:159]
  v_exp_f32 v40, v40
  v_exp_f32 v41, v41
  v_exp_f32 v42, v42
  v_exp_f32 v43, v43
  v_exp_f32 v44, v44
  v_exp_f32 v45, v45
  v_exp_f32 v46, v46
  v_exp_f32 v47, v47
  v_exp_f32 v48, v48
  v_exp_f32 v49, v49
  v_exp_f32 v50, v50
  v_exp_f32 v51, v51
  v_exp_f32 v52, v52
  v_exp_f32 v53, v53
  v_exp_f32 v54, v54
  v_exp_f32 v55, v55
  v_pk_add_f32 v[40:41], v[40:41], v[30:31]
  v_pk_add_f32 v[42:43], v[42:43], v[30:31]
  v_pk_add_f32 v[44:45], v[44:45], v[30:31]
  v_pk_add_f32 v[46:47], v[46:47], v[30:31]
  v_pk_add_f32 v[48:49], v[48:49], v[30:31]
  v_pk_add_f32 v[50:51], v[50:51], v[30:31]
  v_pk_add_f32 v[52:53], v[52:53], v[30:31]
  v_pk_add_f32 v[54:55], v[54:55], v[30:31]
  v_rcp_f32 v40, v40
  v_rcp_f32 v41, v41
  v_rcp_f32 v42, v42
  v_rcp_f32 v43, v43
  v_rcp_f32 v44, v44
  v_rcp_f32 v45, v45
  v_rcp_f32 v46, v46
  v_rcp_f32 v47, v47
  v_rcp_f32 v48, v48
  v_rcp_f32 v49, v49
  v_rcp_f32 v50, v50
  v_rcp_f32 v51, v51
  v_rcp_f32 v52, v52
  v_rcp_f32 v53, v53
  v_rcp_f32 v54, v54
  v_rcp_f32 v55, v55
  v_pk_mul_f32 v[40:41], v[40:41], v[144:145]
  v_pk_mul_f32 v[42:43], v[42:43], v[146:147]
  v_pk_mul_f32 v[44:45], v[44:45], v[148:149]
  v_pk_mul_f32 v[46:47], v[46:47], v[150:151]
  v_pk_mul_f32 v[48:49], v[48:49], v[152:153]
  v_pk_mul_f32 v[50:51], v[50:51], v[154:155]
  v_pk_mul_f32 v[52:53], v[52:53], v[156:157]
  v_pk_mul_f32 v[54:55], v[54:55], v[158:159]
  v_cvt_pk_bf16_f32 v144, v40, v41
  v_cvt_pk_bf16_f32 v145, v42, v43
  v_cvt_pk_bf16_f32 v146, v44, v45
  v_cvt_pk_bf16_f32 v147, v46, v47
  v_cvt_pk_bf16_f32 v152, v48, v49
  v_cvt_pk_bf16_f32 v153, v50, v51
  v_cvt_pk_bf16_f32 v154, v52, v53
  v_cvt_pk_bf16_f32 v155, v54, v55
  s_add_u32 s3, s68, 4096
  buffer_store_dwordx4 v[144:147], v4, s[16:19], s3 offen offset:0 sc1
  s_add_u32 s3, s68, 4096
  buffer_store_dwordx4 v[152:155], v4, s[16:19], s3 offen offset:1024 sc1
  s_add_u32 s68, s68, 36864
  v_pk_mul_f32 v[40:41], v[160:161], v[160:161]
  v_pk_mul_f32 v[42:43], v[162:163], v[162:163]
  v_pk_mul_f32 v[44:45], v[164:165], v[164:165]
  v_pk_mul_f32 v[46:47], v[166:167], v[166:167]
  v_pk_mul_f32 v[48:49], v[168:169], v[168:169]
  v_pk_mul_f32 v[50:51], v[170:171], v[170:171]
  v_pk_mul_f32 v[52:53], v[172:173], v[172:173]
  v_pk_mul_f32 v[54:55], v[174:175], v[174:175]
  v_pk_fma_f32 v[40:41], v[40:41], v[28:29], v[26:27]
  v_pk_fma_f32 v[42:43], v[42:43], v[28:29], v[26:27]
  v_pk_fma_f32 v[44:45], v[44:45], v[28:29], v[26:27]
  v_pk_fma_f32 v[46:47], v[46:47], v[28:29], v[26:27]
  v_pk_fma_f32 v[48:49], v[48:49], v[28:29], v[26:27]
  v_pk_fma_f32 v[50:51], v[50:51], v[28:29], v[26:27]
  v_pk_fma_f32 v[52:53], v[52:53], v[28:29], v[26:27]
  v_pk_fma_f32 v[54:55], v[54:55], v[28:29], v[26:27]
  v_pk_mul_f32 v[40:41], v[40:41], v[160:161]
  v_pk_mul_f32 v[42:43], v[42:43], v[162:163]
  v_pk_mul_f32 v[44:45], v[44:45], v[164:165]
  v_pk_mul_f32 v[46:47], v[46:47], v[166:167]
  v_pk_mul_f32 v[48:49], v[48:49], v[168:169]
  v_pk_mul_f32 v[50:51], v[50:51], v[170:171]
  v_pk_mul_f32 v[52:53], v[52:53], v[172:173]
  v_pk_mul_f32 v[54:55], v[54:55], v[174:175]
  v_exp_f32 v40, v40
  v_exp_f32 v41, v41
  v_exp_f32 v42, v42
  v_exp_f32 v43, v43
  v_exp_f32 v44, v44
  v_exp_f32 v45, v45
  v_exp_f32 v46, v46
  v_exp_f32 v47, v47
  v_exp_f32 v48, v48
  v_exp_f32 v49, v49
  v_exp_f32 v50, v50
  v_exp_f32 v51, v51
  v_exp_f32 v52, v52
  v_exp_f32 v53, v53
  v_exp_f32 v54, v54
  v_exp_f32 v55, v55
  v_pk_add_f32 v[40:41], v[40:41], v[30:31]
  v_pk_add_f32 v[42:43], v[42:43], v[30:31]
  v_pk_add_f32 v[44:45], v[44:45], v[30:31]
  v_pk_add_f32 v[46:47], v[46:47], v[30:31]
  v_pk_add_f32 v[48:49], v[48:49], v[30:31]
  v_pk_add_f32 v[50:51], v[50:51], v[30:31]
  v_pk_add_f32 v[52:53], v[52:53], v[30:31]
  v_pk_add_f32 v[54:55], v[54:55], v[30:31]
  v_rcp_f32 v40, v40
  v_rcp_f32 v41, v41
  v_rcp_f32 v42, v42
  v_rcp_f32 v43, v43
  v_rcp_f32 v44, v44
  v_rcp_f32 v45, v45
  v_rcp_f32 v46, v46
  v_rcp_f32 v47, v47
  v_rcp_f32 v48, v48
  v_rcp_f32 v49, v49
  v_rcp_f32 v50, v50
  v_rcp_f32 v51, v51
  v_rcp_f32 v52, v52
  v_rcp_f32 v53, v53
  v_rcp_f32 v54, v54
  v_rcp_f32 v55, v55
  v_pk_mul_f32 v[40:41], v[40:41], v[160:161]
  v_pk_mul_f32 v[42:43], v[42:43], v[162:163]
  v_pk_mul_f32 v[44:45], v[44:45], v[164:165]
  v_pk_mul_f32 v[46:47], v[46:47], v[166:167]
  v_pk_mul_f32 v[48:49], v[48:49], v[168:169]
  v_pk_mul_f32 v[50:51], v[50:51], v[170:171]
  v_pk_mul_f32 v[52:53], v[52:53], v[172:173]
  v_pk_mul_f32 v[54:55], v[54:55], v[174:175]
  v_cvt_pk_bf16_f32 v160, v40, v41
  v_cvt_pk_bf16_f32 v161, v42, v43
  v_cvt_pk_bf16_f32 v162, v44, v45
  v_cvt_pk_bf16_f32 v163, v46, v47
  v_cvt_pk_bf16_f32 v168, v48, v49
  v_cvt_pk_bf16_f32 v169, v50, v51
  v_cvt_pk_bf16_f32 v170, v52, v53
  v_cvt_pk_bf16_f32 v171, v54, v55
  buffer_store_dwordx4 v[160:163], v4, s[16:19], s68 offen offset:0 sc1
  buffer_store_dwordx4 v[168:171], v4, s[16:19], s68 offen offset:1024 sc1
  v_pk_mul_f32 v[56:57], v[176:177], v[176:177]
  v_pk_mul_f32 v[58:59], v[178:179], v[178:179]
  v_pk_mul_f32 v[60:61], v[180:181], v[180:181]
  v_pk_mul_f32 v[62:63], v[182:183], v[182:183]
  v_pk_mul_f32 v[64:65], v[184:185], v[184:185]
  v_pk_mul_f32 v[66:67], v[186:187], v[186:187]
  v_pk_mul_f32 v[68:69], v[188:189], v[188:189]
  v_pk_mul_f32 v[70:71], v[190:191], v[190:191]
  v_pk_fma_f32 v[56:57], v[56:57], v[28:29], v[26:27]
  v_pk_fma_f32 v[58:59], v[58:59], v[28:29], v[26:27]
  v_pk_fma_f32 v[60:61], v[60:61], v[28:29], v[26:27]
  v_pk_fma_f32 v[62:63], v[62:63], v[28:29], v[26:27]
  v_pk_fma_f32 v[64:65], v[64:65], v[28:29], v[26:27]
  v_pk_fma_f32 v[66:67], v[66:67], v[28:29], v[26:27]
  v_pk_fma_f32 v[68:69], v[68:69], v[28:29], v[26:27]
  v_pk_fma_f32 v[70:71], v[70:71], v[28:29], v[26:27]
  v_pk_mul_f32 v[56:57], v[56:57], v[176:177]
  v_pk_mul_f32 v[58:59], v[58:59], v[178:179]
  v_pk_mul_f32 v[60:61], v[60:61], v[180:181]
  v_pk_mul_f32 v[62:63], v[62:63], v[182:183]
  v_pk_mul_f32 v[64:65], v[64:65], v[184:185]
  v_pk_mul_f32 v[66:67], v[66:67], v[186:187]
  v_pk_mul_f32 v[68:69], v[68:69], v[188:189]
  v_pk_mul_f32 v[70:71], v[70:71], v[190:191]
  v_exp_f32 v56, v56
  v_exp_f32 v57, v57
  v_exp_f32 v58, v58
  v_exp_f32 v59, v59
  v_exp_f32 v60, v60
  v_exp_f32 v61, v61
  v_exp_f32 v62, v62
  v_exp_f32 v63, v63
  v_exp_f32 v64, v64
  v_exp_f32 v65, v65
  v_exp_f32 v66, v66
  v_exp_f32 v67, v67
  v_exp_f32 v68, v68
  v_exp_f32 v69, v69
  v_exp_f32 v70, v70
  v_exp_f32 v71, v71
  v_pk_add_f32 v[56:57], v[56:57], v[30:31]
  v_pk_add_f32 v[58:59], v[58:59], v[30:31]
  v_pk_add_f32 v[60:61], v[60:61], v[30:31]
  v_pk_add_f32 v[62:63], v[62:63], v[30:31]
  v_pk_add_f32 v[64:65], v[64:65], v[30:31]
  v_pk_add_f32 v[66:67], v[66:67], v[30:31]
  v_pk_add_f32 v[68:69], v[68:69], v[30:31]
  v_pk_add_f32 v[70:71], v[70:71], v[30:31]
  v_rcp_f32 v56, v56
  v_rcp_f32 v57, v57
  v_rcp_f32 v58, v58
  v_rcp_f32 v59, v59
  v_rcp_f32 v60, v60
  v_rcp_f32 v61, v61
  v_rcp_f32 v62, v62
  v_rcp_f32 v63, v63
  v_rcp_f32 v64, v64
  v_rcp_f32 v65, v65
  v_rcp_f32 v66, v66
  v_rcp_f32 v67, v67
  v_rcp_f32 v68, v68
  v_rcp_f32 v69, v69
  v_rcp_f32 v70, v70
  v_rcp_f32 v71, v71
  v_pk_mul_f32 v[56:57], v[56:57], v[176:177]
  v_pk_mul_f32 v[58:59], v[58:59], v[178:179]
  v_pk_mul_f32 v[60:61], v[60:61], v[180:181]
  v_pk_mul_f32 v[62:63], v[62:63], v[182:183]
  v_pk_mul_f32 v[64:65], v[64:65], v[184:185]
  v_pk_mul_f32 v[66:67], v[66:67], v[186:187]
  v_pk_mul_f32 v[68:69], v[68:69], v[188:189]
  v_pk_mul_f32 v[70:71], v[70:71], v[190:191]
  v_cvt_pk_bf16_f32 v176, v56, v57
  v_cvt_pk_bf16_f32 v177, v58, v59
  v_cvt_pk_bf16_f32 v178, v60, v61
  v_cvt_pk_bf16_f32 v179, v62, v63
  v_cvt_pk_bf16_f32 v184, v64, v65
  v_cvt_pk_bf16_f32 v185, v66, v67
  v_cvt_pk_bf16_f32 v186, v68, v69
  v_cvt_pk_bf16_f32 v187, v70, v71
  buffer_store_dwordx4 v[176:179], v4, s[16:19], s68 offen offset:2048 sc1
  buffer_store_dwordx4 v[184:187], v4, s[16:19], s68 offen offset:3072 sc1
  v_pk_mul_f32 v[40:41], v[192:193], v[192:193]
  v_pk_mul_f32 v[42:43], v[194:195], v[194:195]
  v_pk_mul_f32 v[44:45], v[196:197], v[196:197]
  v_pk_mul_f32 v[46:47], v[198:199], v[198:199]
  v_pk_mul_f32 v[48:49], v[200:201], v[200:201]
  v_pk_mul_f32 v[50:51], v[202:203], v[202:203]
  v_pk_mul_f32 v[52:53], v[204:205], v[204:205]
  v_pk_mul_f32 v[54:55], v[206:207], v[206:207]
  v_pk_fma_f32 v[40:41], v[40:41], v[28:29], v[26:27]
  v_pk_fma_f32 v[42:43], v[42:43], v[28:29], v[26:27]
  v_pk_fma_f32 v[44:45], v[44:45], v[28:29], v[26:27]
  v_pk_fma_f32 v[46:47], v[46:47], v[28:29], v[26:27]
  v_pk_fma_f32 v[48:49], v[48:49], v[28:29], v[26:27]
  v_pk_fma_f32 v[50:51], v[50:51], v[28:29], v[26:27]
  v_pk_fma_f32 v[52:53], v[52:53], v[28:29], v[26:27]
  v_pk_fma_f32 v[54:55], v[54:55], v[28:29], v[26:27]
  v_pk_mul_f32 v[40:41], v[40:41], v[192:193]
  v_pk_mul_f32 v[42:43], v[42:43], v[194:195]
  v_pk_mul_f32 v[44:45], v[44:45], v[196:197]
  v_pk_mul_f32 v[46:47], v[46:47], v[198:199]
  v_pk_mul_f32 v[48:49], v[48:49], v[200:201]
  v_pk_mul_f32 v[50:51], v[50:51], v[202:203]
  v_pk_mul_f32 v[52:53], v[52:53], v[204:205]
  v_pk_mul_f32 v[54:55], v[54:55], v[206:207]
  v_exp_f32 v40, v40
  v_exp_f32 v41, v41
  v_exp_f32 v42, v42
  v_exp_f32 v43, v43
  v_exp_f32 v44, v44
  v_exp_f32 v45, v45
  v_exp_f32 v46, v46
  v_exp_f32 v47, v47
  v_exp_f32 v48, v48
  v_exp_f32 v49, v49
  v_exp_f32 v50, v50
  v_exp_f32 v51, v51
  v_exp_f32 v52, v52
  v_exp_f32 v53, v53
  v_exp_f32 v54, v54
  v_exp_f32 v55, v55
  v_pk_add_f32 v[40:41], v[40:41], v[30:31]
  v_pk_add_f32 v[42:43], v[42:43], v[30:31]
  v_pk_add_f32 v[44:45], v[44:45], v[30:31]
  v_pk_add_f32 v[46:47], v[46:47], v[30:31]
  v_pk_add_f32 v[48:49], v[48:49], v[30:31]
  v_pk_add_f32 v[50:51], v[50:51], v[30:31]
  v_pk_add_f32 v[52:53], v[52:53], v[30:31]
  v_pk_add_f32 v[54:55], v[54:55], v[30:31]
  v_rcp_f32 v40, v40
  v_rcp_f32 v41, v41
  v_rcp_f32 v42, v42
  v_rcp_f32 v43, v43
  v_rcp_f32 v44, v44
  v_rcp_f32 v45, v45
  v_rcp_f32 v46, v46
  v_rcp_f32 v47, v47
  v_rcp_f32 v48, v48
  v_rcp_f32 v49, v49
  v_rcp_f32 v50, v50
  v_rcp_f32 v51, v51
  v_rcp_f32 v52, v52
  v_rcp_f32 v53, v53
  v_rcp_f32 v54, v54
  v_rcp_f32 v55, v55
  v_pk_mul_f32 v[40:41], v[40:41], v[192:193]
  v_pk_mul_f32 v[42:43], v[42:43], v[194:195]
  v_pk_mul_f32 v[44:45], v[44:45], v[196:197]
  v_pk_mul_f32 v[46:47], v[46:47], v[198:199]
  v_pk_mul_f32 v[48:49], v[48:49], v[200:201]
  v_pk_mul_f32 v[50:51], v[50:51], v[202:203]
  v_pk_mul_f32 v[52:53], v[52:53], v[204:205]
  v_pk_mul_f32 v[54:55], v[54:55], v[206:207]
  v_cvt_pk_bf16_f32 v192, v40, v41
  v_cvt_pk_bf16_f32 v193, v42, v43
  v_cvt_pk_bf16_f32 v194, v44, v45
  v_cvt_pk_bf16_f32 v195, v46, v47
  v_cvt_pk_bf16_f32 v200, v48, v49
  v_cvt_pk_bf16_f32 v201, v50, v51
  v_cvt_pk_bf16_f32 v202, v52, v53
  v_cvt_pk_bf16_f32 v203, v54, v55
  s_add_u32 s3, s68, 4096
  buffer_store_dwordx4 v[192:195], v4, s[16:19], s3 offen offset:0 sc1
  s_add_u32 s3, s68, 4096
  buffer_store_dwordx4 v[200:203], v4, s[16:19], s3 offen offset:1024 sc1
  s_add_u32 s68, s68, 36864
  v_pk_mul_f32 v[40:41], v[208:209], v[208:209]
  v_pk_mul_f32 v[42:43], v[210:211], v[210:211]
  v_pk_mul_f32 v[44:45], v[212:213], v[212:213]
  v_pk_mul_f32 v[46:47], v[214:215], v[214:215]
  v_pk_mul_f32 v[48:49], v[216:217], v[216:217]
  v_pk_mul_f32 v[50:51], v[218:219], v[218:219]
  v_pk_mul_f32 v[52:53], v[220:221], v[220:221]
  v_pk_mul_f32 v[54:55], v[222:223], v[222:223]
  v_pk_fma_f32 v[40:41], v[40:41], v[28:29], v[26:27]
  v_pk_fma_f32 v[42:43], v[42:43], v[28:29], v[26:27]
  v_pk_fma_f32 v[44:45], v[44:45], v[28:29], v[26:27]
  v_pk_fma_f32 v[46:47], v[46:47], v[28:29], v[26:27]
  v_pk_fma_f32 v[48:49], v[48:49], v[28:29], v[26:27]
  v_pk_fma_f32 v[50:51], v[50:51], v[28:29], v[26:27]
  v_pk_fma_f32 v[52:53], v[52:53], v[28:29], v[26:27]
  v_pk_fma_f32 v[54:55], v[54:55], v[28:29], v[26:27]
  v_pk_mul_f32 v[40:41], v[40:41], v[208:209]
  v_pk_mul_f32 v[42:43], v[42:43], v[210:211]
  v_pk_mul_f32 v[44:45], v[44:45], v[212:213]
  v_pk_mul_f32 v[46:47], v[46:47], v[214:215]
  v_pk_mul_f32 v[48:49], v[48:49], v[216:217]
  v_pk_mul_f32 v[50:51], v[50:51], v[218:219]
  v_pk_mul_f32 v[52:53], v[52:53], v[220:221]
  v_pk_mul_f32 v[54:55], v[54:55], v[222:223]
  v_exp_f32 v40, v40
  v_exp_f32 v41, v41
  v_exp_f32 v42, v42
  v_exp_f32 v43, v43
  v_exp_f32 v44, v44
  v_exp_f32 v45, v45
  v_exp_f32 v46, v46
  v_exp_f32 v47, v47
  v_exp_f32 v48, v48
  v_exp_f32 v49, v49
  v_exp_f32 v50, v50
  v_exp_f32 v51, v51
  v_exp_f32 v52, v52
  v_exp_f32 v53, v53
  v_exp_f32 v54, v54
  v_exp_f32 v55, v55
  v_pk_add_f32 v[40:41], v[40:41], v[30:31]
  v_pk_add_f32 v[42:43], v[42:43], v[30:31]
  v_pk_add_f32 v[44:45], v[44:45], v[30:31]
  v_pk_add_f32 v[46:47], v[46:47], v[30:31]
  v_pk_add_f32 v[48:49], v[48:49], v[30:31]
  v_pk_add_f32 v[50:51], v[50:51], v[30:31]
  v_pk_add_f32 v[52:53], v[52:53], v[30:31]
  v_pk_add_f32 v[54:55], v[54:55], v[30:31]
  v_rcp_f32 v40, v40
  v_rcp_f32 v41, v41
  v_rcp_f32 v42, v42
  v_rcp_f32 v43, v43
  v_rcp_f32 v44, v44
  v_rcp_f32 v45, v45
  v_rcp_f32 v46, v46
  v_rcp_f32 v47, v47
  v_rcp_f32 v48, v48
  v_rcp_f32 v49, v49
  v_rcp_f32 v50, v50
  v_rcp_f32 v51, v51
  v_rcp_f32 v52, v52
  v_rcp_f32 v53, v53
  v_rcp_f32 v54, v54
  v_rcp_f32 v55, v55
  v_pk_mul_f32 v[40:41], v[40:41], v[208:209]
  v_pk_mul_f32 v[42:43], v[42:43], v[210:211]
  v_pk_mul_f32 v[44:45], v[44:45], v[212:213]
  v_pk_mul_f32 v[46:47], v[46:47], v[214:215]
  v_pk_mul_f32 v[48:49], v[48:49], v[216:217]
  v_pk_mul_f32 v[50:51], v[50:51], v[218:219]
  v_pk_mul_f32 v[52:53], v[52:53], v[220:221]
  v_pk_mul_f32 v[54:55], v[54:55], v[222:223]
  v_cvt_pk_bf16_f32 v208, v40, v41
  v_cvt_pk_bf16_f32 v209, v42, v43
  v_cvt_pk_bf16_f32 v210, v44, v45
  v_cvt_pk_bf16_f32 v211, v46, v47
  v_cvt_pk_bf16_f32 v216, v48, v49
  v_cvt_pk_bf16_f32 v217, v50, v51
  v_cvt_pk_bf16_f32 v218, v52, v53
  v_cvt_pk_bf16_f32 v219, v54, v55
  buffer_store_dwordx4 v[208:211], v4, s[16:19], s68 offen offset:0 sc1
  buffer_store_dwordx4 v[216:219], v4, s[16:19], s68 offen offset:1024 sc1
  v_pk_mul_f32 v[56:57], v[224:225], v[224:225]
  v_pk_mul_f32 v[58:59], v[226:227], v[226:227]
  v_pk_mul_f32 v[60:61], v[228:229], v[228:229]
  v_pk_mul_f32 v[62:63], v[230:231], v[230:231]
  v_pk_mul_f32 v[64:65], v[232:233], v[232:233]
  v_pk_mul_f32 v[66:67], v[234:235], v[234:235]
  v_pk_mul_f32 v[68:69], v[236:237], v[236:237]
  v_pk_mul_f32 v[70:71], v[238:239], v[238:239]
  v_pk_fma_f32 v[56:57], v[56:57], v[28:29], v[26:27]
  v_pk_fma_f32 v[58:59], v[58:59], v[28:29], v[26:27]
  v_pk_fma_f32 v[60:61], v[60:61], v[28:29], v[26:27]
  v_pk_fma_f32 v[62:63], v[62:63], v[28:29], v[26:27]
  v_pk_fma_f32 v[64:65], v[64:65], v[28:29], v[26:27]
  v_pk_fma_f32 v[66:67], v[66:67], v[28:29], v[26:27]
  v_pk_fma_f32 v[68:69], v[68:69], v[28:29], v[26:27]
  v_pk_fma_f32 v[70:71], v[70:71], v[28:29], v[26:27]
  v_pk_mul_f32 v[56:57], v[56:57], v[224:225]
  v_pk_mul_f32 v[58:59], v[58:59], v[226:227]
  v_pk_mul_f32 v[60:61], v[60:61], v[228:229]
  v_pk_mul_f32 v[62:63], v[62:63], v[230:231]
  v_pk_mul_f32 v[64:65], v[64:65], v[232:233]
  v_pk_mul_f32 v[66:67], v[66:67], v[234:235]
  v_pk_mul_f32 v[68:69], v[68:69], v[236:237]
  v_pk_mul_f32 v[70:71], v[70:71], v[238:239]
  v_exp_f32 v56, v56
  v_exp_f32 v57, v57
  v_exp_f32 v58, v58
  v_exp_f32 v59, v59
  v_exp_f32 v60, v60
  v_exp_f32 v61, v61
  v_exp_f32 v62, v62
  v_exp_f32 v63, v63
  v_exp_f32 v64, v64
  v_exp_f32 v65, v65
  v_exp_f32 v66, v66
  v_exp_f32 v67, v67
  v_exp_f32 v68, v68
  v_exp_f32 v69, v69
  v_exp_f32 v70, v70
  v_exp_f32 v71, v71
  v_pk_add_f32 v[56:57], v[56:57], v[30:31]
  v_pk_add_f32 v[58:59], v[58:59], v[30:31]
  v_pk_add_f32 v[60:61], v[60:61], v[30:31]
  v_pk_add_f32 v[62:63], v[62:63], v[30:31]
  v_pk_add_f32 v[64:65], v[64:65], v[30:31]
  v_pk_add_f32 v[66:67], v[66:67], v[30:31]
  v_pk_add_f32 v[68:69], v[68:69], v[30:31]
  v_pk_add_f32 v[70:71], v[70:71], v[30:31]
  v_rcp_f32 v56, v56
  v_rcp_f32 v57, v57
  v_rcp_f32 v58, v58
  v_rcp_f32 v59, v59
  v_rcp_f32 v60, v60
  v_rcp_f32 v61, v61
  v_rcp_f32 v62, v62
  v_rcp_f32 v63, v63
  v_rcp_f32 v64, v64
  v_rcp_f32 v65, v65
  v_rcp_f32 v66, v66
  v_rcp_f32 v67, v67
  v_rcp_f32 v68, v68
  v_rcp_f32 v69, v69
  v_rcp_f32 v70, v70
  v_rcp_f32 v71, v71
  v_pk_mul_f32 v[56:57], v[56:57], v[224:225]
  v_pk_mul_f32 v[58:59], v[58:59], v[226:227]
  v_pk_mul_f32 v[60:61], v[60:61], v[228:229]
  v_pk_mul_f32 v[62:63], v[62:63], v[230:231]
  v_pk_mul_f32 v[64:65], v[64:65], v[232:233]
  v_pk_mul_f32 v[66:67], v[66:67], v[234:235]
  v_pk_mul_f32 v[68:69], v[68:69], v[236:237]
  v_pk_mul_f32 v[70:71], v[70:71], v[238:239]
  v_cvt_pk_bf16_f32 v224, v56, v57
  v_cvt_pk_bf16_f32 v225, v58, v59
  v_cvt_pk_bf16_f32 v226, v60, v61
  v_cvt_pk_bf16_f32 v227, v62, v63
  v_cvt_pk_bf16_f32 v232, v64, v65
  v_cvt_pk_bf16_f32 v233, v66, v67
  v_cvt_pk_bf16_f32 v234, v68, v69
  v_cvt_pk_bf16_f32 v235, v70, v71
  buffer_store_dwordx4 v[224:227], v4, s[16:19], s68 offen offset:2048 sc1
  buffer_store_dwordx4 v[232:235], v4, s[16:19], s68 offen offset:3072 sc1
  v_pk_mul_f32 v[40:41], v[240:241], v[240:241]
  v_pk_mul_f32 v[42:43], v[242:243], v[242:243]
  v_pk_mul_f32 v[44:45], v[244:245], v[244:245]
  v_pk_mul_f32 v[46:47], v[246:247], v[246:247]
  v_pk_mul_f32 v[48:49], v[248:249], v[248:249]
  v_pk_mul_f32 v[50:51], v[250:251], v[250:251]
  v_pk_mul_f32 v[52:53], v[252:253], v[252:253]
  v_pk_mul_f32 v[54:55], v[254:255], v[254:255]
  v_pk_fma_f32 v[40:41], v[40:41], v[28:29], v[26:27]
  v_pk_fma_f32 v[42:43], v[42:43], v[28:29], v[26:27]
  v_pk_fma_f32 v[44:45], v[44:45], v[28:29], v[26:27]
  v_pk_fma_f32 v[46:47], v[46:47], v[28:29], v[26:27]
  v_pk_fma_f32 v[48:49], v[48:49], v[28:29], v[26:27]
  v_pk_fma_f32 v[50:51], v[50:51], v[28:29], v[26:27]
  v_pk_fma_f32 v[52:53], v[52:53], v[28:29], v[26:27]
  v_pk_fma_f32 v[54:55], v[54:55], v[28:29], v[26:27]
  v_pk_mul_f32 v[40:41], v[40:41], v[240:241]
  v_pk_mul_f32 v[42:43], v[42:43], v[242:243]
  v_pk_mul_f32 v[44:45], v[44:45], v[244:245]
  v_pk_mul_f32 v[46:47], v[46:47], v[246:247]
  v_pk_mul_f32 v[48:49], v[48:49], v[248:249]
  v_pk_mul_f32 v[50:51], v[50:51], v[250:251]
  v_pk_mul_f32 v[52:53], v[52:53], v[252:253]
  v_pk_mul_f32 v[54:55], v[54:55], v[254:255]
  v_exp_f32 v40, v40
  v_exp_f32 v41, v41
  v_exp_f32 v42, v42
  v_exp_f32 v43, v43
  v_exp_f32 v44, v44
  v_exp_f32 v45, v45
  v_exp_f32 v46, v46
  v_exp_f32 v47, v47
  v_exp_f32 v48, v48
  v_exp_f32 v49, v49
  v_exp_f32 v50, v50
  v_exp_f32 v51, v51
  v_exp_f32 v52, v52
  v_exp_f32 v53, v53
  v_exp_f32 v54, v54
  v_exp_f32 v55, v55
  v_pk_add_f32 v[40:41], v[40:41], v[30:31]
  v_pk_add_f32 v[42:43], v[42:43], v[30:31]
  v_pk_add_f32 v[44:45], v[44:45], v[30:31]
  v_pk_add_f32 v[46:47], v[46:47], v[30:31]
  v_pk_add_f32 v[48:49], v[48:49], v[30:31]
  v_pk_add_f32 v[50:51], v[50:51], v[30:31]
  v_pk_add_f32 v[52:53], v[52:53], v[30:31]
  v_pk_add_f32 v[54:55], v[54:55], v[30:31]
  v_rcp_f32 v40, v40
  v_rcp_f32 v41, v41
  v_rcp_f32 v42, v42
  v_rcp_f32 v43, v43
  v_rcp_f32 v44, v44
  v_rcp_f32 v45, v45
  v_rcp_f32 v46, v46
  v_rcp_f32 v47, v47
  v_rcp_f32 v48, v48
  v_rcp_f32 v49, v49
  v_rcp_f32 v50, v50
  v_rcp_f32 v51, v51
  v_rcp_f32 v52, v52
  v_rcp_f32 v53, v53
  v_rcp_f32 v54, v54
  v_rcp_f32 v55, v55
  v_pk_mul_f32 v[40:41], v[40:41], v[240:241]
  v_pk_mul_f32 v[42:43], v[42:43], v[242:243]
  v_pk_mul_f32 v[44:45], v[44:45], v[244:245]
  v_pk_mul_f32 v[46:47], v[46:47], v[246:247]
  v_pk_mul_f32 v[48:49], v[48:49], v[248:249]
  v_pk_mul_f32 v[50:51], v[50:51], v[250:251]
  v_pk_mul_f32 v[52:53], v[52:53], v[252:253]
  v_pk_mul_f32 v[54:55], v[54:55], v[254:255]
  v_cvt_pk_bf16_f32 v240, v40, v41
  v_cvt_pk_bf16_f32 v241, v42, v43
  v_cvt_pk_bf16_f32 v242, v44, v45
  v_cvt_pk_bf16_f32 v243, v46, v47
  v_cvt_pk_bf16_f32 v248, v48, v49
  v_cvt_pk_bf16_f32 v249, v50, v51
  v_cvt_pk_bf16_f32 v250, v52, v53
  v_cvt_pk_bf16_f32 v251, v54, v55
  s_add_u32 s3, s68, 4096
  buffer_store_dwordx4 v[240:243], v4, s[16:19], s3 offen offset:0 sc1
  s_add_u32 s3, s68, 4096
  buffer_store_dwordx4 v[248:251], v4, s[16:19], s3 offen offset:1024 sc1
  s_add_u32 s68, s68, 36864
  s_waitcnt vmcnt(18)
  s_branch L_phase2
  .p2align 6
L_spare:
  s_getpc_b64 s[8:9]
  s_mov_b32 s10, 2048
  s_mov_b32 s11, 0x20000
  v_lshlrev_b32 v30, 5, v0
  buffer_load_dword v31, v30, s[8:11], 0 offen
  s_mul_i32 s4, s28, 786432
  v_lshrrev_b32 v178, 2, v177
  v_lshlrev_b32 v178, 17, v178
  v_and_b32 v179, 3, v177
  v_lshl_add_u32 v178, v179, 8, v178
  v_lshl_add_u32 v178, v176, 4, v178
  s_lshr_b32 s3, s2, 1
  s_lshl_b32 s3, s3, 10
  s_add_u32 s4, s4, s3
  s_and_b32 s3, s2, 1
  s_lshl_b32 s3, s3, 7
  s_add_u32 s4, s4, s3
  v_add_u32 v171, s4, v178
  v_lshlrev_b32 v172, 3, v176
  v_add_u32 v172, 163584, v172
  s_lshl_b32 s3, s28, 6
  v_add_u32 v173, s3, v172
  s_barrier
  s_load_dword s100, s[60:61], 0
  s_getpc_b64 s[24:25]
L_spare_pc:
  s_sub_u32 s24, s24, L_spare_pc-recurrent_scan__sliding_block_cached__mixer_token_mlp__prompt_kernel
  s_subb_u32 s25, s25, 0
  s_mov_b32 s26, L_end-recurrent_scan__sliding_block_cached__mixer_token_mlp__prompt_kernel
  s_mov_b32 s27, 0x20000
  s_lshl_b32 s3, s30, 2
  s_add_u32 s3, s3, s28
  s_mul_i32 s3, s3, 896
  v_min_u32 v174, 6, v1
  v_lshlrev_b32 v174, 7, v174
  v_add_u32 v174, s3, v174
  buffer_load_dword v175, v174, s[24:27], 0 offen
  s_add_u32 s16, s60, 131072
  s_addc_u32 s17, s61, 0
  s_mov_b32 s18, 2359296
  s_mov_b32 s19, 0x20000
  s_add_u32 s20, s60, 2490368
  s_addc_u32 s21, s61, 0
  s_mov_b32 s22, 2359296
  s_mov_b32 s23, 0x20000
  s_mov_b32 s64, s60
  s_mov_b32 s65, s61
  s_mov_b32 s66, 131072
  s_mov_b32 s67, 0x20000
  s_lshl_b32 s3, s2, 2
  s_add_u32 s3, s3, s28
  s_lshl_b32 s3, s3, 7
  v_mov_b32 v174, s3
  buffer_load_dword v175, v174, s[64:67], 0 offen sc1
  s_cmp_lg_u32 s28, 3
  s_cbranch_scc1 L_spare_ln
  s_waitcnt lgkmcnt(0)
  s_barrier
  s_mul_i32 s100, s100, 0x9e3779b1
  s_add_u32 s100, s100, 0x7f4a7c15
  s_branch L_spare_st
L_spare_ln:
  s_mov_b32 s3, 0xffff0000
  s_waitcnt vmcnt(3)
  v_lshlrev_b32 v112, 16, v100
  v_and_b32 v113, s3, v100
  v_lshlrev_b32 v114, 16, v101
  v_and_b32 v115, s3, v101
  v_lshlrev_b32 v116, 16, v102
  v_and_b32 v117, s3, v102
  v_lshlrev_b32 v118, 16, v103
  v_and_b32 v119, s3, v103
  v_lshlrev_b32 v120, 16, v104
  v_and_b32 v121, s3, v104
  v_lshlrev_b32 v122, 16, v105
  v_and_b32 v123, s3, v105
  v_lshlrev_b32 v124, 16, v106
  v_and_b32 v125, s3, v106
  v_lshlrev_b32 v126, 16, v107
  v_and_b32 v127, s3, v107
  v_lshlrev_b32 v128, 16, v108
  v_and_b32 v129, s3, v108
  v_lshlrev_b32 v130, 16, v109
  v_and_b32 v131, s3, v109
  v_lshlrev_b32 v132, 16, v110
  v_and_b32 v133, s3, v110
  v_lshlrev_b32 v134, 16, v111
  v_and_b32 v135, s3, v111
  v_pk_add_f32 v[140:141], v[112:113], v[114:115]
  v_pk_add_f32 v[142:143], v[116:117], v[118:119]
  v_pk_add_f32 v[140:141], v[140:141], v[120:121]
  v_pk_add_f32 v[142:143], v[142:143], v[122:123]
  v_pk_add_f32 v[140:141], v[140:141], v[124:125]
  v_pk_add_f32 v[142:143], v[142:143], v[126:127]
  v_pk_add_f32 v[140:141], v[140:141], v[128:129]
  v_pk_add_f32 v[142:143], v[142:143], v[130:131]
  v_pk_add_f32 v[140:141], v[140:141], v[132:133]
  v_pk_add_f32 v[142:143], v[142:143], v[134:135]
  v_pk_add_f32 v[140:141], v[140:141], v[142:143]
  v_add_f32 v140, v140, v141
  s_nop 1
  v_add_f32_dpp v140, v140, v140 row_ror:8 row_mask:0xf bank_mask:0xf
  v_mov_b32 v141, v140
  s_nop 1
  v_permlane16_swap_b32 v140, v141
  v_add_f32 v140, v140, v141
  v_mov_b32 v141, v140
  s_nop 1
  v_permlane32_swap_b32 v140, v141
  v_add_f32 v140, v140, v141
  v_mul_f32 v144, 0x3baaaaab, v140
  v_pk_add_f32 v[112:113], v[112:113], v[144:145] op_sel_hi:[1,0] neg_lo:[0,1] neg_hi:[0,1]
  v_pk_add_f32 v[114:115], v[114:115], v[144:145] op_sel_hi:[1,0] neg_lo:[0,1] neg_hi:[0,1]
  v_pk_add_f32 v[116:117], v[116:117], v[144:145] op_sel_hi:[1,0] neg_lo:[0,1] neg_hi:[0,1]
  v_pk_add_f32 v[118:119], v[118:119], v[144:145] op_sel_hi:[1,0] neg_lo:[0,1] neg_hi:[0,1]
  v_pk_add_f32 v[120:121], v[120:121], v[144:145] op_sel_hi:[1,0] neg_lo:[0,1] neg_hi:[0,1]
  v_pk_add_f32 v[122:123], v[122:123], v[144:145] op_sel_hi:[1,0] neg_lo:[0,1] neg_hi:[0,1]
  v_pk_add_f32 v[124:125], v[124:125], v[144:145] op_sel_hi:[1,0] neg_lo:[0,1] neg_hi:[0,1]
  v_pk_add_f32 v[126:127], v[126:127], v[144:145] op_sel_hi:[1,0] neg_lo:[0,1] neg_hi:[0,1]
  v_pk_add_f32 v[128:129], v[128:129], v[144:145] op_sel_hi:[1,0] neg_lo:[0,1] neg_hi:[0,1]
  v_pk_add_f32 v[130:131], v[130:131], v[144:145] op_sel_hi:[1,0] neg_lo:[0,1] neg_hi:[0,1]
  v_pk_add_f32 v[132:133], v[132:133], v[144:145] op_sel_hi:[1,0] neg_lo:[0,1] neg_hi:[0,1]
  v_pk_add_f32 v[134:135], v[134:135], v[144:145] op_sel_hi:[1,0] neg_lo:[0,1] neg_hi:[0,1]
  v_pk_mul_f32 v[140:141], v[112:113], v[112:113]
  v_pk_mul_f32 v[142:143], v[114:115], v[114:115]
  v_pk_fma_f32 v[140:141], v[116:117], v[116:117], v[140:141]
  v_pk_fma_f32 v[142:143], v[118:119], v[118:119], v[142:143]
  v_pk_fma_f32 v[140:141], v[120:121], v[120:121], v[140:141]
  v_pk_fma_f32 v[142:143], v[122:123], v[122:123], v[142:143]
  v_pk_fma_f32 v[140:141], v[124:125], v[124:125], v[140:141]
  v_pk_fma_f32 v[142:143], v[126:127], v[126:127], v[142:143]
  v_pk_fma_f32 v[140:141], v[128:129], v[128:129], v[140:141]
  v_pk_fma_f32 v[142:143], v[130:131], v[130:131], v[142:143]
  v_pk_fma_f32 v[140:141], v[132:133], v[132:133], v[140:141]
  v_pk_fma_f32 v[142:143], v[134:135], v[134:135], v[142:143]
  v_pk_add_f32 v[140:141], v[140:141], v[142:143]
  v_add_f32 v140, v140, v141
  s_nop 1
  v_add_f32_dpp v140, v140, v140 row_ror:8 row_mask:0xf bank_mask:0xf
  v_mov_b32 v141, v140
  s_nop 1
  v_permlane16_swap_b32 v140, v141
  v_add_f32 v140, v140, v141
  v_mov_b32 v141, v140
  s_nop 1
  v_permlane32_swap_b32 v140, v141
  v_add_f32 v140, v140, v141
  v_mov_b32 v145, v140
  ds_write_b64 v173, v[144:145]
  s_waitcnt lgkmcnt(0)
  s_barrier
  ds_read_b64 v[148:149], v172 offset:0
  ds_read_b64 v[150:151], v172 offset:64
  ds_read_b64 v[152:153], v172 offset:128
  s_mul_i32 s100, s100, 0x9e3779b1
  s_add_u32 s100, s100, 0x7f4a7c15
  s_waitcnt lgkmcnt(0)
  v_add_f32 v140, v148, v150
  v_add_f32 v142, v149, v151
  v_add_f32 v140, v140, v152
  v_add_f32 v142, v142, v153
  v_mul_f32 v140, 0x3eaaaaab, v140
  v_sub_f32 v148, v148, v140
  v_sub_f32 v150, v150, v140
  v_sub_f32 v152, v152, v140
  v_mul_f32 v141, v148, v148
  v_fmac_f32 v141, v150, v150
  v_fmac_f32 v141, v152, v152
  v_fmac_f32 v142, 0x43400000, v141
  v_mul_f32 v142, 0x3ae38e39, v142
  v_sub_f32 v144, v144, v140
  v_add_f32 v140, 0x3727c5ac, v142
  v_rsq_f32 v140, v140
  s_nop 0
  v_mul_f32 v142, v142, v140
  v_mul_f32 v142, v142, v140
  v_add_f32 v142, 0x3727c5ac, v142
  v_rsq_f32 v142, v142
  v_mul_f32 v148, 0x3e0293ee, v140
  v_mul_f32 v152, v144, v148
  v_mul_f32 v150, v142, v140
  v_mul_f32 v154, v144, v150
  s_mov_b32 s3, 262144
  s_mov_b32 s4, 524288
  v_pk_fma_f32 v[180:181], v[112:113], v[148:149], v[152:153] op_sel_hi:[1,0,0]
  v_pk_fma_f32 v[182:183], v[114:115], v[148:149], v[152:153] op_sel_hi:[1,0,0]
  v_pk_fma_f32 v[184:185], v[116:117], v[148:149], v[152:153] op_sel_hi:[1,0,0]
  v_pk_fma_f32 v[186:187], v[118:119], v[148:149], v[152:153] op_sel_hi:[1,0,0]
  v_cvt_pk_bf16_f32 v100, v180, v181
  v_cvt_pk_bf16_f32 v101, v182, v183
  v_cvt_pk_bf16_f32 v102, v184, v185
  v_cvt_pk_bf16_f32 v103, v186, v187
  buffer_store_dwordx4 v[100:103], v171, s[16:19], 0 offen sc1
  v_pk_fma_f32 v[188:189], v[112:113], v[150:151], v[154:155] op_sel_hi:[1,0,0]
  v_pk_fma_f32 v[190:191], v[114:115], v[150:151], v[154:155] op_sel_hi:[1,0,0]
  v_pk_fma_f32 v[192:193], v[116:117], v[150:151], v[154:155] op_sel_hi:[1,0,0]
  v_pk_fma_f32 v[194:195], v[118:119], v[150:151], v[154:155] op_sel_hi:[1,0,0]
  v_cvt_pk_bf16_f32 v156, v188, v189
  v_cvt_pk_bf16_f32 v157, v190, v191
  v_cvt_pk_bf16_f32 v158, v192, v193
  v_cvt_pk_bf16_f32 v159, v194, v195
  buffer_store_dwordx4 v[156:159], v170, s[20:23], 0 offen offset:0 sc1
  v_pk_fma_f32 v[180:181], v[120:121], v[148:149], v[152:153] op_sel_hi:[1,0,0]
  v_pk_fma_f32 v[182:183], v[122:123], v[148:149], v[152:153] op_sel_hi:[1,0,0]
  v_pk_fma_f32 v[184:185], v[124:125], v[148:149], v[152:153] op_sel_hi:[1,0,0]
  v_pk_fma_f32 v[186:187], v[126:127], v[148:149], v[152:153] op_sel_hi:[1,0,0]
  v_cvt_pk_bf16_f32 v104, v180, v181
  v_cvt_pk_bf16_f32 v105, v182, v183
  v_cvt_pk_bf16_f32 v106, v184, v185
  v_cvt_pk_bf16_f32 v107, v186, v187
  buffer_store_dwordx4 v[104:107], v171, s[16:19], s3 offen sc1
  v_pk_fma_f32 v[188:189], v[120:121], v[150:151], v[154:155] op_sel_hi:[1,0,0]
  v_pk_fma_f32 v[190:191], v[122:123], v[150:151], v[154:155] op_sel_hi:[1,0,0]
  v_pk_fma_f32 v[192:193], v[124:125], v[150:151], v[154:155] op_sel_hi:[1,0,0]
  v_pk_fma_f32 v[194:195], v[126:127], v[150:151], v[154:155] op_sel_hi:[1,0,0]
  v_cvt_pk_bf16_f32 v160, v188, v189
  v_cvt_pk_bf16_f32 v161, v190, v191
  v_cvt_pk_bf16_f32 v162, v192, v193
  v_cvt_pk_bf16_f32 v163, v194, v195
  buffer_store_dwordx4 v[160:163], v170, s[20:23], 0 offen offset:128 sc1
  v_pk_fma_f32 v[180:181], v[128:129], v[148:149], v[152:153] op_sel_hi:[1,0,0]
  v_pk_fma_f32 v[182:183], v[130:131], v[148:149], v[152:153] op_sel_hi:[1,0,0]
  v_pk_fma_f32 v[184:185], v[132:133], v[148:149], v[152:153] op_sel_hi:[1,0,0]
  v_pk_fma_f32 v[186:187], v[134:135], v[148:149], v[152:153] op_sel_hi:[1,0,0]
  v_cvt_pk_bf16_f32 v108, v180, v181
  v_cvt_pk_bf16_f32 v109, v182, v183
  v_cvt_pk_bf16_f32 v110, v184, v185
  v_cvt_pk_bf16_f32 v111, v186, v187
  buffer_store_dwordx4 v[108:111], v171, s[16:19], s4 offen sc1
  v_pk_fma_f32 v[188:189], v[128:129], v[150:151], v[154:155] op_sel_hi:[1,0,0]
  v_pk_fma_f32 v[190:191], v[130:131], v[150:151], v[154:155] op_sel_hi:[1,0,0]
  v_pk_fma_f32 v[192:193], v[132:133], v[150:151], v[154:155] op_sel_hi:[1,0,0]
  v_pk_fma_f32 v[194:195], v[134:135], v[150:151], v[154:155] op_sel_hi:[1,0,0]
  v_cvt_pk_bf16_f32 v164, v188, v189
  v_cvt_pk_bf16_f32 v165, v190, v191
  v_cvt_pk_bf16_f32 v166, v192, v193
  v_cvt_pk_bf16_f32 v167, v194, v195
  buffer_store_dwordx4 v[164:167], v170, s[20:23], 0 offen offset:256 sc1
L_spare_st:
  v_lshlrev_b32 v176, 12, v1
  s_lshl_b32 s3, s2, 4
  s_add_u32 s3, s3, 4096
  v_mov_b32 v177, s100
  s_waitcnt vmcnt(0)
  s_barrier
  s_cmp_lg_u32 s28, 0
  s_cbranch_scc1 L_spare_nf
  s_mov_b64 exec, 0xff
  buffer_store_dword v177, v176, s[64:67], s3 offen sc1
  s_mov_b64 exec, -1
L_spare_nf:
  v_mul_u32_u24 v2, 7282, v1
  v_lshrrev_b32 v2, 16, v2
  v_mul_u32_u24 v3, 9, v2
  v_sub_u32 v3, v1, v3
  v_min_u32 v2, 6, v2
  s_mul_i32 s3, s28, 7
  v_add_u32 v2, s3, v2
  v_mul_u32_u24 v2, 9216, v2
  v_lshl_add_u32 v2, v3, 7, v2
  s_mul_i32 s3, s29, 1152
  s_add_u32 s3, s3, 7529472
  v_add_u32 v2, s3, v2
  s_mov_b32 s4, 16
  s_mov_b32 s8, s54
  s_mov_b32 s9, s55
  s_mov_b32 s10, 4096
  s_mov_b32 s11, 0x20000
  v_lshlrev_b32 v5, 7, v0
  buffer_load_dword v4, v5, s[8:11], 0 offen
  s_mov_b32 s8, s48
  s_mov_b32 s9, s49
  s_mov_b32 s10, 18874368
  s_mov_b32 s11, 0x20000
L_pfloop:
  buffer_load_dword v4, v2, s[8:11], 0 offen
  v_add_u32 v2, 258048, v2
  s_waitcnt vmcnt(1)
  s_sub_u32 s4, s4, 1
  s_cmp_lg_u32 s4, 0
  s_cbranch_scc1 L_pfloop
  s_waitcnt vmcnt(0)
  s_branch L_phase2
L_end:
L_slow:
  s_nop 15
  s_sub_u32 s5, s71, s72
  v_and_b32 v2, 15, v1
  v_lshrrev_b32 v3, 4, v1
  v_lshlrev_b32 v3, 4, v3
  v_lshl_add_u32 v2, v2, 8, v3
  v_add_u32 v3, 4096, v2
  s_lshl_b32 s6, s28, 13
  s_add_u32 s6, s6, 65536
  v_add_u32 v26, s6, v26
  v_add_u32 v27, s6, v27
  v_add_u32 v28, s6, v28
  v_add_u32 v29, s6, v29
  v_add_u32 v30, s6, v30
  v_add_u32 v31, s6, v31
  v_add_u32 v32, s6, v32
  v_add_u32 v33, s6, v33
  v_mov_b32 v40, 0xff800000
  v_mov_b32 v44, 0xff800000
  v_mov_b32 v48, 0xff800000
  v_mov_b32 v52, 0xff800000
  v_mov_b32 v56, 0xff800000
  v_mov_b32 v60, 0xff800000
  s_mov_b32 s3, s5
  s_mov_b32 s4, 16
L_slow1:
  buffer_load_dwordx4 a[192:195], v2, s[16:19], s3 offen offset:0
  buffer_load_dwordx4 a[196:199], v2, s[16:19], s3 offen offset:64
  buffer_load_dwordx4 a[200:203], v2, s[16:19], s3 offen offset:128
  buffer_load_dwordx4 a[204:207], v2, s[16:19], s3 offen offset:192
  buffer_load_dwordx4 a[208:211], v3, s[16:19], s3 offen offset:0
  buffer_load_dwordx4 a[212:215], v3, s[16:19], s3 offen offset:64
  buffer_load_dwordx4 a[216:219], v3, s[16:19], s3 offen offset:128
  buffer_load_dwordx4 a[220:223], v3, s[16:19], s3 offen offset:192
  s_waitcnt vmcnt(0)
  v_mfma_f32_16x16x32_bf16 v[160:163], a[192:195], v[64:67], 0
  v_mfma_f32_16x16x32_bf16 v[168:171], a[192:195], v[68:71], 0
  v_mfma_f32_16x16x32_bf16 v[176:179], a[192:195], v[72:75], 0
  v_mfma_f32_16x16x32_bf16 v[184:187], a[192:195], v[76:79], 0
  v_mfma_f32_16x16x32_bf16 v[192:195], a[192:195], v[80:83], 0
  v_mfma_f32_16x16x32_bf16 v[200:203], a[192:195], v[84:87], 0
  v_mfma_f32_16x16x32_bf16 v[160:163], a[196:199], v[88:91], v[160:163]
  v_mfma_f32_16x16x32_bf16 v[168:171], a[196:199], v[92:95], v[168:171]
  v_mfma_f32_16x16x32_bf16 v[176:179], a[196:199], v[96:99], v[176:179]
  v_mfma_f32_16x16x32_bf16 v[184:187], a[196:199], v[100:103], v[184:187]
  v_mfma_f32_16x16x32_bf16 v[192:195], a[196:199], v[104:107], v[192:195]
  v_mfma_f32_16x16x32_bf16 v[200:203], a[196:199], v[108:111], v[200:203]
  v_mfma_f32_16x16x32_bf16 v[160:163], a[200:203], v[112:115], v[160:163]
  v_mfma_f32_16x16x32_bf16 v[168:171], a[200:203], v[116:119], v[168:171]
  v_mfma_f32_16x16x32_bf16 v[176:179], a[200:203], v[120:123], v[176:179]
  v_mfma_f32_16x16x32_bf16 v[184:187], a[200:203], v[124:127], v[184:187]
  v_mfma_f32_16x16x32_bf16 v[192:195], a[200:203], v[128:131], v[192:195]
  v_mfma_f32_16x16x32_bf16 v[200:203], a[200:203], v[132:135], v[200:203]
  v_mfma_f32_16x16x32_bf16 v[160:163], a[204:207], v[136:139], v[160:163]
  v_mfma_f32_16x16x32_bf16 v[168:171], a[204:207], v[140:143], v[168:171]
  v_mfma_f32_16x16x32_bf16 v[176:179], a[204:207], v[144:147], v[176:179]
  v_mfma_f32_16x16x32_bf16 v[184:187], a[204:207], v[148:151], v[184:187]
  v_mfma_f32_16x16x32_bf16 v[192:195], a[204:207], v[152:155], v[192:195]
  v_mfma_f32_16x16x32_bf16 v[200:203], a[204:207], v[156:159], v[200:203]
  v_mfma_f32_16x16x32_bf16 v[164:167], a[208:211], v[64:67], 0
  v_mfma_f32_16x16x32_bf16 v[172:175], a[208:211], v[68:71], 0
  v_mfma_f32_16x16x32_bf16 v[180:183], a[208:211], v[72:75], 0
  v_mfma_f32_16x16x32_bf16 v[188:191], a[208:211], v[76:79], 0
  v_mfma_f32_16x16x32_bf16 v[196:199], a[208:211], v[80:83], 0
  v_mfma_f32_16x16x32_bf16 v[204:207], a[208:211], v[84:87], 0
  v_mfma_f32_16x16x32_bf16 v[164:167], a[212:215], v[88:91], v[164:167]
  v_mfma_f32_16x16x32_bf16 v[172:175], a[212:215], v[92:95], v[172:175]
  v_mfma_f32_16x16x32_bf16 v[180:183], a[212:215], v[96:99], v[180:183]
  v_mfma_f32_16x16x32_bf16 v[188:191], a[212:215], v[100:103], v[188:191]
  v_mfma_f32_16x16x32_bf16 v[196:199], a[212:215], v[104:107], v[196:199]
  v_mfma_f32_16x16x32_bf16 v[204:207], a[212:215], v[108:111], v[204:207]
  v_mfma_f32_16x16x32_bf16 v[164:167], a[216:219], v[112:115], v[164:167]
  v_mfma_f32_16x16x32_bf16 v[172:175], a[216:219], v[116:119], v[172:175]
  v_mfma_f32_16x16x32_bf16 v[180:183], a[216:219], v[120:123], v[180:183]
  v_mfma_f32_16x16x32_bf16 v[188:191], a[216:219], v[124:127], v[188:191]
  v_mfma_f32_16x16x32_bf16 v[196:199], a[216:219], v[128:131], v[196:199]
  v_mfma_f32_16x16x32_bf16 v[204:207], a[216:219], v[132:135], v[204:207]
  v_mfma_f32_16x16x32_bf16 v[164:167], a[220:223], v[136:139], v[164:167]
  v_mfma_f32_16x16x32_bf16 v[172:175], a[220:223], v[140:143], v[172:175]
  v_mfma_f32_16x16x32_bf16 v[180:183], a[220:223], v[144:147], v[180:183]
  v_mfma_f32_16x16x32_bf16 v[188:191], a[220:223], v[148:151], v[188:191]
  v_mfma_f32_16x16x32_bf16 v[196:199], a[220:223], v[152:155], v[196:199]
  v_mfma_f32_16x16x32_bf16 v[204:207], a[220:223], v[156:159], v[204:207]
  s_nop 15
  v_max3_f32 v40, v40, v160, v161
  v_max3_f32 v40, v40, v162, v163
  v_max3_f32 v40, v40, v164, v165
  v_max3_f32 v40, v40, v166, v167
  v_max3_f32 v44, v44, v168, v169
  v_max3_f32 v44, v44, v170, v171
  v_max3_f32 v44, v44, v172, v173
  v_max3_f32 v44, v44, v174, v175
  v_max3_f32 v48, v48, v176, v177
  v_max3_f32 v48, v48, v178, v179
  v_max3_f32 v48, v48, v180, v181
  v_max3_f32 v48, v48, v182, v183
  v_max3_f32 v52, v52, v184, v185
  v_max3_f32 v52, v52, v186, v187
  v_max3_f32 v52, v52, v188, v189
  v_max3_f32 v52, v52, v190, v191
  v_max3_f32 v56, v56, v192, v193
  v_max3_f32 v56, v56, v194, v195
  v_max3_f32 v56, v56, v196, v197
  v_max3_f32 v56, v56, v198, v199
  v_max3_f32 v60, v60, v200, v201
  v_max3_f32 v60, v60, v202, v203
  v_max3_f32 v60, v60, v204, v205
  v_max3_f32 v60, v60, v206, v207
  s_add_u32 s3, s3, 8192
  s_sub_u32 s4, s4, 1
  s_cmp_lg_u32 s4, 0
  s_cbranch_scc1 L_slow1
  v_mov_b32 v41, v40
  v_mov_b32 v45, v44
  v_mov_b32 v49, v48
  v_mov_b32 v53, v52
  v_mov_b32 v57, v56
  v_mov_b32 v61, v60
  v_permlane32_swap_b32 v40, v41
  v_permlane32_swap_b32 v44, v45
  v_permlane32_swap_b32 v48, v49
  v_permlane32_swap_b32 v52, v53
  v_permlane32_swap_b32 v56, v57
  v_permlane32_swap_b32 v60, v61
  v_max_f32 v40, v40, v41
  v_max_f32 v44, v44, v45
  v_max_f32 v48, v48, v49
  v_max_f32 v52, v52, v53
  v_max_f32 v56, v56, v57
  v_max_f32 v60, v60, v61
  v_mov_b32 v41, v40
  v_mov_b32 v45, v44
  v_mov_b32 v49, v48
  v_mov_b32 v53, v52
  v_mov_b32 v57, v56
  v_mov_b32 v61, v60
  v_permlane16_swap_b32 v40, v41
  v_permlane16_swap_b32 v44, v45
  v_permlane16_swap_b32 v48, v49
  v_permlane16_swap_b32 v52, v53
  v_permlane16_swap_b32 v56, v57
  v_permlane16_swap_b32 v60, v61
  v_max_f32 v40, v40, v41
  v_max_f32 v44, v44, v45
  v_max_f32 v48, v48, v49
  v_max_f32 v52, v52, v53
  v_max_f32 v56, v56, v57
  v_max_f32 v60, v60, v61
  v_mul_f32 v41, -1.0, v40
  v_mul_f32 v42, -1.0, v40
  v_mul_f32 v43, -1.0, v40
  v_mul_f32 v40, -1.0, v40
  v_mov_b32 v34, 0
  v_mul_f32 v45, -1.0, v44
  v_mul_f32 v46, -1.0, v44
  v_mul_f32 v47, -1.0, v44
  v_mul_f32 v44, -1.0, v44
  v_mov_b32 v35, 0
  v_mul_f32 v49, -1.0, v48
  v_mul_f32 v50, -1.0, v48
  v_mul_f32 v51, -1.0, v48
  v_mul_f32 v48, -1.0, v48
  v_mov_b32 v36, 0
  v_mul_f32 v53, -1.0, v52
  v_mul_f32 v54, -1.0, v52
  v_mul_f32 v55, -1.0, v52
  v_mul_f32 v52, -1.0, v52
  v_mov_b32 v37, 0
  v_mul_f32 v57, -1.0, v56
  v_mul_f32 v58, -1.0, v56
  v_mul_f32 v59, -1.0, v56
  v_mul_f32 v56, -1.0, v56
  v_mov_b32 v38, 0
  v_mul_f32 v61, -1.0, v60
  v_mul_f32 v62, -1.0, v60
  v_mul_f32 v63, -1.0, v60
  v_mul_f32 v60, -1.0, v60
  v_mov_b32 v39, 0
  v_accvgpr_write_b32 a0, 0
  v_accvgpr_write_b32 a1, 0
  v_accvgpr_write_b32 a2, 0
  v_accvgpr_write_b32 a3, 0
  v_accvgpr_write_b32 a4, 0
  v_accvgpr_write_b32 a5, 0
  v_accvgpr_write_b32 a6, 0
  v_accvgpr_write_b32 a7, 0
  v_accvgpr_write_b32 a8, 0
  v_accvgpr_write_b32 a9, 0
  v_accvgpr_write_b32 a10, 0
  v_accvgpr_write_b32 a11, 0
  v_accvgpr_write_b32 a12, 0
  v_accvgpr_write_b32 a13, 0
  v_accvgpr_write_b32 a14, 0
  v_accvgpr_write_b32 a15, 0
  v_accvgpr_write_b32 a16, 0
  v_accvgpr_write_b32 a17, 0
  v_accvgpr_write_b32 a18, 0
  v_accvgpr_write_b32 a19, 0
  v_accvgpr_write_b32 a20, 0
  v_accvgpr_write_b32 a21, 0
  v_accvgpr_write_b32 a22, 0
  v_accvgpr_write_b32 a23, 0
  v_accvgpr_write_b32 a24, 0
  v_accvgpr_write_b32 a25, 0
  v_accvgpr_write_b32 a26, 0
  v_accvgpr_write_b32 a27, 0
  v_accvgpr_write_b32 a28, 0
  v_accvgpr_write_b32 a29, 0
  v_accvgpr_write_b32 a30, 0
  v_accvgpr_write_b32 a31, 0
  v_accvgpr_write_b32 a32, 0
  v_accvgpr_write_b32 a33, 0
  v_accvgpr_write_b32 a34, 0
  v_accvgpr_write_b32 a35, 0
  v_accvgpr_write_b32 a36, 0
  v_accvgpr_write_b32 a37, 0
  v_accvgpr_write_b32 a38, 0
  v_accvgpr_write_b32 a39, 0
  v_accvgpr_write_b32 a40, 0
  v_accvgpr_write_b32 a41, 0
  v_accvgpr_write_b32 a42, 0
  v_accvgpr_write_b32 a43, 0
  v_accvgpr_write_b32 a44, 0
  v_accvgpr_write_b32 a45, 0
  v_accvgpr_write_b32 a46, 0
  v_accvgpr_write_b32 a47, 0
  v_accvgpr_write_b32 a48, 0
  v_accvgpr_write_b32 a49, 0
  v_accvgpr_write_b32 a50, 0
  v_accvgpr_write_b32 a51, 0
  v_accvgpr_write_b32 a52, 0
  v_accvgpr_write_b32 a53, 0
  v_accvgpr_write_b32 a54, 0
  v_accvgpr_write_b32 a55, 0
  v_accvgpr_write_b32 a56, 0
  v_accvgpr_write_b32 a57, 0
  v_accvgpr_write_b32 a58, 0
  v_accvgpr_write_b32 a59, 0
  v_accvgpr_write_b32 a60, 0
  v_accvgpr_write_b32 a61, 0
  v_accvgpr_write_b32 a62, 0
  v_accvgpr_write_b32 a63, 0
  v_accvgpr_write_b32 a64, 0
  v_accvgpr_write_b32 a65, 0
  v_accvgpr_write_b32 a66, 0
  v_accvgpr_write_b32 a67, 0
  v_accvgpr_write_b32 a68, 0
  v_accvgpr_write_b32 a69, 0
  v_accvgpr_write_b32 a70, 0
  v_accvgpr_write_b32 a71, 0
  v_accvgpr_write_b32 a72, 0
  v_accvgpr_write_b32 a73, 0
  v_accvgpr_write_b32 a74, 0
  v_accvgpr_write_b32 a75, 0
  v_accvgpr_write_b32 a76, 0
  v_accvgpr_write_b32 a77, 0
  v_accvgpr_write_b32 a78, 0
  v_accvgpr_write_b32 a79, 0
  v_accvgpr_write_b32 a80, 0
  v_accvgpr_write_b32 a81, 0
  v_accvgpr_write_b32 a82, 0
  v_accvgpr_write_b32 a83, 0
  v_accvgpr_write_b32 a84, 0
  v_accvgpr_write_b32 a85, 0
  v_accvgpr_write_b32 a86, 0
  v_accvgpr_write_b32 a87, 0
  v_accvgpr_write_b32 a88, 0
  v_accvgpr_write_b32 a89, 0
  v_accvgpr_write_b32 a90, 0
  v_accvgpr_write_b32 a91, 0
  v_accvgpr_write_b32 a92, 0
  v_accvgpr_write_b32 a93, 0
  v_accvgpr_write_b32 a94, 0
  v_accvgpr_write_b32 a95, 0
  v_accvgpr_write_b32 a96, 0
  v_accvgpr_write_b32 a97, 0
  v_accvgpr_write_b32 a98, 0
  v_accvgpr_write_b32 a99, 0
  v_accvgpr_write_b32 a100, 0
  v_accvgpr_write_b32 a101, 0
  v_accvgpr_write_b32 a102, 0
  v_accvgpr_write_b32 a103, 0
  v_accvgpr_write_b32 a104, 0
  v_accvgpr_write_b32 a105, 0
  v_accvgpr_write_b32 a106, 0
  v_accvgpr_write_b32 a107, 0
  v_accvgpr_write_b32 a108, 0
  v_accvgpr_write_b32 a109, 0
  v_accvgpr_write_b32 a110, 0
  v_accvgpr_write_b32 a111, 0
  v_accvgpr_write_b32 a112, 0
  v_accvgpr_write_b32 a113, 0
  v_accvgpr_write_b32 a114, 0
  v_accvgpr_write_b32 a115, 0
  v_accvgpr_write_b32 a116, 0
  v_accvgpr_write_b32 a117, 0
  v_accvgpr_write_b32 a118, 0
  v_accvgpr_write_b32 a119, 0
  v_accvgpr_write_b32 a120, 0
  v_accvgpr_write_b32 a121, 0
  v_accvgpr_write_b32 a122, 0
  v_accvgpr_write_b32 a123, 0
  v_accvgpr_write_b32 a124, 0
  v_accvgpr_write_b32 a125, 0
  v_accvgpr_write_b32 a126, 0
  v_accvgpr_write_b32 a127, 0
  v_accvgpr_write_b32 a128, 0
  v_accvgpr_write_b32 a129, 0
  v_accvgpr_write_b32 a130, 0
  v_accvgpr_write_b32 a131, 0
  v_accvgpr_write_b32 a132, 0
  v_accvgpr_write_b32 a133, 0
  v_accvgpr_write_b32 a134, 0
  v_accvgpr_write_b32 a135, 0
  v_accvgpr_write_b32 a136, 0
  v_accvgpr_write_b32 a137, 0
  v_accvgpr_write_b32 a138, 0
  v_accvgpr_write_b32 a139, 0
  v_accvgpr_write_b32 a140, 0
  v_accvgpr_write_b32 a141, 0
  v_accvgpr_write_b32 a142, 0
  v_accvgpr_write_b32 a143, 0
  v_accvgpr_write_b32 a144, 0
  v_accvgpr_write_b32 a145, 0
  v_accvgpr_write_b32 a146, 0
  v_accvgpr_write_b32 a147, 0
  v_accvgpr_write_b32 a148, 0
  v_accvgpr_write_b32 a149, 0
  v_accvgpr_write_b32 a150, 0
  v_accvgpr_write_b32 a151, 0
  v_accvgpr_write_b32 a152, 0
  v_accvgpr_write_b32 a153, 0
  v_accvgpr_write_b32 a154, 0
  v_accvgpr_write_b32 a155, 0
  v_accvgpr_write_b32 a156, 0
  v_accvgpr_write_b32 a157, 0
  v_accvgpr_write_b32 a158, 0
  v_accvgpr_write_b32 a159, 0
  v_accvgpr_write_b32 a160, 0
  v_accvgpr_write_b32 a161, 0
  v_accvgpr_write_b32 a162, 0
  v_accvgpr_write_b32 a163, 0
  v_accvgpr_write_b32 a164, 0
  v_accvgpr_write_b32 a165, 0
  v_accvgpr_write_b32 a166, 0
  v_accvgpr_write_b32 a167, 0
  v_accvgpr_write_b32 a168, 0
  v_accvgpr_write_b32 a169, 0
  v_accvgpr_write_b32 a170, 0
  v_accvgpr_write_b32 a171, 0
  v_accvgpr_write_b32 a172, 0
  v_accvgpr_write_b32 a173, 0
  v_accvgpr_write_b32 a174, 0
  v_accvgpr_write_b32 a175, 0
  v_accvgpr_write_b32 a176, 0
  v_accvgpr_write_b32 a177, 0
  v_accvgpr_write_b32 a178, 0
  v_accvgpr_write_b32 a179, 0
  v_accvgpr_write_b32 a180, 0
  v_accvgpr_write_b32 a181, 0
  v_accvgpr_write_b32 a182, 0
  v_accvgpr_write_b32 a183, 0
  v_accvgpr_write_b32 a184, 0
  v_accvgpr_write_b32 a185, 0
  v_accvgpr_write_b32 a186, 0
  v_accvgpr_write_b32 a187, 0
  v_accvgpr_write_b32 a188, 0
  v_accvgpr_write_b32 a189, 0
  v_accvgpr_write_b32 a190, 0
  v_accvgpr_write_b32 a191, 0
  s_mov_b32 s3, s5
  s_mov_b32 s4, 16
L_slow2:
  buffer_load_dwordx4 a[192:195], v2, s[16:19], s3 offen offset:0
  buffer_load_dwordx4 a[196:199], v2, s[16:19], s3 offen offset:64
  buffer_load_dwordx4 a[200:203], v2, s[16:19], s3 offen offset:128
  buffer_load_dwordx4 a[204:207], v2, s[16:19], s3 offen offset:192
  buffer_load_dwordx4 a[208:211], v3, s[16:19], s3 offen offset:0
  buffer_load_dwordx4 a[212:215], v3, s[16:19], s3 offen offset:64
  buffer_load_dwordx4 a[216:219], v3, s[16:19], s3 offen offset:128
  buffer_load_dwordx4 a[220:223], v3, s[16:19], s3 offen offset:192
  s_add_u32 m0, s6, 0
  s_add_u32 s7, s3, 0
  buffer_load_dwordx4 v7, s[20:23], s7 offen offset:0 lds
  buffer_load_dwordx4 v8, s[20:23], s7 offen offset:1024 lds
  buffer_load_dwordx4 v7, s[20:23], s7 offen offset:2048 lds
  buffer_load_dwordx4 v8, s[20:23], s7 offen offset:3072 lds
  s_add_u32 m0, s6, 4096
  s_add_u32 s7, s3, 4096
  buffer_load_dwordx4 v7, s[20:23], s7 offen offset:0 lds
  buffer_load_dwordx4 v8, s[20:23], s7 offen offset:1024 lds
  buffer_load_dwordx4 v7, s[20:23], s7 offen offset:2048 lds
  buffer_load_dwordx4 v8, s[20:23], s7 offen offset:3072 lds
  s_waitcnt vmcnt(0)
  ds_read_b64_tr_b16 a[224:225], v26 offset:0
  ds_read_b64_tr_b16 a[226:227], v26 offset:4096
  ds_read_b64_tr_b16 a[228:229], v27 offset:0
  ds_read_b64_tr_b16 a[230:231], v27 offset:4096
  ds_read_b64_tr_b16 a[232:233], v28 offset:0
  ds_read_b64_tr_b16 a[234:235], v28 offset:4096
  ds_read_b64_tr_b16 a[236:237], v29 offset:0
  ds_read_b64_tr_b16 a[238:239], v29 offset:4096
  ds_read_b64_tr_b16 a[240:241], v30 offset:0
  ds_read_b64_tr_b16 a[242:243], v30 offset:4096
  ds_read_b64_tr_b16 a[244:245], v31 offset:0
  ds_read_b64_tr_b16 a[246:247], v31 offset:4096
  ds_read_b64_tr_b16 a[248:249], v32 offset:0
  ds_read_b64_tr_b16 a[250:251], v32 offset:4096
  ds_read_b64_tr_b16 a[252:253], v33 offset:0
  ds_read_b64_tr_b16 a[254:255], v33 offset:4096
  v_mfma_f32_16x16x32_bf16 v[160:163], a[192:195], v[64:67], v[40:43]
  v_mfma_f32_16x16x32_bf16 v[168:171], a[192:195], v[68:71], v[44:47]
  v_mfma_f32_16x16x32_bf16 v[176:179], a[192:195], v[72:75], v[48:51]
  v_mfma_f32_16x16x32_bf16 v[184:187], a[192:195], v[76:79], v[52:55]
  v_mfma_f32_16x16x32_bf16 v[192:195], a[192:195], v[80:83], v[56:59]
  v_mfma_f32_16x16x32_bf16 v[200:203], a[192:195], v[84:87], v[60:63]
  v_mfma_f32_16x16x32_bf16 v[160:163], a[196:199], v[88:91], v[160:163]
  v_mfma_f32_16x16x32_bf16 v[168:171], a[196:199], v[92:95], v[168:171]
  v_mfma_f32_16x16x32_bf16 v[176:179], a[196:199], v[96:99], v[176:179]
  v_mfma_f32_16x16x32_bf16 v[184:187], a[196:199], v[100:103], v[184:187]
  v_mfma_f32_16x16x32_bf16 v[192:195], a[196:199], v[104:107], v[192:195]
  v_mfma_f32_16x16x32_bf16 v[200:203], a[196:199], v[108:111], v[200:203]
  v_mfma_f32_16x16x32_bf16 v[160:163], a[200:203], v[112:115], v[160:163]
  v_mfma_f32_16x16x32_bf16 v[168:171], a[200:203], v[116:119], v[168:171]
  v_mfma_f32_16x16x32_bf16 v[176:179], a[200:203], v[120:123], v[176:179]
  v_mfma_f32_16x16x32_bf16 v[184:187], a[200:203], v[124:127], v[184:187]
  v_mfma_f32_16x16x32_bf16 v[192:195], a[200:203], v[128:131], v[192:195]
  v_mfma_f32_16x16x32_bf16 v[200:203], a[200:203], v[132:135], v[200:203]
  v_mfma_f32_16x16x32_bf16 v[160:163], a[204:207], v[136:139], v[160:163]
  v_mfma_f32_16x16x32_bf16 v[168:171], a[204:207], v[140:143], v[168:171]
  v_mfma_f32_16x16x32_bf16 v[176:179], a[204:207], v[144:147], v[176:179]
  v_mfma_f32_16x16x32_bf16 v[184:187], a[204:207], v[148:151], v[184:187]
  v_mfma_f32_16x16x32_bf16 v[192:195], a[204:207], v[152:155], v[192:195]
  v_mfma_f32_16x16x32_bf16 v[200:203], a[204:207], v[156:159], v[200:203]
  v_mfma_f32_16x16x32_bf16 v[164:167], a[208:211], v[64:67], v[40:43]
  v_mfma_f32_16x16x32_bf16 v[172:175], a[208:211], v[68:71], v[44:47]
  v_mfma_f32_16x16x32_bf16 v[180:183], a[208:211], v[72:75], v[48:51]
  v_mfma_f32_16x16x32_bf16 v[188:191], a[208:211], v[76:79], v[52:55]
  v_mfma_f32_16x16x32_bf16 v[196:199], a[208:211], v[80:83], v[56:59]
  v_mfma_f32_16x16x32_bf16 v[204:207], a[208:211], v[84:87], v[60:63]
  v_mfma_f32_16x16x32_bf16 v[164:167], a[212:215], v[88:91], v[164:167]
  v_mfma_f32_16x16x32_bf16 v[172:175], a[212:215], v[92:95], v[172:175]
  v_mfma_f32_16x16x32_bf16 v[180:183], a[212:215], v[96:99], v[180:183]
  v_mfma_f32_16x16x32_bf16 v[188:191], a[212:215], v[100:103], v[188:191]
  v_mfma_f32_16x16x32_bf16 v[196:199], a[212:215], v[104:107], v[196:199]
  v_mfma_f32_16x16x32_bf16 v[204:207], a[212:215], v[108:111], v[204:207]
  v_mfma_f32_16x16x32_bf16 v[164:167], a[216:219], v[112:115], v[164:167]
  v_mfma_f32_16x16x32_bf16 v[172:175], a[216:219], v[116:119], v[172:175]
  v_mfma_f32_16x16x32_bf16 v[180:183], a[216:219], v[120:123], v[180:183]
  v_mfma_f32_16x16x32_bf16 v[188:191], a[216:219], v[124:127], v[188:191]
  v_mfma_f32_16x16x32_bf16 v[196:199], a[216:219], v[128:131], v[196:199]
  v_mfma_f32_16x16x32_bf16 v[204:207], a[216:219], v[132:135], v[204:207]
  v_mfma_f32_16x16x32_bf16 v[164:167], a[220:223], v[136:139], v[164:167]
  v_mfma_f32_16x16x32_bf16 v[172:175], a[220:223], v[140:143], v[172:175]
  v_mfma_f32_16x16x32_bf16 v[180:183], a[220:223], v[144:147], v[180:183]
  v_mfma_f32_16x16x32_bf16 v[188:191], a[220:223], v[148:151], v[188:191]
  v_mfma_f32_16x16x32_bf16 v[196:199], a[220:223], v[152:155], v[196:199]
  v_mfma_f32_16x16x32_bf16 v[204:207], a[220:223], v[156:159], v[204:207]
  s_nop 15
  v_exp_f32 v160, v160
  v_exp_f32 v161, v161
  v_exp_f32 v162, v162
  v_exp_f32 v163, v163
  v_exp_f32 v164, v164
  v_exp_f32 v165, v165
  v_exp_f32 v166, v166
  v_exp_f32 v167, v167
  v_add_f32 v34, v34, v160
  v_add_f32 v34, v34, v161
  v_add_f32 v34, v34, v162
  v_add_f32 v34, v34, v163
  v_add_f32 v34, v34, v164
  v_add_f32 v34, v34, v165
  v_add_f32 v34, v34, v166
  v_add_f32 v34, v34, v167
  v_cvt_pk_bf16_f32 v160, v160, v161
  v_cvt_pk_bf16_f32 v161, v162, v163
  v_cvt_pk_bf16_f32 v162, v164, v165
  v_cvt_pk_bf16_f32 v163, v166, v167
  v_exp_f32 v168, v168
  v_exp_f32 v169, v169
  v_exp_f32 v170, v170
  v_exp_f32 v171, v171
  v_exp_f32 v172, v172
  v_exp_f32 v173, v173
  v_exp_f32 v174, v174
  v_exp_f32 v175, v175
  v_add_f32 v35, v35, v168
  v_add_f32 v35, v35, v169
  v_add_f32 v35, v35, v170
  v_add_f32 v35, v35, v171
  v_add_f32 v35, v35, v172
  v_add_f32 v35, v35, v173
  v_add_f32 v35, v35, v174
  v_add_f32 v35, v35, v175
  v_cvt_pk_bf16_f32 v168, v168, v169
  v_cvt_pk_bf16_f32 v169, v170, v171
  v_cvt_pk_bf16_f32 v170, v172, v173
  v_cvt_pk_bf16_f32 v171, v174, v175
  v_exp_f32 v176, v176
  v_exp_f32 v177, v177
  v_exp_f32 v178, v178
  v_exp_f32 v179, v179
  v_exp_f32 v180, v180
  v_exp_f32 v181, v181
  v_exp_f32 v182, v182
  v_exp_f32 v183, v183
  v_add_f32 v36, v36, v176
  v_add_f32 v36, v36, v177
  v_add_f32 v36, v36, v178
  v_add_f32 v36, v36, v179
  v_add_f32 v36, v36, v180
  v_add_f32 v36, v36, v181
  v_add_f32 v36, v36, v182
  v_add_f32 v36, v36, v183
  v_cvt_pk_bf16_f32 v176, v176, v177
  v_cvt_pk_bf16_f32 v177, v178, v179
  v_cvt_pk_bf16_f32 v178, v180, v181
  v_cvt_pk_bf16_f32 v179, v182, v183
  v_exp_f32 v184, v184
  v_exp_f32 v185, v185
  v_exp_f32 v186, v186
  v_exp_f32 v187, v187
  v_exp_f32 v188, v188
  v_exp_f32 v189, v189
  v_exp_f32 v190, v190
  v_exp_f32 v191, v191
  v_add_f32 v37, v37, v184
  v_add_f32 v37, v37, v185
  v_add_f32 v37, v37, v186
  v_add_f32 v37, v37, v187
  v_add_f32 v37, v37, v188
  v_add_f32 v37, v37, v189
  v_add_f32 v37, v37, v190
  v_add_f32 v37, v37, v191
  v_cvt_pk_bf16_f32 v184, v184, v185
  v_cvt_pk_bf16_f32 v185, v186, v187
  v_cvt_pk_bf16_f32 v186, v188, v189
  v_cvt_pk_bf16_f32 v187, v190, v191
  v_exp_f32 v192, v192
  v_exp_f32 v193, v193
  v_exp_f32 v194, v194
  v_exp_f32 v195, v195
  v_exp_f32 v196, v196
  v_exp_f32 v197, v197
  v_exp_f32 v198, v198
  v_exp_f32 v199, v199
  v_add_f32 v38, v38, v192
  v_add_f32 v38, v38, v193
  v_add_f32 v38, v38, v194
  v_add_f32 v38, v38, v195
  v_add_f32 v38, v38, v196
  v_add_f32 v38, v38, v197
  v_add_f32 v38, v38, v198
  v_add_f32 v38, v38, v199
  v_cvt_pk_bf16_f32 v192, v192, v193
  v_cvt_pk_bf16_f32 v193, v194, v195
  v_cvt_pk_bf16_f32 v194, v196, v197
  v_cvt_pk_bf16_f32 v195, v198, v199
  v_exp_f32 v200, v200
  v_exp_f32 v201, v201
  v_exp_f32 v202, v202
  v_exp_f32 v203, v203
  v_exp_f32 v204, v204
  v_exp_f32 v205, v205
  v_exp_f32 v206, v206
  v_exp_f32 v207, v207
  v_add_f32 v39, v39, v200
  v_add_f32 v39, v39, v201
  v_add_f32 v39, v39, v202
  v_add_f32 v39, v39, v203
  v_add_f32 v39, v39, v204
  v_add_f32 v39, v39, v205
  v_add_f32 v39, v39, v206
  v_add_f32 v39, v39, v207
  v_cvt_pk_bf16_f32 v200, v200, v201
  v_cvt_pk_bf16_f32 v201, v202, v203
  v_cvt_pk_bf16_f32 v202, v204, v205
  v_cvt_pk_bf16_f32 v203, v206, v207
  s_waitcnt lgkmcnt(0)
  v_mfma_f32_16x16x32_bf16 a[0:3], a[224:227], v[160:163], a[0:3]
  v_mfma_f32_16x16x32_bf16 a[32:35], a[224:227], v[168:171], a[32:35]
  v_mfma_f32_16x16x32_bf16 a[64:67], a[224:227], v[176:179], a[64:67]
  v_mfma_f32_16x16x32_bf16 a[96:99], a[224:227], v[184:187], a[96:99]
  v_mfma_f32_16x16x32_bf16 a[128:131], a[224:227], v[192:195], a[128:131]
  v_mfma_f32_16x16x32_bf16 a[160:163], a[224:227], v[200:203], a[160:163]
  v_mfma_f32_16x16x32_bf16 a[4:7], a[228:231], v[160:163], a[4:7]
  v_mfma_f32_16x16x32_bf16 a[36:39], a[228:231], v[168:171], a[36:39]
  v_mfma_f32_16x16x32_bf16 a[68:71], a[228:231], v[176:179], a[68:71]
  v_mfma_f32_16x16x32_bf16 a[100:103], a[228:231], v[184:187], a[100:103]
  v_mfma_f32_16x16x32_bf16 a[132:135], a[228:231], v[192:195], a[132:135]
  v_mfma_f32_16x16x32_bf16 a[164:167], a[228:231], v[200:203], a[164:167]
  v_mfma_f32_16x16x32_bf16 a[8:11], a[232:235], v[160:163], a[8:11]
  v_mfma_f32_16x16x32_bf16 a[40:43], a[232:235], v[168:171], a[40:43]
  v_mfma_f32_16x16x32_bf16 a[72:75], a[232:235], v[176:179], a[72:75]
  v_mfma_f32_16x16x32_bf16 a[104:107], a[232:235], v[184:187], a[104:107]
  v_mfma_f32_16x16x32_bf16 a[136:139], a[232:235], v[192:195], a[136:139]
  v_mfma_f32_16x16x32_bf16 a[168:171], a[232:235], v[200:203], a[168:171]
  v_mfma_f32_16x16x32_bf16 a[12:15], a[236:239], v[160:163], a[12:15]
  v_mfma_f32_16x16x32_bf16 a[44:47], a[236:239], v[168:171], a[44:47]
  v_mfma_f32_16x16x32_bf16 a[76:79], a[236:239], v[176:179], a[76:79]
  v_mfma_f32_16x16x32_bf16 a[108:111], a[236:239], v[184:187], a[108:111]
  v_mfma_f32_16x16x32_bf16 a[140:143], a[236:239], v[192:195], a[140:143]
  v_mfma_f32_16x16x32_bf16 a[172:175], a[236:239], v[200:203], a[172:175]
  v_mfma_f32_16x16x32_bf16 a[16:19], a[240:243], v[160:163], a[16:19]
  v_mfma_f32_16x16x32_bf16 a[48:51], a[240:243], v[168:171], a[48:51]
  v_mfma_f32_16x16x32_bf16 a[80:83], a[240:243], v[176:179], a[80:83]
  v_mfma_f32_16x16x32_bf16 a[112:115], a[240:243], v[184:187], a[112:115]
  v_mfma_f32_16x16x32_bf16 a[144:147], a[240:243], v[192:195], a[144:147]
  v_mfma_f32_16x16x32_bf16 a[176:179], a[240:243], v[200:203], a[176:179]
  v_mfma_f32_16x16x32_bf16 a[20:23], a[244:247], v[160:163], a[20:23]
  v_mfma_f32_16x16x32_bf16 a[52:55], a[244:247], v[168:171], a[52:55]
  v_mfma_f32_16x16x32_bf16 a[84:87], a[244:247], v[176:179], a[84:87]
  v_mfma_f32_16x16x32_bf16 a[116:119], a[244:247], v[184:187], a[116:119]
  v_mfma_f32_16x16x32_bf16 a[148:151], a[244:247], v[192:195], a[148:151]
  v_mfma_f32_16x16x32_bf16 a[180:183], a[244:247], v[200:203], a[180:183]
  v_mfma_f32_16x16x32_bf16 a[24:27], a[248:251], v[160:163], a[24:27]
  v_mfma_f32_16x16x32_bf16 a[56:59], a[248:251], v[168:171], a[56:59]
  v_mfma_f32_16x16x32_bf16 a[88:91], a[248:251], v[176:179], a[88:91]
  v_mfma_f32_16x16x32_bf16 a[120:123], a[248:251], v[184:187], a[120:123]
  v_mfma_f32_16x16x32_bf16 a[152:155], a[248:251], v[192:195], a[152:155]
  v_mfma_f32_16x16x32_bf16 a[184:187], a[248:251], v[200:203], a[184:187]
  v_mfma_f32_16x16x32_bf16 a[28:31], a[252:255], v[160:163], a[28:31]
  v_mfma_f32_16x16x32_bf16 a[60:63], a[252:255], v[168:171], a[60:63]
  v_mfma_f32_16x16x32_bf16 a[92:95], a[252:255], v[176:179], a[92:95]
  v_mfma_f32_16x16x32_bf16 a[124:127], a[252:255], v[184:187], a[124:127]
  v_mfma_f32_16x16x32_bf16 a[156:159], a[252:255], v[192:195], a[156:159]
  v_mfma_f32_16x16x32_bf16 a[188:191], a[252:255], v[200:203], a[188:191]
  s_add_u32 s3, s3, 8192
  s_sub_u32 s4, s4, 1
  s_cmp_lg_u32 s4, 0
  s_cbranch_scc1 L_slow2
  s_nop 15
  v_mov_b32 v40, v34
  v_mov_b32 v41, v35
  v_mov_b32 v42, v36
  v_mov_b32 v43, v37
  v_mov_b32 v44, v38
  v_mov_b32 v45, v39
  v_permlane32_swap_b32 v34, v40
  v_permlane32_swap_b32 v35, v41
  v_permlane32_swap_b32 v36, v42
  v_permlane32_swap_b32 v37, v43
  v_permlane32_swap_b32 v38, v44
  v_permlane32_swap_b32 v39, v45
  v_add_f32 v34, v34, v40
  v_add_f32 v35, v35, v41
  v_add_f32 v36, v36, v42
  v_add_f32 v37, v37, v43
  v_add_f32 v38, v38, v44
  v_add_f32 v39, v39, v45
  v_mov_b32 v40, v34
  v_mov_b32 v41, v35
  v_mov_b32 v42, v36
  v_mov_b32 v43, v37
  v_mov_b32 v44, v38
  v_mov_b32 v45, v39
  v_permlane16_swap_b32 v34, v40
  v_permlane16_swap_b32 v35, v41
  v_permlane16_swap_b32 v36, v42
  v_permlane16_swap_b32 v37, v43
  v_permlane16_swap_b32 v38, v44
  v_permlane16_swap_b32 v39, v45
  v_add_f32 v34, v34, v40
  v_add_f32 v35, v35, v41
  v_add_f32 v36, v36, v42
  v_add_f32 v37, v37, v43
  v_add_f32 v38, v38, v44
  v_add_f32 v39, v39, v45
  v_rcp_f32 v40, v34
  v_rcp_f32 v42, v35
  v_rcp_f32 v44, v36
  v_rcp_f32 v46, v37
  v_rcp_f32 v48, v38
  v_rcp_f32 v50, v39
  v_accvgpr_read_b32 v160, a0
  v_accvgpr_read_b32 v161, a1
  v_accvgpr_read_b32 v162, a2
  v_accvgpr_read_b32 v163, a3
  v_accvgpr_read_b32 v164, a4
  v_accvgpr_read_b32 v165, a5
  v_accvgpr_read_b32 v166, a6
  v_accvgpr_read_b32 v167, a7
  v_pk_mul_f32 v[160:161], v[160:161], v[40:41] op_sel_hi:[1,0]
  v_pk_mul_f32 v[162:163], v[162:163], v[40:41] op_sel_hi:[1,0]
  v_pk_mul_f32 v[164:165], v[164:165], v[40:41] op_sel_hi:[1,0]
  v_pk_mul_f32 v[166:167], v[166:167], v[40:41] op_sel_hi:[1,0]
  v_cvt_pk_bf16_f32 v160, v160, v161
  v_cvt_pk_bf16_f32 v161, v162, v163
  v_cvt_pk_bf16_f32 v162, v164, v165
  v_cvt_pk_bf16_f32 v163, v166, v167
  s_add_u32 s3, s74, 0
  buffer_store_dwordx4 v[160:163], v6, s[24:27], s3 offen sc1
  v_accvgpr_read_b32 v168, a8
  v_accvgpr_read_b32 v169, a9
  v_accvgpr_read_b32 v170, a10
  v_accvgpr_read_b32 v171, a11
  v_accvgpr_read_b32 v172, a12
  v_accvgpr_read_b32 v173, a13
  v_accvgpr_read_b32 v174, a14
  v_accvgpr_read_b32 v175, a15
  v_pk_mul_f32 v[168:169], v[168:169], v[40:41] op_sel_hi:[1,0]
  v_pk_mul_f32 v[170:171], v[170:171], v[40:41] op_sel_hi:[1,0]
  v_pk_mul_f32 v[172:173], v[172:173], v[40:41] op_sel_hi:[1,0]
  v_pk_mul_f32 v[174:175], v[174:175], v[40:41] op_sel_hi:[1,0]
  v_cvt_pk_bf16_f32 v168, v168, v169
  v_cvt_pk_bf16_f32 v169, v170, v171
  v_cvt_pk_bf16_f32 v170, v172, v173
  v_cvt_pk_bf16_f32 v171, v174, v175
  s_add_u32 s3, s74, 131072
  buffer_store_dwordx4 v[168:171], v6, s[24:27], s3 offen sc1
  v_accvgpr_read_b32 v176, a16
  v_accvgpr_read_b32 v177, a17
  v_accvgpr_read_b32 v178, a18
  v_accvgpr_read_b32 v179, a19
  v_accvgpr_read_b32 v180, a20
  v_accvgpr_read_b32 v181, a21
  v_accvgpr_read_b32 v182, a22
  v_accvgpr_read_b32 v183, a23
  v_pk_mul_f32 v[176:177], v[176:177], v[40:41] op_sel_hi:[1,0]
  v_pk_mul_f32 v[178:179], v[178:179], v[40:41] op_sel_hi:[1,0]
  v_pk_mul_f32 v[180:181], v[180:181], v[40:41] op_sel_hi:[1,0]
  v_pk_mul_f32 v[182:183], v[182:183], v[40:41] op_sel_hi:[1,0]
  v_cvt_pk_bf16_f32 v176, v176, v177
  v_cvt_pk_bf16_f32 v177, v178, v179
  v_cvt_pk_bf16_f32 v178, v180, v181
  v_cvt_pk_bf16_f32 v179, v182, v183
  s_add_u32 s3, s74, 262144
  buffer_store_dwordx4 v[176:179], v6, s[24:27], s3 offen sc1
  v_accvgpr_read_b32 v184, a24
  v_accvgpr_read_b32 v185, a25
  v_accvgpr_read_b32 v186, a26
  v_accvgpr_read_b32 v187, a27
  v_accvgpr_read_b32 v188, a28
  v_accvgpr_read_b32 v189, a29
  v_accvgpr_read_b32 v190, a30
  v_accvgpr_read_b32 v191, a31
  v_pk_mul_f32 v[184:185], v[184:185], v[40:41] op_sel_hi:[1,0]
  v_pk_mul_f32 v[186:187], v[186:187], v[40:41] op_sel_hi:[1,0]
  v_pk_mul_f32 v[188:189], v[188:189], v[40:41] op_sel_hi:[1,0]
  v_pk_mul_f32 v[190:191], v[190:191], v[40:41] op_sel_hi:[1,0]
  v_cvt_pk_bf16_f32 v184, v184, v185
  v_cvt_pk_bf16_f32 v185, v186, v187
  v_cvt_pk_bf16_f32 v186, v188, v189
  v_cvt_pk_bf16_f32 v187, v190, v191
  s_add_u32 s3, s74, 393216
  buffer_store_dwordx4 v[184:187], v6, s[24:27], s3 offen sc1
  v_accvgpr_read_b32 v192, a32
  v_accvgpr_read_b32 v193, a33
  v_accvgpr_read_b32 v194, a34
  v_accvgpr_read_b32 v195, a35
  v_accvgpr_read_b32 v196, a36
  v_accvgpr_read_b32 v197, a37
  v_accvgpr_read_b32 v198, a38
  v_accvgpr_read_b32 v199, a39
  v_pk_mul_f32 v[192:193], v[192:193], v[42:43] op_sel_hi:[1,0]
  v_pk_mul_f32 v[194:195], v[194:195], v[42:43] op_sel_hi:[1,0]
  v_pk_mul_f32 v[196:197], v[196:197], v[42:43] op_sel_hi:[1,0]
  v_pk_mul_f32 v[198:199], v[198:199], v[42:43] op_sel_hi:[1,0]
  v_cvt_pk_bf16_f32 v192, v192, v193
  v_cvt_pk_bf16_f32 v193, v194, v195
  v_cvt_pk_bf16_f32 v194, v196, v197
  v_cvt_pk_bf16_f32 v195, v198, v199
  s_add_u32 s3, s74, 1024
  buffer_store_dwordx4 v[192:195], v6, s[24:27], s3 offen sc1
  v_accvgpr_read_b32 v200, a40
  v_accvgpr_read_b32 v201, a41
  v_accvgpr_read_b32 v202, a42
  v_accvgpr_read_b32 v203, a43
  v_accvgpr_read_b32 v204, a44
  v_accvgpr_read_b32 v205, a45
  v_accvgpr_read_b32 v206, a46
  v_accvgpr_read_b32 v207, a47
  v_pk_mul_f32 v[200:201], v[200:201], v[42:43] op_sel_hi:[1,0]
  v_pk_mul_f32 v[202:203], v[202:203], v[42:43] op_sel_hi:[1,0]
  v_pk_mul_f32 v[204:205], v[204:205], v[42:43] op_sel_hi:[1,0]
  v_pk_mul_f32 v[206:207], v[206:207], v[42:43] op_sel_hi:[1,0]
  v_cvt_pk_bf16_f32 v200, v200, v201
  v_cvt_pk_bf16_f32 v201, v202, v203
  v_cvt_pk_bf16_f32 v202, v204, v205
  v_cvt_pk_bf16_f32 v203, v206, v207
  s_add_u32 s3, s74, 132096
  buffer_store_dwordx4 v[200:203], v6, s[24:27], s3 offen sc1
  v_accvgpr_read_b32 v208, a48
  v_accvgpr_read_b32 v209, a49
  v_accvgpr_read_b32 v210, a50
  v_accvgpr_read_b32 v211, a51
  v_accvgpr_read_b32 v212, a52
  v_accvgpr_read_b32 v213, a53
  v_accvgpr_read_b32 v214, a54
  v_accvgpr_read_b32 v215, a55
  v_pk_mul_f32 v[208:209], v[208:209], v[42:43] op_sel_hi:[1,0]
  v_pk_mul_f32 v[210:211], v[210:211], v[42:43] op_sel_hi:[1,0]
  v_pk_mul_f32 v[212:213], v[212:213], v[42:43] op_sel_hi:[1,0]
  v_pk_mul_f32 v[214:215], v[214:215], v[42:43] op_sel_hi:[1,0]
  v_cvt_pk_bf16_f32 v208, v208, v209
  v_cvt_pk_bf16_f32 v209, v210, v211
  v_cvt_pk_bf16_f32 v210, v212, v213
  v_cvt_pk_bf16_f32 v211, v214, v215
  s_add_u32 s3, s74, 263168
  buffer_store_dwordx4 v[208:211], v6, s[24:27], s3 offen sc1
  v_accvgpr_read_b32 v216, a56
  v_accvgpr_read_b32 v217, a57
  v_accvgpr_read_b32 v218, a58
  v_accvgpr_read_b32 v219, a59
  v_accvgpr_read_b32 v220, a60
  v_accvgpr_read_b32 v221, a61
  v_accvgpr_read_b32 v222, a62
  v_accvgpr_read_b32 v223, a63
  v_pk_mul_f32 v[216:217], v[216:217], v[42:43] op_sel_hi:[1,0]
  v_pk_mul_f32 v[218:219], v[218:219], v[42:43] op_sel_hi:[1,0]
  v_pk_mul_f32 v[220:221], v[220:221], v[42:43] op_sel_hi:[1,0]
  v_pk_mul_f32 v[222:223], v[222:223], v[42:43] op_sel_hi:[1,0]
  v_cvt_pk_bf16_f32 v216, v216, v217
  v_cvt_pk_bf16_f32 v217, v218, v219
  v_cvt_pk_bf16_f32 v218, v220, v221
  v_cvt_pk_bf16_f32 v219, v222, v223
  s_add_u32 s3, s74, 394240
  buffer_store_dwordx4 v[216:219], v6, s[24:27], s3 offen sc1
  s_cmp_le_u32 s75, 2
  s_cbranch_scc1 L_attn_done
  v_accvgpr_read_b32 v160, a64
  v_accvgpr_read_b32 v161, a65
  v_accvgpr_read_b32 v162, a66
  v_accvgpr_read_b32 v163, a67
  v_accvgpr_read_b32 v164, a68
  v_accvgpr_read_b32 v165, a69
  v_accvgpr_read_b32 v166, a70
  v_accvgpr_read_b32 v167, a71
  v_pk_mul_f32 v[160:161], v[160:161], v[44:45] op_sel_hi:[1,0]
  v_pk_mul_f32 v[162:163], v[162:163], v[44:45] op_sel_hi:[1,0]
  v_pk_mul_f32 v[164:165], v[164:165], v[44:45] op_sel_hi:[1,0]
  v_pk_mul_f32 v[166:167], v[166:167], v[44:45] op_sel_hi:[1,0]
  v_cvt_pk_bf16_f32 v160, v160, v161
  v_cvt_pk_bf16_f32 v161, v162, v163
  v_cvt_pk_bf16_f32 v162, v164, v165
  v_cvt_pk_bf16_f32 v163, v166, v167
  s_add_u32 s3, s74, 2048
  buffer_store_dwordx4 v[160:163], v6, s[24:27], s3 offen sc1
  v_accvgpr_read_b32 v168, a72
  v_accvgpr_read_b32 v169, a73
  v_accvgpr_read_b32 v170, a74
  v_accvgpr_read_b32 v171, a75
  v_accvgpr_read_b32 v172, a76
  v_accvgpr_read_b32 v173, a77
  v_accvgpr_read_b32 v174, a78
  v_accvgpr_read_b32 v175, a79
  v_pk_mul_f32 v[168:169], v[168:169], v[44:45] op_sel_hi:[1,0]
  v_pk_mul_f32 v[170:171], v[170:171], v[44:45] op_sel_hi:[1,0]
  v_pk_mul_f32 v[172:173], v[172:173], v[44:45] op_sel_hi:[1,0]
  v_pk_mul_f32 v[174:175], v[174:175], v[44:45] op_sel_hi:[1,0]
  v_cvt_pk_bf16_f32 v168, v168, v169
  v_cvt_pk_bf16_f32 v169, v170, v171
  v_cvt_pk_bf16_f32 v170, v172, v173
  v_cvt_pk_bf16_f32 v171, v174, v175
  s_add_u32 s3, s74, 133120
  buffer_store_dwordx4 v[168:171], v6, s[24:27], s3 offen sc1
  v_accvgpr_read_b32 v176, a80
  v_accvgpr_read_b32 v177, a81
  v_accvgpr_read_b32 v178, a82
  v_accvgpr_read_b32 v179, a83
  v_accvgpr_read_b32 v180, a84
  v_accvgpr_read_b32 v181, a85
  v_accvgpr_read_b32 v182, a86
  v_accvgpr_read_b32 v183, a87
  v_pk_mul_f32 v[176:177], v[176:177], v[44:45] op_sel_hi:[1,0]
  v_pk_mul_f32 v[178:179], v[178:179], v[44:45] op_sel_hi:[1,0]
  v_pk_mul_f32 v[180:181], v[180:181], v[44:45] op_sel_hi:[1,0]
  v_pk_mul_f32 v[182:183], v[182:183], v[44:45] op_sel_hi:[1,0]
  v_cvt_pk_bf16_f32 v176, v176, v177
  v_cvt_pk_bf16_f32 v177, v178, v179
  v_cvt_pk_bf16_f32 v178, v180, v181
  v_cvt_pk_bf16_f32 v179, v182, v183
  s_add_u32 s3, s74, 264192
  buffer_store_dwordx4 v[176:179], v6, s[24:27], s3 offen sc1
  v_accvgpr_read_b32 v184, a88
  v_accvgpr_read_b32 v185, a89
  v_accvgpr_read_b32 v186, a90
  v_accvgpr_read_b32 v187, a91
  v_accvgpr_read_b32 v188, a92
  v_accvgpr_read_b32 v189, a93
  v_accvgpr_read_b32 v190, a94
  v_accvgpr_read_b32 v191, a95
  v_pk_mul_f32 v[184:185], v[184:185], v[44:45] op_sel_hi:[1,0]
  v_pk_mul_f32 v[186:187], v[186:187], v[44:45] op_sel_hi:[1,0]
  v_pk_mul_f32 v[188:189], v[188:189], v[44:45] op_sel_hi:[1,0]
  v_pk_mul_f32 v[190:191], v[190:191], v[44:45] op_sel_hi:[1,0]
  v_cvt_pk_bf16_f32 v184, v184, v185
  v_cvt_pk_bf16_f32 v185, v186, v187
  v_cvt_pk_bf16_f32 v186, v188, v189
  v_cvt_pk_bf16_f32 v187, v190, v191
  s_add_u32 s3, s74, 395264
  buffer_store_dwordx4 v[184:187], v6, s[24:27], s3 offen sc1
  s_cmp_le_u32 s75, 3
  s_cbranch_scc1 L_attn_done
  v_accvgpr_read_b32 v192, a96
  v_accvgpr_read_b32 v193, a97
  v_accvgpr_read_b32 v194, a98
  v_accvgpr_read_b32 v195, a99
  v_accvgpr_read_b32 v196, a100
  v_accvgpr_read_b32 v197, a101
  v_accvgpr_read_b32 v198, a102
  v_accvgpr_read_b32 v199, a103
  v_pk_mul_f32 v[192:193], v[192:193], v[46:47] op_sel_hi:[1,0]
  v_pk_mul_f32 v[194:195], v[194:195], v[46:47] op_sel_hi:[1,0]
  v_pk_mul_f32 v[196:197], v[196:197], v[46:47] op_sel_hi:[1,0]
  v_pk_mul_f32 v[198:199], v[198:199], v[46:47] op_sel_hi:[1,0]
  v_cvt_pk_bf16_f32 v192, v192, v193
  v_cvt_pk_bf16_f32 v193, v194, v195
  v_cvt_pk_bf16_f32 v194, v196, v197
  v_cvt_pk_bf16_f32 v195, v198, v199
  s_add_u32 s3, s74, 3072
  buffer_store_dwordx4 v[192:195], v6, s[24:27], s3 offen sc1
  v_accvgpr_read_b32 v200, a104
  v_accvgpr_read_b32 v201, a105
  v_accvgpr_read_b32 v202, a106
  v_accvgpr_read_b32 v203, a107
  v_accvgpr_read_b32 v204, a108
  v_accvgpr_read_b32 v205, a109
  v_accvgpr_read_b32 v206, a110
  v_accvgpr_read_b32 v207, a111
  v_pk_mul_f32 v[200:201], v[200:201], v[46:47] op_sel_hi:[1,0]
  v_pk_mul_f32 v[202:203], v[202:203], v[46:47] op_sel_hi:[1,0]
  v_pk_mul_f32 v[204:205], v[204:205], v[46:47] op_sel_hi:[1,0]
  v_pk_mul_f32 v[206:207], v[206:207], v[46:47] op_sel_hi:[1,0]
  v_cvt_pk_bf16_f32 v200, v200, v201
  v_cvt_pk_bf16_f32 v201, v202, v203
  v_cvt_pk_bf16_f32 v202, v204, v205
  v_cvt_pk_bf16_f32 v203, v206, v207
  s_add_u32 s3, s74, 134144
  buffer_store_dwordx4 v[200:203], v6, s[24:27], s3 offen sc1
  v_accvgpr_read_b32 v208, a112
  v_accvgpr_read_b32 v209, a113
  v_accvgpr_read_b32 v210, a114
  v_accvgpr_read_b32 v211, a115
  v_accvgpr_read_b32 v212, a116
  v_accvgpr_read_b32 v213, a117
  v_accvgpr_read_b32 v214, a118
  v_accvgpr_read_b32 v215, a119
  v_pk_mul_f32 v[208:209], v[208:209], v[46:47] op_sel_hi:[1,0]
  v_pk_mul_f32 v[210:211], v[210:211], v[46:47] op_sel_hi:[1,0]
  v_pk_mul_f32 v[212:213], v[212:213], v[46:47] op_sel_hi:[1,0]
  v_pk_mul_f32 v[214:215], v[214:215], v[46:47] op_sel_hi:[1,0]
  v_cvt_pk_bf16_f32 v208, v208, v209
  v_cvt_pk_bf16_f32 v209, v210, v211
  v_cvt_pk_bf16_f32 v210, v212, v213
  v_cvt_pk_bf16_f32 v211, v214, v215
  s_add_u32 s3, s74, 265216
  buffer_store_dwordx4 v[208:211], v6, s[24:27], s3 offen sc1
  v_accvgpr_read_b32 v216, a120
  v_accvgpr_read_b32 v217, a121
  v_accvgpr_read_b32 v218, a122
  v_accvgpr_read_b32 v219, a123
  v_accvgpr_read_b32 v220, a124
  v_accvgpr_read_b32 v221, a125
  v_accvgpr_read_b32 v222, a126
  v_accvgpr_read_b32 v223, a127
  v_pk_mul_f32 v[216:217], v[216:217], v[46:47] op_sel_hi:[1,0]
  v_pk_mul_f32 v[218:219], v[218:219], v[46:47] op_sel_hi:[1,0]
  v_pk_mul_f32 v[220:221], v[220:221], v[46:47] op_sel_hi:[1,0]
  v_pk_mul_f32 v[222:223], v[222:223], v[46:47] op_sel_hi:[1,0]
  v_cvt_pk_bf16_f32 v216, v216, v217
  v_cvt_pk_bf16_f32 v217, v218, v219
  v_cvt_pk_bf16_f32 v218, v220, v221
  v_cvt_pk_bf16_f32 v219, v222, v223
  s_add_u32 s3, s74, 396288
  buffer_store_dwordx4 v[216:219], v6, s[24:27], s3 offen sc1
  s_cmp_le_u32 s75, 4
  s_cbranch_scc1 L_attn_done
  v_accvgpr_read_b32 v160, a128
  v_accvgpr_read_b32 v161, a129
  v_accvgpr_read_b32 v162, a130
  v_accvgpr_read_b32 v163, a131
  v_accvgpr_read_b32 v164, a132
  v_accvgpr_read_b32 v165, a133
  v_accvgpr_read_b32 v166, a134
  v_accvgpr_read_b32 v167, a135
  v_pk_mul_f32 v[160:161], v[160:161], v[48:49] op_sel_hi:[1,0]
  v_pk_mul_f32 v[162:163], v[162:163], v[48:49] op_sel_hi:[1,0]
  v_pk_mul_f32 v[164:165], v[164:165], v[48:49] op_sel_hi:[1,0]
  v_pk_mul_f32 v[166:167], v[166:167], v[48:49] op_sel_hi:[1,0]
  v_cvt_pk_bf16_f32 v160, v160, v161
  v_cvt_pk_bf16_f32 v161, v162, v163
  v_cvt_pk_bf16_f32 v162, v164, v165
  v_cvt_pk_bf16_f32 v163, v166, v167
  s_add_u32 s3, s74, 4096
  buffer_store_dwordx4 v[160:163], v6, s[24:27], s3 offen sc1
  v_accvgpr_read_b32 v168, a136
  v_accvgpr_read_b32 v169, a137
  v_accvgpr_read_b32 v170, a138
  v_accvgpr_read_b32 v171, a139
  v_accvgpr_read_b32 v172, a140
  v_accvgpr_read_b32 v173, a141
  v_accvgpr_read_b32 v174, a142
  v_accvgpr_read_b32 v175, a143
  v_pk_mul_f32 v[168:169], v[168:169], v[48:49] op_sel_hi:[1,0]
  v_pk_mul_f32 v[170:171], v[170:171], v[48:49] op_sel_hi:[1,0]
  v_pk_mul_f32 v[172:173], v[172:173], v[48:49] op_sel_hi:[1,0]
  v_pk_mul_f32 v[174:175], v[174:175], v[48:49] op_sel_hi:[1,0]
  v_cvt_pk_bf16_f32 v168, v168, v169
  v_cvt_pk_bf16_f32 v169, v170, v171
  v_cvt_pk_bf16_f32 v170, v172, v173
  v_cvt_pk_bf16_f32 v171, v174, v175
  s_add_u32 s3, s74, 135168
  buffer_store_dwordx4 v[168:171], v6, s[24:27], s3 offen sc1
  v_accvgpr_read_b32 v176, a144
  v_accvgpr_read_b32 v177, a145
  v_accvgpr_read_b32 v178, a146
  v_accvgpr_read_b32 v179, a147
  v_accvgpr_read_b32 v180, a148
  v_accvgpr_read_b32 v181, a149
  v_accvgpr_read_b32 v182, a150
  v_accvgpr_read_b32 v183, a151
  v_pk_mul_f32 v[176:177], v[176:177], v[48:49] op_sel_hi:[1,0]
  v_pk_mul_f32 v[178:179], v[178:179], v[48:49] op_sel_hi:[1,0]
  v_pk_mul_f32 v[180:181], v[180:181], v[48:49] op_sel_hi:[1,0]
  v_pk_mul_f32 v[182:183], v[182:183], v[48:49] op_sel_hi:[1,0]
  v_cvt_pk_bf16_f32 v176, v176, v177
  v_cvt_pk_bf16_f32 v177, v178, v179
  v_cvt_pk_bf16_f32 v178, v180, v181
  v_cvt_pk_bf16_f32 v179, v182, v183
  s_add_u32 s3, s74, 266240
  buffer_store_dwordx4 v[176:179], v6, s[24:27], s3 offen sc1
  v_accvgpr_read_b32 v184, a152
  v_accvgpr_read_b32 v185, a153
  v_accvgpr_read_b32 v186, a154
  v_accvgpr_read_b32 v187, a155
  v_accvgpr_read_b32 v188, a156
  v_accvgpr_read_b32 v189, a157
  v_accvgpr_read_b32 v190, a158
  v_accvgpr_read_b32 v191, a159
  v_pk_mul_f32 v[184:185], v[184:185], v[48:49] op_sel_hi:[1,0]
  v_pk_mul_f32 v[186:187], v[186:187], v[48:49] op_sel_hi:[1,0]
  v_pk_mul_f32 v[188:189], v[188:189], v[48:49] op_sel_hi:[1,0]
  v_pk_mul_f32 v[190:191], v[190:191], v[48:49] op_sel_hi:[1,0]
  v_cvt_pk_bf16_f32 v184, v184, v185
  v_cvt_pk_bf16_f32 v185, v186, v187
  v_cvt_pk_bf16_f32 v186, v188, v189
  v_cvt_pk_bf16_f32 v187, v190, v191
  s_add_u32 s3, s74, 397312
  buffer_store_dwordx4 v[184:187], v6, s[24:27], s3 offen sc1
  s_cmp_le_u32 s75, 5
  s_cbranch_scc1 L_attn_done
  v_accvgpr_read_b32 v192, a160
  v_accvgpr_read_b32 v193, a161
  v_accvgpr_read_b32 v194, a162
  v_accvgpr_read_b32 v195, a163
  v_accvgpr_read_b32 v196, a164
  v_accvgpr_read_b32 v197, a165
  v_accvgpr_read_b32 v198, a166
  v_accvgpr_read_b32 v199, a167
  v_pk_mul_f32 v[192:193], v[192:193], v[50:51] op_sel_hi:[1,0]
  v_pk_mul_f32 v[194:195], v[194:195], v[50:51] op_sel_hi:[1,0]
  v_pk_mul_f32 v[196:197], v[196:197], v[50:51] op_sel_hi:[1,0]
  v_pk_mul_f32 v[198:199], v[198:199], v[50:51] op_sel_hi:[1,0]
  v_cvt_pk_bf16_f32 v192, v192, v193
  v_cvt_pk_bf16_f32 v193, v194, v195
  v_cvt_pk_bf16_f32 v194, v196, v197
  v_cvt_pk_bf16_f32 v195, v198, v199
  s_add_u32 s3, s74, 5120
  buffer_store_dwordx4 v[192:195], v6, s[24:27], s3 offen sc1
  v_accvgpr_read_b32 v200, a168
  v_accvgpr_read_b32 v201, a169
  v_accvgpr_read_b32 v202, a170
  v_accvgpr_read_b32 v203, a171
  v_accvgpr_read_b32 v204, a172
  v_accvgpr_read_b32 v205, a173
  v_accvgpr_read_b32 v206, a174
  v_accvgpr_read_b32 v207, a175
  v_pk_mul_f32 v[200:201], v[200:201], v[50:51] op_sel_hi:[1,0]
  v_pk_mul_f32 v[202:203], v[202:203], v[50:51] op_sel_hi:[1,0]
  v_pk_mul_f32 v[204:205], v[204:205], v[50:51] op_sel_hi:[1,0]
  v_pk_mul_f32 v[206:207], v[206:207], v[50:51] op_sel_hi:[1,0]
  v_cvt_pk_bf16_f32 v200, v200, v201
  v_cvt_pk_bf16_f32 v201, v202, v203
  v_cvt_pk_bf16_f32 v202, v204, v205
  v_cvt_pk_bf16_f32 v203, v206, v207
  s_add_u32 s3, s74, 136192
  buffer_store_dwordx4 v[200:203], v6, s[24:27], s3 offen sc1
  v_accvgpr_read_b32 v208, a176
  v_accvgpr_read_b32 v209, a177
  v_accvgpr_read_b32 v210, a178
  v_accvgpr_read_b32 v211, a179
  v_accvgpr_read_b32 v212, a180
  v_accvgpr_read_b32 v213, a181
  v_accvgpr_read_b32 v214, a182
  v_accvgpr_read_b32 v215, a183
  v_pk_mul_f32 v[208:209], v[208:209], v[50:51] op_sel_hi:[1,0]
  v_pk_mul_f32 v[210:211], v[210:211], v[50:51] op_sel_hi:[1,0]
  v_pk_mul_f32 v[212:213], v[212:213], v[50:51] op_sel_hi:[1,0]
  v_pk_mul_f32 v[214:215], v[214:215], v[50:51] op_sel_hi:[1,0]
  v_cvt_pk_bf16_f32 v208, v208, v209
  v_cvt_pk_bf16_f32 v209, v210, v211
  v_cvt_pk_bf16_f32 v210, v212, v213
  v_cvt_pk_bf16_f32 v211, v214, v215
  s_add_u32 s3, s74, 267264
  buffer_store_dwordx4 v[208:211], v6, s[24:27], s3 offen sc1
  v_accvgpr_read_b32 v216, a184
  v_accvgpr_read_b32 v217, a185
  v_accvgpr_read_b32 v218, a186
  v_accvgpr_read_b32 v219, a187
  v_accvgpr_read_b32 v220, a188
  v_accvgpr_read_b32 v221, a189
  v_accvgpr_read_b32 v222, a190
  v_accvgpr_read_b32 v223, a191
  v_pk_mul_f32 v[216:217], v[216:217], v[50:51] op_sel_hi:[1,0]
  v_pk_mul_f32 v[218:219], v[218:219], v[50:51] op_sel_hi:[1,0]
  v_pk_mul_f32 v[220:221], v[220:221], v[50:51] op_sel_hi:[1,0]
  v_pk_mul_f32 v[222:223], v[222:223], v[50:51] op_sel_hi:[1,0]
  v_cvt_pk_bf16_f32 v216, v216, v217
  v_cvt_pk_bf16_f32 v217, v218, v219
  v_cvt_pk_bf16_f32 v218, v220, v221
  v_cvt_pk_bf16_f32 v219, v222, v223
  s_add_u32 s3, s74, 398336
  buffer_store_dwordx4 v[216:219], v6, s[24:27], s3 offen sc1
  s_branch L_attn_done
.section .rodata,"a"
.p2align 6
.amdhsa_kernel recurrent_scan__sliding_block_cached__mixer_token_mlp__prompt_kernel
  .amdhsa_next_free_vgpr 512
  .amdhsa_next_free_sgpr 102
  .amdhsa_accum_offset 256
  .amdhsa_group_segment_fixed_size 0
  .amdhsa_kernarg_size 104
  .amdhsa_user_sgpr_count 2
  .amdhsa_user_sgpr_kernarg_segment_ptr 1
  .amdhsa_system_sgpr_workgroup_id_x 1
  .amdhsa_float_denorm_mode_32 3
  .amdhsa_float_denorm_mode_16_64 3
.end_amdhsa_kernel
```
